```python
import torch

def _softmax(x, axis=-1):
    return torch.softmax(x, dim=axis)
def _gelu(x):
    return torch.nn.functional.gelu(x, approximate="tanh")
def _silu(x):
    return torch.nn.functional.silu(x)
def _sigmoid(x):
    return torch.sigmoid(x)
def _layernorm(x, axis=-1, eps=1e-5):
    m = x.mean(dim=axis, keepdim=True)
    v = x.var(dim=axis, keepdim=True, unbiased=False)
    return (x - m) / torch.sqrt(v + eps)
def _scatter_add(tgt, idx, src, axis=0):
    return tgt.clone().index_add_(axis, idx, src)
def _segment_sum(src, seg, n):
    out = torch.zeros((n,) + src.shape[1:], dtype=src.dtype)
    return out.index_add_(0, seg, src)
def _pad(x, pw):
    flat = tuple(v for pair in reversed(pw) for v in pair)
    return torch.nn.functional.pad(x, flat)

kernel_name = 'gated_mix__mha_block_cached__geglu_ffn__decode'

def setup_inputs():

    _w = (lambda a: (lambda t: t.to(torch.bfloat16) if t.is_floating_point() else t)(torch.as_tensor(a)))
    def _A_setup():
        B, Sq, D = 4, 1, 512
        H, Sk, Dh = 32, 4096, 128
        return {
            "x": _w((lambda *s: torch.randn(*s, dtype=torch.bfloat16) * 0.05)(B, Sq, D)),
            "k_cache": _w((lambda *s: torch.randn(*s, dtype=torch.bfloat16) * 6.4)(B, H, Sk, Dh)),
            "v_cache": _w((lambda *s: torch.randn(*s, dtype=torch.bfloat16) * 0.2)(B, H, Sk, Dh)),
            "wq": _w((lambda *s: torch.randn(*s, dtype=torch.bfloat16) * 6.4)(D, H * Dh) * (D ** -0.5)),
            "wo": _w((lambda *s: torch.randn(*s, dtype=torch.bfloat16) * 0.2)(H * Dh, D) * ((H * Dh) ** -0.5)),
        }
    _A_in = _A_setup()

    def _B_setup():
        B, S, D, F = 4, 1, 512, 1792
        return {
            "x": _w((lambda *s: torch.randn(*s, dtype=torch.bfloat16) * 0.05)(B, S, D)),
            "w_gate": _w((lambda *s: torch.randn(*s, dtype=torch.bfloat16) * 0.05)(D, F)),
            "w_up": _w((lambda *s: torch.randn(*s, dtype=torch.bfloat16) * 0.05)(D, F)),
            "w_down": _w((lambda *s: torch.randn(*s, dtype=torch.bfloat16) * 0.05)(F, D)),
        }
    _B_in = _B_setup()

    return {
        "A_x": _A_in["x"],
        "A_k_cache": _A_in["k_cache"],
        "A_v_cache": _A_in["v_cache"],
        "A_wq": _A_in["wq"],
        "A_wo": _A_in["wo"],
        "B_x": _B_in["x"],
        "B_w_gate": _B_in["w_gate"],
        "B_w_up": _B_in["w_up"],
        "B_w_down": _B_in["w_down"],
        "gate_w": _w((lambda *s: torch.randn(*s, dtype=torch.bfloat16) * 0.05)(512) * 16.0),
    }

def reference(A_x, A_k_cache, A_v_cache, A_wq, A_wo, B_x, B_w_gate, B_w_up, B_w_down, gate_w):
    def _A_ref(x, k_cache, v_cache, wq, wo):
        B, Sq, D = x.shape
        H, Dh = 32, 128
        q = (lambda x, *d: x.permute(*d))((x @ wq).reshape(B, Sq, H, Dh), 0, 2, 1, 3)
        scores = torch.einsum("bhqd,bhkd->bhqk", q, k_cache) * (Dh ** -0.5)
        p = _softmax(scores, axis=-1)
        o = torch.einsum("bhqk,bhkd->bhqd", p, v_cache)
        return (lambda x, *d: x.permute(*d))(o, 0, 2, 1, 3).reshape(B, Sq, H * Dh) @ wo

    def _B_ref(x, w_gate, w_up, w_down):
        return (_gelu(x @ w_gate) * (x @ w_up)) @ w_down

    x = A_x
    g = _sigmoid((x * gate_w).sum(-1, keepdims=True))
    a = _A_ref(x, A_k_cache, A_v_cache, A_wq, A_wo)
    b = _B_ref(x, B_w_gate, B_w_up, B_w_down)
    return g * a + (1 - g) * b
```

```asm
; @launch grid=(256,1,1) block=(320,1,1) lds=8192
.amdgcn_target "amdgcn-amd-amdhsa--gfx950"
.text
.globl gated_mix__mha_block_cached__geglu_ffn__decode_kernel
.p2align 8
.type gated_mix__mha_block_cached__geglu_ffn__decode_kernel,@function
gated_mix__mha_block_cached__geglu_ffn__decode_kernel:
    s_cmp_ge_u32 s2, 256
    s_cbranch_scc1 L_end
    s_load_dwordx16 s[4:19], s[0:1], 0
    s_load_dwordx8 s[20:27], s[0:1], 64
    s_load_dwordx2 s[28:29], s[0:1], 96
    v_lshrrev_b32 v4, 6, v0
    v_and_b32 v0, 63, v0
    v_readfirstlane_b32 s3, v4
    s_and_b32 s60, s2, 7
    s_lshr_b32 s61, s2, 3
    s_lshr_b32 s62, s61, 3
    s_lshl_b32 s63, s60, 2
    s_add_u32 s63, s63, s62
    s_lshr_b32 s64, s61, 1
    s_and_b32 s64, s64, 3
    s_and_b32 s65, s61, 1
    s_lshl_b32 s66, s64, 5
    s_add_u32 s66, s66, s63
    s_lshl_b32 s67, s63, 1
    s_add_u32 s67, s67, s65
    s_and_b32 s68, s61, 7
    s_cmp_eq_u32 s3, 4
    s_cbranch_scc1 L_helper
    s_and_b32 s80, s2, 1
    s_cbranch_scc1 L_stream1
    v_lshrrev_b32 v42, 4, v0
    v_and_b32 v43, 15, v0
    s_lshl_b32 s80, s3, 10
    v_lshlrev_b32 v1, 4, v0
    v_add_u32 v1, s80, v1
    s_lshl_b32 s80, s3, 20
    v_lshlrev_b32 v2, 13, v42
    v_lshl_add_u32 v2, v43, 4, v2
    v_add_u32 v2, s80, v2
    s_lshl_b32 s80, s64, 10
    s_lshl_b32 s81, s3, 8
    s_add_u32 s80, s80, s81
    s_lshl_b32 s81, s68, 2
    v_add_u32 v4, s81, v43
    v_add_u32 v5, 16, v4
    v_and_b32 v4, 31, v4
    v_and_b32 v5, 31, v5
    v_lshl_add_u32 v4, v4, 2, v42
    v_lshlrev_b32 v4, 1, v4
    v_add_u32 v4, s80, v4
    v_lshl_add_u32 v5, v5, 2, v42
    v_lshlrev_b32 v5, 1, v5
    v_add_u32 v5, s80, v5
    s_waitcnt lgkmcnt(0)
    global_load_ushort v58, v4, s[4:5]
    global_load_ushort v59, v5, s[4:5]
    s_lshl_b32 s80, s63, 8
    s_sub_u32 s81, 0x400000, s80
    s_add_u32 s40, s10, s80
    s_addc_u32 s41, s11, 0
    s_and_b32 s41, s41, 0xffff
    s_mov_b32 s42, s81
    s_mov_b32 s43, 0x20000
    s_lshl_b32 s71, s68, 17
    buffer_load_dwordx4 v[128:131], v2, s[40:43], s71 offen
    s_add_u32 s71, s71, 0x8000
    s_and_b32 s71, s71, 0xfffff
    buffer_load_dwordx4 v[132:135], v2, s[40:43], s71 offen
    s_add_u32 s71, s71, 0x8000
    s_and_b32 s71, s71, 0xfffff
    buffer_load_dwordx4 v[136:139], v2, s[40:43], s71 offen
    s_add_u32 s71, s71, 0x8000
    s_and_b32 s71, s71, 0xfffff
    buffer_load_dwordx4 v[140:143], v2, s[40:43], s71 offen
    s_add_u32 s71, s71, 0x8000
    s_and_b32 s71, s71, 0xfffff
    buffer_load_dwordx4 v[144:147], v2, s[40:43], s71 offen
    s_add_u32 s71, s71, 0x8000
    s_and_b32 s71, s71, 0xfffff
    buffer_load_dwordx4 v[148:151], v2, s[40:43], s71 offen
    s_add_u32 s71, s71, 0x8000
    s_and_b32 s71, s71, 0xfffff
    buffer_load_dwordx4 v[152:155], v2, s[40:43], s71 offen
    s_add_u32 s71, s71, 0x8000
    s_and_b32 s71, s71, 0xfffff
    buffer_load_dwordx4 v[156:159], v2, s[40:43], s71 offen
    s_add_u32 s71, s71, 0x8000
    s_and_b32 s71, s71, 0xfffff
    s_lshl_b32 s80, s66, 20
    s_add_u32 s32, s6, s80
    s_addc_u32 s33, s7, 0
    s_and_b32 s33, s33, 0xffff
    s_mov_b32 s34, 0x100000
    s_mov_b32 s35, 0x20000
    s_add_u32 s36, s8, s80
    s_addc_u32 s37, s9, 0
    s_and_b32 s37, s37, 0xffff
    s_mov_b32 s38, 0x100000
    s_mov_b32 s39, 0x20000
    s_mul_i32 s75, s65, 32768
    s_mov_b32 s70, s75
    s_lshl_b32 s80, s3, 8
    v_lshlrev_b32 v3, 10, v42
    v_lshl_add_u32 v3, v43, 4, v3
    v_add_u32 v3, s80, v3
    s_lshl_b32 s80, s63, 17
    s_add_u32 s44, s12, s80
    s_addc_u32 s45, s13, 0
    s_and_b32 s45, s45, 0xffff
    s_mov_b32 s46, 0x20000
    s_mov_b32 s47, 0x20000
    s_lshl_b32 s72, s68, 14
    s_mov_b32 s76, 0xcccccccc
    s_mov_b32 s77, 0xcccccccc
    s_mov_b32 s78, 0xaaaaaaaa
    s_mov_b32 s79, 0xaaaaaaaa
    s_lshl_b32 s80, s64, 6
    s_add_u32 s80, s80, s67
    s_lshl_b32 s80, s80, 11
    s_lshl_b32 s81, s3, 9
    v_lshlrev_b32 v47, 5, v43
    v_lshl_add_u32 v47, v42, 3, v47
    v_add_u32 v47, s81, v47
    v_add_u32 v62, s80, v47
    v_mov_b32 v10, 0
    v_mov_b32 v11, 0
    v_mov_b32 v12, 0
    v_mov_b32 v13, 0
    v_mov_b32 v14, 0
    v_mov_b32 v15, 0
    v_mov_b32 v16, 0
    v_mov_b32 v17, 0
    s_waitcnt vmcnt(8)
    v_lshlrev_b32 v60, 16, v58
    v_lshlrev_b32 v61, 16, v59
    s_waitcnt vmcnt(7)
    v_dot2c_f32_bf16_dpp v10, v58, v128 row_newbcast:0 row_mask:0xf bank_mask:0xf
    v_dot2c_f32_bf16_dpp v11, v60, v128 row_newbcast:0 row_mask:0xf bank_mask:0xf
    v_dot2c_f32_bf16_dpp v12, v58, v129 row_newbcast:0 row_mask:0xf bank_mask:0xf
    v_dot2c_f32_bf16_dpp v13, v60, v129 row_newbcast:0 row_mask:0xf bank_mask:0xf
    v_dot2c_f32_bf16_dpp v14, v58, v130 row_newbcast:0 row_mask:0xf bank_mask:0xf
    v_dot2c_f32_bf16_dpp v15, v60, v130 row_newbcast:0 row_mask:0xf bank_mask:0xf
    v_dot2c_f32_bf16_dpp v16, v58, v131 row_newbcast:0 row_mask:0xf bank_mask:0xf
    v_dot2c_f32_bf16_dpp v17, v60, v131 row_newbcast:0 row_mask:0xf bank_mask:0xf
    buffer_load_dwordx4 v[160:163], v2, s[40:43], s71 offen
    s_add_u32 s71, s71, 0x8000
    s_and_b32 s71, s71, 0xfffff
    s_waitcnt vmcnt(7)
    v_dot2c_f32_bf16_dpp v10, v58, v132 row_newbcast:1 row_mask:0xf bank_mask:0xf
    v_dot2c_f32_bf16_dpp v11, v60, v132 row_newbcast:1 row_mask:0xf bank_mask:0xf
    v_dot2c_f32_bf16_dpp v12, v58, v133 row_newbcast:1 row_mask:0xf bank_mask:0xf
    v_dot2c_f32_bf16_dpp v13, v60, v133 row_newbcast:1 row_mask:0xf bank_mask:0xf
    v_dot2c_f32_bf16_dpp v14, v58, v134 row_newbcast:1 row_mask:0xf bank_mask:0xf
    v_dot2c_f32_bf16_dpp v15, v60, v134 row_newbcast:1 row_mask:0xf bank_mask:0xf
    v_dot2c_f32_bf16_dpp v16, v58, v135 row_newbcast:1 row_mask:0xf bank_mask:0xf
    v_dot2c_f32_bf16_dpp v17, v60, v135 row_newbcast:1 row_mask:0xf bank_mask:0xf
    buffer_load_dwordx4 v[164:167], v2, s[40:43], s71 offen
    s_add_u32 s71, s71, 0x8000
    s_and_b32 s71, s71, 0xfffff
    s_waitcnt vmcnt(7)
    v_dot2c_f32_bf16_dpp v10, v58, v136 row_newbcast:2 row_mask:0xf bank_mask:0xf
    v_dot2c_f32_bf16_dpp v11, v60, v136 row_newbcast:2 row_mask:0xf bank_mask:0xf
    v_dot2c_f32_bf16_dpp v12, v58, v137 row_newbcast:2 row_mask:0xf bank_mask:0xf
    v_dot2c_f32_bf16_dpp v13, v60, v137 row_newbcast:2 row_mask:0xf bank_mask:0xf
    v_dot2c_f32_bf16_dpp v14, v58, v138 row_newbcast:2 row_mask:0xf bank_mask:0xf
    v_dot2c_f32_bf16_dpp v15, v60, v138 row_newbcast:2 row_mask:0xf bank_mask:0xf
    v_dot2c_f32_bf16_dpp v16, v58, v139 row_newbcast:2 row_mask:0xf bank_mask:0xf
    v_dot2c_f32_bf16_dpp v17, v60, v139 row_newbcast:2 row_mask:0xf bank_mask:0xf
    buffer_load_dwordx4 v[168:171], v2, s[40:43], s71 offen
    s_add_u32 s71, s71, 0x8000
    s_and_b32 s71, s71, 0xfffff
    s_waitcnt vmcnt(7)
    v_dot2c_f32_bf16_dpp v10, v58, v140 row_newbcast:3 row_mask:0xf bank_mask:0xf
    v_dot2c_f32_bf16_dpp v11, v60, v140 row_newbcast:3 row_mask:0xf bank_mask:0xf
    v_dot2c_f32_bf16_dpp v12, v58, v141 row_newbcast:3 row_mask:0xf bank_mask:0xf
    v_dot2c_f32_bf16_dpp v13, v60, v141 row_newbcast:3 row_mask:0xf bank_mask:0xf
    v_dot2c_f32_bf16_dpp v14, v58, v142 row_newbcast:3 row_mask:0xf bank_mask:0xf
    v_dot2c_f32_bf16_dpp v15, v60, v142 row_newbcast:3 row_mask:0xf bank_mask:0xf
    v_dot2c_f32_bf16_dpp v16, v58, v143 row_newbcast:3 row_mask:0xf bank_mask:0xf
    v_dot2c_f32_bf16_dpp v17, v60, v143 row_newbcast:3 row_mask:0xf bank_mask:0xf
    buffer_load_dwordx4 v[172:175], v2, s[40:43], s71 offen
    s_add_u32 s71, s71, 0x8000
    s_and_b32 s71, s71, 0xfffff
    s_waitcnt vmcnt(7)
    v_dot2c_f32_bf16_dpp v10, v58, v144 row_newbcast:4 row_mask:0xf bank_mask:0xf
    v_dot2c_f32_bf16_dpp v11, v60, v144 row_newbcast:4 row_mask:0xf bank_mask:0xf
    v_dot2c_f32_bf16_dpp v12, v58, v145 row_newbcast:4 row_mask:0xf bank_mask:0xf
    v_dot2c_f32_bf16_dpp v13, v60, v145 row_newbcast:4 row_mask:0xf bank_mask:0xf
    v_dot2c_f32_bf16_dpp v14, v58, v146 row_newbcast:4 row_mask:0xf bank_mask:0xf
    v_dot2c_f32_bf16_dpp v15, v60, v146 row_newbcast:4 row_mask:0xf bank_mask:0xf
    v_dot2c_f32_bf16_dpp v16, v58, v147 row_newbcast:4 row_mask:0xf bank_mask:0xf
    v_dot2c_f32_bf16_dpp v17, v60, v147 row_newbcast:4 row_mask:0xf bank_mask:0xf
    buffer_load_dwordx4 v[176:179], v2, s[40:43], s71 offen
    s_add_u32 s71, s71, 0x8000
    s_and_b32 s71, s71, 0xfffff
    s_waitcnt vmcnt(7)
    v_dot2c_f32_bf16_dpp v10, v58, v148 row_newbcast:5 row_mask:0xf bank_mask:0xf
    v_dot2c_f32_bf16_dpp v11, v60, v148 row_newbcast:5 row_mask:0xf bank_mask:0xf
    v_dot2c_f32_bf16_dpp v12, v58, v149 row_newbcast:5 row_mask:0xf bank_mask:0xf
    v_dot2c_f32_bf16_dpp v13, v60, v149 row_newbcast:5 row_mask:0xf bank_mask:0xf
    v_dot2c_f32_bf16_dpp v14, v58, v150 row_newbcast:5 row_mask:0xf bank_mask:0xf
    v_dot2c_f32_bf16_dpp v15, v60, v150 row_newbcast:5 row_mask:0xf bank_mask:0xf
    v_dot2c_f32_bf16_dpp v16, v58, v151 row_newbcast:5 row_mask:0xf bank_mask:0xf
    v_dot2c_f32_bf16_dpp v17, v60, v151 row_newbcast:5 row_mask:0xf bank_mask:0xf
    buffer_load_dwordx4 v[180:183], v2, s[40:43], s71 offen
    s_add_u32 s71, s71, 0x8000
    s_and_b32 s71, s71, 0xfffff
    s_waitcnt vmcnt(7)
    v_dot2c_f32_bf16_dpp v10, v58, v152 row_newbcast:6 row_mask:0xf bank_mask:0xf
    v_dot2c_f32_bf16_dpp v11, v60, v152 row_newbcast:6 row_mask:0xf bank_mask:0xf
    v_dot2c_f32_bf16_dpp v12, v58, v153 row_newbcast:6 row_mask:0xf bank_mask:0xf
    v_dot2c_f32_bf16_dpp v13, v60, v153 row_newbcast:6 row_mask:0xf bank_mask:0xf
    v_dot2c_f32_bf16_dpp v14, v58, v154 row_newbcast:6 row_mask:0xf bank_mask:0xf
    v_dot2c_f32_bf16_dpp v15, v60, v154 row_newbcast:6 row_mask:0xf bank_mask:0xf
    v_dot2c_f32_bf16_dpp v16, v58, v155 row_newbcast:6 row_mask:0xf bank_mask:0xf
    v_dot2c_f32_bf16_dpp v17, v60, v155 row_newbcast:6 row_mask:0xf bank_mask:0xf
    buffer_load_dwordx4 v[184:187], v2, s[40:43], s71 offen
    s_add_u32 s71, s71, 0x8000
    s_and_b32 s71, s71, 0xfffff
    s_waitcnt vmcnt(7)
    v_dot2c_f32_bf16_dpp v10, v58, v156 row_newbcast:7 row_mask:0xf bank_mask:0xf
    v_dot2c_f32_bf16_dpp v11, v60, v156 row_newbcast:7 row_mask:0xf bank_mask:0xf
    v_dot2c_f32_bf16_dpp v12, v58, v157 row_newbcast:7 row_mask:0xf bank_mask:0xf
    v_dot2c_f32_bf16_dpp v13, v60, v157 row_newbcast:7 row_mask:0xf bank_mask:0xf
    v_dot2c_f32_bf16_dpp v14, v58, v158 row_newbcast:7 row_mask:0xf bank_mask:0xf
    v_dot2c_f32_bf16_dpp v15, v60, v158 row_newbcast:7 row_mask:0xf bank_mask:0xf
    v_dot2c_f32_bf16_dpp v16, v58, v159 row_newbcast:7 row_mask:0xf bank_mask:0xf
    v_dot2c_f32_bf16_dpp v17, v60, v159 row_newbcast:7 row_mask:0xf bank_mask:0xf
    buffer_load_dwordx4 v[188:191], v2, s[40:43], s71 offen
    s_add_u32 s71, s71, 0x8000
    s_and_b32 s71, s71, 0xfffff
    s_waitcnt vmcnt(7)
    v_dot2c_f32_bf16_dpp v10, v58, v160 row_newbcast:8 row_mask:0xf bank_mask:0xf
    v_dot2c_f32_bf16_dpp v11, v60, v160 row_newbcast:8 row_mask:0xf bank_mask:0xf
    v_dot2c_f32_bf16_dpp v12, v58, v161 row_newbcast:8 row_mask:0xf bank_mask:0xf
    v_dot2c_f32_bf16_dpp v13, v60, v161 row_newbcast:8 row_mask:0xf bank_mask:0xf
    v_dot2c_f32_bf16_dpp v14, v58, v162 row_newbcast:8 row_mask:0xf bank_mask:0xf
    v_dot2c_f32_bf16_dpp v15, v60, v162 row_newbcast:8 row_mask:0xf bank_mask:0xf
    v_dot2c_f32_bf16_dpp v16, v58, v163 row_newbcast:8 row_mask:0xf bank_mask:0xf
    v_dot2c_f32_bf16_dpp v17, v60, v163 row_newbcast:8 row_mask:0xf bank_mask:0xf
    buffer_load_dwordx4 v[128:131], v2, s[40:43], s71 offen
    s_add_u32 s71, s71, 0x8000
    s_and_b32 s71, s71, 0xfffff
    s_waitcnt vmcnt(7)
    v_dot2c_f32_bf16_dpp v10, v58, v164 row_newbcast:9 row_mask:0xf bank_mask:0xf
    v_dot2c_f32_bf16_dpp v11, v60, v164 row_newbcast:9 row_mask:0xf bank_mask:0xf
    v_dot2c_f32_bf16_dpp v12, v58, v165 row_newbcast:9 row_mask:0xf bank_mask:0xf
    v_dot2c_f32_bf16_dpp v13, v60, v165 row_newbcast:9 row_mask:0xf bank_mask:0xf
    v_dot2c_f32_bf16_dpp v14, v58, v166 row_newbcast:9 row_mask:0xf bank_mask:0xf
    v_dot2c_f32_bf16_dpp v15, v60, v166 row_newbcast:9 row_mask:0xf bank_mask:0xf
    v_dot2c_f32_bf16_dpp v16, v58, v167 row_newbcast:9 row_mask:0xf bank_mask:0xf
    v_dot2c_f32_bf16_dpp v17, v60, v167 row_newbcast:9 row_mask:0xf bank_mask:0xf
    buffer_load_dwordx4 v[132:135], v2, s[40:43], s71 offen
    s_add_u32 s71, s71, 0x8000
    s_and_b32 s71, s71, 0xfffff
    s_waitcnt vmcnt(7)
    v_dot2c_f32_bf16_dpp v10, v58, v168 row_newbcast:10 row_mask:0xf bank_mask:0xf
    v_dot2c_f32_bf16_dpp v11, v60, v168 row_newbcast:10 row_mask:0xf bank_mask:0xf
    v_dot2c_f32_bf16_dpp v12, v58, v169 row_newbcast:10 row_mask:0xf bank_mask:0xf
    v_dot2c_f32_bf16_dpp v13, v60, v169 row_newbcast:10 row_mask:0xf bank_mask:0xf
    v_dot2c_f32_bf16_dpp v14, v58, v170 row_newbcast:10 row_mask:0xf bank_mask:0xf
    v_dot2c_f32_bf16_dpp v15, v60, v170 row_newbcast:10 row_mask:0xf bank_mask:0xf
    v_dot2c_f32_bf16_dpp v16, v58, v171 row_newbcast:10 row_mask:0xf bank_mask:0xf
    v_dot2c_f32_bf16_dpp v17, v60, v171 row_newbcast:10 row_mask:0xf bank_mask:0xf
    buffer_load_dwordx4 v[136:139], v2, s[40:43], s71 offen
    s_add_u32 s71, s71, 0x8000
    s_and_b32 s71, s71, 0xfffff
    s_waitcnt vmcnt(7)
    v_dot2c_f32_bf16_dpp v10, v58, v172 row_newbcast:11 row_mask:0xf bank_mask:0xf
    v_dot2c_f32_bf16_dpp v11, v60, v172 row_newbcast:11 row_mask:0xf bank_mask:0xf
    v_dot2c_f32_bf16_dpp v12, v58, v173 row_newbcast:11 row_mask:0xf bank_mask:0xf
    v_dot2c_f32_bf16_dpp v13, v60, v173 row_newbcast:11 row_mask:0xf bank_mask:0xf
    v_dot2c_f32_bf16_dpp v14, v58, v174 row_newbcast:11 row_mask:0xf bank_mask:0xf
    v_dot2c_f32_bf16_dpp v15, v60, v174 row_newbcast:11 row_mask:0xf bank_mask:0xf
    v_dot2c_f32_bf16_dpp v16, v58, v175 row_newbcast:11 row_mask:0xf bank_mask:0xf
    v_dot2c_f32_bf16_dpp v17, v60, v175 row_newbcast:11 row_mask:0xf bank_mask:0xf
    buffer_load_dwordx4 v[140:143], v2, s[40:43], s71 offen
    s_add_u32 s71, s71, 0x8000
    s_and_b32 s71, s71, 0xfffff
    s_waitcnt vmcnt(7)
    v_dot2c_f32_bf16_dpp v10, v58, v176 row_newbcast:12 row_mask:0xf bank_mask:0xf
    v_dot2c_f32_bf16_dpp v11, v60, v176 row_newbcast:12 row_mask:0xf bank_mask:0xf
    v_dot2c_f32_bf16_dpp v12, v58, v177 row_newbcast:12 row_mask:0xf bank_mask:0xf
    v_dot2c_f32_bf16_dpp v13, v60, v177 row_newbcast:12 row_mask:0xf bank_mask:0xf
    v_dot2c_f32_bf16_dpp v14, v58, v178 row_newbcast:12 row_mask:0xf bank_mask:0xf
    v_dot2c_f32_bf16_dpp v15, v60, v178 row_newbcast:12 row_mask:0xf bank_mask:0xf
    v_dot2c_f32_bf16_dpp v16, v58, v179 row_newbcast:12 row_mask:0xf bank_mask:0xf
    v_dot2c_f32_bf16_dpp v17, v60, v179 row_newbcast:12 row_mask:0xf bank_mask:0xf
    buffer_load_dwordx4 v[144:147], v2, s[40:43], s71 offen
    s_add_u32 s71, s71, 0x8000
    s_and_b32 s71, s71, 0xfffff
    s_waitcnt vmcnt(7)
    v_dot2c_f32_bf16_dpp v10, v58, v180 row_newbcast:13 row_mask:0xf bank_mask:0xf
    v_dot2c_f32_bf16_dpp v11, v60, v180 row_newbcast:13 row_mask:0xf bank_mask:0xf
    v_dot2c_f32_bf16_dpp v12, v58, v181 row_newbcast:13 row_mask:0xf bank_mask:0xf
    v_dot2c_f32_bf16_dpp v13, v60, v181 row_newbcast:13 row_mask:0xf bank_mask:0xf
    v_dot2c_f32_bf16_dpp v14, v58, v182 row_newbcast:13 row_mask:0xf bank_mask:0xf
    v_dot2c_f32_bf16_dpp v15, v60, v182 row_newbcast:13 row_mask:0xf bank_mask:0xf
    v_dot2c_f32_bf16_dpp v16, v58, v183 row_newbcast:13 row_mask:0xf bank_mask:0xf
    v_dot2c_f32_bf16_dpp v17, v60, v183 row_newbcast:13 row_mask:0xf bank_mask:0xf
    buffer_load_dwordx4 v[148:151], v2, s[40:43], s71 offen
    s_add_u32 s71, s71, 0x8000
    s_and_b32 s71, s71, 0xfffff
    s_waitcnt vmcnt(7)
    v_dot2c_f32_bf16_dpp v10, v58, v184 row_newbcast:14 row_mask:0xf bank_mask:0xf
    v_dot2c_f32_bf16_dpp v11, v60, v184 row_newbcast:14 row_mask:0xf bank_mask:0xf
    v_dot2c_f32_bf16_dpp v12, v58, v185 row_newbcast:14 row_mask:0xf bank_mask:0xf
    v_dot2c_f32_bf16_dpp v13, v60, v185 row_newbcast:14 row_mask:0xf bank_mask:0xf
    v_dot2c_f32_bf16_dpp v14, v58, v186 row_newbcast:14 row_mask:0xf bank_mask:0xf
    v_dot2c_f32_bf16_dpp v15, v60, v186 row_newbcast:14 row_mask:0xf bank_mask:0xf
    v_dot2c_f32_bf16_dpp v16, v58, v187 row_newbcast:14 row_mask:0xf bank_mask:0xf
    v_dot2c_f32_bf16_dpp v17, v60, v187 row_newbcast:14 row_mask:0xf bank_mask:0xf
    buffer_load_dwordx4 v[152:155], v2, s[40:43], s71 offen
    s_add_u32 s71, s71, 0x8000
    s_and_b32 s71, s71, 0xfffff
    s_waitcnt vmcnt(7)
    v_dot2c_f32_bf16_dpp v10, v58, v188 row_newbcast:15 row_mask:0xf bank_mask:0xf
    v_dot2c_f32_bf16_dpp v11, v60, v188 row_newbcast:15 row_mask:0xf bank_mask:0xf
    v_dot2c_f32_bf16_dpp v12, v58, v189 row_newbcast:15 row_mask:0xf bank_mask:0xf
    v_dot2c_f32_bf16_dpp v13, v60, v189 row_newbcast:15 row_mask:0xf bank_mask:0xf
    v_dot2c_f32_bf16_dpp v14, v58, v190 row_newbcast:15 row_mask:0xf bank_mask:0xf
    v_dot2c_f32_bf16_dpp v15, v60, v190 row_newbcast:15 row_mask:0xf bank_mask:0xf
    v_dot2c_f32_bf16_dpp v16, v58, v191 row_newbcast:15 row_mask:0xf bank_mask:0xf
    v_dot2c_f32_bf16_dpp v17, v60, v191 row_newbcast:15 row_mask:0xf bank_mask:0xf
    buffer_load_dwordx4 v[156:159], v2, s[40:43], s71 offen
    s_add_u32 s71, s71, 0x8000
    s_and_b32 s71, s71, 0xfffff
    s_waitcnt vmcnt(7)
    v_dot2c_f32_bf16_dpp v10, v59, v128 row_newbcast:0 row_mask:0xf bank_mask:0xf
    v_dot2c_f32_bf16_dpp v11, v61, v128 row_newbcast:0 row_mask:0xf bank_mask:0xf
    v_dot2c_f32_bf16_dpp v12, v59, v129 row_newbcast:0 row_mask:0xf bank_mask:0xf
    v_dot2c_f32_bf16_dpp v13, v61, v129 row_newbcast:0 row_mask:0xf bank_mask:0xf
    v_dot2c_f32_bf16_dpp v14, v59, v130 row_newbcast:0 row_mask:0xf bank_mask:0xf
    v_dot2c_f32_bf16_dpp v15, v61, v130 row_newbcast:0 row_mask:0xf bank_mask:0xf
    v_dot2c_f32_bf16_dpp v16, v59, v131 row_newbcast:0 row_mask:0xf bank_mask:0xf
    v_dot2c_f32_bf16_dpp v17, v61, v131 row_newbcast:0 row_mask:0xf bank_mask:0xf
    buffer_load_dwordx4 v[160:163], v2, s[40:43], s71 offen
    s_add_u32 s71, s71, 0x8000
    s_and_b32 s71, s71, 0xfffff
    s_waitcnt vmcnt(7)
    v_dot2c_f32_bf16_dpp v10, v59, v132 row_newbcast:1 row_mask:0xf bank_mask:0xf
    v_dot2c_f32_bf16_dpp v11, v61, v132 row_newbcast:1 row_mask:0xf bank_mask:0xf
    v_dot2c_f32_bf16_dpp v12, v59, v133 row_newbcast:1 row_mask:0xf bank_mask:0xf
    v_dot2c_f32_bf16_dpp v13, v61, v133 row_newbcast:1 row_mask:0xf bank_mask:0xf
    v_dot2c_f32_bf16_dpp v14, v59, v134 row_newbcast:1 row_mask:0xf bank_mask:0xf
    v_dot2c_f32_bf16_dpp v15, v61, v134 row_newbcast:1 row_mask:0xf bank_mask:0xf
    v_dot2c_f32_bf16_dpp v16, v59, v135 row_newbcast:1 row_mask:0xf bank_mask:0xf
    v_dot2c_f32_bf16_dpp v17, v61, v135 row_newbcast:1 row_mask:0xf bank_mask:0xf
    buffer_load_dwordx4 v[164:167], v2, s[40:43], s71 offen
    s_add_u32 s71, s71, 0x8000
    s_and_b32 s71, s71, 0xfffff
    s_waitcnt vmcnt(7)
    v_dot2c_f32_bf16_dpp v10, v59, v136 row_newbcast:2 row_mask:0xf bank_mask:0xf
    v_dot2c_f32_bf16_dpp v11, v61, v136 row_newbcast:2 row_mask:0xf bank_mask:0xf
    v_dot2c_f32_bf16_dpp v12, v59, v137 row_newbcast:2 row_mask:0xf bank_mask:0xf
    v_dot2c_f32_bf16_dpp v13, v61, v137 row_newbcast:2 row_mask:0xf bank_mask:0xf
    v_dot2c_f32_bf16_dpp v14, v59, v138 row_newbcast:2 row_mask:0xf bank_mask:0xf
    v_dot2c_f32_bf16_dpp v15, v61, v138 row_newbcast:2 row_mask:0xf bank_mask:0xf
    v_dot2c_f32_bf16_dpp v16, v59, v139 row_newbcast:2 row_mask:0xf bank_mask:0xf
    v_dot2c_f32_bf16_dpp v17, v61, v139 row_newbcast:2 row_mask:0xf bank_mask:0xf
    buffer_load_dwordx4 v[168:171], v2, s[40:43], s71 offen
    s_add_u32 s71, s71, 0x8000
    s_and_b32 s71, s71, 0xfffff
    s_waitcnt vmcnt(7)
    v_dot2c_f32_bf16_dpp v10, v59, v140 row_newbcast:3 row_mask:0xf bank_mask:0xf
    v_dot2c_f32_bf16_dpp v11, v61, v140 row_newbcast:3 row_mask:0xf bank_mask:0xf
    v_dot2c_f32_bf16_dpp v12, v59, v141 row_newbcast:3 row_mask:0xf bank_mask:0xf
    v_dot2c_f32_bf16_dpp v13, v61, v141 row_newbcast:3 row_mask:0xf bank_mask:0xf
    v_dot2c_f32_bf16_dpp v14, v59, v142 row_newbcast:3 row_mask:0xf bank_mask:0xf
    v_dot2c_f32_bf16_dpp v15, v61, v142 row_newbcast:3 row_mask:0xf bank_mask:0xf
    v_dot2c_f32_bf16_dpp v16, v59, v143 row_newbcast:3 row_mask:0xf bank_mask:0xf
    v_dot2c_f32_bf16_dpp v17, v61, v143 row_newbcast:3 row_mask:0xf bank_mask:0xf
    buffer_load_dwordx4 v[172:175], v2, s[40:43], s71 offen
    s_add_u32 s71, s71, 0x8000
    s_and_b32 s71, s71, 0xfffff
    s_waitcnt vmcnt(7)
    v_dot2c_f32_bf16_dpp v10, v59, v144 row_newbcast:4 row_mask:0xf bank_mask:0xf
    v_dot2c_f32_bf16_dpp v11, v61, v144 row_newbcast:4 row_mask:0xf bank_mask:0xf
    v_dot2c_f32_bf16_dpp v12, v59, v145 row_newbcast:4 row_mask:0xf bank_mask:0xf
    v_dot2c_f32_bf16_dpp v13, v61, v145 row_newbcast:4 row_mask:0xf bank_mask:0xf
    v_dot2c_f32_bf16_dpp v14, v59, v146 row_newbcast:4 row_mask:0xf bank_mask:0xf
    v_dot2c_f32_bf16_dpp v15, v61, v146 row_newbcast:4 row_mask:0xf bank_mask:0xf
    v_dot2c_f32_bf16_dpp v16, v59, v147 row_newbcast:4 row_mask:0xf bank_mask:0xf
    v_dot2c_f32_bf16_dpp v17, v61, v147 row_newbcast:4 row_mask:0xf bank_mask:0xf
    buffer_load_dwordx4 v[176:179], v2, s[40:43], s71 offen
    s_add_u32 s71, s71, 0x8000
    s_and_b32 s71, s71, 0xfffff
    s_waitcnt vmcnt(7)
    v_dot2c_f32_bf16_dpp v10, v59, v148 row_newbcast:5 row_mask:0xf bank_mask:0xf
    v_dot2c_f32_bf16_dpp v11, v61, v148 row_newbcast:5 row_mask:0xf bank_mask:0xf
    v_dot2c_f32_bf16_dpp v12, v59, v149 row_newbcast:5 row_mask:0xf bank_mask:0xf
    v_dot2c_f32_bf16_dpp v13, v61, v149 row_newbcast:5 row_mask:0xf bank_mask:0xf
    v_dot2c_f32_bf16_dpp v14, v59, v150 row_newbcast:5 row_mask:0xf bank_mask:0xf
    v_dot2c_f32_bf16_dpp v15, v61, v150 row_newbcast:5 row_mask:0xf bank_mask:0xf
    v_dot2c_f32_bf16_dpp v16, v59, v151 row_newbcast:5 row_mask:0xf bank_mask:0xf
    v_dot2c_f32_bf16_dpp v17, v61, v151 row_newbcast:5 row_mask:0xf bank_mask:0xf
    buffer_load_dwordx4 v[180:183], v2, s[40:43], s71 offen
    s_add_u32 s71, s71, 0x8000
    s_and_b32 s71, s71, 0xfffff
    s_waitcnt vmcnt(7)
    v_dot2c_f32_bf16_dpp v10, v59, v152 row_newbcast:6 row_mask:0xf bank_mask:0xf
    v_dot2c_f32_bf16_dpp v11, v61, v152 row_newbcast:6 row_mask:0xf bank_mask:0xf
    v_dot2c_f32_bf16_dpp v12, v59, v153 row_newbcast:6 row_mask:0xf bank_mask:0xf
    v_dot2c_f32_bf16_dpp v13, v61, v153 row_newbcast:6 row_mask:0xf bank_mask:0xf
    v_dot2c_f32_bf16_dpp v14, v59, v154 row_newbcast:6 row_mask:0xf bank_mask:0xf
    v_dot2c_f32_bf16_dpp v15, v61, v154 row_newbcast:6 row_mask:0xf bank_mask:0xf
    v_dot2c_f32_bf16_dpp v16, v59, v155 row_newbcast:6 row_mask:0xf bank_mask:0xf
    v_dot2c_f32_bf16_dpp v17, v61, v155 row_newbcast:6 row_mask:0xf bank_mask:0xf
    buffer_load_dwordx4 v[184:187], v2, s[40:43], s71 offen
    s_add_u32 s71, s71, 0x8000
    s_and_b32 s71, s71, 0xfffff
    s_waitcnt vmcnt(7)
    v_dot2c_f32_bf16_dpp v10, v59, v156 row_newbcast:7 row_mask:0xf bank_mask:0xf
    v_dot2c_f32_bf16_dpp v11, v61, v156 row_newbcast:7 row_mask:0xf bank_mask:0xf
    v_dot2c_f32_bf16_dpp v12, v59, v157 row_newbcast:7 row_mask:0xf bank_mask:0xf
    v_dot2c_f32_bf16_dpp v13, v61, v157 row_newbcast:7 row_mask:0xf bank_mask:0xf
    v_dot2c_f32_bf16_dpp v14, v59, v158 row_newbcast:7 row_mask:0xf bank_mask:0xf
    v_dot2c_f32_bf16_dpp v15, v61, v158 row_newbcast:7 row_mask:0xf bank_mask:0xf
    v_dot2c_f32_bf16_dpp v16, v59, v159 row_newbcast:7 row_mask:0xf bank_mask:0xf
    v_dot2c_f32_bf16_dpp v17, v61, v159 row_newbcast:7 row_mask:0xf bank_mask:0xf
    buffer_load_dwordx4 v[188:191], v2, s[40:43], s71 offen
    s_add_u32 s71, s71, 0x8000
    s_and_b32 s71, s71, 0xfffff
    s_waitcnt vmcnt(7)
    v_dot2c_f32_bf16_dpp v10, v59, v160 row_newbcast:8 row_mask:0xf bank_mask:0xf
    v_dot2c_f32_bf16_dpp v11, v61, v160 row_newbcast:8 row_mask:0xf bank_mask:0xf
    v_dot2c_f32_bf16_dpp v12, v59, v161 row_newbcast:8 row_mask:0xf bank_mask:0xf
    v_dot2c_f32_bf16_dpp v13, v61, v161 row_newbcast:8 row_mask:0xf bank_mask:0xf
    v_dot2c_f32_bf16_dpp v14, v59, v162 row_newbcast:8 row_mask:0xf bank_mask:0xf
    v_dot2c_f32_bf16_dpp v15, v61, v162 row_newbcast:8 row_mask:0xf bank_mask:0xf
    v_dot2c_f32_bf16_dpp v16, v59, v163 row_newbcast:8 row_mask:0xf bank_mask:0xf
    v_dot2c_f32_bf16_dpp v17, v61, v163 row_newbcast:8 row_mask:0xf bank_mask:0xf
    buffer_load_dwordx4 v[64:67], v1, s[32:35], s70 offen nt
    s_add_u32 s70, s70, 0x1000
    s_waitcnt vmcnt(7)
    v_dot2c_f32_bf16_dpp v10, v59, v164 row_newbcast:9 row_mask:0xf bank_mask:0xf
    v_dot2c_f32_bf16_dpp v11, v61, v164 row_newbcast:9 row_mask:0xf bank_mask:0xf
    v_dot2c_f32_bf16_dpp v12, v59, v165 row_newbcast:9 row_mask:0xf bank_mask:0xf
    v_dot2c_f32_bf16_dpp v13, v61, v165 row_newbcast:9 row_mask:0xf bank_mask:0xf
    v_dot2c_f32_bf16_dpp v14, v59, v166 row_newbcast:9 row_mask:0xf bank_mask:0xf
    v_dot2c_f32_bf16_dpp v15, v61, v166 row_newbcast:9 row_mask:0xf bank_mask:0xf
    v_dot2c_f32_bf16_dpp v16, v59, v167 row_newbcast:9 row_mask:0xf bank_mask:0xf
    v_dot2c_f32_bf16_dpp v17, v61, v167 row_newbcast:9 row_mask:0xf bank_mask:0xf
    buffer_load_dwordx4 v[68:71], v1, s[32:35], s70 offen nt
    s_add_u32 s70, s70, 0x1000
    s_waitcnt vmcnt(7)
    v_dot2c_f32_bf16_dpp v10, v59, v168 row_newbcast:10 row_mask:0xf bank_mask:0xf
    v_dot2c_f32_bf16_dpp v11, v61, v168 row_newbcast:10 row_mask:0xf bank_mask:0xf
    v_dot2c_f32_bf16_dpp v12, v59, v169 row_newbcast:10 row_mask:0xf bank_mask:0xf
    v_dot2c_f32_bf16_dpp v13, v61, v169 row_newbcast:10 row_mask:0xf bank_mask:0xf
    v_dot2c_f32_bf16_dpp v14, v59, v170 row_newbcast:10 row_mask:0xf bank_mask:0xf
    v_dot2c_f32_bf16_dpp v15, v61, v170 row_newbcast:10 row_mask:0xf bank_mask:0xf
    v_dot2c_f32_bf16_dpp v16, v59, v171 row_newbcast:10 row_mask:0xf bank_mask:0xf
    v_dot2c_f32_bf16_dpp v17, v61, v171 row_newbcast:10 row_mask:0xf bank_mask:0xf
    buffer_load_dwordx4 v[72:75], v1, s[32:35], s70 offen nt
    s_add_u32 s70, s70, 0x1000
    s_waitcnt vmcnt(7)
    v_dot2c_f32_bf16_dpp v10, v59, v172 row_newbcast:11 row_mask:0xf bank_mask:0xf
    v_dot2c_f32_bf16_dpp v11, v61, v172 row_newbcast:11 row_mask:0xf bank_mask:0xf
    v_dot2c_f32_bf16_dpp v12, v59, v173 row_newbcast:11 row_mask:0xf bank_mask:0xf
    v_dot2c_f32_bf16_dpp v13, v61, v173 row_newbcast:11 row_mask:0xf bank_mask:0xf
    v_dot2c_f32_bf16_dpp v14, v59, v174 row_newbcast:11 row_mask:0xf bank_mask:0xf
    v_dot2c_f32_bf16_dpp v15, v61, v174 row_newbcast:11 row_mask:0xf bank_mask:0xf
    v_dot2c_f32_bf16_dpp v16, v59, v175 row_newbcast:11 row_mask:0xf bank_mask:0xf
    v_dot2c_f32_bf16_dpp v17, v61, v175 row_newbcast:11 row_mask:0xf bank_mask:0xf
    buffer_load_dwordx4 v[76:79], v1, s[32:35], s70 offen nt
    s_add_u32 s70, s70, 0x1000
    s_waitcnt vmcnt(7)
    v_dot2c_f32_bf16_dpp v10, v59, v176 row_newbcast:12 row_mask:0xf bank_mask:0xf
    v_dot2c_f32_bf16_dpp v11, v61, v176 row_newbcast:12 row_mask:0xf bank_mask:0xf
    v_dot2c_f32_bf16_dpp v12, v59, v177 row_newbcast:12 row_mask:0xf bank_mask:0xf
    v_dot2c_f32_bf16_dpp v13, v61, v177 row_newbcast:12 row_mask:0xf bank_mask:0xf
    v_dot2c_f32_bf16_dpp v14, v59, v178 row_newbcast:12 row_mask:0xf bank_mask:0xf
    v_dot2c_f32_bf16_dpp v15, v61, v178 row_newbcast:12 row_mask:0xf bank_mask:0xf
    v_dot2c_f32_bf16_dpp v16, v59, v179 row_newbcast:12 row_mask:0xf bank_mask:0xf
    v_dot2c_f32_bf16_dpp v17, v61, v179 row_newbcast:12 row_mask:0xf bank_mask:0xf
    buffer_load_dwordx4 v[80:83], v1, s[32:35], s70 offen nt
    s_add_u32 s70, s70, 0x1000
    s_waitcnt vmcnt(7)
    v_dot2c_f32_bf16_dpp v10, v59, v180 row_newbcast:13 row_mask:0xf bank_mask:0xf
    v_dot2c_f32_bf16_dpp v11, v61, v180 row_newbcast:13 row_mask:0xf bank_mask:0xf
    v_dot2c_f32_bf16_dpp v12, v59, v181 row_newbcast:13 row_mask:0xf bank_mask:0xf
    v_dot2c_f32_bf16_dpp v13, v61, v181 row_newbcast:13 row_mask:0xf bank_mask:0xf
    v_dot2c_f32_bf16_dpp v14, v59, v182 row_newbcast:13 row_mask:0xf bank_mask:0xf
    v_dot2c_f32_bf16_dpp v15, v61, v182 row_newbcast:13 row_mask:0xf bank_mask:0xf
    v_dot2c_f32_bf16_dpp v16, v59, v183 row_newbcast:13 row_mask:0xf bank_mask:0xf
    v_dot2c_f32_bf16_dpp v17, v61, v183 row_newbcast:13 row_mask:0xf bank_mask:0xf
    buffer_load_dwordx4 v[84:87], v1, s[32:35], s70 offen nt
    s_add_u32 s70, s70, 0x1000
    s_waitcnt vmcnt(7)
    v_dot2c_f32_bf16_dpp v10, v59, v184 row_newbcast:14 row_mask:0xf bank_mask:0xf
    v_dot2c_f32_bf16_dpp v11, v61, v184 row_newbcast:14 row_mask:0xf bank_mask:0xf
    v_dot2c_f32_bf16_dpp v12, v59, v185 row_newbcast:14 row_mask:0xf bank_mask:0xf
    v_dot2c_f32_bf16_dpp v13, v61, v185 row_newbcast:14 row_mask:0xf bank_mask:0xf
    v_dot2c_f32_bf16_dpp v14, v59, v186 row_newbcast:14 row_mask:0xf bank_mask:0xf
    v_dot2c_f32_bf16_dpp v15, v61, v186 row_newbcast:14 row_mask:0xf bank_mask:0xf
    v_dot2c_f32_bf16_dpp v16, v59, v187 row_newbcast:14 row_mask:0xf bank_mask:0xf
    v_dot2c_f32_bf16_dpp v17, v61, v187 row_newbcast:14 row_mask:0xf bank_mask:0xf
    buffer_load_dwordx4 v[88:91], v1, s[32:35], s70 offen nt
    s_add_u32 s70, s70, 0x1000
    s_waitcnt vmcnt(7)
    v_dot2c_f32_bf16_dpp v10, v59, v188 row_newbcast:15 row_mask:0xf bank_mask:0xf
    v_dot2c_f32_bf16_dpp v11, v61, v188 row_newbcast:15 row_mask:0xf bank_mask:0xf
    v_dot2c_f32_bf16_dpp v12, v59, v189 row_newbcast:15 row_mask:0xf bank_mask:0xf
    v_dot2c_f32_bf16_dpp v13, v61, v189 row_newbcast:15 row_mask:0xf bank_mask:0xf
    v_dot2c_f32_bf16_dpp v14, v59, v190 row_newbcast:15 row_mask:0xf bank_mask:0xf
    v_dot2c_f32_bf16_dpp v15, v61, v190 row_newbcast:15 row_mask:0xf bank_mask:0xf
    v_dot2c_f32_bf16_dpp v16, v59, v191 row_newbcast:15 row_mask:0xf bank_mask:0xf
    v_dot2c_f32_bf16_dpp v17, v61, v191 row_newbcast:15 row_mask:0xf bank_mask:0xf
    buffer_load_dwordx4 v[92:95], v1, s[32:35], s70 offen nt
    s_add_u32 s70, s70, 0x9000
    v_permlane32_swap_b32 v10, v14
    v_permlane32_swap_b32 v11, v15
    v_permlane32_swap_b32 v12, v16
    v_permlane32_swap_b32 v13, v17
    v_add_f32 v10, v10, v14
    v_add_f32 v11, v11, v15
    v_add_f32 v12, v12, v16
    v_add_f32 v13, v13, v17
    s_nop 0
    v_permlane16_swap_b32 v10, v12
    v_permlane16_swap_b32 v11, v13
    v_add_f32 v10, v10, v12
    v_add_f32 v11, v11, v13
    ds_write_b64 v47, v[10:11] offset:0
    v_lshlrev_b32 v4, 5, v43
    s_waitcnt lgkmcnt(0)
    s_barrier
    ds_read_b128 v[128:131], v4 offset:0
    ds_read_b128 v[132:135], v4 offset:16
    ds_read_b128 v[136:139], v4 offset:512
    ds_read_b128 v[140:143], v4 offset:528
    ds_read_b128 v[144:147], v4 offset:1024
    ds_read_b128 v[148:151], v4 offset:1040
    ds_read_b128 v[152:155], v4 offset:1536
    ds_read_b128 v[156:159], v4 offset:1552
    v_mov_b32 v10, 0
    v_mov_b32 v11, 0
    v_mov_b32 v12, 0
    v_mov_b32 v13, 0
    v_mov_b32 v14, 0
    v_mov_b32 v15, 0
    v_mov_b32 v16, 0
    v_mov_b32 v17, 0
    s_waitcnt lgkmcnt(0)
    v_add_f32 v128, v128, v136
    v_add_f32 v144, v144, v152
    v_add_f32 v129, v129, v137
    v_add_f32 v145, v145, v153
    v_add_f32 v130, v130, v138
    v_add_f32 v146, v146, v154
    v_add_f32 v131, v131, v139
    v_add_f32 v147, v147, v155
    v_add_f32 v132, v132, v140
    v_add_f32 v148, v148, v156
    v_add_f32 v133, v133, v141
    v_add_f32 v149, v149, v157
    v_add_f32 v134, v134, v142
    v_add_f32 v150, v150, v158
    v_add_f32 v135, v135, v143
    v_add_f32 v151, v151, v159
    v_add_f32 v128, v128, v144
    v_add_f32 v129, v129, v145
    v_add_f32 v130, v130, v146
    v_add_f32 v131, v131, v147
    v_add_f32 v132, v132, v148
    v_add_f32 v133, v133, v149
    v_add_f32 v134, v134, v150
    v_add_f32 v135, v135, v151
    v_cvt_pk_bf16_f32 v6, v128, v129
    v_cvt_pk_bf16_f32 v7, v130, v131
    v_cvt_pk_bf16_f32 v8, v132, v133
    v_cvt_pk_bf16_f32 v9, v134, v135
    buffer_load_dwordx4 v[96:99], v1, s[32:35], s70 offen nt
    s_add_u32 s70, s70, 0x1000
    buffer_load_dwordx4 v[100:103], v1, s[32:35], s70 offen nt
    s_add_u32 s70, s70, 0x1000
    buffer_load_dwordx4 v[104:107], v1, s[32:35], s70 offen nt
    s_add_u32 s70, s70, 0x1000
    buffer_load_dwordx4 v[108:111], v1, s[32:35], s70 offen nt
    s_add_u32 s70, s70, 0x1000
    buffer_load_dwordx4 v[112:115], v1, s[32:35], s70 offen nt
    s_add_u32 s70, s70, 0x1000
    buffer_load_dwordx4 v[116:119], v1, s[32:35], s70 offen nt
    s_add_u32 s70, s70, 0x1000
    buffer_load_dwordx4 v[120:123], v1, s[32:35], s70 offen nt
    s_add_u32 s70, s70, 0x1000
    buffer_load_dwordx4 v[124:127], v1, s[32:35], s70 offen nt
    s_add_u32 s70, s70, 0x9000
    s_add_u32 s89, s75, 0x20000
    buffer_load_dwordx4 v[192:195], v1, s[32:35], s89 offen nt
    s_add_u32 s89, s89, 0x1000
    s_waitcnt vmcnt(16)
    v_dot2_f32_bf16 v42, v64, v6, 0
    v_dot2_f32_bf16 v42, v65, v7, v42
    v_dot2_f32_bf16 v42, v66, v8, v42
    v_dot2_f32_bf16 v42, v67, v9, v42
    buffer_load_dwordx4 v[196:199], v1, s[32:35], s89 offen nt
    s_add_u32 s89, s89, 0x1000
    s_waitcnt vmcnt(16)
    v_dot2_f32_bf16 v43, v68, v6, 0
    v_dot2_f32_bf16 v43, v69, v7, v43
    v_dot2_f32_bf16 v43, v70, v8, v43
    v_dot2_f32_bf16 v43, v71, v9, v43
    buffer_load_dwordx4 v[200:203], v1, s[32:35], s89 offen nt
    s_add_u32 s89, s89, 0x1000
    s_waitcnt vmcnt(16)
    v_dot2_f32_bf16 v44, v72, v6, 0
    v_dot2_f32_bf16 v44, v73, v7, v44
    v_dot2_f32_bf16 v44, v74, v8, v44
    v_dot2_f32_bf16 v44, v75, v9, v44
    buffer_load_dwordx4 v[204:207], v1, s[32:35], s89 offen nt
    s_add_u32 s89, s89, 0x1000
    s_waitcnt vmcnt(16)
    v_dot2_f32_bf16 v45, v76, v6, 0
    v_dot2_f32_bf16 v45, v77, v7, v45
    v_dot2_f32_bf16 v45, v78, v8, v45
    v_dot2_f32_bf16 v45, v79, v9, v45
    buffer_load_dwordx4 v[208:211], v1, s[32:35], s89 offen nt
    s_add_u32 s89, s89, 0x1000
    s_waitcnt vmcnt(16)
    v_dot2_f32_bf16 v46, v80, v6, 0
    v_dot2_f32_bf16 v46, v81, v7, v46
    v_dot2_f32_bf16 v46, v82, v8, v46
    v_dot2_f32_bf16 v46, v83, v9, v46
    buffer_load_dwordx4 v[212:215], v1, s[32:35], s89 offen nt
    s_add_u32 s89, s89, 0x1000
    s_waitcnt vmcnt(16)
    v_dot2_f32_bf16 v47, v84, v6, 0
    v_dot2_f32_bf16 v47, v85, v7, v47
    v_dot2_f32_bf16 v47, v86, v8, v47
    v_dot2_f32_bf16 v47, v87, v9, v47
    buffer_load_dwordx4 v[216:219], v1, s[32:35], s89 offen nt
    s_add_u32 s89, s89, 0x1000
    s_waitcnt vmcnt(16)
    v_dot2_f32_bf16 v48, v88, v6, 0
    v_dot2_f32_bf16 v48, v89, v7, v48
    v_dot2_f32_bf16 v48, v90, v8, v48
    v_dot2_f32_bf16 v48, v91, v9, v48
    buffer_load_dwordx4 v[220:223], v1, s[32:35], s89 offen nt
    s_add_u32 s89, s89, 0x9000
    s_waitcnt vmcnt(16)
    v_dot2_f32_bf16 v49, v92, v6, 0
    v_dot2_f32_bf16 v49, v93, v7, v49
    v_dot2_f32_bf16 v49, v94, v8, v49
    v_dot2_f32_bf16 v49, v95, v9, v49
    buffer_load_dwordx4 v[224:227], v1, s[32:35], s89 offen nt
    s_add_u32 s89, s89, 0x1000
    s_waitcnt vmcnt(16)
    v_dot2_f32_bf16 v50, v96, v6, 0
    v_dot2_f32_bf16 v50, v97, v7, v50
    v_dot2_f32_bf16 v50, v98, v8, v50
    v_dot2_f32_bf16 v50, v99, v9, v50
    buffer_load_dwordx4 v[228:231], v1, s[32:35], s89 offen nt
    s_add_u32 s89, s89, 0x1000
    s_waitcnt vmcnt(16)
    v_dot2_f32_bf16 v51, v100, v6, 0
    v_dot2_f32_bf16 v51, v101, v7, v51
    v_dot2_f32_bf16 v51, v102, v8, v51
    v_dot2_f32_bf16 v51, v103, v9, v51
    buffer_load_dwordx4 v[232:235], v1, s[32:35], s89 offen nt
    s_add_u32 s89, s89, 0x1000
    s_waitcnt vmcnt(16)
    v_dot2_f32_bf16 v52, v104, v6, 0
    v_dot2_f32_bf16 v52, v105, v7, v52
    v_dot2_f32_bf16 v52, v106, v8, v52
    v_dot2_f32_bf16 v52, v107, v9, v52
    s_add_u32 s70, s75, 0x40000
    buffer_load_dwordx4 v[64:67], v1, s[32:35], s70 offen nt
    s_add_u32 s70, s70, 0x1000
    buffer_load_dwordx4 v[236:239], v1, s[32:35], s89 offen nt
    s_add_u32 s89, s89, 0x1000
    s_waitcnt vmcnt(17)
    v_dot2_f32_bf16 v53, v108, v6, 0
    v_dot2_f32_bf16 v53, v109, v7, v53
    v_dot2_f32_bf16 v53, v110, v8, v53
    v_dot2_f32_bf16 v53, v111, v9, v53
    buffer_load_dwordx4 v[68:71], v1, s[32:35], s70 offen nt
    s_add_u32 s70, s70, 0x1000
    buffer_load_dwordx4 v[240:243], v1, s[32:35], s89 offen nt
    s_add_u32 s89, s89, 0x1000
    s_waitcnt vmcnt(18)
    v_dot2_f32_bf16 v54, v112, v6, 0
    v_dot2_f32_bf16 v54, v113, v7, v54
    v_dot2_f32_bf16 v54, v114, v8, v54
    v_dot2_f32_bf16 v54, v115, v9, v54
    buffer_load_dwordx4 v[72:75], v1, s[32:35], s70 offen nt
    s_add_u32 s70, s70, 0x1000
    buffer_load_dwordx4 v[244:247], v1, s[32:35], s89 offen nt
    s_add_u32 s89, s89, 0x1000
    s_waitcnt vmcnt(19)
    v_dot2_f32_bf16 v55, v116, v6, 0
    v_dot2_f32_bf16 v55, v117, v7, v55
    v_dot2_f32_bf16 v55, v118, v8, v55
    v_dot2_f32_bf16 v55, v119, v9, v55
    buffer_load_dwordx4 v[76:79], v1, s[32:35], s70 offen nt
    s_add_u32 s70, s70, 0x1000
    buffer_load_dwordx4 v[248:251], v1, s[32:35], s89 offen nt
    s_add_u32 s89, s89, 0x1000
    s_waitcnt vmcnt(20)
    v_dot2_f32_bf16 v56, v120, v6, 0
    v_dot2_f32_bf16 v56, v121, v7, v56
    v_dot2_f32_bf16 v56, v122, v8, v56
    v_dot2_f32_bf16 v56, v123, v9, v56
    buffer_load_dwordx4 v[80:83], v1, s[32:35], s70 offen nt
    s_add_u32 s70, s70, 0x1000
    buffer_load_dwordx4 v[252:255], v1, s[32:35], s89 offen nt
    s_add_u32 s89, s89, 0x9000
    s_waitcnt vmcnt(21)
    v_dot2_f32_bf16 v57, v124, v6, 0
    v_dot2_f32_bf16 v57, v125, v7, v57
    v_dot2_f32_bf16 v57, v126, v8, v57
    v_dot2_f32_bf16 v57, v127, v9, v57
    buffer_load_dwordx4 v[84:87], v1, s[32:35], s70 offen nt
    s_add_u32 s70, s70, 0x1000
    v_add_f32_dpp v42, v42, v42 row_ror:8 row_mask:0xf bank_mask:0x3
    s_nop 1
    v_add_f32_dpp v42, v50, v50 row_ror:8 row_mask:0xf bank_mask:0xc
    v_add_f32_dpp v43, v43, v43 row_ror:8 row_mask:0xf bank_mask:0x3
    s_nop 1
    v_add_f32_dpp v43, v51, v51 row_ror:8 row_mask:0xf bank_mask:0xc
    v_add_f32_dpp v44, v44, v44 row_ror:8 row_mask:0xf bank_mask:0x3
    s_nop 1
    v_add_f32_dpp v44, v52, v52 row_ror:8 row_mask:0xf bank_mask:0xc
    v_add_f32_dpp v45, v45, v45 row_ror:8 row_mask:0xf bank_mask:0x3
    s_nop 1
    v_add_f32_dpp v45, v53, v53 row_ror:8 row_mask:0xf bank_mask:0xc
    v_add_f32_dpp v46, v46, v46 row_ror:8 row_mask:0xf bank_mask:0x3
    s_nop 1
    v_add_f32_dpp v46, v54, v54 row_ror:8 row_mask:0xf bank_mask:0xc
    v_add_f32_dpp v47, v47, v47 row_ror:8 row_mask:0xf bank_mask:0x3
    s_nop 1
    v_add_f32_dpp v47, v55, v55 row_ror:8 row_mask:0xf bank_mask:0xc
    v_add_f32_dpp v48, v48, v48 row_ror:8 row_mask:0xf bank_mask:0x3
    s_nop 1
    v_add_f32_dpp v48, v56, v56 row_ror:8 row_mask:0xf bank_mask:0xc
    v_add_f32_dpp v49, v49, v49 row_ror:8 row_mask:0xf bank_mask:0x3
    s_nop 1
    v_add_f32_dpp v49, v57, v57 row_ror:8 row_mask:0xf bank_mask:0xc
    v_add_f32_dpp v42, v42, v42 row_shl:4 row_mask:0xf bank_mask:0x5
    s_nop 1
    v_add_f32_dpp v42, v46, v46 row_shr:4 row_mask:0xf bank_mask:0xa
    v_add_f32_dpp v43, v43, v43 row_shl:4 row_mask:0xf bank_mask:0x5
    s_nop 1
    v_add_f32_dpp v43, v47, v47 row_shr:4 row_mask:0xf bank_mask:0xa
    v_add_f32_dpp v44, v44, v44 row_shl:4 row_mask:0xf bank_mask:0x5
    s_nop 1
    v_add_f32_dpp v44, v48, v48 row_shr:4 row_mask:0xf bank_mask:0xa
    v_add_f32_dpp v45, v45, v45 row_shl:4 row_mask:0xf bank_mask:0x5
    s_nop 1
    v_add_f32_dpp v45, v49, v49 row_shr:4 row_mask:0xf bank_mask:0xa
    v_add_f32_dpp v42, v42, v42 quad_perm:[2,3,0,1] row_mask:0xf bank_mask:0xf
    v_add_f32_dpp v43, v43, v43 quad_perm:[2,3,0,1] row_mask:0xf bank_mask:0xf
    v_add_f32_dpp v44, v44, v44 quad_perm:[2,3,0,1] row_mask:0xf bank_mask:0xf
    v_add_f32_dpp v45, v45, v45 quad_perm:[2,3,0,1] row_mask:0xf bank_mask:0xf
    v_cndmask_b32 v42, v42, v44, s[76:77]
    v_cndmask_b32 v43, v43, v45, s[76:77]
    s_nop 0
    v_add_f32_dpp v42, v42, v42 quad_perm:[1,0,3,2] row_mask:0xf bank_mask:0xf
    v_add_f32_dpp v43, v43, v43 quad_perm:[1,0,3,2] row_mask:0xf bank_mask:0xf
    v_cndmask_b32 v42, v42, v43, s[78:79]
    v_cvt_pk_bf16_f32 v42, 0, v42
    v_mul_f32 v42, 0x3db504f3, v42
    v_cvt_pk_bf16_f32 v26, 0, v42
    s_waitcnt vmcnt(21)
    v_dot2_f32_bf16 v42, v192, v6, 0
    v_dot2_f32_bf16 v42, v193, v7, v42
    v_dot2_f32_bf16 v42, v194, v8, v42
    v_dot2_f32_bf16 v42, v195, v9, v42
    buffer_load_dwordx4 v[88:91], v1, s[32:35], s70 offen nt
    s_add_u32 s70, s70, 0x1000
    s_waitcnt vmcnt(21)
    v_dot2_f32_bf16 v43, v196, v6, 0
    v_dot2_f32_bf16 v43, v197, v7, v43
    v_dot2_f32_bf16 v43, v198, v8, v43
    v_dot2_f32_bf16 v43, v199, v9, v43
    s_waitcnt vmcnt(20)
    v_dot2_f32_bf16 v44, v200, v6, 0
    v_dot2_f32_bf16 v44, v201, v7, v44
    v_dot2_f32_bf16 v44, v202, v8, v44
    v_dot2_f32_bf16 v44, v203, v9, v44
    s_waitcnt vmcnt(19)
    v_dot2_f32_bf16 v45, v204, v6, 0
    v_dot2_f32_bf16 v45, v205, v7, v45
    v_dot2_f32_bf16 v45, v206, v8, v45
    v_dot2_f32_bf16 v45, v207, v9, v45
    s_waitcnt vmcnt(18)
    v_dot2_f32_bf16 v46, v208, v6, 0
    v_dot2_f32_bf16 v46, v209, v7, v46
    v_dot2_f32_bf16 v46, v210, v8, v46
    v_dot2_f32_bf16 v46, v211, v9, v46
    s_waitcnt vmcnt(17)
    v_dot2_f32_bf16 v47, v212, v6, 0
    v_dot2_f32_bf16 v47, v213, v7, v47
    v_dot2_f32_bf16 v47, v214, v8, v47
    v_dot2_f32_bf16 v47, v215, v9, v47
    s_waitcnt vmcnt(16)
    v_dot2_f32_bf16 v48, v216, v6, 0
    v_dot2_f32_bf16 v48, v217, v7, v48
    v_dot2_f32_bf16 v48, v218, v8, v48
    v_dot2_f32_bf16 v48, v219, v9, v48
    s_waitcnt vmcnt(15)
    v_dot2_f32_bf16 v49, v220, v6, 0
    v_dot2_f32_bf16 v49, v221, v7, v49
    v_dot2_f32_bf16 v49, v222, v8, v49
    v_dot2_f32_bf16 v49, v223, v9, v49
    s_waitcnt vmcnt(14)
    v_dot2_f32_bf16 v50, v224, v6, 0
    v_dot2_f32_bf16 v50, v225, v7, v50
    v_dot2_f32_bf16 v50, v226, v8, v50
    v_dot2_f32_bf16 v50, v227, v9, v50
    s_waitcnt vmcnt(13)
    v_dot2_f32_bf16 v51, v228, v6, 0
    v_dot2_f32_bf16 v51, v229, v7, v51
    v_dot2_f32_bf16 v51, v230, v8, v51
    v_dot2_f32_bf16 v51, v231, v9, v51
    s_waitcnt vmcnt(12)
    v_dot2_f32_bf16 v52, v232, v6, 0
    v_dot2_f32_bf16 v52, v233, v7, v52
    v_dot2_f32_bf16 v52, v234, v8, v52
    v_dot2_f32_bf16 v52, v235, v9, v52
    s_waitcnt vmcnt(10)
    v_dot2_f32_bf16 v53, v236, v6, 0
    v_dot2_f32_bf16 v53, v237, v7, v53
    v_dot2_f32_bf16 v53, v238, v8, v53
    v_dot2_f32_bf16 v53, v239, v9, v53
    s_waitcnt vmcnt(8)
    v_dot2_f32_bf16 v54, v240, v6, 0
    v_dot2_f32_bf16 v54, v241, v7, v54
    v_dot2_f32_bf16 v54, v242, v8, v54
    v_dot2_f32_bf16 v54, v243, v9, v54
    s_waitcnt vmcnt(6)
    v_dot2_f32_bf16 v55, v244, v6, 0
    v_dot2_f32_bf16 v55, v245, v7, v55
    v_dot2_f32_bf16 v55, v246, v8, v55
    v_dot2_f32_bf16 v55, v247, v9, v55
    s_waitcnt vmcnt(4)
    v_dot2_f32_bf16 v56, v248, v6, 0
    v_dot2_f32_bf16 v56, v249, v7, v56
    v_dot2_f32_bf16 v56, v250, v8, v56
    v_dot2_f32_bf16 v56, v251, v9, v56
    s_waitcnt vmcnt(2)
    v_dot2_f32_bf16 v57, v252, v6, 0
    v_dot2_f32_bf16 v57, v253, v7, v57
    v_dot2_f32_bf16 v57, v254, v8, v57
    v_dot2_f32_bf16 v57, v255, v9, v57
    v_add_f32_dpp v42, v42, v42 row_ror:8 row_mask:0xf bank_mask:0x3
    s_nop 1
    v_add_f32_dpp v42, v50, v50 row_ror:8 row_mask:0xf bank_mask:0xc
    v_add_f32_dpp v43, v43, v43 row_ror:8 row_mask:0xf bank_mask:0x3
    s_nop 1
    v_add_f32_dpp v43, v51, v51 row_ror:8 row_mask:0xf bank_mask:0xc
    v_add_f32_dpp v44, v44, v44 row_ror:8 row_mask:0xf bank_mask:0x3
    s_nop 1
    v_add_f32_dpp v44, v52, v52 row_ror:8 row_mask:0xf bank_mask:0xc
    v_add_f32_dpp v45, v45, v45 row_ror:8 row_mask:0xf bank_mask:0x3
    s_nop 1
    v_add_f32_dpp v45, v53, v53 row_ror:8 row_mask:0xf bank_mask:0xc
    v_add_f32_dpp v46, v46, v46 row_ror:8 row_mask:0xf bank_mask:0x3
    s_nop 1
    v_add_f32_dpp v46, v54, v54 row_ror:8 row_mask:0xf bank_mask:0xc
    v_add_f32_dpp v47, v47, v47 row_ror:8 row_mask:0xf bank_mask:0x3
    s_nop 1
    v_add_f32_dpp v47, v55, v55 row_ror:8 row_mask:0xf bank_mask:0xc
    v_add_f32_dpp v48, v48, v48 row_ror:8 row_mask:0xf bank_mask:0x3
    s_nop 1
    v_add_f32_dpp v48, v56, v56 row_ror:8 row_mask:0xf bank_mask:0xc
    v_add_f32_dpp v49, v49, v49 row_ror:8 row_mask:0xf bank_mask:0x3
    s_nop 1
    v_add_f32_dpp v49, v57, v57 row_ror:8 row_mask:0xf bank_mask:0xc
    v_add_f32_dpp v42, v42, v42 row_shl:4 row_mask:0xf bank_mask:0x5
    s_nop 1
    v_add_f32_dpp v42, v46, v46 row_shr:4 row_mask:0xf bank_mask:0xa
    v_add_f32_dpp v43, v43, v43 row_shl:4 row_mask:0xf bank_mask:0x5
    s_nop 1
    v_add_f32_dpp v43, v47, v47 row_shr:4 row_mask:0xf bank_mask:0xa
    v_add_f32_dpp v44, v44, v44 row_shl:4 row_mask:0xf bank_mask:0x5
    s_nop 1
    v_add_f32_dpp v44, v48, v48 row_shr:4 row_mask:0xf bank_mask:0xa
    v_add_f32_dpp v45, v45, v45 row_shl:4 row_mask:0xf bank_mask:0x5
    s_nop 1
    v_add_f32_dpp v45, v49, v49 row_shr:4 row_mask:0xf bank_mask:0xa
    v_add_f32_dpp v42, v42, v42 quad_perm:[2,3,0,1] row_mask:0xf bank_mask:0xf
    v_add_f32_dpp v43, v43, v43 quad_perm:[2,3,0,1] row_mask:0xf bank_mask:0xf
    v_add_f32_dpp v44, v44, v44 quad_perm:[2,3,0,1] row_mask:0xf bank_mask:0xf
    v_add_f32_dpp v45, v45, v45 quad_perm:[2,3,0,1] row_mask:0xf bank_mask:0xf
    v_cndmask_b32 v42, v42, v44, s[76:77]
    v_cndmask_b32 v43, v43, v45, s[76:77]
    s_nop 0
    v_add_f32_dpp v42, v42, v42 quad_perm:[1,0,3,2] row_mask:0xf bank_mask:0xf
    v_add_f32_dpp v43, v43, v43 quad_perm:[1,0,3,2] row_mask:0xf bank_mask:0xf
    v_cndmask_b32 v42, v42, v43, s[78:79]
    v_cvt_pk_bf16_f32 v42, 0, v42
    v_mul_f32 v42, 0x3db504f3, v42
    v_cvt_pk_bf16_f32 v27, 0, v42
    v_dot2_f32_bf16 v42, v64, v6, 0
    v_dot2_f32_bf16 v42, v65, v7, v42
    v_dot2_f32_bf16 v42, v66, v8, v42
    v_dot2_f32_bf16 v42, v67, v9, v42
    v_dot2_f32_bf16 v43, v68, v6, 0
    v_dot2_f32_bf16 v43, v69, v7, v43
    v_dot2_f32_bf16 v43, v70, v8, v43
    v_dot2_f32_bf16 v43, v71, v9, v43
    buffer_load_dwordx4 v[92:95], v1, s[32:35], s70 offen nt
    s_add_u32 s70, s70, 0x9000
    v_dot2_f32_bf16 v44, v72, v6, 0
    v_dot2_f32_bf16 v44, v73, v7, v44
    v_dot2_f32_bf16 v44, v74, v8, v44
    v_dot2_f32_bf16 v44, v75, v9, v44
    buffer_load_dwordx4 v[96:99], v1, s[32:35], s70 offen nt
    s_add_u32 s70, s70, 0x1000
    v_dot2_f32_bf16 v45, v76, v6, 0
    v_dot2_f32_bf16 v45, v77, v7, v45
    v_dot2_f32_bf16 v45, v78, v8, v45
    v_dot2_f32_bf16 v45, v79, v9, v45
    buffer_load_dwordx4 v[100:103], v1, s[32:35], s70 offen nt
    s_add_u32 s70, s70, 0x1000
    v_dot2_f32_bf16 v46, v80, v6, 0
    v_dot2_f32_bf16 v46, v81, v7, v46
    v_dot2_f32_bf16 v46, v82, v8, v46
    v_dot2_f32_bf16 v46, v83, v9, v46
    buffer_load_dwordx4 v[104:107], v1, s[32:35], s70 offen nt
    s_add_u32 s70, s70, 0x1000
    s_waitcnt vmcnt(5)
    v_dot2_f32_bf16 v47, v84, v6, 0
    v_dot2_f32_bf16 v47, v85, v7, v47
    v_dot2_f32_bf16 v47, v86, v8, v47
    v_dot2_f32_bf16 v47, v87, v9, v47
    buffer_load_dwordx4 v[108:111], v1, s[32:35], s70 offen nt
    s_add_u32 s70, s70, 0x1000
    s_waitcnt vmcnt(5)
    v_dot2_f32_bf16 v48, v88, v6, 0
    v_dot2_f32_bf16 v48, v89, v7, v48
    v_dot2_f32_bf16 v48, v90, v8, v48
    v_dot2_f32_bf16 v48, v91, v9, v48
    buffer_load_dwordx4 v[112:115], v1, s[32:35], s70 offen nt
    s_add_u32 s70, s70, 0x1000
    s_waitcnt vmcnt(5)
    v_dot2_f32_bf16 v49, v92, v6, 0
    v_dot2_f32_bf16 v49, v93, v7, v49
    v_dot2_f32_bf16 v49, v94, v8, v49
    v_dot2_f32_bf16 v49, v95, v9, v49
    buffer_load_dwordx4 v[116:119], v1, s[32:35], s70 offen nt
    s_add_u32 s70, s70, 0x1000
    s_waitcnt vmcnt(5)
    v_dot2_f32_bf16 v50, v96, v6, 0
    v_dot2_f32_bf16 v50, v97, v7, v50
    v_dot2_f32_bf16 v50, v98, v8, v50
    v_dot2_f32_bf16 v50, v99, v9, v50
    buffer_load_dwordx4 v[120:123], v1, s[32:35], s70 offen nt
    s_add_u32 s70, s70, 0x1000
    s_waitcnt vmcnt(5)
    v_dot2_f32_bf16 v51, v100, v6, 0
    v_dot2_f32_bf16 v51, v101, v7, v51
    v_dot2_f32_bf16 v51, v102, v8, v51
    v_dot2_f32_bf16 v51, v103, v9, v51
    buffer_load_dwordx4 v[124:127], v1, s[32:35], s70 offen nt
    s_add_u32 s70, s70, 0x9000
    s_waitcnt vmcnt(5)
    v_dot2_f32_bf16 v52, v104, v6, 0
    v_dot2_f32_bf16 v52, v105, v7, v52
    v_dot2_f32_bf16 v52, v106, v8, v52
    v_dot2_f32_bf16 v52, v107, v9, v52
    buffer_load_dwordx4 v[64:67], v1, s[32:35], s70 offen nt
    s_add_u32 s70, s70, 0x1000
    s_waitcnt vmcnt(5)
    v_dot2_f32_bf16 v53, v108, v6, 0
    v_dot2_f32_bf16 v53, v109, v7, v53
    v_dot2_f32_bf16 v53, v110, v8, v53
    v_dot2_f32_bf16 v53, v111, v9, v53
    buffer_load_dwordx4 v[68:71], v1, s[32:35], s70 offen nt
    s_add_u32 s70, s70, 0x1000
    s_waitcnt vmcnt(5)
    v_dot2_f32_bf16 v54, v112, v6, 0
    v_dot2_f32_bf16 v54, v113, v7, v54
    v_dot2_f32_bf16 v54, v114, v8, v54
    v_dot2_f32_bf16 v54, v115, v9, v54
    buffer_load_dwordx4 v[72:75], v1, s[32:35], s70 offen nt
    s_add_u32 s70, s70, 0x1000
    s_waitcnt vmcnt(5)
    v_dot2_f32_bf16 v55, v116, v6, 0
    v_dot2_f32_bf16 v55, v117, v7, v55
    v_dot2_f32_bf16 v55, v118, v8, v55
    v_dot2_f32_bf16 v55, v119, v9, v55
    buffer_load_dwordx4 v[76:79], v1, s[32:35], s70 offen nt
    s_add_u32 s70, s70, 0x1000
    s_waitcnt vmcnt(5)
    v_dot2_f32_bf16 v56, v120, v6, 0
    v_dot2_f32_bf16 v56, v121, v7, v56
    v_dot2_f32_bf16 v56, v122, v8, v56
    v_dot2_f32_bf16 v56, v123, v9, v56
    buffer_load_dwordx4 v[80:83], v1, s[32:35], s70 offen nt
    s_add_u32 s70, s70, 0x1000
    s_waitcnt vmcnt(5)
    v_dot2_f32_bf16 v57, v124, v6, 0
    v_dot2_f32_bf16 v57, v125, v7, v57
    v_dot2_f32_bf16 v57, v126, v8, v57
    v_dot2_f32_bf16 v57, v127, v9, v57
    buffer_load_dwordx4 v[84:87], v1, s[32:35], s70 offen nt
    s_add_u32 s70, s70, 0x1000
    v_add_f32_dpp v42, v42, v42 row_ror:8 row_mask:0xf bank_mask:0x3
    s_nop 1
    v_add_f32_dpp v42, v50, v50 row_ror:8 row_mask:0xf bank_mask:0xc
    v_add_f32_dpp v43, v43, v43 row_ror:8 row_mask:0xf bank_mask:0x3
    s_nop 1
    v_add_f32_dpp v43, v51, v51 row_ror:8 row_mask:0xf bank_mask:0xc
    v_add_f32_dpp v44, v44, v44 row_ror:8 row_mask:0xf bank_mask:0x3
    s_nop 1
    v_add_f32_dpp v44, v52, v52 row_ror:8 row_mask:0xf bank_mask:0xc
    v_add_f32_dpp v45, v45, v45 row_ror:8 row_mask:0xf bank_mask:0x3
    s_nop 1
    v_add_f32_dpp v45, v53, v53 row_ror:8 row_mask:0xf bank_mask:0xc
    v_add_f32_dpp v46, v46, v46 row_ror:8 row_mask:0xf bank_mask:0x3
    s_nop 1
    v_add_f32_dpp v46, v54, v54 row_ror:8 row_mask:0xf bank_mask:0xc
    v_add_f32_dpp v47, v47, v47 row_ror:8 row_mask:0xf bank_mask:0x3
    s_nop 1
    v_add_f32_dpp v47, v55, v55 row_ror:8 row_mask:0xf bank_mask:0xc
    v_add_f32_dpp v48, v48, v48 row_ror:8 row_mask:0xf bank_mask:0x3
    s_nop 1
    v_add_f32_dpp v48, v56, v56 row_ror:8 row_mask:0xf bank_mask:0xc
    v_add_f32_dpp v49, v49, v49 row_ror:8 row_mask:0xf bank_mask:0x3
    s_nop 1
    v_add_f32_dpp v49, v57, v57 row_ror:8 row_mask:0xf bank_mask:0xc
    v_add_f32_dpp v42, v42, v42 row_shl:4 row_mask:0xf bank_mask:0x5
    s_nop 1
    v_add_f32_dpp v42, v46, v46 row_shr:4 row_mask:0xf bank_mask:0xa
    v_add_f32_dpp v43, v43, v43 row_shl:4 row_mask:0xf bank_mask:0x5
    s_nop 1
    v_add_f32_dpp v43, v47, v47 row_shr:4 row_mask:0xf bank_mask:0xa
    v_add_f32_dpp v44, v44, v44 row_shl:4 row_mask:0xf bank_mask:0x5
    s_nop 1
    v_add_f32_dpp v44, v48, v48 row_shr:4 row_mask:0xf bank_mask:0xa
    v_add_f32_dpp v45, v45, v45 row_shl:4 row_mask:0xf bank_mask:0x5
    s_nop 1
    v_add_f32_dpp v45, v49, v49 row_shr:4 row_mask:0xf bank_mask:0xa
    v_add_f32_dpp v42, v42, v42 quad_perm:[2,3,0,1] row_mask:0xf bank_mask:0xf
    v_add_f32_dpp v43, v43, v43 quad_perm:[2,3,0,1] row_mask:0xf bank_mask:0xf
    v_add_f32_dpp v44, v44, v44 quad_perm:[2,3,0,1] row_mask:0xf bank_mask:0xf
    v_add_f32_dpp v45, v45, v45 quad_perm:[2,3,0,1] row_mask:0xf bank_mask:0xf
    v_cndmask_b32 v42, v42, v44, s[76:77]
    v_cndmask_b32 v43, v43, v45, s[76:77]
    s_nop 0
    v_add_f32_dpp v42, v42, v42 quad_perm:[1,0,3,2] row_mask:0xf bank_mask:0xf
    v_add_f32_dpp v43, v43, v43 quad_perm:[1,0,3,2] row_mask:0xf bank_mask:0xf
    v_cndmask_b32 v42, v42, v43, s[78:79]
    v_cvt_pk_bf16_f32 v42, 0, v42
    v_mul_f32 v42, 0x3db504f3, v42
    v_cvt_pk_bf16_f32 v28, 0, v42
    s_waitcnt vmcnt(5)
    v_dot2_f32_bf16 v42, v64, v6, 0
    v_dot2_f32_bf16 v42, v65, v7, v42
    v_dot2_f32_bf16 v42, v66, v8, v42
    v_dot2_f32_bf16 v42, v67, v9, v42
    buffer_load_dwordx4 v[88:91], v1, s[32:35], s70 offen nt
    s_add_u32 s70, s70, 0x1000
    buffer_load_dwordx4 v[128:131], v3, s[44:47], s72 offen
    s_add_u32 s72, s72, 0x1000
    s_and_b32 s72, s72, 0x1ffff
    s_waitcnt vmcnt(6)
    v_dot2_f32_bf16 v43, v68, v6, 0
    v_dot2_f32_bf16 v43, v69, v7, v43
    v_dot2_f32_bf16 v43, v70, v8, v43
    v_dot2_f32_bf16 v43, v71, v9, v43
    buffer_load_dwordx4 v[92:95], v1, s[32:35], s70 offen nt
    s_add_u32 s70, s70, 0x9000
    s_waitcnt vmcnt(6)
    v_dot2_f32_bf16 v44, v72, v6, 0
    v_dot2_f32_bf16 v44, v73, v7, v44
    v_dot2_f32_bf16 v44, v74, v8, v44
    v_dot2_f32_bf16 v44, v75, v9, v44
    buffer_load_dwordx4 v[96:99], v1, s[32:35], s70 offen nt
    s_add_u32 s70, s70, 0x1000
    buffer_load_dwordx4 v[132:135], v3, s[44:47], s72 offen
    s_add_u32 s72, s72, 0x1000
    s_and_b32 s72, s72, 0x1ffff
    s_waitcnt vmcnt(7)
    v_dot2_f32_bf16 v45, v76, v6, 0
    v_dot2_f32_bf16 v45, v77, v7, v45
    v_dot2_f32_bf16 v45, v78, v8, v45
    v_dot2_f32_bf16 v45, v79, v9, v45
    buffer_load_dwordx4 v[100:103], v1, s[32:35], s70 offen nt
    s_add_u32 s70, s70, 0x1000
    s_waitcnt vmcnt(7)
    v_dot2_f32_bf16 v46, v80, v6, 0
    v_dot2_f32_bf16 v46, v81, v7, v46
    v_dot2_f32_bf16 v46, v82, v8, v46
    v_dot2_f32_bf16 v46, v83, v9, v46
    buffer_load_dwordx4 v[104:107], v1, s[32:35], s70 offen nt
    s_add_u32 s70, s70, 0x1000
    buffer_load_dwordx4 v[136:139], v3, s[44:47], s72 offen
    s_add_u32 s72, s72, 0x1000
    s_and_b32 s72, s72, 0x1ffff
    s_waitcnt vmcnt(8)
    v_dot2_f32_bf16 v47, v84, v6, 0
    v_dot2_f32_bf16 v47, v85, v7, v47
    v_dot2_f32_bf16 v47, v86, v8, v47
    v_dot2_f32_bf16 v47, v87, v9, v47
    buffer_load_dwordx4 v[108:111], v1, s[32:35], s70 offen nt
    s_add_u32 s70, s70, 0x1000
    s_waitcnt vmcnt(8)
    v_dot2_f32_bf16 v48, v88, v6, 0
    v_dot2_f32_bf16 v48, v89, v7, v48
    v_dot2_f32_bf16 v48, v90, v8, v48
    v_dot2_f32_bf16 v48, v91, v9, v48
    buffer_load_dwordx4 v[112:115], v1, s[32:35], s70 offen nt
    s_add_u32 s70, s70, 0x1000
    buffer_load_dwordx4 v[140:143], v3, s[44:47], s72 offen
    s_add_u32 s72, s72, 0x1000
    s_and_b32 s72, s72, 0x1ffff
    s_waitcnt vmcnt(8)
    v_dot2_f32_bf16 v49, v92, v6, 0
    v_dot2_f32_bf16 v49, v93, v7, v49
    v_dot2_f32_bf16 v49, v94, v8, v49
    v_dot2_f32_bf16 v49, v95, v9, v49
    buffer_load_dwordx4 v[116:119], v1, s[32:35], s70 offen nt
    s_add_u32 s70, s70, 0x1000
    s_waitcnt vmcnt(8)
    v_dot2_f32_bf16 v50, v96, v6, 0
    v_dot2_f32_bf16 v50, v97, v7, v50
    v_dot2_f32_bf16 v50, v98, v8, v50
    v_dot2_f32_bf16 v50, v99, v9, v50
    buffer_load_dwordx4 v[120:123], v1, s[32:35], s70 offen nt
    s_add_u32 s70, s70, 0x1000
    buffer_load_dwordx4 v[144:147], v3, s[44:47], s72 offen
    s_add_u32 s72, s72, 0x1000
    s_and_b32 s72, s72, 0x1ffff
    s_waitcnt vmcnt(8)
    v_dot2_f32_bf16 v51, v100, v6, 0
    v_dot2_f32_bf16 v51, v101, v7, v51
    v_dot2_f32_bf16 v51, v102, v8, v51
    v_dot2_f32_bf16 v51, v103, v9, v51
    buffer_load_dwordx4 v[124:127], v1, s[32:35], s70 offen nt
    s_add_u32 s70, s70, 0x9000
    s_waitcnt vmcnt(8)
    v_dot2_f32_bf16 v52, v104, v6, 0
    v_dot2_f32_bf16 v52, v105, v7, v52
    v_dot2_f32_bf16 v52, v106, v8, v52
    v_dot2_f32_bf16 v52, v107, v9, v52
    buffer_load_dwordx4 v[64:67], v1, s[32:35], s70 offen nt
    s_add_u32 s70, s70, 0x1000
    buffer_load_dwordx4 v[148:151], v3, s[44:47], s72 offen
    s_add_u32 s72, s72, 0x1000
    s_and_b32 s72, s72, 0x1ffff
    s_waitcnt vmcnt(8)
    v_dot2_f32_bf16 v53, v108, v6, 0
    v_dot2_f32_bf16 v53, v109, v7, v53
    v_dot2_f32_bf16 v53, v110, v8, v53
    v_dot2_f32_bf16 v53, v111, v9, v53
    buffer_load_dwordx4 v[68:71], v1, s[32:35], s70 offen nt
    s_add_u32 s70, s70, 0x1000
    s_waitcnt vmcnt(8)
    v_dot2_f32_bf16 v54, v112, v6, 0
    v_dot2_f32_bf16 v54, v113, v7, v54
    v_dot2_f32_bf16 v54, v114, v8, v54
    v_dot2_f32_bf16 v54, v115, v9, v54
    buffer_load_dwordx4 v[72:75], v1, s[32:35], s70 offen nt
    s_add_u32 s70, s70, 0x1000
    buffer_load_dwordx4 v[152:155], v3, s[44:47], s72 offen
    s_add_u32 s72, s72, 0x1000
    s_and_b32 s72, s72, 0x1ffff
    s_waitcnt vmcnt(8)
    v_dot2_f32_bf16 v55, v116, v6, 0
    v_dot2_f32_bf16 v55, v117, v7, v55
    v_dot2_f32_bf16 v55, v118, v8, v55
    v_dot2_f32_bf16 v55, v119, v9, v55
    buffer_load_dwordx4 v[76:79], v1, s[32:35], s70 offen nt
    s_add_u32 s70, s70, 0x1000
    s_waitcnt vmcnt(8)
    v_dot2_f32_bf16 v56, v120, v6, 0
    v_dot2_f32_bf16 v56, v121, v7, v56
    v_dot2_f32_bf16 v56, v122, v8, v56
    v_dot2_f32_bf16 v56, v123, v9, v56
    buffer_load_dwordx4 v[80:83], v1, s[32:35], s70 offen nt
    s_add_u32 s70, s70, 0x1000
    buffer_load_dwordx4 v[156:159], v3, s[44:47], s72 offen
    s_add_u32 s72, s72, 0x1000
    s_and_b32 s72, s72, 0x1ffff
    s_waitcnt vmcnt(8)
    v_dot2_f32_bf16 v57, v124, v6, 0
    v_dot2_f32_bf16 v57, v125, v7, v57
    v_dot2_f32_bf16 v57, v126, v8, v57
    v_dot2_f32_bf16 v57, v127, v9, v57
    buffer_load_dwordx4 v[84:87], v1, s[32:35], s70 offen nt
    s_add_u32 s70, s70, 0x1000
    v_add_f32_dpp v42, v42, v42 row_ror:8 row_mask:0xf bank_mask:0x3
    s_nop 1
    v_add_f32_dpp v42, v50, v50 row_ror:8 row_mask:0xf bank_mask:0xc
    v_add_f32_dpp v43, v43, v43 row_ror:8 row_mask:0xf bank_mask:0x3
    s_nop 1
    v_add_f32_dpp v43, v51, v51 row_ror:8 row_mask:0xf bank_mask:0xc
    v_add_f32_dpp v44, v44, v44 row_ror:8 row_mask:0xf bank_mask:0x3
    s_nop 1
    v_add_f32_dpp v44, v52, v52 row_ror:8 row_mask:0xf bank_mask:0xc
    v_add_f32_dpp v45, v45, v45 row_ror:8 row_mask:0xf bank_mask:0x3
    s_nop 1
    v_add_f32_dpp v45, v53, v53 row_ror:8 row_mask:0xf bank_mask:0xc
    v_add_f32_dpp v46, v46, v46 row_ror:8 row_mask:0xf bank_mask:0x3
    s_nop 1
    v_add_f32_dpp v46, v54, v54 row_ror:8 row_mask:0xf bank_mask:0xc
    v_add_f32_dpp v47, v47, v47 row_ror:8 row_mask:0xf bank_mask:0x3
    s_nop 1
    v_add_f32_dpp v47, v55, v55 row_ror:8 row_mask:0xf bank_mask:0xc
    v_add_f32_dpp v48, v48, v48 row_ror:8 row_mask:0xf bank_mask:0x3
    s_nop 1
    v_add_f32_dpp v48, v56, v56 row_ror:8 row_mask:0xf bank_mask:0xc
    v_add_f32_dpp v49, v49, v49 row_ror:8 row_mask:0xf bank_mask:0x3
    s_nop 1
    v_add_f32_dpp v49, v57, v57 row_ror:8 row_mask:0xf bank_mask:0xc
    v_add_f32_dpp v42, v42, v42 row_shl:4 row_mask:0xf bank_mask:0x5
    s_nop 1
    v_add_f32_dpp v42, v46, v46 row_shr:4 row_mask:0xf bank_mask:0xa
    v_add_f32_dpp v43, v43, v43 row_shl:4 row_mask:0xf bank_mask:0x5
    s_nop 1
    v_add_f32_dpp v43, v47, v47 row_shr:4 row_mask:0xf bank_mask:0xa
    v_add_f32_dpp v44, v44, v44 row_shl:4 row_mask:0xf bank_mask:0x5
    s_nop 1
    v_add_f32_dpp v44, v48, v48 row_shr:4 row_mask:0xf bank_mask:0xa
    v_add_f32_dpp v45, v45, v45 row_shl:4 row_mask:0xf bank_mask:0x5
    s_nop 1
    v_add_f32_dpp v45, v49, v49 row_shr:4 row_mask:0xf bank_mask:0xa
    v_add_f32_dpp v42, v42, v42 quad_perm:[2,3,0,1] row_mask:0xf bank_mask:0xf
    v_add_f32_dpp v43, v43, v43 quad_perm:[2,3,0,1] row_mask:0xf bank_mask:0xf
    v_add_f32_dpp v44, v44, v44 quad_perm:[2,3,0,1] row_mask:0xf bank_mask:0xf
    v_add_f32_dpp v45, v45, v45 quad_perm:[2,3,0,1] row_mask:0xf bank_mask:0xf
    v_cndmask_b32 v42, v42, v44, s[76:77]
    v_cndmask_b32 v43, v43, v45, s[76:77]
    s_nop 0
    v_add_f32_dpp v42, v42, v42 quad_perm:[1,0,3,2] row_mask:0xf bank_mask:0xf
    v_add_f32_dpp v43, v43, v43 quad_perm:[1,0,3,2] row_mask:0xf bank_mask:0xf
    v_cndmask_b32 v42, v42, v43, s[78:79]
    v_cvt_pk_bf16_f32 v42, 0, v42
    v_mul_f32 v42, 0x3db504f3, v42
    v_cvt_pk_bf16_f32 v29, 0, v42
    s_waitcnt vmcnt(8)
    v_dot2_f32_bf16 v42, v64, v6, 0
    v_dot2_f32_bf16 v42, v65, v7, v42
    v_dot2_f32_bf16 v42, v66, v8, v42
    v_dot2_f32_bf16 v42, v67, v9, v42
    buffer_load_dwordx4 v[88:91], v1, s[32:35], s70 offen nt
    s_add_u32 s70, s70, 0x1000
    buffer_load_dwordx4 v[160:163], v3, s[44:47], s72 offen
    s_add_u32 s72, s72, 0x1000
    s_and_b32 s72, s72, 0x1ffff
    s_waitcnt vmcnt(8)
    v_dot2_f32_bf16 v43, v68, v6, 0
    v_dot2_f32_bf16 v43, v69, v7, v43
    v_dot2_f32_bf16 v43, v70, v8, v43
    v_dot2_f32_bf16 v43, v71, v9, v43
    buffer_load_dwordx4 v[92:95], v1, s[32:35], s70 offen nt
    s_add_u32 s70, s70, 0x9000
    s_waitcnt vmcnt(8)
    v_dot2_f32_bf16 v44, v72, v6, 0
    v_dot2_f32_bf16 v44, v73, v7, v44
    v_dot2_f32_bf16 v44, v74, v8, v44
    v_dot2_f32_bf16 v44, v75, v9, v44
    buffer_load_dwordx4 v[96:99], v1, s[32:35], s70 offen nt
    s_add_u32 s70, s70, 0x1000
    buffer_load_dwordx4 v[164:167], v3, s[44:47], s72 offen
    s_add_u32 s72, s72, 0x1000
    s_and_b32 s72, s72, 0x1ffff
    s_waitcnt vmcnt(8)
    v_dot2_f32_bf16 v45, v76, v6, 0
    v_dot2_f32_bf16 v45, v77, v7, v45
    v_dot2_f32_bf16 v45, v78, v8, v45
    v_dot2_f32_bf16 v45, v79, v9, v45
    buffer_load_dwordx4 v[100:103], v1, s[32:35], s70 offen nt
    s_add_u32 s70, s70, 0x1000
    s_waitcnt vmcnt(8)
    v_dot2_f32_bf16 v46, v80, v6, 0
    v_dot2_f32_bf16 v46, v81, v7, v46
    v_dot2_f32_bf16 v46, v82, v8, v46
    v_dot2_f32_bf16 v46, v83, v9, v46
    buffer_load_dwordx4 v[104:107], v1, s[32:35], s70 offen nt
    s_add_u32 s70, s70, 0x1000
    buffer_load_dwordx4 v[168:171], v3, s[44:47], s72 offen
    s_add_u32 s72, s72, 0x1000
    s_and_b32 s72, s72, 0x1ffff
    s_waitcnt vmcnt(8)
    v_dot2_f32_bf16 v47, v84, v6, 0
    v_dot2_f32_bf16 v47, v85, v7, v47
    v_dot2_f32_bf16 v47, v86, v8, v47
    v_dot2_f32_bf16 v47, v87, v9, v47
    buffer_load_dwordx4 v[108:111], v1, s[32:35], s70 offen nt
    s_add_u32 s70, s70, 0x1000
    s_waitcnt vmcnt(8)
    v_dot2_f32_bf16 v48, v88, v6, 0
    v_dot2_f32_bf16 v48, v89, v7, v48
    v_dot2_f32_bf16 v48, v90, v8, v48
    v_dot2_f32_bf16 v48, v91, v9, v48
    buffer_load_dwordx4 v[112:115], v1, s[32:35], s70 offen nt
    s_add_u32 s70, s70, 0x1000
    buffer_load_dwordx4 v[172:175], v3, s[44:47], s72 offen
    s_add_u32 s72, s72, 0x1000
    s_and_b32 s72, s72, 0x1ffff
    s_waitcnt vmcnt(8)
    v_dot2_f32_bf16 v49, v92, v6, 0
    v_dot2_f32_bf16 v49, v93, v7, v49
    v_dot2_f32_bf16 v49, v94, v8, v49
    v_dot2_f32_bf16 v49, v95, v9, v49
    buffer_load_dwordx4 v[116:119], v1, s[32:35], s70 offen nt
    s_add_u32 s70, s70, 0x1000
    s_waitcnt vmcnt(8)
    v_dot2_f32_bf16 v50, v96, v6, 0
    v_dot2_f32_bf16 v50, v97, v7, v50
    v_dot2_f32_bf16 v50, v98, v8, v50
    v_dot2_f32_bf16 v50, v99, v9, v50
    buffer_load_dwordx4 v[120:123], v1, s[32:35], s70 offen nt
    s_add_u32 s70, s70, 0x1000
    buffer_load_dwordx4 v[176:179], v3, s[44:47], s72 offen
    s_add_u32 s72, s72, 0x1000
    s_and_b32 s72, s72, 0x1ffff
    s_waitcnt vmcnt(8)
    v_dot2_f32_bf16 v51, v100, v6, 0
    v_dot2_f32_bf16 v51, v101, v7, v51
    v_dot2_f32_bf16 v51, v102, v8, v51
    v_dot2_f32_bf16 v51, v103, v9, v51
    buffer_load_dwordx4 v[124:127], v1, s[32:35], s70 offen nt
    s_add_u32 s70, s70, 0x9000
    s_waitcnt vmcnt(8)
    v_dot2_f32_bf16 v52, v104, v6, 0
    v_dot2_f32_bf16 v52, v105, v7, v52
    v_dot2_f32_bf16 v52, v106, v8, v52
    v_dot2_f32_bf16 v52, v107, v9, v52
    buffer_load_dwordx4 v[64:67], v1, s[32:35], s70 offen nt
    s_add_u32 s70, s70, 0x1000
    buffer_load_dwordx4 v[180:183], v3, s[44:47], s72 offen
    s_add_u32 s72, s72, 0x1000
    s_and_b32 s72, s72, 0x1ffff
    s_waitcnt vmcnt(8)
    v_dot2_f32_bf16 v53, v108, v6, 0
    v_dot2_f32_bf16 v53, v109, v7, v53
    v_dot2_f32_bf16 v53, v110, v8, v53
    v_dot2_f32_bf16 v53, v111, v9, v53
    buffer_load_dwordx4 v[68:71], v1, s[32:35], s70 offen nt
    s_add_u32 s70, s70, 0x1000
    s_waitcnt vmcnt(8)
    v_dot2_f32_bf16 v54, v112, v6, 0
    v_dot2_f32_bf16 v54, v113, v7, v54
    v_dot2_f32_bf16 v54, v114, v8, v54
    v_dot2_f32_bf16 v54, v115, v9, v54
    buffer_load_dwordx4 v[72:75], v1, s[32:35], s70 offen nt
    s_add_u32 s70, s70, 0x1000
    buffer_load_dwordx4 v[184:187], v3, s[44:47], s72 offen
    s_add_u32 s72, s72, 0x1000
    s_and_b32 s72, s72, 0x1ffff
    s_waitcnt vmcnt(8)
    v_dot2_f32_bf16 v55, v116, v6, 0
    v_dot2_f32_bf16 v55, v117, v7, v55
    v_dot2_f32_bf16 v55, v118, v8, v55
    v_dot2_f32_bf16 v55, v119, v9, v55
    buffer_load_dwordx4 v[76:79], v1, s[32:35], s70 offen nt
    s_add_u32 s70, s70, 0x1000
    s_waitcnt vmcnt(8)
    v_dot2_f32_bf16 v56, v120, v6, 0
    v_dot2_f32_bf16 v56, v121, v7, v56
    v_dot2_f32_bf16 v56, v122, v8, v56
    v_dot2_f32_bf16 v56, v123, v9, v56
    buffer_load_dwordx4 v[80:83], v1, s[32:35], s70 offen nt
    s_add_u32 s70, s70, 0x1000
    buffer_load_dwordx4 v[188:191], v3, s[44:47], s72 offen
    s_add_u32 s72, s72, 0x1000
    s_and_b32 s72, s72, 0x1ffff
    s_waitcnt vmcnt(8)
    v_dot2_f32_bf16 v57, v124, v6, 0
    v_dot2_f32_bf16 v57, v125, v7, v57
    v_dot2_f32_bf16 v57, v126, v8, v57
    v_dot2_f32_bf16 v57, v127, v9, v57
    buffer_load_dwordx4 v[84:87], v1, s[32:35], s70 offen nt
    s_add_u32 s70, s70, 0x1000
    v_add_f32_dpp v42, v42, v42 row_ror:8 row_mask:0xf bank_mask:0x3
    s_nop 1
    v_add_f32_dpp v42, v50, v50 row_ror:8 row_mask:0xf bank_mask:0xc
    v_add_f32_dpp v43, v43, v43 row_ror:8 row_mask:0xf bank_mask:0x3
    s_nop 1
    v_add_f32_dpp v43, v51, v51 row_ror:8 row_mask:0xf bank_mask:0xc
    v_add_f32_dpp v44, v44, v44 row_ror:8 row_mask:0xf bank_mask:0x3
    s_nop 1
    v_add_f32_dpp v44, v52, v52 row_ror:8 row_mask:0xf bank_mask:0xc
    v_add_f32_dpp v45, v45, v45 row_ror:8 row_mask:0xf bank_mask:0x3
    s_nop 1
    v_add_f32_dpp v45, v53, v53 row_ror:8 row_mask:0xf bank_mask:0xc
    v_add_f32_dpp v46, v46, v46 row_ror:8 row_mask:0xf bank_mask:0x3
    s_nop 1
    v_add_f32_dpp v46, v54, v54 row_ror:8 row_mask:0xf bank_mask:0xc
    v_add_f32_dpp v47, v47, v47 row_ror:8 row_mask:0xf bank_mask:0x3
    s_nop 1
    v_add_f32_dpp v47, v55, v55 row_ror:8 row_mask:0xf bank_mask:0xc
    v_add_f32_dpp v48, v48, v48 row_ror:8 row_mask:0xf bank_mask:0x3
    s_nop 1
    v_add_f32_dpp v48, v56, v56 row_ror:8 row_mask:0xf bank_mask:0xc
    v_add_f32_dpp v49, v49, v49 row_ror:8 row_mask:0xf bank_mask:0x3
    s_nop 1
    v_add_f32_dpp v49, v57, v57 row_ror:8 row_mask:0xf bank_mask:0xc
    v_add_f32_dpp v42, v42, v42 row_shl:4 row_mask:0xf bank_mask:0x5
    s_nop 1
    v_add_f32_dpp v42, v46, v46 row_shr:4 row_mask:0xf bank_mask:0xa
    v_add_f32_dpp v43, v43, v43 row_shl:4 row_mask:0xf bank_mask:0x5
    s_nop 1
    v_add_f32_dpp v43, v47, v47 row_shr:4 row_mask:0xf bank_mask:0xa
    v_add_f32_dpp v44, v44, v44 row_shl:4 row_mask:0xf bank_mask:0x5
    s_nop 1
    v_add_f32_dpp v44, v48, v48 row_shr:4 row_mask:0xf bank_mask:0xa
    v_add_f32_dpp v45, v45, v45 row_shl:4 row_mask:0xf bank_mask:0x5
    s_nop 1
    v_add_f32_dpp v45, v49, v49 row_shr:4 row_mask:0xf bank_mask:0xa
    v_add_f32_dpp v42, v42, v42 quad_perm:[2,3,0,1] row_mask:0xf bank_mask:0xf
    v_add_f32_dpp v43, v43, v43 quad_perm:[2,3,0,1] row_mask:0xf bank_mask:0xf
    v_add_f32_dpp v44, v44, v44 quad_perm:[2,3,0,1] row_mask:0xf bank_mask:0xf
    v_add_f32_dpp v45, v45, v45 quad_perm:[2,3,0,1] row_mask:0xf bank_mask:0xf
    v_cndmask_b32 v42, v42, v44, s[76:77]
    v_cndmask_b32 v43, v43, v45, s[76:77]
    s_nop 0
    v_add_f32_dpp v42, v42, v42 quad_perm:[1,0,3,2] row_mask:0xf bank_mask:0xf
    v_add_f32_dpp v43, v43, v43 quad_perm:[1,0,3,2] row_mask:0xf bank_mask:0xf
    v_cndmask_b32 v42, v42, v43, s[78:79]
    v_cvt_pk_bf16_f32 v42, 0, v42
    v_mul_f32 v42, 0x3db504f3, v42
    v_cvt_pk_bf16_f32 v30, 0, v42
    s_waitcnt vmcnt(8)
    v_dot2_f32_bf16 v42, v64, v6, 0
    v_dot2_f32_bf16 v42, v65, v7, v42
    v_dot2_f32_bf16 v42, v66, v8, v42
    v_dot2_f32_bf16 v42, v67, v9, v42
    buffer_load_dwordx4 v[88:91], v1, s[32:35], s70 offen nt
    s_add_u32 s70, s70, 0x1000
    buffer_load_dwordx4 v[192:195], v3, s[44:47], s72 offen
    s_add_u32 s72, s72, 0x1000
    s_and_b32 s72, s72, 0x1ffff
    s_waitcnt vmcnt(8)
    v_dot2_f32_bf16 v43, v68, v6, 0
    v_dot2_f32_bf16 v43, v69, v7, v43
    v_dot2_f32_bf16 v43, v70, v8, v43
    v_dot2_f32_bf16 v43, v71, v9, v43
    buffer_load_dwordx4 v[92:95], v1, s[32:35], s70 offen nt
    s_add_u32 s70, s70, 0x9000
    s_waitcnt vmcnt(8)
    v_dot2_f32_bf16 v44, v72, v6, 0
    v_dot2_f32_bf16 v44, v73, v7, v44
    v_dot2_f32_bf16 v44, v74, v8, v44
    v_dot2_f32_bf16 v44, v75, v9, v44
    buffer_load_dwordx4 v[96:99], v1, s[32:35], s70 offen nt
    s_add_u32 s70, s70, 0x1000
    buffer_load_dwordx4 v[196:199], v3, s[44:47], s72 offen
    s_add_u32 s72, s72, 0x1000
    s_and_b32 s72, s72, 0x1ffff
    s_waitcnt vmcnt(8)
    v_dot2_f32_bf16 v45, v76, v6, 0
    v_dot2_f32_bf16 v45, v77, v7, v45
    v_dot2_f32_bf16 v45, v78, v8, v45
    v_dot2_f32_bf16 v45, v79, v9, v45
    buffer_load_dwordx4 v[100:103], v1, s[32:35], s70 offen nt
    s_add_u32 s70, s70, 0x1000
    s_waitcnt vmcnt(8)
    v_dot2_f32_bf16 v46, v80, v6, 0
    v_dot2_f32_bf16 v46, v81, v7, v46
    v_dot2_f32_bf16 v46, v82, v8, v46
    v_dot2_f32_bf16 v46, v83, v9, v46
    buffer_load_dwordx4 v[104:107], v1, s[32:35], s70 offen nt
    s_add_u32 s70, s70, 0x1000
    buffer_load_dwordx4 v[200:203], v3, s[44:47], s72 offen
    s_add_u32 s72, s72, 0x1000
    s_and_b32 s72, s72, 0x1ffff
    s_waitcnt vmcnt(8)
    v_dot2_f32_bf16 v47, v84, v6, 0
    v_dot2_f32_bf16 v47, v85, v7, v47
    v_dot2_f32_bf16 v47, v86, v8, v47
    v_dot2_f32_bf16 v47, v87, v9, v47
    buffer_load_dwordx4 v[108:111], v1, s[32:35], s70 offen nt
    s_add_u32 s70, s70, 0x1000
    s_waitcnt vmcnt(8)
    v_dot2_f32_bf16 v48, v88, v6, 0
    v_dot2_f32_bf16 v48, v89, v7, v48
    v_dot2_f32_bf16 v48, v90, v8, v48
    v_dot2_f32_bf16 v48, v91, v9, v48
    buffer_load_dwordx4 v[112:115], v1, s[32:35], s70 offen nt
    s_add_u32 s70, s70, 0x1000
    buffer_load_dwordx4 v[204:207], v3, s[44:47], s72 offen
    s_add_u32 s72, s72, 0x1000
    s_and_b32 s72, s72, 0x1ffff
    s_waitcnt vmcnt(8)
    v_dot2_f32_bf16 v49, v92, v6, 0
    v_dot2_f32_bf16 v49, v93, v7, v49
    v_dot2_f32_bf16 v49, v94, v8, v49
    v_dot2_f32_bf16 v49, v95, v9, v49
    buffer_load_dwordx4 v[116:119], v1, s[32:35], s70 offen nt
    s_add_u32 s70, s70, 0x1000
    s_waitcnt vmcnt(8)
    v_dot2_f32_bf16 v50, v96, v6, 0
    v_dot2_f32_bf16 v50, v97, v7, v50
    v_dot2_f32_bf16 v50, v98, v8, v50
    v_dot2_f32_bf16 v50, v99, v9, v50
    buffer_load_dwordx4 v[120:123], v1, s[32:35], s70 offen nt
    s_add_u32 s70, s70, 0x1000
    buffer_load_dwordx4 v[208:211], v3, s[44:47], s72 offen
    s_add_u32 s72, s72, 0x1000
    s_and_b32 s72, s72, 0x1ffff
    s_waitcnt vmcnt(8)
    v_dot2_f32_bf16 v51, v100, v6, 0
    v_dot2_f32_bf16 v51, v101, v7, v51
    v_dot2_f32_bf16 v51, v102, v8, v51
    v_dot2_f32_bf16 v51, v103, v9, v51
    buffer_load_dwordx4 v[124:127], v1, s[32:35], s70 offen nt
    s_add_u32 s70, s70, 0x9000
    s_waitcnt vmcnt(8)
    v_dot2_f32_bf16 v52, v104, v6, 0
    v_dot2_f32_bf16 v52, v105, v7, v52
    v_dot2_f32_bf16 v52, v106, v8, v52
    v_dot2_f32_bf16 v52, v107, v9, v52
    buffer_load_dwordx4 v[64:67], v1, s[32:35], s70 offen nt
    s_add_u32 s70, s70, 0x1000
    buffer_load_dwordx4 v[212:215], v3, s[44:47], s72 offen
    s_add_u32 s72, s72, 0x1000
    s_and_b32 s72, s72, 0x1ffff
    s_waitcnt vmcnt(8)
    v_dot2_f32_bf16 v53, v108, v6, 0
    v_dot2_f32_bf16 v53, v109, v7, v53
    v_dot2_f32_bf16 v53, v110, v8, v53
    v_dot2_f32_bf16 v53, v111, v9, v53
    buffer_load_dwordx4 v[68:71], v1, s[32:35], s70 offen nt
    s_add_u32 s70, s70, 0x1000
    s_waitcnt vmcnt(8)
    v_dot2_f32_bf16 v54, v112, v6, 0
    v_dot2_f32_bf16 v54, v113, v7, v54
    v_dot2_f32_bf16 v54, v114, v8, v54
    v_dot2_f32_bf16 v54, v115, v9, v54
    buffer_load_dwordx4 v[72:75], v1, s[32:35], s70 offen nt
    s_add_u32 s70, s70, 0x1000
    buffer_load_dwordx4 v[216:219], v3, s[44:47], s72 offen
    s_add_u32 s72, s72, 0x1000
    s_and_b32 s72, s72, 0x1ffff
    s_waitcnt vmcnt(8)
    v_dot2_f32_bf16 v55, v116, v6, 0
    v_dot2_f32_bf16 v55, v117, v7, v55
    v_dot2_f32_bf16 v55, v118, v8, v55
    v_dot2_f32_bf16 v55, v119, v9, v55
    buffer_load_dwordx4 v[76:79], v1, s[32:35], s70 offen nt
    s_add_u32 s70, s70, 0x1000
    s_waitcnt vmcnt(8)
    v_dot2_f32_bf16 v56, v120, v6, 0
    v_dot2_f32_bf16 v56, v121, v7, v56
    v_dot2_f32_bf16 v56, v122, v8, v56
    v_dot2_f32_bf16 v56, v123, v9, v56
    buffer_load_dwordx4 v[80:83], v1, s[32:35], s70 offen nt
    s_add_u32 s70, s70, 0x1000
    buffer_load_dwordx4 v[220:223], v3, s[44:47], s72 offen
    s_add_u32 s72, s72, 0x1000
    s_and_b32 s72, s72, 0x1ffff
    s_waitcnt vmcnt(8)
    v_dot2_f32_bf16 v57, v124, v6, 0
    v_dot2_f32_bf16 v57, v125, v7, v57
    v_dot2_f32_bf16 v57, v126, v8, v57
    v_dot2_f32_bf16 v57, v127, v9, v57
    buffer_load_dwordx4 v[84:87], v1, s[32:35], s70 offen nt
    s_add_u32 s70, s70, 0x1000
    v_add_f32_dpp v42, v42, v42 row_ror:8 row_mask:0xf bank_mask:0x3
    s_nop 1
    v_add_f32_dpp v42, v50, v50 row_ror:8 row_mask:0xf bank_mask:0xc
    v_add_f32_dpp v43, v43, v43 row_ror:8 row_mask:0xf bank_mask:0x3
    s_nop 1
    v_add_f32_dpp v43, v51, v51 row_ror:8 row_mask:0xf bank_mask:0xc
    v_add_f32_dpp v44, v44, v44 row_ror:8 row_mask:0xf bank_mask:0x3
    s_nop 1
    v_add_f32_dpp v44, v52, v52 row_ror:8 row_mask:0xf bank_mask:0xc
    v_add_f32_dpp v45, v45, v45 row_ror:8 row_mask:0xf bank_mask:0x3
    s_nop 1
    v_add_f32_dpp v45, v53, v53 row_ror:8 row_mask:0xf bank_mask:0xc
    v_add_f32_dpp v46, v46, v46 row_ror:8 row_mask:0xf bank_mask:0x3
    s_nop 1
    v_add_f32_dpp v46, v54, v54 row_ror:8 row_mask:0xf bank_mask:0xc
    v_add_f32_dpp v47, v47, v47 row_ror:8 row_mask:0xf bank_mask:0x3
    s_nop 1
    v_add_f32_dpp v47, v55, v55 row_ror:8 row_mask:0xf bank_mask:0xc
    v_add_f32_dpp v48, v48, v48 row_ror:8 row_mask:0xf bank_mask:0x3
    s_nop 1
    v_add_f32_dpp v48, v56, v56 row_ror:8 row_mask:0xf bank_mask:0xc
    v_add_f32_dpp v49, v49, v49 row_ror:8 row_mask:0xf bank_mask:0x3
    s_nop 1
    v_add_f32_dpp v49, v57, v57 row_ror:8 row_mask:0xf bank_mask:0xc
    v_add_f32_dpp v42, v42, v42 row_shl:4 row_mask:0xf bank_mask:0x5
    s_nop 1
    v_add_f32_dpp v42, v46, v46 row_shr:4 row_mask:0xf bank_mask:0xa
    v_add_f32_dpp v43, v43, v43 row_shl:4 row_mask:0xf bank_mask:0x5
    s_nop 1
    v_add_f32_dpp v43, v47, v47 row_shr:4 row_mask:0xf bank_mask:0xa
    v_add_f32_dpp v44, v44, v44 row_shl:4 row_mask:0xf bank_mask:0x5
    s_nop 1
    v_add_f32_dpp v44, v48, v48 row_shr:4 row_mask:0xf bank_mask:0xa
    v_add_f32_dpp v45, v45, v45 row_shl:4 row_mask:0xf bank_mask:0x5
    s_nop 1
    v_add_f32_dpp v45, v49, v49 row_shr:4 row_mask:0xf bank_mask:0xa
    v_add_f32_dpp v42, v42, v42 quad_perm:[2,3,0,1] row_mask:0xf bank_mask:0xf
    v_add_f32_dpp v43, v43, v43 quad_perm:[2,3,0,1] row_mask:0xf bank_mask:0xf
    v_add_f32_dpp v44, v44, v44 quad_perm:[2,3,0,1] row_mask:0xf bank_mask:0xf
    v_add_f32_dpp v45, v45, v45 quad_perm:[2,3,0,1] row_mask:0xf bank_mask:0xf
    v_cndmask_b32 v42, v42, v44, s[76:77]
    v_cndmask_b32 v43, v43, v45, s[76:77]
    s_nop 0
    v_add_f32_dpp v42, v42, v42 quad_perm:[1,0,3,2] row_mask:0xf bank_mask:0xf
    v_add_f32_dpp v43, v43, v43 quad_perm:[1,0,3,2] row_mask:0xf bank_mask:0xf
    v_cndmask_b32 v42, v42, v43, s[78:79]
    v_cvt_pk_bf16_f32 v42, 0, v42
    v_mul_f32 v42, 0x3db504f3, v42
    v_cvt_pk_bf16_f32 v31, 0, v42
    s_waitcnt vmcnt(8)
    v_dot2_f32_bf16 v42, v64, v6, 0
    v_dot2_f32_bf16 v42, v65, v7, v42
    v_dot2_f32_bf16 v42, v66, v8, v42
    v_dot2_f32_bf16 v42, v67, v9, v42
    buffer_load_dwordx4 v[88:91], v1, s[32:35], s70 offen nt
    s_add_u32 s70, s70, 0x1000
    buffer_load_dwordx4 v[224:227], v3, s[44:47], s72 offen
    s_add_u32 s72, s72, 0x1000
    s_and_b32 s72, s72, 0x1ffff
    s_waitcnt vmcnt(8)
    v_dot2_f32_bf16 v43, v68, v6, 0
    v_dot2_f32_bf16 v43, v69, v7, v43
    v_dot2_f32_bf16 v43, v70, v8, v43
    v_dot2_f32_bf16 v43, v71, v9, v43
    buffer_load_dwordx4 v[92:95], v1, s[32:35], s70 offen nt
    s_add_u32 s70, s70, 0x9000
    s_waitcnt vmcnt(8)
    v_dot2_f32_bf16 v44, v72, v6, 0
    v_dot2_f32_bf16 v44, v73, v7, v44
    v_dot2_f32_bf16 v44, v74, v8, v44
    v_dot2_f32_bf16 v44, v75, v9, v44
    buffer_load_dwordx4 v[96:99], v1, s[32:35], s70 offen nt
    s_add_u32 s70, s70, 0x1000
    buffer_load_dwordx4 v[228:231], v3, s[44:47], s72 offen
    s_add_u32 s72, s72, 0x1000
    s_and_b32 s72, s72, 0x1ffff
    s_waitcnt vmcnt(8)
    v_dot2_f32_bf16 v45, v76, v6, 0
    v_dot2_f32_bf16 v45, v77, v7, v45
    v_dot2_f32_bf16 v45, v78, v8, v45
    v_dot2_f32_bf16 v45, v79, v9, v45
    buffer_load_dwordx4 v[100:103], v1, s[32:35], s70 offen nt
    s_add_u32 s70, s70, 0x1000
    s_waitcnt vmcnt(8)
    v_dot2_f32_bf16 v46, v80, v6, 0
    v_dot2_f32_bf16 v46, v81, v7, v46
    v_dot2_f32_bf16 v46, v82, v8, v46
    v_dot2_f32_bf16 v46, v83, v9, v46
    buffer_load_dwordx4 v[104:107], v1, s[32:35], s70 offen nt
    s_add_u32 s70, s70, 0x1000
    buffer_load_dwordx4 v[232:235], v3, s[44:47], s72 offen
    s_add_u32 s72, s72, 0x1000
    s_and_b32 s72, s72, 0x1ffff
    s_waitcnt vmcnt(8)
    v_dot2_f32_bf16 v47, v84, v6, 0
    v_dot2_f32_bf16 v47, v85, v7, v47
    v_dot2_f32_bf16 v47, v86, v8, v47
    v_dot2_f32_bf16 v47, v87, v9, v47
    buffer_load_dwordx4 v[108:111], v1, s[32:35], s70 offen nt
    s_add_u32 s70, s70, 0x1000
    s_waitcnt vmcnt(8)
    v_dot2_f32_bf16 v48, v88, v6, 0
    v_dot2_f32_bf16 v48, v89, v7, v48
    v_dot2_f32_bf16 v48, v90, v8, v48
    v_dot2_f32_bf16 v48, v91, v9, v48
    buffer_load_dwordx4 v[112:115], v1, s[32:35], s70 offen nt
    s_add_u32 s70, s70, 0x1000
    buffer_load_dwordx4 v[236:239], v3, s[44:47], s72 offen
    s_add_u32 s72, s72, 0x1000
    s_and_b32 s72, s72, 0x1ffff
    s_waitcnt vmcnt(8)
    v_dot2_f32_bf16 v49, v92, v6, 0
    v_dot2_f32_bf16 v49, v93, v7, v49
    v_dot2_f32_bf16 v49, v94, v8, v49
    v_dot2_f32_bf16 v49, v95, v9, v49
    buffer_load_dwordx4 v[116:119], v1, s[32:35], s70 offen nt
    s_add_u32 s70, s70, 0x1000
    s_waitcnt vmcnt(8)
    v_dot2_f32_bf16 v50, v96, v6, 0
    v_dot2_f32_bf16 v50, v97, v7, v50
    v_dot2_f32_bf16 v50, v98, v8, v50
    v_dot2_f32_bf16 v50, v99, v9, v50
    buffer_load_dwordx4 v[120:123], v1, s[32:35], s70 offen nt
    s_add_u32 s70, s70, 0x1000
    buffer_load_dwordx4 v[240:243], v3, s[44:47], s72 offen
    s_add_u32 s72, s72, 0x1000
    s_and_b32 s72, s72, 0x1ffff
    s_waitcnt vmcnt(8)
    v_dot2_f32_bf16 v51, v100, v6, 0
    v_dot2_f32_bf16 v51, v101, v7, v51
    v_dot2_f32_bf16 v51, v102, v8, v51
    v_dot2_f32_bf16 v51, v103, v9, v51
    buffer_load_dwordx4 v[124:127], v1, s[32:35], s70 offen nt
    s_add_u32 s70, s70, 0x9000
    s_waitcnt vmcnt(8)
    v_dot2_f32_bf16 v52, v104, v6, 0
    v_dot2_f32_bf16 v52, v105, v7, v52
    v_dot2_f32_bf16 v52, v106, v8, v52
    v_dot2_f32_bf16 v52, v107, v9, v52
    buffer_load_dwordx4 v[64:67], v1, s[32:35], s70 offen nt
    s_add_u32 s70, s70, 0x1000
    buffer_load_dwordx4 v[244:247], v3, s[44:47], s72 offen
    s_add_u32 s72, s72, 0x1000
    s_and_b32 s72, s72, 0x1ffff
    s_waitcnt vmcnt(8)
    v_dot2_f32_bf16 v53, v108, v6, 0
    v_dot2_f32_bf16 v53, v109, v7, v53
    v_dot2_f32_bf16 v53, v110, v8, v53
    v_dot2_f32_bf16 v53, v111, v9, v53
    buffer_load_dwordx4 v[68:71], v1, s[32:35], s70 offen nt
    s_add_u32 s70, s70, 0x1000
    s_waitcnt vmcnt(8)
    v_dot2_f32_bf16 v54, v112, v6, 0
    v_dot2_f32_bf16 v54, v113, v7, v54
    v_dot2_f32_bf16 v54, v114, v8, v54
    v_dot2_f32_bf16 v54, v115, v9, v54
    buffer_load_dwordx4 v[72:75], v1, s[32:35], s70 offen nt
    s_add_u32 s70, s70, 0x1000
    buffer_load_dwordx4 v[248:251], v3, s[44:47], s72 offen
    s_add_u32 s72, s72, 0x1000
    s_and_b32 s72, s72, 0x1ffff
    s_waitcnt vmcnt(8)
    v_dot2_f32_bf16 v55, v116, v6, 0
    v_dot2_f32_bf16 v55, v117, v7, v55
    v_dot2_f32_bf16 v55, v118, v8, v55
    v_dot2_f32_bf16 v55, v119, v9, v55
    buffer_load_dwordx4 v[76:79], v1, s[32:35], s70 offen nt
    s_add_u32 s70, s70, 0x1000
    s_waitcnt vmcnt(8)
    v_dot2_f32_bf16 v56, v120, v6, 0
    v_dot2_f32_bf16 v56, v121, v7, v56
    v_dot2_f32_bf16 v56, v122, v8, v56
    v_dot2_f32_bf16 v56, v123, v9, v56
    buffer_load_dwordx4 v[80:83], v1, s[32:35], s70 offen nt
    s_add_u32 s70, s70, 0x1000
    buffer_load_dwordx4 v[252:255], v3, s[44:47], s72 offen
    s_add_u32 s72, s72, 0x1000
    s_and_b32 s72, s72, 0x1ffff
    s_waitcnt vmcnt(8)
    v_dot2_f32_bf16 v57, v124, v6, 0
    v_dot2_f32_bf16 v57, v125, v7, v57
    v_dot2_f32_bf16 v57, v126, v8, v57
    v_dot2_f32_bf16 v57, v127, v9, v57
    buffer_load_dwordx4 v[84:87], v1, s[32:35], s70 offen nt
    s_add_u32 s70, s70, 0x1000
    v_add_f32_dpp v42, v42, v42 row_ror:8 row_mask:0xf bank_mask:0x3
    s_nop 1
    v_add_f32_dpp v42, v50, v50 row_ror:8 row_mask:0xf bank_mask:0xc
    v_add_f32_dpp v43, v43, v43 row_ror:8 row_mask:0xf bank_mask:0x3
    s_nop 1
    v_add_f32_dpp v43, v51, v51 row_ror:8 row_mask:0xf bank_mask:0xc
    v_add_f32_dpp v44, v44, v44 row_ror:8 row_mask:0xf bank_mask:0x3
    s_nop 1
    v_add_f32_dpp v44, v52, v52 row_ror:8 row_mask:0xf bank_mask:0xc
    v_add_f32_dpp v45, v45, v45 row_ror:8 row_mask:0xf bank_mask:0x3
    s_nop 1
    v_add_f32_dpp v45, v53, v53 row_ror:8 row_mask:0xf bank_mask:0xc
    v_add_f32_dpp v46, v46, v46 row_ror:8 row_mask:0xf bank_mask:0x3
    s_nop 1
    v_add_f32_dpp v46, v54, v54 row_ror:8 row_mask:0xf bank_mask:0xc
    v_add_f32_dpp v47, v47, v47 row_ror:8 row_mask:0xf bank_mask:0x3
    s_nop 1
    v_add_f32_dpp v47, v55, v55 row_ror:8 row_mask:0xf bank_mask:0xc
    v_add_f32_dpp v48, v48, v48 row_ror:8 row_mask:0xf bank_mask:0x3
    s_nop 1
    v_add_f32_dpp v48, v56, v56 row_ror:8 row_mask:0xf bank_mask:0xc
    v_add_f32_dpp v49, v49, v49 row_ror:8 row_mask:0xf bank_mask:0x3
    s_nop 1
    v_add_f32_dpp v49, v57, v57 row_ror:8 row_mask:0xf bank_mask:0xc
    v_add_f32_dpp v42, v42, v42 row_shl:4 row_mask:0xf bank_mask:0x5
    s_nop 1
    v_add_f32_dpp v42, v46, v46 row_shr:4 row_mask:0xf bank_mask:0xa
    v_add_f32_dpp v43, v43, v43 row_shl:4 row_mask:0xf bank_mask:0x5
    s_nop 1
    v_add_f32_dpp v43, v47, v47 row_shr:4 row_mask:0xf bank_mask:0xa
    v_add_f32_dpp v44, v44, v44 row_shl:4 row_mask:0xf bank_mask:0x5
    s_nop 1
    v_add_f32_dpp v44, v48, v48 row_shr:4 row_mask:0xf bank_mask:0xa
    v_add_f32_dpp v45, v45, v45 row_shl:4 row_mask:0xf bank_mask:0x5
    s_nop 1
    v_add_f32_dpp v45, v49, v49 row_shr:4 row_mask:0xf bank_mask:0xa
    v_add_f32_dpp v42, v42, v42 quad_perm:[2,3,0,1] row_mask:0xf bank_mask:0xf
    v_add_f32_dpp v43, v43, v43 quad_perm:[2,3,0,1] row_mask:0xf bank_mask:0xf
    v_add_f32_dpp v44, v44, v44 quad_perm:[2,3,0,1] row_mask:0xf bank_mask:0xf
    v_add_f32_dpp v45, v45, v45 quad_perm:[2,3,0,1] row_mask:0xf bank_mask:0xf
    v_cndmask_b32 v42, v42, v44, s[76:77]
    v_cndmask_b32 v43, v43, v45, s[76:77]
    s_nop 0
    v_add_f32_dpp v42, v42, v42 quad_perm:[1,0,3,2] row_mask:0xf bank_mask:0xf
    v_add_f32_dpp v43, v43, v43 quad_perm:[1,0,3,2] row_mask:0xf bank_mask:0xf
    v_cndmask_b32 v42, v42, v43, s[78:79]
    v_cvt_pk_bf16_f32 v42, 0, v42
    v_mul_f32 v42, 0x3db504f3, v42
    v_cvt_pk_bf16_f32 v32, 0, v42
    s_waitcnt vmcnt(8)
    v_dot2_f32_bf16 v42, v64, v6, 0
    v_dot2_f32_bf16 v42, v65, v7, v42
    v_dot2_f32_bf16 v42, v66, v8, v42
    v_dot2_f32_bf16 v42, v67, v9, v42
    buffer_load_dwordx4 v[88:91], v1, s[32:35], s70 offen nt
    s_add_u32 s70, s70, 0x1000
    s_waitcnt vmcnt(7)
    v_dot2_f32_bf16 v43, v68, v6, 0
    v_dot2_f32_bf16 v43, v69, v7, v43
    v_dot2_f32_bf16 v43, v70, v8, v43
    v_dot2_f32_bf16 v43, v71, v9, v43
    buffer_load_dwordx4 v[92:95], v1, s[32:35], s70 offen nt
    s_add_u32 s70, s70, 0x9000
    s_waitcnt vmcnt(7)
    v_dot2_f32_bf16 v44, v72, v6, 0
    v_dot2_f32_bf16 v44, v73, v7, v44
    v_dot2_f32_bf16 v44, v74, v8, v44
    v_dot2_f32_bf16 v44, v75, v9, v44
    buffer_load_dwordx4 v[96:99], v1, s[32:35], s70 offen nt
    s_add_u32 s70, s70, 0x1000
    s_waitcnt vmcnt(6)
    v_dot2_f32_bf16 v45, v76, v6, 0
    v_dot2_f32_bf16 v45, v77, v7, v45
    v_dot2_f32_bf16 v45, v78, v8, v45
    v_dot2_f32_bf16 v45, v79, v9, v45
    buffer_load_dwordx4 v[100:103], v1, s[32:35], s70 offen nt
    s_add_u32 s70, s70, 0x1000
    s_waitcnt vmcnt(6)
    v_dot2_f32_bf16 v46, v80, v6, 0
    v_dot2_f32_bf16 v46, v81, v7, v46
    v_dot2_f32_bf16 v46, v82, v8, v46
    v_dot2_f32_bf16 v46, v83, v9, v46
    buffer_load_dwordx4 v[104:107], v1, s[32:35], s70 offen nt
    s_add_u32 s70, s70, 0x1000
    s_waitcnt vmcnt(5)
    v_dot2_f32_bf16 v47, v84, v6, 0
    v_dot2_f32_bf16 v47, v85, v7, v47
    v_dot2_f32_bf16 v47, v86, v8, v47
    v_dot2_f32_bf16 v47, v87, v9, v47
    buffer_load_dwordx4 v[108:111], v1, s[32:35], s70 offen nt
    s_add_u32 s70, s70, 0x1000
    s_waitcnt vmcnt(5)
    v_dot2_f32_bf16 v48, v88, v6, 0
    v_dot2_f32_bf16 v48, v89, v7, v48
    v_dot2_f32_bf16 v48, v90, v8, v48
    v_dot2_f32_bf16 v48, v91, v9, v48
    buffer_load_dwordx4 v[112:115], v1, s[32:35], s70 offen nt
    s_add_u32 s70, s70, 0x1000
    s_waitcnt vmcnt(5)
    v_dot2_f32_bf16 v49, v92, v6, 0
    v_dot2_f32_bf16 v49, v93, v7, v49
    v_dot2_f32_bf16 v49, v94, v8, v49
    v_dot2_f32_bf16 v49, v95, v9, v49
    buffer_load_dwordx4 v[116:119], v1, s[32:35], s70 offen nt
    s_add_u32 s70, s70, 0x1000
    s_waitcnt vmcnt(5)
    v_dot2_f32_bf16 v50, v96, v6, 0
    v_dot2_f32_bf16 v50, v97, v7, v50
    v_dot2_f32_bf16 v50, v98, v8, v50
    v_dot2_f32_bf16 v50, v99, v9, v50
    buffer_load_dwordx4 v[120:123], v1, s[32:35], s70 offen nt
    s_add_u32 s70, s70, 0x1000
    s_waitcnt vmcnt(5)
    v_dot2_f32_bf16 v51, v100, v6, 0
    v_dot2_f32_bf16 v51, v101, v7, v51
    v_dot2_f32_bf16 v51, v102, v8, v51
    v_dot2_f32_bf16 v51, v103, v9, v51
    buffer_load_dwordx4 v[124:127], v1, s[32:35], s70 offen nt
    s_add_u32 s70, s70, 0x9000
    s_waitcnt vmcnt(5)
    v_dot2_f32_bf16 v52, v104, v6, 0
    v_dot2_f32_bf16 v52, v105, v7, v52
    v_dot2_f32_bf16 v52, v106, v8, v52
    v_dot2_f32_bf16 v52, v107, v9, v52
    s_mov_b32 s70, s75
    buffer_load_dwordx4 v[64:67], v1, s[36:39], s70 offen nt
    s_add_u32 s70, s70, 0x1000
    s_waitcnt vmcnt(5)
    v_dot2_f32_bf16 v53, v108, v6, 0
    v_dot2_f32_bf16 v53, v109, v7, v53
    v_dot2_f32_bf16 v53, v110, v8, v53
    v_dot2_f32_bf16 v53, v111, v9, v53
    buffer_load_dwordx4 v[68:71], v1, s[36:39], s70 offen nt
    s_add_u32 s70, s70, 0x1000
    s_waitcnt vmcnt(5)
    v_dot2_f32_bf16 v54, v112, v6, 0
    v_dot2_f32_bf16 v54, v113, v7, v54
    v_dot2_f32_bf16 v54, v114, v8, v54
    v_dot2_f32_bf16 v54, v115, v9, v54
    buffer_load_dwordx4 v[72:75], v1, s[36:39], s70 offen nt
    s_add_u32 s70, s70, 0x1000
    s_waitcnt vmcnt(5)
    v_dot2_f32_bf16 v55, v116, v6, 0
    v_dot2_f32_bf16 v55, v117, v7, v55
    v_dot2_f32_bf16 v55, v118, v8, v55
    v_dot2_f32_bf16 v55, v119, v9, v55
    buffer_load_dwordx4 v[76:79], v1, s[36:39], s70 offen nt
    s_add_u32 s70, s70, 0x1000
    s_waitcnt vmcnt(5)
    v_dot2_f32_bf16 v56, v120, v6, 0
    v_dot2_f32_bf16 v56, v121, v7, v56
    v_dot2_f32_bf16 v56, v122, v8, v56
    v_dot2_f32_bf16 v56, v123, v9, v56
    buffer_load_dwordx4 v[80:83], v1, s[36:39], s70 offen nt
    s_add_u32 s70, s70, 0x1000
    s_waitcnt vmcnt(5)
    v_dot2_f32_bf16 v57, v124, v6, 0
    v_dot2_f32_bf16 v57, v125, v7, v57
    v_dot2_f32_bf16 v57, v126, v8, v57
    v_dot2_f32_bf16 v57, v127, v9, v57
    buffer_load_dwordx4 v[84:87], v1, s[36:39], s70 offen nt
    s_add_u32 s70, s70, 0x1000
    v_add_f32_dpp v42, v42, v42 row_ror:8 row_mask:0xf bank_mask:0x3
    s_nop 1
    v_add_f32_dpp v42, v50, v50 row_ror:8 row_mask:0xf bank_mask:0xc
    v_add_f32_dpp v43, v43, v43 row_ror:8 row_mask:0xf bank_mask:0x3
    s_nop 1
    v_add_f32_dpp v43, v51, v51 row_ror:8 row_mask:0xf bank_mask:0xc
    v_add_f32_dpp v44, v44, v44 row_ror:8 row_mask:0xf bank_mask:0x3
    s_nop 1
    v_add_f32_dpp v44, v52, v52 row_ror:8 row_mask:0xf bank_mask:0xc
    v_add_f32_dpp v45, v45, v45 row_ror:8 row_mask:0xf bank_mask:0x3
    s_nop 1
    v_add_f32_dpp v45, v53, v53 row_ror:8 row_mask:0xf bank_mask:0xc
    v_add_f32_dpp v46, v46, v46 row_ror:8 row_mask:0xf bank_mask:0x3
    s_nop 1
    v_add_f32_dpp v46, v54, v54 row_ror:8 row_mask:0xf bank_mask:0xc
    v_add_f32_dpp v47, v47, v47 row_ror:8 row_mask:0xf bank_mask:0x3
    s_nop 1
    v_add_f32_dpp v47, v55, v55 row_ror:8 row_mask:0xf bank_mask:0xc
    v_add_f32_dpp v48, v48, v48 row_ror:8 row_mask:0xf bank_mask:0x3
    s_nop 1
    v_add_f32_dpp v48, v56, v56 row_ror:8 row_mask:0xf bank_mask:0xc
    v_add_f32_dpp v49, v49, v49 row_ror:8 row_mask:0xf bank_mask:0x3
    s_nop 1
    v_add_f32_dpp v49, v57, v57 row_ror:8 row_mask:0xf bank_mask:0xc
    v_add_f32_dpp v42, v42, v42 row_shl:4 row_mask:0xf bank_mask:0x5
    s_nop 1
    v_add_f32_dpp v42, v46, v46 row_shr:4 row_mask:0xf bank_mask:0xa
    v_add_f32_dpp v43, v43, v43 row_shl:4 row_mask:0xf bank_mask:0x5
    s_nop 1
    v_add_f32_dpp v43, v47, v47 row_shr:4 row_mask:0xf bank_mask:0xa
    v_add_f32_dpp v44, v44, v44 row_shl:4 row_mask:0xf bank_mask:0x5
    s_nop 1
    v_add_f32_dpp v44, v48, v48 row_shr:4 row_mask:0xf bank_mask:0xa
    v_add_f32_dpp v45, v45, v45 row_shl:4 row_mask:0xf bank_mask:0x5
    s_nop 1
    v_add_f32_dpp v45, v49, v49 row_shr:4 row_mask:0xf bank_mask:0xa
    v_add_f32_dpp v42, v42, v42 quad_perm:[2,3,0,1] row_mask:0xf bank_mask:0xf
    v_add_f32_dpp v43, v43, v43 quad_perm:[2,3,0,1] row_mask:0xf bank_mask:0xf
    v_add_f32_dpp v44, v44, v44 quad_perm:[2,3,0,1] row_mask:0xf bank_mask:0xf
    v_add_f32_dpp v45, v45, v45 quad_perm:[2,3,0,1] row_mask:0xf bank_mask:0xf
    v_cndmask_b32 v42, v42, v44, s[76:77]
    v_cndmask_b32 v43, v43, v45, s[76:77]
    s_nop 0
    v_add_f32_dpp v42, v42, v42 quad_perm:[1,0,3,2] row_mask:0xf bank_mask:0xf
    v_add_f32_dpp v43, v43, v43 quad_perm:[1,0,3,2] row_mask:0xf bank_mask:0xf
    v_cndmask_b32 v42, v42, v43, s[78:79]
    v_cvt_pk_bf16_f32 v42, 0, v42
    v_mul_f32 v42, 0x3db504f3, v42
    v_cvt_pk_bf16_f32 v33, 0, v42
    v_max3_f32 v42, v26, v27, v28
    v_max3_f32 v44, v29, v30, v31
    v_max3_f32 v42, v42, v32, v33
    v_max_f32 v42, v42, v44
    s_nop 1
    v_max_f32_dpp v42, v42, v42 quad_perm:[1,0,3,2] row_mask:0xf bank_mask:0xf
    s_nop 1
    v_max_f32_dpp v42, v42, v42 quad_perm:[2,3,0,1] row_mask:0xf bank_mask:0xf
    s_nop 1
    v_max_f32_dpp v42, v42, v42 row_half_mirror row_mask:0xf bank_mask:0xf
    s_nop 1
    v_max_f32_dpp v42, v42, v42 row_mirror row_mask:0xf bank_mask:0xf
    v_mov_b32 v44, v42
    s_nop 1
    v_permlane16_swap_b32 v42, v44
    v_max_f32 v42, v42, v44
    v_mov_b32 v44, v42
    s_nop 1
    v_permlane32_swap_b32 v42, v44
    v_max_f32 v42, v42, v44
    v_sub_f32 v26, v26, v42
    v_sub_f32 v27, v27, v42
    v_sub_f32 v28, v28, v42
    v_sub_f32 v29, v29, v42
    v_sub_f32 v30, v30, v42
    v_sub_f32 v31, v31, v42
    v_sub_f32 v32, v32, v42
    v_sub_f32 v33, v33, v42
    v_mul_f32 v26, 0x3fb8aa3b, v26
    v_mul_f32 v27, 0x3fb8aa3b, v27
    v_mul_f32 v28, 0x3fb8aa3b, v28
    v_mul_f32 v29, 0x3fb8aa3b, v29
    v_mul_f32 v30, 0x3fb8aa3b, v30
    v_mul_f32 v31, 0x3fb8aa3b, v31
    v_mul_f32 v32, 0x3fb8aa3b, v32
    v_mul_f32 v33, 0x3fb8aa3b, v33
    v_exp_f32 v26, v26
    v_exp_f32 v27, v27
    v_exp_f32 v28, v28
    v_exp_f32 v29, v29
    v_exp_f32 v30, v30
    v_exp_f32 v31, v31
    v_exp_f32 v32, v32
    v_exp_f32 v33, v33
    v_add_f32 v43, v26, v27
    v_add_f32 v44, v28, v29
    v_add_f32 v45, v30, v31
    v_add_f32 v46, v32, v33
    v_add_f32 v43, v43, v44
    v_add_f32 v45, v45, v46
    v_add_f32 v43, v43, v45
    v_cvt_pk_bf16_f32 v34, 0, v26
    v_cvt_pk_bf16_f32 v26, v26, 0
    v_cvt_pk_bf16_f32 v35, 0, v27
    v_cvt_pk_bf16_f32 v27, v27, 0
    v_cvt_pk_bf16_f32 v36, 0, v28
    v_cvt_pk_bf16_f32 v28, v28, 0
    v_cvt_pk_bf16_f32 v37, 0, v29
    v_cvt_pk_bf16_f32 v29, v29, 0
    v_cvt_pk_bf16_f32 v38, 0, v30
    v_cvt_pk_bf16_f32 v30, v30, 0
    v_cvt_pk_bf16_f32 v39, 0, v31
    v_cvt_pk_bf16_f32 v31, v31, 0
    v_cvt_pk_bf16_f32 v40, 0, v32
    v_cvt_pk_bf16_f32 v32, v32, 0
    v_cvt_pk_bf16_f32 v41, 0, v33
    v_cvt_pk_bf16_f32 v33, v33, 0
    v_add_f32_dpp v43, v43, v43 quad_perm:[1,0,3,2] row_mask:0xf bank_mask:0xf
    s_nop 1
    v_add_f32_dpp v43, v43, v43 quad_perm:[2,3,0,1] row_mask:0xf bank_mask:0xf
    s_nop 1
    v_add_f32_dpp v43, v43, v43 row_half_mirror row_mask:0xf bank_mask:0xf
    s_nop 1
    v_add_f32_dpp v43, v43, v43 row_mirror row_mask:0xf bank_mask:0xf
    v_mov_b32 v44, v43
    s_nop 1
    v_permlane16_swap_b32 v43, v44
    v_add_f32 v43, v43, v44
    v_mov_b32 v44, v43
    s_nop 1
    v_permlane32_swap_b32 v43, v44
    v_add_f32 v43, v43, v44
    s_lshl_b32 s80, s3, 3
    v_mov_b32 v44, s80
    s_mov_b64 exec, 1
    ds_write_b64 v44, v[42:43] offset:2048
    s_mov_b64 exec, -1
    s_mov_b32 s82, 0x05040100
    s_mov_b32 s83, 0x07060302
    s_waitcnt vmcnt(5)
    v_dot2c_f32_bf16_dpp v10, v26, v64 row_newbcast:0 row_mask:0xf bank_mask:0xf
    v_dot2c_f32_bf16_dpp v11, v34, v64 row_newbcast:0 row_mask:0xf bank_mask:0xf
    v_dot2c_f32_bf16_dpp v12, v26, v65 row_newbcast:0 row_mask:0xf bank_mask:0xf
    v_dot2c_f32_bf16_dpp v13, v34, v65 row_newbcast:0 row_mask:0xf bank_mask:0xf
    v_dot2c_f32_bf16_dpp v14, v26, v66 row_newbcast:0 row_mask:0xf bank_mask:0xf
    v_dot2c_f32_bf16_dpp v15, v34, v66 row_newbcast:0 row_mask:0xf bank_mask:0xf
    v_dot2c_f32_bf16_dpp v16, v26, v67 row_newbcast:0 row_mask:0xf bank_mask:0xf
    v_dot2c_f32_bf16_dpp v17, v34, v67 row_newbcast:0 row_mask:0xf bank_mask:0xf
    buffer_load_dwordx4 v[88:91], v1, s[36:39], s70 offen nt
    s_add_u32 s70, s70, 0x1000
    v_perm_b32 v57, v132, v128, s82
    v_perm_b32 v132, v132, v128, s83
    s_waitcnt vmcnt(5)
    v_dot2c_f32_bf16_dpp v10, v26, v68 row_newbcast:1 row_mask:0xf bank_mask:0xf
    v_dot2c_f32_bf16_dpp v11, v34, v68 row_newbcast:1 row_mask:0xf bank_mask:0xf
    v_dot2c_f32_bf16_dpp v12, v26, v69 row_newbcast:1 row_mask:0xf bank_mask:0xf
    v_dot2c_f32_bf16_dpp v13, v34, v69 row_newbcast:1 row_mask:0xf bank_mask:0xf
    v_dot2c_f32_bf16_dpp v14, v26, v70 row_newbcast:1 row_mask:0xf bank_mask:0xf
    v_dot2c_f32_bf16_dpp v15, v34, v70 row_newbcast:1 row_mask:0xf bank_mask:0xf
    v_dot2c_f32_bf16_dpp v16, v26, v71 row_newbcast:1 row_mask:0xf bank_mask:0xf
    v_dot2c_f32_bf16_dpp v17, v34, v71 row_newbcast:1 row_mask:0xf bank_mask:0xf
    buffer_load_dwordx4 v[92:95], v1, s[36:39], s70 offen nt
    s_add_u32 s70, s70, 0x9000
    v_perm_b32 v128, v133, v129, s82
    v_perm_b32 v133, v133, v129, s83
    s_waitcnt vmcnt(5)
    v_dot2c_f32_bf16_dpp v10, v26, v72 row_newbcast:2 row_mask:0xf bank_mask:0xf
    v_dot2c_f32_bf16_dpp v11, v34, v72 row_newbcast:2 row_mask:0xf bank_mask:0xf
    v_dot2c_f32_bf16_dpp v12, v26, v73 row_newbcast:2 row_mask:0xf bank_mask:0xf
    v_dot2c_f32_bf16_dpp v13, v34, v73 row_newbcast:2 row_mask:0xf bank_mask:0xf
    v_dot2c_f32_bf16_dpp v14, v26, v74 row_newbcast:2 row_mask:0xf bank_mask:0xf
    v_dot2c_f32_bf16_dpp v15, v34, v74 row_newbcast:2 row_mask:0xf bank_mask:0xf
    v_dot2c_f32_bf16_dpp v16, v26, v75 row_newbcast:2 row_mask:0xf bank_mask:0xf
    v_dot2c_f32_bf16_dpp v17, v34, v75 row_newbcast:2 row_mask:0xf bank_mask:0xf
    buffer_load_dwordx4 v[96:99], v1, s[36:39], s70 offen nt
    s_add_u32 s70, s70, 0x1000
    v_perm_b32 v129, v134, v130, s82
    v_perm_b32 v134, v134, v130, s83
    s_waitcnt vmcnt(5)
    v_dot2c_f32_bf16_dpp v10, v26, v76 row_newbcast:3 row_mask:0xf bank_mask:0xf
    v_dot2c_f32_bf16_dpp v11, v34, v76 row_newbcast:3 row_mask:0xf bank_mask:0xf
    v_dot2c_f32_bf16_dpp v12, v26, v77 row_newbcast:3 row_mask:0xf bank_mask:0xf
    v_dot2c_f32_bf16_dpp v13, v34, v77 row_newbcast:3 row_mask:0xf bank_mask:0xf
    v_dot2c_f32_bf16_dpp v14, v26, v78 row_newbcast:3 row_mask:0xf bank_mask:0xf
    v_dot2c_f32_bf16_dpp v15, v34, v78 row_newbcast:3 row_mask:0xf bank_mask:0xf
    v_dot2c_f32_bf16_dpp v16, v26, v79 row_newbcast:3 row_mask:0xf bank_mask:0xf
    v_dot2c_f32_bf16_dpp v17, v34, v79 row_newbcast:3 row_mask:0xf bank_mask:0xf
    buffer_load_dwordx4 v[100:103], v1, s[36:39], s70 offen nt
    s_add_u32 s70, s70, 0x1000
    v_perm_b32 v130, v135, v131, s82
    v_perm_b32 v135, v135, v131, s83
    s_waitcnt vmcnt(5)
    v_dot2c_f32_bf16_dpp v10, v26, v80 row_newbcast:4 row_mask:0xf bank_mask:0xf
    v_dot2c_f32_bf16_dpp v11, v34, v80 row_newbcast:4 row_mask:0xf bank_mask:0xf
    v_dot2c_f32_bf16_dpp v12, v26, v81 row_newbcast:4 row_mask:0xf bank_mask:0xf
    v_dot2c_f32_bf16_dpp v13, v34, v81 row_newbcast:4 row_mask:0xf bank_mask:0xf
    v_dot2c_f32_bf16_dpp v14, v26, v82 row_newbcast:4 row_mask:0xf bank_mask:0xf
    v_dot2c_f32_bf16_dpp v15, v34, v82 row_newbcast:4 row_mask:0xf bank_mask:0xf
    v_dot2c_f32_bf16_dpp v16, v26, v83 row_newbcast:4 row_mask:0xf bank_mask:0xf
    v_dot2c_f32_bf16_dpp v17, v34, v83 row_newbcast:4 row_mask:0xf bank_mask:0xf
    buffer_load_dwordx4 v[104:107], v1, s[36:39], s70 offen nt
    s_add_u32 s70, s70, 0x1000
    v_perm_b32 v131, v140, v136, s82
    v_perm_b32 v140, v140, v136, s83
    s_waitcnt vmcnt(5)
    v_dot2c_f32_bf16_dpp v10, v26, v84 row_newbcast:5 row_mask:0xf bank_mask:0xf
    v_dot2c_f32_bf16_dpp v11, v34, v84 row_newbcast:5 row_mask:0xf bank_mask:0xf
    v_dot2c_f32_bf16_dpp v12, v26, v85 row_newbcast:5 row_mask:0xf bank_mask:0xf
    v_dot2c_f32_bf16_dpp v13, v34, v85 row_newbcast:5 row_mask:0xf bank_mask:0xf
    v_dot2c_f32_bf16_dpp v14, v26, v86 row_newbcast:5 row_mask:0xf bank_mask:0xf
    v_dot2c_f32_bf16_dpp v15, v34, v86 row_newbcast:5 row_mask:0xf bank_mask:0xf
    v_dot2c_f32_bf16_dpp v16, v26, v87 row_newbcast:5 row_mask:0xf bank_mask:0xf
    v_dot2c_f32_bf16_dpp v17, v34, v87 row_newbcast:5 row_mask:0xf bank_mask:0xf
    buffer_load_dwordx4 v[108:111], v1, s[36:39], s70 offen nt
    s_add_u32 s70, s70, 0x1000
    v_perm_b32 v136, v141, v137, s82
    v_perm_b32 v141, v141, v137, s83
    s_waitcnt vmcnt(5)
    v_dot2c_f32_bf16_dpp v10, v26, v88 row_newbcast:6 row_mask:0xf bank_mask:0xf
    v_dot2c_f32_bf16_dpp v11, v34, v88 row_newbcast:6 row_mask:0xf bank_mask:0xf
    v_dot2c_f32_bf16_dpp v12, v26, v89 row_newbcast:6 row_mask:0xf bank_mask:0xf
    v_dot2c_f32_bf16_dpp v13, v34, v89 row_newbcast:6 row_mask:0xf bank_mask:0xf
    v_dot2c_f32_bf16_dpp v14, v26, v90 row_newbcast:6 row_mask:0xf bank_mask:0xf
    v_dot2c_f32_bf16_dpp v15, v34, v90 row_newbcast:6 row_mask:0xf bank_mask:0xf
    v_dot2c_f32_bf16_dpp v16, v26, v91 row_newbcast:6 row_mask:0xf bank_mask:0xf
    v_dot2c_f32_bf16_dpp v17, v34, v91 row_newbcast:6 row_mask:0xf bank_mask:0xf
    buffer_load_dwordx4 v[112:115], v1, s[36:39], s70 offen nt
    s_add_u32 s70, s70, 0x1000
    v_perm_b32 v137, v142, v138, s82
    v_perm_b32 v142, v142, v138, s83
    s_waitcnt vmcnt(5)
    v_dot2c_f32_bf16_dpp v10, v26, v92 row_newbcast:7 row_mask:0xf bank_mask:0xf
    v_dot2c_f32_bf16_dpp v11, v34, v92 row_newbcast:7 row_mask:0xf bank_mask:0xf
    v_dot2c_f32_bf16_dpp v12, v26, v93 row_newbcast:7 row_mask:0xf bank_mask:0xf
    v_dot2c_f32_bf16_dpp v13, v34, v93 row_newbcast:7 row_mask:0xf bank_mask:0xf
    v_dot2c_f32_bf16_dpp v14, v26, v94 row_newbcast:7 row_mask:0xf bank_mask:0xf
    v_dot2c_f32_bf16_dpp v15, v34, v94 row_newbcast:7 row_mask:0xf bank_mask:0xf
    v_dot2c_f32_bf16_dpp v16, v26, v95 row_newbcast:7 row_mask:0xf bank_mask:0xf
    v_dot2c_f32_bf16_dpp v17, v34, v95 row_newbcast:7 row_mask:0xf bank_mask:0xf
    buffer_load_dwordx4 v[116:119], v1, s[36:39], s70 offen nt
    s_add_u32 s70, s70, 0x1000
    v_perm_b32 v138, v143, v139, s82
    v_perm_b32 v143, v143, v139, s83
    s_waitcnt vmcnt(5)
    v_dot2c_f32_bf16_dpp v10, v26, v96 row_newbcast:8 row_mask:0xf bank_mask:0xf
    v_dot2c_f32_bf16_dpp v11, v34, v96 row_newbcast:8 row_mask:0xf bank_mask:0xf
    v_dot2c_f32_bf16_dpp v12, v26, v97 row_newbcast:8 row_mask:0xf bank_mask:0xf
    v_dot2c_f32_bf16_dpp v13, v34, v97 row_newbcast:8 row_mask:0xf bank_mask:0xf
    v_dot2c_f32_bf16_dpp v14, v26, v98 row_newbcast:8 row_mask:0xf bank_mask:0xf
    v_dot2c_f32_bf16_dpp v15, v34, v98 row_newbcast:8 row_mask:0xf bank_mask:0xf
    v_dot2c_f32_bf16_dpp v16, v26, v99 row_newbcast:8 row_mask:0xf bank_mask:0xf
    v_dot2c_f32_bf16_dpp v17, v34, v99 row_newbcast:8 row_mask:0xf bank_mask:0xf
    buffer_load_dwordx4 v[120:123], v1, s[36:39], s70 offen nt
    s_add_u32 s70, s70, 0x1000
    v_perm_b32 v139, v148, v144, s82
    v_perm_b32 v148, v148, v144, s83
    s_waitcnt vmcnt(5)
    v_dot2c_f32_bf16_dpp v10, v26, v100 row_newbcast:9 row_mask:0xf bank_mask:0xf
    v_dot2c_f32_bf16_dpp v11, v34, v100 row_newbcast:9 row_mask:0xf bank_mask:0xf
    v_dot2c_f32_bf16_dpp v12, v26, v101 row_newbcast:9 row_mask:0xf bank_mask:0xf
    v_dot2c_f32_bf16_dpp v13, v34, v101 row_newbcast:9 row_mask:0xf bank_mask:0xf
    v_dot2c_f32_bf16_dpp v14, v26, v102 row_newbcast:9 row_mask:0xf bank_mask:0xf
    v_dot2c_f32_bf16_dpp v15, v34, v102 row_newbcast:9 row_mask:0xf bank_mask:0xf
    v_dot2c_f32_bf16_dpp v16, v26, v103 row_newbcast:9 row_mask:0xf bank_mask:0xf
    v_dot2c_f32_bf16_dpp v17, v34, v103 row_newbcast:9 row_mask:0xf bank_mask:0xf
    buffer_load_dwordx4 v[124:127], v1, s[36:39], s70 offen nt
    s_add_u32 s70, s70, 0x9000
    v_perm_b32 v144, v149, v145, s82
    v_perm_b32 v149, v149, v145, s83
    s_waitcnt vmcnt(5)
    v_dot2c_f32_bf16_dpp v10, v26, v104 row_newbcast:10 row_mask:0xf bank_mask:0xf
    v_dot2c_f32_bf16_dpp v11, v34, v104 row_newbcast:10 row_mask:0xf bank_mask:0xf
    v_dot2c_f32_bf16_dpp v12, v26, v105 row_newbcast:10 row_mask:0xf bank_mask:0xf
    v_dot2c_f32_bf16_dpp v13, v34, v105 row_newbcast:10 row_mask:0xf bank_mask:0xf
    v_dot2c_f32_bf16_dpp v14, v26, v106 row_newbcast:10 row_mask:0xf bank_mask:0xf
    v_dot2c_f32_bf16_dpp v15, v34, v106 row_newbcast:10 row_mask:0xf bank_mask:0xf
    v_dot2c_f32_bf16_dpp v16, v26, v107 row_newbcast:10 row_mask:0xf bank_mask:0xf
    v_dot2c_f32_bf16_dpp v17, v34, v107 row_newbcast:10 row_mask:0xf bank_mask:0xf
    buffer_load_dwordx4 v[64:67], v1, s[36:39], s70 offen nt
    s_add_u32 s70, s70, 0x1000
    v_perm_b32 v145, v150, v146, s82
    v_perm_b32 v150, v150, v146, s83
    s_waitcnt vmcnt(5)
    v_dot2c_f32_bf16_dpp v10, v26, v108 row_newbcast:11 row_mask:0xf bank_mask:0xf
    v_dot2c_f32_bf16_dpp v11, v34, v108 row_newbcast:11 row_mask:0xf bank_mask:0xf
    v_dot2c_f32_bf16_dpp v12, v26, v109 row_newbcast:11 row_mask:0xf bank_mask:0xf
    v_dot2c_f32_bf16_dpp v13, v34, v109 row_newbcast:11 row_mask:0xf bank_mask:0xf
    v_dot2c_f32_bf16_dpp v14, v26, v110 row_newbcast:11 row_mask:0xf bank_mask:0xf
    v_dot2c_f32_bf16_dpp v15, v34, v110 row_newbcast:11 row_mask:0xf bank_mask:0xf
    v_dot2c_f32_bf16_dpp v16, v26, v111 row_newbcast:11 row_mask:0xf bank_mask:0xf
    v_dot2c_f32_bf16_dpp v17, v34, v111 row_newbcast:11 row_mask:0xf bank_mask:0xf
    buffer_load_dwordx4 v[68:71], v1, s[36:39], s70 offen nt
    s_add_u32 s70, s70, 0x1000
    v_perm_b32 v146, v151, v147, s82
    v_perm_b32 v151, v151, v147, s83
    s_waitcnt vmcnt(5)
    v_dot2c_f32_bf16_dpp v10, v26, v112 row_newbcast:12 row_mask:0xf bank_mask:0xf
    v_dot2c_f32_bf16_dpp v11, v34, v112 row_newbcast:12 row_mask:0xf bank_mask:0xf
    v_dot2c_f32_bf16_dpp v12, v26, v113 row_newbcast:12 row_mask:0xf bank_mask:0xf
    v_dot2c_f32_bf16_dpp v13, v34, v113 row_newbcast:12 row_mask:0xf bank_mask:0xf
    v_dot2c_f32_bf16_dpp v14, v26, v114 row_newbcast:12 row_mask:0xf bank_mask:0xf
    v_dot2c_f32_bf16_dpp v15, v34, v114 row_newbcast:12 row_mask:0xf bank_mask:0xf
    v_dot2c_f32_bf16_dpp v16, v26, v115 row_newbcast:12 row_mask:0xf bank_mask:0xf
    v_dot2c_f32_bf16_dpp v17, v34, v115 row_newbcast:12 row_mask:0xf bank_mask:0xf
    buffer_load_dwordx4 v[72:75], v1, s[36:39], s70 offen nt
    s_add_u32 s70, s70, 0x1000
    v_perm_b32 v147, v156, v152, s82
    v_perm_b32 v156, v156, v152, s83
    s_waitcnt vmcnt(5)
    v_dot2c_f32_bf16_dpp v10, v26, v116 row_newbcast:13 row_mask:0xf bank_mask:0xf
    v_dot2c_f32_bf16_dpp v11, v34, v116 row_newbcast:13 row_mask:0xf bank_mask:0xf
    v_dot2c_f32_bf16_dpp v12, v26, v117 row_newbcast:13 row_mask:0xf bank_mask:0xf
    v_dot2c_f32_bf16_dpp v13, v34, v117 row_newbcast:13 row_mask:0xf bank_mask:0xf
    v_dot2c_f32_bf16_dpp v14, v26, v118 row_newbcast:13 row_mask:0xf bank_mask:0xf
    v_dot2c_f32_bf16_dpp v15, v34, v118 row_newbcast:13 row_mask:0xf bank_mask:0xf
    v_dot2c_f32_bf16_dpp v16, v26, v119 row_newbcast:13 row_mask:0xf bank_mask:0xf
    v_dot2c_f32_bf16_dpp v17, v34, v119 row_newbcast:13 row_mask:0xf bank_mask:0xf
    buffer_load_dwordx4 v[76:79], v1, s[36:39], s70 offen nt
    s_add_u32 s70, s70, 0x1000
    v_perm_b32 v152, v157, v153, s82
    v_perm_b32 v157, v157, v153, s83
    s_waitcnt vmcnt(5)
    v_dot2c_f32_bf16_dpp v10, v26, v120 row_newbcast:14 row_mask:0xf bank_mask:0xf
    v_dot2c_f32_bf16_dpp v11, v34, v120 row_newbcast:14 row_mask:0xf bank_mask:0xf
    v_dot2c_f32_bf16_dpp v12, v26, v121 row_newbcast:14 row_mask:0xf bank_mask:0xf
    v_dot2c_f32_bf16_dpp v13, v34, v121 row_newbcast:14 row_mask:0xf bank_mask:0xf
    v_dot2c_f32_bf16_dpp v14, v26, v122 row_newbcast:14 row_mask:0xf bank_mask:0xf
    v_dot2c_f32_bf16_dpp v15, v34, v122 row_newbcast:14 row_mask:0xf bank_mask:0xf
    v_dot2c_f32_bf16_dpp v16, v26, v123 row_newbcast:14 row_mask:0xf bank_mask:0xf
    v_dot2c_f32_bf16_dpp v17, v34, v123 row_newbcast:14 row_mask:0xf bank_mask:0xf
    buffer_load_dwordx4 v[80:83], v1, s[36:39], s70 offen nt
    s_add_u32 s70, s70, 0x1000
    v_perm_b32 v153, v158, v154, s82
    v_perm_b32 v158, v158, v154, s83
    s_waitcnt vmcnt(5)
    v_dot2c_f32_bf16_dpp v10, v26, v124 row_newbcast:15 row_mask:0xf bank_mask:0xf
    v_dot2c_f32_bf16_dpp v11, v34, v124 row_newbcast:15 row_mask:0xf bank_mask:0xf
    v_dot2c_f32_bf16_dpp v12, v26, v125 row_newbcast:15 row_mask:0xf bank_mask:0xf
    v_dot2c_f32_bf16_dpp v13, v34, v125 row_newbcast:15 row_mask:0xf bank_mask:0xf
    v_dot2c_f32_bf16_dpp v14, v26, v126 row_newbcast:15 row_mask:0xf bank_mask:0xf
    v_dot2c_f32_bf16_dpp v15, v34, v126 row_newbcast:15 row_mask:0xf bank_mask:0xf
    v_dot2c_f32_bf16_dpp v16, v26, v127 row_newbcast:15 row_mask:0xf bank_mask:0xf
    v_dot2c_f32_bf16_dpp v17, v34, v127 row_newbcast:15 row_mask:0xf bank_mask:0xf
    buffer_load_dwordx4 v[84:87], v1, s[36:39], s70 offen nt
    s_add_u32 s70, s70, 0x1000
    v_perm_b32 v154, v159, v155, s82
    v_perm_b32 v159, v159, v155, s83
    s_waitcnt vmcnt(5)
    v_dot2c_f32_bf16_dpp v10, v27, v64 row_newbcast:0 row_mask:0xf bank_mask:0xf
    v_dot2c_f32_bf16_dpp v11, v35, v64 row_newbcast:0 row_mask:0xf bank_mask:0xf
    v_dot2c_f32_bf16_dpp v12, v27, v65 row_newbcast:0 row_mask:0xf bank_mask:0xf
    v_dot2c_f32_bf16_dpp v13, v35, v65 row_newbcast:0 row_mask:0xf bank_mask:0xf
    v_dot2c_f32_bf16_dpp v14, v27, v66 row_newbcast:0 row_mask:0xf bank_mask:0xf
    v_dot2c_f32_bf16_dpp v15, v35, v66 row_newbcast:0 row_mask:0xf bank_mask:0xf
    v_dot2c_f32_bf16_dpp v16, v27, v67 row_newbcast:0 row_mask:0xf bank_mask:0xf
    v_dot2c_f32_bf16_dpp v17, v35, v67 row_newbcast:0 row_mask:0xf bank_mask:0xf
    buffer_load_dwordx4 v[88:91], v1, s[36:39], s70 offen nt
    s_add_u32 s70, s70, 0x1000
    v_perm_b32 v155, v164, v160, s82
    v_perm_b32 v164, v164, v160, s83
    s_waitcnt vmcnt(5)
    v_dot2c_f32_bf16_dpp v10, v27, v68 row_newbcast:1 row_mask:0xf bank_mask:0xf
    v_dot2c_f32_bf16_dpp v11, v35, v68 row_newbcast:1 row_mask:0xf bank_mask:0xf
    v_dot2c_f32_bf16_dpp v12, v27, v69 row_newbcast:1 row_mask:0xf bank_mask:0xf
    v_dot2c_f32_bf16_dpp v13, v35, v69 row_newbcast:1 row_mask:0xf bank_mask:0xf
    v_dot2c_f32_bf16_dpp v14, v27, v70 row_newbcast:1 row_mask:0xf bank_mask:0xf
    v_dot2c_f32_bf16_dpp v15, v35, v70 row_newbcast:1 row_mask:0xf bank_mask:0xf
    v_dot2c_f32_bf16_dpp v16, v27, v71 row_newbcast:1 row_mask:0xf bank_mask:0xf
    v_dot2c_f32_bf16_dpp v17, v35, v71 row_newbcast:1 row_mask:0xf bank_mask:0xf
    buffer_load_dwordx4 v[92:95], v1, s[36:39], s70 offen nt
    s_add_u32 s70, s70, 0x9000
    v_perm_b32 v160, v165, v161, s82
    v_perm_b32 v165, v165, v161, s83
    s_waitcnt vmcnt(5)
    v_dot2c_f32_bf16_dpp v10, v27, v72 row_newbcast:2 row_mask:0xf bank_mask:0xf
    v_dot2c_f32_bf16_dpp v11, v35, v72 row_newbcast:2 row_mask:0xf bank_mask:0xf
    v_dot2c_f32_bf16_dpp v12, v27, v73 row_newbcast:2 row_mask:0xf bank_mask:0xf
    v_dot2c_f32_bf16_dpp v13, v35, v73 row_newbcast:2 row_mask:0xf bank_mask:0xf
    v_dot2c_f32_bf16_dpp v14, v27, v74 row_newbcast:2 row_mask:0xf bank_mask:0xf
    v_dot2c_f32_bf16_dpp v15, v35, v74 row_newbcast:2 row_mask:0xf bank_mask:0xf
    v_dot2c_f32_bf16_dpp v16, v27, v75 row_newbcast:2 row_mask:0xf bank_mask:0xf
    v_dot2c_f32_bf16_dpp v17, v35, v75 row_newbcast:2 row_mask:0xf bank_mask:0xf
    buffer_load_dwordx4 v[96:99], v1, s[36:39], s70 offen nt
    s_add_u32 s70, s70, 0x1000
    v_perm_b32 v161, v166, v162, s82
    v_perm_b32 v166, v166, v162, s83
    s_waitcnt vmcnt(5)
    v_dot2c_f32_bf16_dpp v10, v27, v76 row_newbcast:3 row_mask:0xf bank_mask:0xf
    v_dot2c_f32_bf16_dpp v11, v35, v76 row_newbcast:3 row_mask:0xf bank_mask:0xf
    v_dot2c_f32_bf16_dpp v12, v27, v77 row_newbcast:3 row_mask:0xf bank_mask:0xf
    v_dot2c_f32_bf16_dpp v13, v35, v77 row_newbcast:3 row_mask:0xf bank_mask:0xf
    v_dot2c_f32_bf16_dpp v14, v27, v78 row_newbcast:3 row_mask:0xf bank_mask:0xf
    v_dot2c_f32_bf16_dpp v15, v35, v78 row_newbcast:3 row_mask:0xf bank_mask:0xf
    v_dot2c_f32_bf16_dpp v16, v27, v79 row_newbcast:3 row_mask:0xf bank_mask:0xf
    v_dot2c_f32_bf16_dpp v17, v35, v79 row_newbcast:3 row_mask:0xf bank_mask:0xf
    buffer_load_dwordx4 v[100:103], v1, s[36:39], s70 offen nt
    s_add_u32 s70, s70, 0x1000
    v_perm_b32 v162, v167, v163, s82
    v_perm_b32 v167, v167, v163, s83
    s_waitcnt vmcnt(5)
    v_dot2c_f32_bf16_dpp v10, v27, v80 row_newbcast:4 row_mask:0xf bank_mask:0xf
    v_dot2c_f32_bf16_dpp v11, v35, v80 row_newbcast:4 row_mask:0xf bank_mask:0xf
    v_dot2c_f32_bf16_dpp v12, v27, v81 row_newbcast:4 row_mask:0xf bank_mask:0xf
    v_dot2c_f32_bf16_dpp v13, v35, v81 row_newbcast:4 row_mask:0xf bank_mask:0xf
    v_dot2c_f32_bf16_dpp v14, v27, v82 row_newbcast:4 row_mask:0xf bank_mask:0xf
    v_dot2c_f32_bf16_dpp v15, v35, v82 row_newbcast:4 row_mask:0xf bank_mask:0xf
    v_dot2c_f32_bf16_dpp v16, v27, v83 row_newbcast:4 row_mask:0xf bank_mask:0xf
    v_dot2c_f32_bf16_dpp v17, v35, v83 row_newbcast:4 row_mask:0xf bank_mask:0xf
    buffer_load_dwordx4 v[104:107], v1, s[36:39], s70 offen nt
    s_add_u32 s70, s70, 0x1000
    v_perm_b32 v163, v172, v168, s82
    v_perm_b32 v172, v172, v168, s83
    s_waitcnt vmcnt(5)
    v_dot2c_f32_bf16_dpp v10, v27, v84 row_newbcast:5 row_mask:0xf bank_mask:0xf
    v_dot2c_f32_bf16_dpp v11, v35, v84 row_newbcast:5 row_mask:0xf bank_mask:0xf
    v_dot2c_f32_bf16_dpp v12, v27, v85 row_newbcast:5 row_mask:0xf bank_mask:0xf
    v_dot2c_f32_bf16_dpp v13, v35, v85 row_newbcast:5 row_mask:0xf bank_mask:0xf
    v_dot2c_f32_bf16_dpp v14, v27, v86 row_newbcast:5 row_mask:0xf bank_mask:0xf
    v_dot2c_f32_bf16_dpp v15, v35, v86 row_newbcast:5 row_mask:0xf bank_mask:0xf
    v_dot2c_f32_bf16_dpp v16, v27, v87 row_newbcast:5 row_mask:0xf bank_mask:0xf
    v_dot2c_f32_bf16_dpp v17, v35, v87 row_newbcast:5 row_mask:0xf bank_mask:0xf
    buffer_load_dwordx4 v[108:111], v1, s[36:39], s70 offen nt
    s_add_u32 s70, s70, 0x1000
    v_perm_b32 v168, v173, v169, s82
    v_perm_b32 v173, v173, v169, s83
    s_waitcnt vmcnt(5)
    v_dot2c_f32_bf16_dpp v10, v27, v88 row_newbcast:6 row_mask:0xf bank_mask:0xf
    v_dot2c_f32_bf16_dpp v11, v35, v88 row_newbcast:6 row_mask:0xf bank_mask:0xf
    v_dot2c_f32_bf16_dpp v12, v27, v89 row_newbcast:6 row_mask:0xf bank_mask:0xf
    v_dot2c_f32_bf16_dpp v13, v35, v89 row_newbcast:6 row_mask:0xf bank_mask:0xf
    v_dot2c_f32_bf16_dpp v14, v27, v90 row_newbcast:6 row_mask:0xf bank_mask:0xf
    v_dot2c_f32_bf16_dpp v15, v35, v90 row_newbcast:6 row_mask:0xf bank_mask:0xf
    v_dot2c_f32_bf16_dpp v16, v27, v91 row_newbcast:6 row_mask:0xf bank_mask:0xf
    v_dot2c_f32_bf16_dpp v17, v35, v91 row_newbcast:6 row_mask:0xf bank_mask:0xf
    buffer_load_dwordx4 v[112:115], v1, s[36:39], s70 offen nt
    s_add_u32 s70, s70, 0x1000
    v_perm_b32 v169, v174, v170, s82
    v_perm_b32 v174, v174, v170, s83
    s_waitcnt vmcnt(5)
    v_dot2c_f32_bf16_dpp v10, v27, v92 row_newbcast:7 row_mask:0xf bank_mask:0xf
    v_dot2c_f32_bf16_dpp v11, v35, v92 row_newbcast:7 row_mask:0xf bank_mask:0xf
    v_dot2c_f32_bf16_dpp v12, v27, v93 row_newbcast:7 row_mask:0xf bank_mask:0xf
    v_dot2c_f32_bf16_dpp v13, v35, v93 row_newbcast:7 row_mask:0xf bank_mask:0xf
    v_dot2c_f32_bf16_dpp v14, v27, v94 row_newbcast:7 row_mask:0xf bank_mask:0xf
    v_dot2c_f32_bf16_dpp v15, v35, v94 row_newbcast:7 row_mask:0xf bank_mask:0xf
    v_dot2c_f32_bf16_dpp v16, v27, v95 row_newbcast:7 row_mask:0xf bank_mask:0xf
    v_dot2c_f32_bf16_dpp v17, v35, v95 row_newbcast:7 row_mask:0xf bank_mask:0xf
    buffer_load_dwordx4 v[116:119], v1, s[36:39], s70 offen nt
    s_add_u32 s70, s70, 0x1000
    v_perm_b32 v170, v175, v171, s82
    v_perm_b32 v175, v175, v171, s83
    s_waitcnt vmcnt(5)
    v_dot2c_f32_bf16_dpp v10, v27, v96 row_newbcast:8 row_mask:0xf bank_mask:0xf
    v_dot2c_f32_bf16_dpp v11, v35, v96 row_newbcast:8 row_mask:0xf bank_mask:0xf
    v_dot2c_f32_bf16_dpp v12, v27, v97 row_newbcast:8 row_mask:0xf bank_mask:0xf
    v_dot2c_f32_bf16_dpp v13, v35, v97 row_newbcast:8 row_mask:0xf bank_mask:0xf
    v_dot2c_f32_bf16_dpp v14, v27, v98 row_newbcast:8 row_mask:0xf bank_mask:0xf
    v_dot2c_f32_bf16_dpp v15, v35, v98 row_newbcast:8 row_mask:0xf bank_mask:0xf
    v_dot2c_f32_bf16_dpp v16, v27, v99 row_newbcast:8 row_mask:0xf bank_mask:0xf
    v_dot2c_f32_bf16_dpp v17, v35, v99 row_newbcast:8 row_mask:0xf bank_mask:0xf
    buffer_load_dwordx4 v[120:123], v1, s[36:39], s70 offen nt
    s_add_u32 s70, s70, 0x1000
    v_perm_b32 v171, v180, v176, s82
    v_perm_b32 v180, v180, v176, s83
    s_waitcnt vmcnt(5)
    v_dot2c_f32_bf16_dpp v10, v27, v100 row_newbcast:9 row_mask:0xf bank_mask:0xf
    v_dot2c_f32_bf16_dpp v11, v35, v100 row_newbcast:9 row_mask:0xf bank_mask:0xf
    v_dot2c_f32_bf16_dpp v12, v27, v101 row_newbcast:9 row_mask:0xf bank_mask:0xf
    v_dot2c_f32_bf16_dpp v13, v35, v101 row_newbcast:9 row_mask:0xf bank_mask:0xf
    v_dot2c_f32_bf16_dpp v14, v27, v102 row_newbcast:9 row_mask:0xf bank_mask:0xf
    v_dot2c_f32_bf16_dpp v15, v35, v102 row_newbcast:9 row_mask:0xf bank_mask:0xf
    v_dot2c_f32_bf16_dpp v16, v27, v103 row_newbcast:9 row_mask:0xf bank_mask:0xf
    v_dot2c_f32_bf16_dpp v17, v35, v103 row_newbcast:9 row_mask:0xf bank_mask:0xf
    buffer_load_dwordx4 v[124:127], v1, s[36:39], s70 offen nt
    s_add_u32 s70, s70, 0x9000
    v_perm_b32 v176, v181, v177, s82
    v_perm_b32 v181, v181, v177, s83
    s_waitcnt vmcnt(5)
    v_dot2c_f32_bf16_dpp v10, v27, v104 row_newbcast:10 row_mask:0xf bank_mask:0xf
    v_dot2c_f32_bf16_dpp v11, v35, v104 row_newbcast:10 row_mask:0xf bank_mask:0xf
    v_dot2c_f32_bf16_dpp v12, v27, v105 row_newbcast:10 row_mask:0xf bank_mask:0xf
    v_dot2c_f32_bf16_dpp v13, v35, v105 row_newbcast:10 row_mask:0xf bank_mask:0xf
    v_dot2c_f32_bf16_dpp v14, v27, v106 row_newbcast:10 row_mask:0xf bank_mask:0xf
    v_dot2c_f32_bf16_dpp v15, v35, v106 row_newbcast:10 row_mask:0xf bank_mask:0xf
    v_dot2c_f32_bf16_dpp v16, v27, v107 row_newbcast:10 row_mask:0xf bank_mask:0xf
    v_dot2c_f32_bf16_dpp v17, v35, v107 row_newbcast:10 row_mask:0xf bank_mask:0xf
    buffer_load_dwordx4 v[64:67], v1, s[36:39], s70 offen nt
    s_add_u32 s70, s70, 0x1000
    v_perm_b32 v177, v182, v178, s82
    v_perm_b32 v182, v182, v178, s83
    s_waitcnt vmcnt(5)
    v_dot2c_f32_bf16_dpp v10, v27, v108 row_newbcast:11 row_mask:0xf bank_mask:0xf
    v_dot2c_f32_bf16_dpp v11, v35, v108 row_newbcast:11 row_mask:0xf bank_mask:0xf
    v_dot2c_f32_bf16_dpp v12, v27, v109 row_newbcast:11 row_mask:0xf bank_mask:0xf
    v_dot2c_f32_bf16_dpp v13, v35, v109 row_newbcast:11 row_mask:0xf bank_mask:0xf
    v_dot2c_f32_bf16_dpp v14, v27, v110 row_newbcast:11 row_mask:0xf bank_mask:0xf
    v_dot2c_f32_bf16_dpp v15, v35, v110 row_newbcast:11 row_mask:0xf bank_mask:0xf
    v_dot2c_f32_bf16_dpp v16, v27, v111 row_newbcast:11 row_mask:0xf bank_mask:0xf
    v_dot2c_f32_bf16_dpp v17, v35, v111 row_newbcast:11 row_mask:0xf bank_mask:0xf
    buffer_load_dwordx4 v[68:71], v1, s[36:39], s70 offen nt
    s_add_u32 s70, s70, 0x1000
    v_perm_b32 v178, v183, v179, s82
    v_perm_b32 v183, v183, v179, s83
    s_waitcnt vmcnt(5)
    v_dot2c_f32_bf16_dpp v10, v27, v112 row_newbcast:12 row_mask:0xf bank_mask:0xf
    v_dot2c_f32_bf16_dpp v11, v35, v112 row_newbcast:12 row_mask:0xf bank_mask:0xf
    v_dot2c_f32_bf16_dpp v12, v27, v113 row_newbcast:12 row_mask:0xf bank_mask:0xf
    v_dot2c_f32_bf16_dpp v13, v35, v113 row_newbcast:12 row_mask:0xf bank_mask:0xf
    v_dot2c_f32_bf16_dpp v14, v27, v114 row_newbcast:12 row_mask:0xf bank_mask:0xf
    v_dot2c_f32_bf16_dpp v15, v35, v114 row_newbcast:12 row_mask:0xf bank_mask:0xf
    v_dot2c_f32_bf16_dpp v16, v27, v115 row_newbcast:12 row_mask:0xf bank_mask:0xf
    v_dot2c_f32_bf16_dpp v17, v35, v115 row_newbcast:12 row_mask:0xf bank_mask:0xf
    buffer_load_dwordx4 v[72:75], v1, s[36:39], s70 offen nt
    s_add_u32 s70, s70, 0x1000
    v_perm_b32 v179, v188, v184, s82
    v_perm_b32 v188, v188, v184, s83
    s_waitcnt vmcnt(5)
    v_dot2c_f32_bf16_dpp v10, v27, v116 row_newbcast:13 row_mask:0xf bank_mask:0xf
    v_dot2c_f32_bf16_dpp v11, v35, v116 row_newbcast:13 row_mask:0xf bank_mask:0xf
    v_dot2c_f32_bf16_dpp v12, v27, v117 row_newbcast:13 row_mask:0xf bank_mask:0xf
    v_dot2c_f32_bf16_dpp v13, v35, v117 row_newbcast:13 row_mask:0xf bank_mask:0xf
    v_dot2c_f32_bf16_dpp v14, v27, v118 row_newbcast:13 row_mask:0xf bank_mask:0xf
    v_dot2c_f32_bf16_dpp v15, v35, v118 row_newbcast:13 row_mask:0xf bank_mask:0xf
    v_dot2c_f32_bf16_dpp v16, v27, v119 row_newbcast:13 row_mask:0xf bank_mask:0xf
    v_dot2c_f32_bf16_dpp v17, v35, v119 row_newbcast:13 row_mask:0xf bank_mask:0xf
    buffer_load_dwordx4 v[76:79], v1, s[36:39], s70 offen nt
    s_add_u32 s70, s70, 0x1000
    v_perm_b32 v184, v189, v185, s82
    v_perm_b32 v189, v189, v185, s83
    s_waitcnt vmcnt(5)
    v_dot2c_f32_bf16_dpp v10, v27, v120 row_newbcast:14 row_mask:0xf bank_mask:0xf
    v_dot2c_f32_bf16_dpp v11, v35, v120 row_newbcast:14 row_mask:0xf bank_mask:0xf
    v_dot2c_f32_bf16_dpp v12, v27, v121 row_newbcast:14 row_mask:0xf bank_mask:0xf
    v_dot2c_f32_bf16_dpp v13, v35, v121 row_newbcast:14 row_mask:0xf bank_mask:0xf
    v_dot2c_f32_bf16_dpp v14, v27, v122 row_newbcast:14 row_mask:0xf bank_mask:0xf
    v_dot2c_f32_bf16_dpp v15, v35, v122 row_newbcast:14 row_mask:0xf bank_mask:0xf
    v_dot2c_f32_bf16_dpp v16, v27, v123 row_newbcast:14 row_mask:0xf bank_mask:0xf
    v_dot2c_f32_bf16_dpp v17, v35, v123 row_newbcast:14 row_mask:0xf bank_mask:0xf
    buffer_load_dwordx4 v[80:83], v1, s[36:39], s70 offen nt
    s_add_u32 s70, s70, 0x1000
    v_perm_b32 v185, v190, v186, s82
    v_perm_b32 v190, v190, v186, s83
    s_waitcnt vmcnt(5)
    v_dot2c_f32_bf16_dpp v10, v27, v124 row_newbcast:15 row_mask:0xf bank_mask:0xf
    v_dot2c_f32_bf16_dpp v11, v35, v124 row_newbcast:15 row_mask:0xf bank_mask:0xf
    v_dot2c_f32_bf16_dpp v12, v27, v125 row_newbcast:15 row_mask:0xf bank_mask:0xf
    v_dot2c_f32_bf16_dpp v13, v35, v125 row_newbcast:15 row_mask:0xf bank_mask:0xf
    v_dot2c_f32_bf16_dpp v14, v27, v126 row_newbcast:15 row_mask:0xf bank_mask:0xf
    v_dot2c_f32_bf16_dpp v15, v35, v126 row_newbcast:15 row_mask:0xf bank_mask:0xf
    v_dot2c_f32_bf16_dpp v16, v27, v127 row_newbcast:15 row_mask:0xf bank_mask:0xf
    v_dot2c_f32_bf16_dpp v17, v35, v127 row_newbcast:15 row_mask:0xf bank_mask:0xf
    buffer_load_dwordx4 v[84:87], v1, s[36:39], s70 offen nt
    s_add_u32 s70, s70, 0x1000
    v_perm_b32 v186, v191, v187, s82
    v_perm_b32 v191, v191, v187, s83
    s_waitcnt vmcnt(5)
    v_dot2c_f32_bf16_dpp v10, v28, v64 row_newbcast:0 row_mask:0xf bank_mask:0xf
    v_dot2c_f32_bf16_dpp v11, v36, v64 row_newbcast:0 row_mask:0xf bank_mask:0xf
    v_dot2c_f32_bf16_dpp v12, v28, v65 row_newbcast:0 row_mask:0xf bank_mask:0xf
    v_dot2c_f32_bf16_dpp v13, v36, v65 row_newbcast:0 row_mask:0xf bank_mask:0xf
    v_dot2c_f32_bf16_dpp v14, v28, v66 row_newbcast:0 row_mask:0xf bank_mask:0xf
    v_dot2c_f32_bf16_dpp v15, v36, v66 row_newbcast:0 row_mask:0xf bank_mask:0xf
    v_dot2c_f32_bf16_dpp v16, v28, v67 row_newbcast:0 row_mask:0xf bank_mask:0xf
    v_dot2c_f32_bf16_dpp v17, v36, v67 row_newbcast:0 row_mask:0xf bank_mask:0xf
    buffer_load_dwordx4 v[88:91], v1, s[36:39], s70 offen nt
    s_add_u32 s70, s70, 0x1000
    v_perm_b32 v187, v196, v192, s82
    v_perm_b32 v196, v196, v192, s83
    s_waitcnt vmcnt(5)
    v_dot2c_f32_bf16_dpp v10, v28, v68 row_newbcast:1 row_mask:0xf bank_mask:0xf
    v_dot2c_f32_bf16_dpp v11, v36, v68 row_newbcast:1 row_mask:0xf bank_mask:0xf
    v_dot2c_f32_bf16_dpp v12, v28, v69 row_newbcast:1 row_mask:0xf bank_mask:0xf
    v_dot2c_f32_bf16_dpp v13, v36, v69 row_newbcast:1 row_mask:0xf bank_mask:0xf
    v_dot2c_f32_bf16_dpp v14, v28, v70 row_newbcast:1 row_mask:0xf bank_mask:0xf
    v_dot2c_f32_bf16_dpp v15, v36, v70 row_newbcast:1 row_mask:0xf bank_mask:0xf
    v_dot2c_f32_bf16_dpp v16, v28, v71 row_newbcast:1 row_mask:0xf bank_mask:0xf
    v_dot2c_f32_bf16_dpp v17, v36, v71 row_newbcast:1 row_mask:0xf bank_mask:0xf
    buffer_load_dwordx4 v[92:95], v1, s[36:39], s70 offen nt
    s_add_u32 s70, s70, 0x9000
    v_perm_b32 v192, v197, v193, s82
    v_perm_b32 v197, v197, v193, s83
    s_waitcnt vmcnt(5)
    v_dot2c_f32_bf16_dpp v10, v28, v72 row_newbcast:2 row_mask:0xf bank_mask:0xf
    v_dot2c_f32_bf16_dpp v11, v36, v72 row_newbcast:2 row_mask:0xf bank_mask:0xf
    v_dot2c_f32_bf16_dpp v12, v28, v73 row_newbcast:2 row_mask:0xf bank_mask:0xf
    v_dot2c_f32_bf16_dpp v13, v36, v73 row_newbcast:2 row_mask:0xf bank_mask:0xf
    v_dot2c_f32_bf16_dpp v14, v28, v74 row_newbcast:2 row_mask:0xf bank_mask:0xf
    v_dot2c_f32_bf16_dpp v15, v36, v74 row_newbcast:2 row_mask:0xf bank_mask:0xf
    v_dot2c_f32_bf16_dpp v16, v28, v75 row_newbcast:2 row_mask:0xf bank_mask:0xf
    v_dot2c_f32_bf16_dpp v17, v36, v75 row_newbcast:2 row_mask:0xf bank_mask:0xf
    buffer_load_dwordx4 v[96:99], v1, s[36:39], s70 offen nt
    s_add_u32 s70, s70, 0x1000
    v_perm_b32 v193, v198, v194, s82
    v_perm_b32 v198, v198, v194, s83
    s_waitcnt vmcnt(5)
    v_dot2c_f32_bf16_dpp v10, v28, v76 row_newbcast:3 row_mask:0xf bank_mask:0xf
    v_dot2c_f32_bf16_dpp v11, v36, v76 row_newbcast:3 row_mask:0xf bank_mask:0xf
    v_dot2c_f32_bf16_dpp v12, v28, v77 row_newbcast:3 row_mask:0xf bank_mask:0xf
    v_dot2c_f32_bf16_dpp v13, v36, v77 row_newbcast:3 row_mask:0xf bank_mask:0xf
    v_dot2c_f32_bf16_dpp v14, v28, v78 row_newbcast:3 row_mask:0xf bank_mask:0xf
    v_dot2c_f32_bf16_dpp v15, v36, v78 row_newbcast:3 row_mask:0xf bank_mask:0xf
    v_dot2c_f32_bf16_dpp v16, v28, v79 row_newbcast:3 row_mask:0xf bank_mask:0xf
    v_dot2c_f32_bf16_dpp v17, v36, v79 row_newbcast:3 row_mask:0xf bank_mask:0xf
    buffer_load_dwordx4 v[100:103], v1, s[36:39], s70 offen nt
    s_add_u32 s70, s70, 0x1000
    v_perm_b32 v194, v199, v195, s82
    v_perm_b32 v199, v199, v195, s83
    s_waitcnt vmcnt(5)
    v_dot2c_f32_bf16_dpp v10, v28, v80 row_newbcast:4 row_mask:0xf bank_mask:0xf
    v_dot2c_f32_bf16_dpp v11, v36, v80 row_newbcast:4 row_mask:0xf bank_mask:0xf
    v_dot2c_f32_bf16_dpp v12, v28, v81 row_newbcast:4 row_mask:0xf bank_mask:0xf
    v_dot2c_f32_bf16_dpp v13, v36, v81 row_newbcast:4 row_mask:0xf bank_mask:0xf
    v_dot2c_f32_bf16_dpp v14, v28, v82 row_newbcast:4 row_mask:0xf bank_mask:0xf
    v_dot2c_f32_bf16_dpp v15, v36, v82 row_newbcast:4 row_mask:0xf bank_mask:0xf
    v_dot2c_f32_bf16_dpp v16, v28, v83 row_newbcast:4 row_mask:0xf bank_mask:0xf
    v_dot2c_f32_bf16_dpp v17, v36, v83 row_newbcast:4 row_mask:0xf bank_mask:0xf
    buffer_load_dwordx4 v[104:107], v1, s[36:39], s70 offen nt
    s_add_u32 s70, s70, 0x1000
    v_perm_b32 v195, v204, v200, s82
    v_perm_b32 v204, v204, v200, s83
    s_waitcnt vmcnt(5)
    v_dot2c_f32_bf16_dpp v10, v28, v84 row_newbcast:5 row_mask:0xf bank_mask:0xf
    v_dot2c_f32_bf16_dpp v11, v36, v84 row_newbcast:5 row_mask:0xf bank_mask:0xf
    v_dot2c_f32_bf16_dpp v12, v28, v85 row_newbcast:5 row_mask:0xf bank_mask:0xf
    v_dot2c_f32_bf16_dpp v13, v36, v85 row_newbcast:5 row_mask:0xf bank_mask:0xf
    v_dot2c_f32_bf16_dpp v14, v28, v86 row_newbcast:5 row_mask:0xf bank_mask:0xf
    v_dot2c_f32_bf16_dpp v15, v36, v86 row_newbcast:5 row_mask:0xf bank_mask:0xf
    v_dot2c_f32_bf16_dpp v16, v28, v87 row_newbcast:5 row_mask:0xf bank_mask:0xf
    v_dot2c_f32_bf16_dpp v17, v36, v87 row_newbcast:5 row_mask:0xf bank_mask:0xf
    buffer_load_dwordx4 v[108:111], v1, s[36:39], s70 offen nt
    s_add_u32 s70, s70, 0x1000
    v_perm_b32 v200, v205, v201, s82
    v_perm_b32 v205, v205, v201, s83
    s_waitcnt vmcnt(5)
    v_dot2c_f32_bf16_dpp v10, v28, v88 row_newbcast:6 row_mask:0xf bank_mask:0xf
    v_dot2c_f32_bf16_dpp v11, v36, v88 row_newbcast:6 row_mask:0xf bank_mask:0xf
    v_dot2c_f32_bf16_dpp v12, v28, v89 row_newbcast:6 row_mask:0xf bank_mask:0xf
    v_dot2c_f32_bf16_dpp v13, v36, v89 row_newbcast:6 row_mask:0xf bank_mask:0xf
    v_dot2c_f32_bf16_dpp v14, v28, v90 row_newbcast:6 row_mask:0xf bank_mask:0xf
    v_dot2c_f32_bf16_dpp v15, v36, v90 row_newbcast:6 row_mask:0xf bank_mask:0xf
    v_dot2c_f32_bf16_dpp v16, v28, v91 row_newbcast:6 row_mask:0xf bank_mask:0xf
    v_dot2c_f32_bf16_dpp v17, v36, v91 row_newbcast:6 row_mask:0xf bank_mask:0xf
    buffer_load_dwordx4 v[112:115], v1, s[36:39], s70 offen nt
    s_add_u32 s70, s70, 0x1000
    v_perm_b32 v201, v206, v202, s82
    v_perm_b32 v206, v206, v202, s83
    s_waitcnt vmcnt(5)
    v_dot2c_f32_bf16_dpp v10, v28, v92 row_newbcast:7 row_mask:0xf bank_mask:0xf
    v_dot2c_f32_bf16_dpp v11, v36, v92 row_newbcast:7 row_mask:0xf bank_mask:0xf
    v_dot2c_f32_bf16_dpp v12, v28, v93 row_newbcast:7 row_mask:0xf bank_mask:0xf
    v_dot2c_f32_bf16_dpp v13, v36, v93 row_newbcast:7 row_mask:0xf bank_mask:0xf
    v_dot2c_f32_bf16_dpp v14, v28, v94 row_newbcast:7 row_mask:0xf bank_mask:0xf
    v_dot2c_f32_bf16_dpp v15, v36, v94 row_newbcast:7 row_mask:0xf bank_mask:0xf
    v_dot2c_f32_bf16_dpp v16, v28, v95 row_newbcast:7 row_mask:0xf bank_mask:0xf
    v_dot2c_f32_bf16_dpp v17, v36, v95 row_newbcast:7 row_mask:0xf bank_mask:0xf
    buffer_load_dwordx4 v[116:119], v1, s[36:39], s70 offen nt
    s_add_u32 s70, s70, 0x1000
    v_perm_b32 v202, v207, v203, s82
    v_perm_b32 v207, v207, v203, s83
    s_waitcnt vmcnt(5)
    v_dot2c_f32_bf16_dpp v10, v28, v96 row_newbcast:8 row_mask:0xf bank_mask:0xf
    v_dot2c_f32_bf16_dpp v11, v36, v96 row_newbcast:8 row_mask:0xf bank_mask:0xf
    v_dot2c_f32_bf16_dpp v12, v28, v97 row_newbcast:8 row_mask:0xf bank_mask:0xf
    v_dot2c_f32_bf16_dpp v13, v36, v97 row_newbcast:8 row_mask:0xf bank_mask:0xf
    v_dot2c_f32_bf16_dpp v14, v28, v98 row_newbcast:8 row_mask:0xf bank_mask:0xf
    v_dot2c_f32_bf16_dpp v15, v36, v98 row_newbcast:8 row_mask:0xf bank_mask:0xf
    v_dot2c_f32_bf16_dpp v16, v28, v99 row_newbcast:8 row_mask:0xf bank_mask:0xf
    v_dot2c_f32_bf16_dpp v17, v36, v99 row_newbcast:8 row_mask:0xf bank_mask:0xf
    buffer_load_dwordx4 v[120:123], v1, s[36:39], s70 offen nt
    s_add_u32 s70, s70, 0x1000
    v_perm_b32 v203, v212, v208, s82
    v_perm_b32 v212, v212, v208, s83
    s_waitcnt vmcnt(5)
    v_dot2c_f32_bf16_dpp v10, v28, v100 row_newbcast:9 row_mask:0xf bank_mask:0xf
    v_dot2c_f32_bf16_dpp v11, v36, v100 row_newbcast:9 row_mask:0xf bank_mask:0xf
    v_dot2c_f32_bf16_dpp v12, v28, v101 row_newbcast:9 row_mask:0xf bank_mask:0xf
    v_dot2c_f32_bf16_dpp v13, v36, v101 row_newbcast:9 row_mask:0xf bank_mask:0xf
    v_dot2c_f32_bf16_dpp v14, v28, v102 row_newbcast:9 row_mask:0xf bank_mask:0xf
    v_dot2c_f32_bf16_dpp v15, v36, v102 row_newbcast:9 row_mask:0xf bank_mask:0xf
    v_dot2c_f32_bf16_dpp v16, v28, v103 row_newbcast:9 row_mask:0xf bank_mask:0xf
    v_dot2c_f32_bf16_dpp v17, v36, v103 row_newbcast:9 row_mask:0xf bank_mask:0xf
    buffer_load_dwordx4 v[124:127], v1, s[36:39], s70 offen nt
    s_add_u32 s70, s70, 0x9000
    v_perm_b32 v208, v213, v209, s82
    v_perm_b32 v213, v213, v209, s83
    s_waitcnt vmcnt(5)
    v_dot2c_f32_bf16_dpp v10, v28, v104 row_newbcast:10 row_mask:0xf bank_mask:0xf
    v_dot2c_f32_bf16_dpp v11, v36, v104 row_newbcast:10 row_mask:0xf bank_mask:0xf
    v_dot2c_f32_bf16_dpp v12, v28, v105 row_newbcast:10 row_mask:0xf bank_mask:0xf
    v_dot2c_f32_bf16_dpp v13, v36, v105 row_newbcast:10 row_mask:0xf bank_mask:0xf
    v_dot2c_f32_bf16_dpp v14, v28, v106 row_newbcast:10 row_mask:0xf bank_mask:0xf
    v_dot2c_f32_bf16_dpp v15, v36, v106 row_newbcast:10 row_mask:0xf bank_mask:0xf
    v_dot2c_f32_bf16_dpp v16, v28, v107 row_newbcast:10 row_mask:0xf bank_mask:0xf
    v_dot2c_f32_bf16_dpp v17, v36, v107 row_newbcast:10 row_mask:0xf bank_mask:0xf
    buffer_load_dwordx4 v[64:67], v1, s[36:39], s70 offen nt
    s_add_u32 s70, s70, 0x1000
    v_perm_b32 v209, v214, v210, s82
    v_perm_b32 v214, v214, v210, s83
    s_waitcnt vmcnt(5)
    v_dot2c_f32_bf16_dpp v10, v28, v108 row_newbcast:11 row_mask:0xf bank_mask:0xf
    v_dot2c_f32_bf16_dpp v11, v36, v108 row_newbcast:11 row_mask:0xf bank_mask:0xf
    v_dot2c_f32_bf16_dpp v12, v28, v109 row_newbcast:11 row_mask:0xf bank_mask:0xf
    v_dot2c_f32_bf16_dpp v13, v36, v109 row_newbcast:11 row_mask:0xf bank_mask:0xf
    v_dot2c_f32_bf16_dpp v14, v28, v110 row_newbcast:11 row_mask:0xf bank_mask:0xf
    v_dot2c_f32_bf16_dpp v15, v36, v110 row_newbcast:11 row_mask:0xf bank_mask:0xf
    v_dot2c_f32_bf16_dpp v16, v28, v111 row_newbcast:11 row_mask:0xf bank_mask:0xf
    v_dot2c_f32_bf16_dpp v17, v36, v111 row_newbcast:11 row_mask:0xf bank_mask:0xf
    buffer_load_dwordx4 v[68:71], v1, s[36:39], s70 offen nt
    s_add_u32 s70, s70, 0x1000
    v_perm_b32 v210, v215, v211, s82
    v_perm_b32 v215, v215, v211, s83
    s_waitcnt vmcnt(5)
    v_dot2c_f32_bf16_dpp v10, v28, v112 row_newbcast:12 row_mask:0xf bank_mask:0xf
    v_dot2c_f32_bf16_dpp v11, v36, v112 row_newbcast:12 row_mask:0xf bank_mask:0xf
    v_dot2c_f32_bf16_dpp v12, v28, v113 row_newbcast:12 row_mask:0xf bank_mask:0xf
    v_dot2c_f32_bf16_dpp v13, v36, v113 row_newbcast:12 row_mask:0xf bank_mask:0xf
    v_dot2c_f32_bf16_dpp v14, v28, v114 row_newbcast:12 row_mask:0xf bank_mask:0xf
    v_dot2c_f32_bf16_dpp v15, v36, v114 row_newbcast:12 row_mask:0xf bank_mask:0xf
    v_dot2c_f32_bf16_dpp v16, v28, v115 row_newbcast:12 row_mask:0xf bank_mask:0xf
    v_dot2c_f32_bf16_dpp v17, v36, v115 row_newbcast:12 row_mask:0xf bank_mask:0xf
    buffer_load_dwordx4 v[72:75], v1, s[36:39], s70 offen nt
    s_add_u32 s70, s70, 0x1000
    v_perm_b32 v211, v220, v216, s82
    v_perm_b32 v220, v220, v216, s83
    s_waitcnt vmcnt(5)
    v_dot2c_f32_bf16_dpp v10, v28, v116 row_newbcast:13 row_mask:0xf bank_mask:0xf
    v_dot2c_f32_bf16_dpp v11, v36, v116 row_newbcast:13 row_mask:0xf bank_mask:0xf
    v_dot2c_f32_bf16_dpp v12, v28, v117 row_newbcast:13 row_mask:0xf bank_mask:0xf
    v_dot2c_f32_bf16_dpp v13, v36, v117 row_newbcast:13 row_mask:0xf bank_mask:0xf
    v_dot2c_f32_bf16_dpp v14, v28, v118 row_newbcast:13 row_mask:0xf bank_mask:0xf
    v_dot2c_f32_bf16_dpp v15, v36, v118 row_newbcast:13 row_mask:0xf bank_mask:0xf
    v_dot2c_f32_bf16_dpp v16, v28, v119 row_newbcast:13 row_mask:0xf bank_mask:0xf
    v_dot2c_f32_bf16_dpp v17, v36, v119 row_newbcast:13 row_mask:0xf bank_mask:0xf
    buffer_load_dwordx4 v[76:79], v1, s[36:39], s70 offen nt
    s_add_u32 s70, s70, 0x1000
    v_perm_b32 v216, v221, v217, s82
    v_perm_b32 v221, v221, v217, s83
    s_waitcnt vmcnt(5)
    v_dot2c_f32_bf16_dpp v10, v28, v120 row_newbcast:14 row_mask:0xf bank_mask:0xf
    v_dot2c_f32_bf16_dpp v11, v36, v120 row_newbcast:14 row_mask:0xf bank_mask:0xf
    v_dot2c_f32_bf16_dpp v12, v28, v121 row_newbcast:14 row_mask:0xf bank_mask:0xf
    v_dot2c_f32_bf16_dpp v13, v36, v121 row_newbcast:14 row_mask:0xf bank_mask:0xf
    v_dot2c_f32_bf16_dpp v14, v28, v122 row_newbcast:14 row_mask:0xf bank_mask:0xf
    v_dot2c_f32_bf16_dpp v15, v36, v122 row_newbcast:14 row_mask:0xf bank_mask:0xf
    v_dot2c_f32_bf16_dpp v16, v28, v123 row_newbcast:14 row_mask:0xf bank_mask:0xf
    v_dot2c_f32_bf16_dpp v17, v36, v123 row_newbcast:14 row_mask:0xf bank_mask:0xf
    buffer_load_dwordx4 v[80:83], v1, s[36:39], s70 offen nt
    s_add_u32 s70, s70, 0x1000
    v_perm_b32 v217, v222, v218, s82
    v_perm_b32 v222, v222, v218, s83
    s_waitcnt vmcnt(5)
    v_dot2c_f32_bf16_dpp v10, v28, v124 row_newbcast:15 row_mask:0xf bank_mask:0xf
    v_dot2c_f32_bf16_dpp v11, v36, v124 row_newbcast:15 row_mask:0xf bank_mask:0xf
    v_dot2c_f32_bf16_dpp v12, v28, v125 row_newbcast:15 row_mask:0xf bank_mask:0xf
    v_dot2c_f32_bf16_dpp v13, v36, v125 row_newbcast:15 row_mask:0xf bank_mask:0xf
    v_dot2c_f32_bf16_dpp v14, v28, v126 row_newbcast:15 row_mask:0xf bank_mask:0xf
    v_dot2c_f32_bf16_dpp v15, v36, v126 row_newbcast:15 row_mask:0xf bank_mask:0xf
    v_dot2c_f32_bf16_dpp v16, v28, v127 row_newbcast:15 row_mask:0xf bank_mask:0xf
    v_dot2c_f32_bf16_dpp v17, v36, v127 row_newbcast:15 row_mask:0xf bank_mask:0xf
    buffer_load_dwordx4 v[84:87], v1, s[36:39], s70 offen nt
    s_add_u32 s70, s70, 0x1000
    v_perm_b32 v218, v223, v219, s82
    v_perm_b32 v223, v223, v219, s83
    s_waitcnt vmcnt(5)
    v_dot2c_f32_bf16_dpp v10, v29, v64 row_newbcast:0 row_mask:0xf bank_mask:0xf
    v_dot2c_f32_bf16_dpp v11, v37, v64 row_newbcast:0 row_mask:0xf bank_mask:0xf
    v_dot2c_f32_bf16_dpp v12, v29, v65 row_newbcast:0 row_mask:0xf bank_mask:0xf
    v_dot2c_f32_bf16_dpp v13, v37, v65 row_newbcast:0 row_mask:0xf bank_mask:0xf
    v_dot2c_f32_bf16_dpp v14, v29, v66 row_newbcast:0 row_mask:0xf bank_mask:0xf
    v_dot2c_f32_bf16_dpp v15, v37, v66 row_newbcast:0 row_mask:0xf bank_mask:0xf
    v_dot2c_f32_bf16_dpp v16, v29, v67 row_newbcast:0 row_mask:0xf bank_mask:0xf
    v_dot2c_f32_bf16_dpp v17, v37, v67 row_newbcast:0 row_mask:0xf bank_mask:0xf
    buffer_load_dwordx4 v[88:91], v1, s[36:39], s70 offen nt
    s_add_u32 s70, s70, 0x1000
    v_perm_b32 v219, v228, v224, s82
    v_perm_b32 v228, v228, v224, s83
    s_waitcnt vmcnt(5)
    v_dot2c_f32_bf16_dpp v10, v29, v68 row_newbcast:1 row_mask:0xf bank_mask:0xf
    v_dot2c_f32_bf16_dpp v11, v37, v68 row_newbcast:1 row_mask:0xf bank_mask:0xf
    v_dot2c_f32_bf16_dpp v12, v29, v69 row_newbcast:1 row_mask:0xf bank_mask:0xf
    v_dot2c_f32_bf16_dpp v13, v37, v69 row_newbcast:1 row_mask:0xf bank_mask:0xf
    v_dot2c_f32_bf16_dpp v14, v29, v70 row_newbcast:1 row_mask:0xf bank_mask:0xf
    v_dot2c_f32_bf16_dpp v15, v37, v70 row_newbcast:1 row_mask:0xf bank_mask:0xf
    v_dot2c_f32_bf16_dpp v16, v29, v71 row_newbcast:1 row_mask:0xf bank_mask:0xf
    v_dot2c_f32_bf16_dpp v17, v37, v71 row_newbcast:1 row_mask:0xf bank_mask:0xf
    buffer_load_dwordx4 v[92:95], v1, s[36:39], s70 offen nt
    s_add_u32 s70, s70, 0x9000
    v_perm_b32 v224, v229, v225, s82
    v_perm_b32 v229, v229, v225, s83
    s_waitcnt vmcnt(5)
    v_dot2c_f32_bf16_dpp v10, v29, v72 row_newbcast:2 row_mask:0xf bank_mask:0xf
    v_dot2c_f32_bf16_dpp v11, v37, v72 row_newbcast:2 row_mask:0xf bank_mask:0xf
    v_dot2c_f32_bf16_dpp v12, v29, v73 row_newbcast:2 row_mask:0xf bank_mask:0xf
    v_dot2c_f32_bf16_dpp v13, v37, v73 row_newbcast:2 row_mask:0xf bank_mask:0xf
    v_dot2c_f32_bf16_dpp v14, v29, v74 row_newbcast:2 row_mask:0xf bank_mask:0xf
    v_dot2c_f32_bf16_dpp v15, v37, v74 row_newbcast:2 row_mask:0xf bank_mask:0xf
    v_dot2c_f32_bf16_dpp v16, v29, v75 row_newbcast:2 row_mask:0xf bank_mask:0xf
    v_dot2c_f32_bf16_dpp v17, v37, v75 row_newbcast:2 row_mask:0xf bank_mask:0xf
    buffer_load_dwordx4 v[96:99], v1, s[36:39], s70 offen nt
    s_add_u32 s70, s70, 0x1000
    v_perm_b32 v225, v230, v226, s82
    v_perm_b32 v230, v230, v226, s83
    s_waitcnt vmcnt(5)
    v_dot2c_f32_bf16_dpp v10, v29, v76 row_newbcast:3 row_mask:0xf bank_mask:0xf
    v_dot2c_f32_bf16_dpp v11, v37, v76 row_newbcast:3 row_mask:0xf bank_mask:0xf
    v_dot2c_f32_bf16_dpp v12, v29, v77 row_newbcast:3 row_mask:0xf bank_mask:0xf
    v_dot2c_f32_bf16_dpp v13, v37, v77 row_newbcast:3 row_mask:0xf bank_mask:0xf
    v_dot2c_f32_bf16_dpp v14, v29, v78 row_newbcast:3 row_mask:0xf bank_mask:0xf
    v_dot2c_f32_bf16_dpp v15, v37, v78 row_newbcast:3 row_mask:0xf bank_mask:0xf
    v_dot2c_f32_bf16_dpp v16, v29, v79 row_newbcast:3 row_mask:0xf bank_mask:0xf
    v_dot2c_f32_bf16_dpp v17, v37, v79 row_newbcast:3 row_mask:0xf bank_mask:0xf
    buffer_load_dwordx4 v[100:103], v1, s[36:39], s70 offen nt
    s_add_u32 s70, s70, 0x1000
    v_perm_b32 v226, v231, v227, s82
    v_perm_b32 v231, v231, v227, s83
    s_waitcnt vmcnt(5)
    v_dot2c_f32_bf16_dpp v10, v29, v80 row_newbcast:4 row_mask:0xf bank_mask:0xf
    v_dot2c_f32_bf16_dpp v11, v37, v80 row_newbcast:4 row_mask:0xf bank_mask:0xf
    v_dot2c_f32_bf16_dpp v12, v29, v81 row_newbcast:4 row_mask:0xf bank_mask:0xf
    v_dot2c_f32_bf16_dpp v13, v37, v81 row_newbcast:4 row_mask:0xf bank_mask:0xf
    v_dot2c_f32_bf16_dpp v14, v29, v82 row_newbcast:4 row_mask:0xf bank_mask:0xf
    v_dot2c_f32_bf16_dpp v15, v37, v82 row_newbcast:4 row_mask:0xf bank_mask:0xf
    v_dot2c_f32_bf16_dpp v16, v29, v83 row_newbcast:4 row_mask:0xf bank_mask:0xf
    v_dot2c_f32_bf16_dpp v17, v37, v83 row_newbcast:4 row_mask:0xf bank_mask:0xf
    buffer_load_dwordx4 v[104:107], v1, s[36:39], s70 offen nt
    s_add_u32 s70, s70, 0x1000
    v_perm_b32 v227, v236, v232, s82
    v_perm_b32 v236, v236, v232, s83
    s_waitcnt vmcnt(5)
    v_dot2c_f32_bf16_dpp v10, v29, v84 row_newbcast:5 row_mask:0xf bank_mask:0xf
    v_dot2c_f32_bf16_dpp v11, v37, v84 row_newbcast:5 row_mask:0xf bank_mask:0xf
    v_dot2c_f32_bf16_dpp v12, v29, v85 row_newbcast:5 row_mask:0xf bank_mask:0xf
    v_dot2c_f32_bf16_dpp v13, v37, v85 row_newbcast:5 row_mask:0xf bank_mask:0xf
    v_dot2c_f32_bf16_dpp v14, v29, v86 row_newbcast:5 row_mask:0xf bank_mask:0xf
    v_dot2c_f32_bf16_dpp v15, v37, v86 row_newbcast:5 row_mask:0xf bank_mask:0xf
    v_dot2c_f32_bf16_dpp v16, v29, v87 row_newbcast:5 row_mask:0xf bank_mask:0xf
    v_dot2c_f32_bf16_dpp v17, v37, v87 row_newbcast:5 row_mask:0xf bank_mask:0xf
    buffer_load_dwordx4 v[108:111], v1, s[36:39], s70 offen nt
    s_add_u32 s70, s70, 0x1000
    v_perm_b32 v232, v237, v233, s82
    v_perm_b32 v237, v237, v233, s83
    s_waitcnt vmcnt(5)
    v_dot2c_f32_bf16_dpp v10, v29, v88 row_newbcast:6 row_mask:0xf bank_mask:0xf
    v_dot2c_f32_bf16_dpp v11, v37, v88 row_newbcast:6 row_mask:0xf bank_mask:0xf
    v_dot2c_f32_bf16_dpp v12, v29, v89 row_newbcast:6 row_mask:0xf bank_mask:0xf
    v_dot2c_f32_bf16_dpp v13, v37, v89 row_newbcast:6 row_mask:0xf bank_mask:0xf
    v_dot2c_f32_bf16_dpp v14, v29, v90 row_newbcast:6 row_mask:0xf bank_mask:0xf
    v_dot2c_f32_bf16_dpp v15, v37, v90 row_newbcast:6 row_mask:0xf bank_mask:0xf
    v_dot2c_f32_bf16_dpp v16, v29, v91 row_newbcast:6 row_mask:0xf bank_mask:0xf
    v_dot2c_f32_bf16_dpp v17, v37, v91 row_newbcast:6 row_mask:0xf bank_mask:0xf
    buffer_load_dwordx4 v[112:115], v1, s[36:39], s70 offen nt
    s_add_u32 s70, s70, 0x1000
    v_perm_b32 v233, v238, v234, s82
    v_perm_b32 v238, v238, v234, s83
    s_waitcnt vmcnt(5)
    v_dot2c_f32_bf16_dpp v10, v29, v92 row_newbcast:7 row_mask:0xf bank_mask:0xf
    v_dot2c_f32_bf16_dpp v11, v37, v92 row_newbcast:7 row_mask:0xf bank_mask:0xf
    v_dot2c_f32_bf16_dpp v12, v29, v93 row_newbcast:7 row_mask:0xf bank_mask:0xf
    v_dot2c_f32_bf16_dpp v13, v37, v93 row_newbcast:7 row_mask:0xf bank_mask:0xf
    v_dot2c_f32_bf16_dpp v14, v29, v94 row_newbcast:7 row_mask:0xf bank_mask:0xf
    v_dot2c_f32_bf16_dpp v15, v37, v94 row_newbcast:7 row_mask:0xf bank_mask:0xf
    v_dot2c_f32_bf16_dpp v16, v29, v95 row_newbcast:7 row_mask:0xf bank_mask:0xf
    v_dot2c_f32_bf16_dpp v17, v37, v95 row_newbcast:7 row_mask:0xf bank_mask:0xf
    buffer_load_dwordx4 v[116:119], v1, s[36:39], s70 offen nt
    s_add_u32 s70, s70, 0x1000
    v_perm_b32 v234, v239, v235, s82
    v_perm_b32 v239, v239, v235, s83
    s_waitcnt vmcnt(5)
    v_dot2c_f32_bf16_dpp v10, v29, v96 row_newbcast:8 row_mask:0xf bank_mask:0xf
    v_dot2c_f32_bf16_dpp v11, v37, v96 row_newbcast:8 row_mask:0xf bank_mask:0xf
    v_dot2c_f32_bf16_dpp v12, v29, v97 row_newbcast:8 row_mask:0xf bank_mask:0xf
    v_dot2c_f32_bf16_dpp v13, v37, v97 row_newbcast:8 row_mask:0xf bank_mask:0xf
    v_dot2c_f32_bf16_dpp v14, v29, v98 row_newbcast:8 row_mask:0xf bank_mask:0xf
    v_dot2c_f32_bf16_dpp v15, v37, v98 row_newbcast:8 row_mask:0xf bank_mask:0xf
    v_dot2c_f32_bf16_dpp v16, v29, v99 row_newbcast:8 row_mask:0xf bank_mask:0xf
    v_dot2c_f32_bf16_dpp v17, v37, v99 row_newbcast:8 row_mask:0xf bank_mask:0xf
    buffer_load_dwordx4 v[120:123], v1, s[36:39], s70 offen nt
    s_add_u32 s70, s70, 0x1000
    v_perm_b32 v235, v244, v240, s82
    v_perm_b32 v244, v244, v240, s83
    s_waitcnt vmcnt(5)
    v_dot2c_f32_bf16_dpp v10, v29, v100 row_newbcast:9 row_mask:0xf bank_mask:0xf
    v_dot2c_f32_bf16_dpp v11, v37, v100 row_newbcast:9 row_mask:0xf bank_mask:0xf
    v_dot2c_f32_bf16_dpp v12, v29, v101 row_newbcast:9 row_mask:0xf bank_mask:0xf
    v_dot2c_f32_bf16_dpp v13, v37, v101 row_newbcast:9 row_mask:0xf bank_mask:0xf
    v_dot2c_f32_bf16_dpp v14, v29, v102 row_newbcast:9 row_mask:0xf bank_mask:0xf
    v_dot2c_f32_bf16_dpp v15, v37, v102 row_newbcast:9 row_mask:0xf bank_mask:0xf
    v_dot2c_f32_bf16_dpp v16, v29, v103 row_newbcast:9 row_mask:0xf bank_mask:0xf
    v_dot2c_f32_bf16_dpp v17, v37, v103 row_newbcast:9 row_mask:0xf bank_mask:0xf
    buffer_load_dwordx4 v[124:127], v1, s[36:39], s70 offen nt
    s_add_u32 s70, s70, 0x9000
    v_perm_b32 v240, v245, v241, s82
    v_perm_b32 v245, v245, v241, s83
    s_waitcnt vmcnt(5)
    v_dot2c_f32_bf16_dpp v10, v29, v104 row_newbcast:10 row_mask:0xf bank_mask:0xf
    v_dot2c_f32_bf16_dpp v11, v37, v104 row_newbcast:10 row_mask:0xf bank_mask:0xf
    v_dot2c_f32_bf16_dpp v12, v29, v105 row_newbcast:10 row_mask:0xf bank_mask:0xf
    v_dot2c_f32_bf16_dpp v13, v37, v105 row_newbcast:10 row_mask:0xf bank_mask:0xf
    v_dot2c_f32_bf16_dpp v14, v29, v106 row_newbcast:10 row_mask:0xf bank_mask:0xf
    v_dot2c_f32_bf16_dpp v15, v37, v106 row_newbcast:10 row_mask:0xf bank_mask:0xf
    v_dot2c_f32_bf16_dpp v16, v29, v107 row_newbcast:10 row_mask:0xf bank_mask:0xf
    v_dot2c_f32_bf16_dpp v17, v37, v107 row_newbcast:10 row_mask:0xf bank_mask:0xf
    buffer_load_dwordx4 v[64:67], v1, s[36:39], s70 offen nt
    s_add_u32 s70, s70, 0x1000
    v_perm_b32 v241, v246, v242, s82
    v_perm_b32 v246, v246, v242, s83
    s_waitcnt vmcnt(5)
    v_dot2c_f32_bf16_dpp v10, v29, v108 row_newbcast:11 row_mask:0xf bank_mask:0xf
    v_dot2c_f32_bf16_dpp v11, v37, v108 row_newbcast:11 row_mask:0xf bank_mask:0xf
    v_dot2c_f32_bf16_dpp v12, v29, v109 row_newbcast:11 row_mask:0xf bank_mask:0xf
    v_dot2c_f32_bf16_dpp v13, v37, v109 row_newbcast:11 row_mask:0xf bank_mask:0xf
    v_dot2c_f32_bf16_dpp v14, v29, v110 row_newbcast:11 row_mask:0xf bank_mask:0xf
    v_dot2c_f32_bf16_dpp v15, v37, v110 row_newbcast:11 row_mask:0xf bank_mask:0xf
    v_dot2c_f32_bf16_dpp v16, v29, v111 row_newbcast:11 row_mask:0xf bank_mask:0xf
    v_dot2c_f32_bf16_dpp v17, v37, v111 row_newbcast:11 row_mask:0xf bank_mask:0xf
    buffer_load_dwordx4 v[68:71], v1, s[36:39], s70 offen nt
    s_add_u32 s70, s70, 0x1000
    v_perm_b32 v242, v247, v243, s82
    v_perm_b32 v247, v247, v243, s83
    s_waitcnt vmcnt(5)
    v_dot2c_f32_bf16_dpp v10, v29, v112 row_newbcast:12 row_mask:0xf bank_mask:0xf
    v_dot2c_f32_bf16_dpp v11, v37, v112 row_newbcast:12 row_mask:0xf bank_mask:0xf
    v_dot2c_f32_bf16_dpp v12, v29, v113 row_newbcast:12 row_mask:0xf bank_mask:0xf
    v_dot2c_f32_bf16_dpp v13, v37, v113 row_newbcast:12 row_mask:0xf bank_mask:0xf
    v_dot2c_f32_bf16_dpp v14, v29, v114 row_newbcast:12 row_mask:0xf bank_mask:0xf
    v_dot2c_f32_bf16_dpp v15, v37, v114 row_newbcast:12 row_mask:0xf bank_mask:0xf
    v_dot2c_f32_bf16_dpp v16, v29, v115 row_newbcast:12 row_mask:0xf bank_mask:0xf
    v_dot2c_f32_bf16_dpp v17, v37, v115 row_newbcast:12 row_mask:0xf bank_mask:0xf
    buffer_load_dwordx4 v[72:75], v1, s[36:39], s70 offen nt
    s_add_u32 s70, s70, 0x1000
    v_perm_b32 v243, v252, v248, s82
    v_perm_b32 v252, v252, v248, s83
    s_waitcnt vmcnt(5)
    v_dot2c_f32_bf16_dpp v10, v29, v116 row_newbcast:13 row_mask:0xf bank_mask:0xf
    v_dot2c_f32_bf16_dpp v11, v37, v116 row_newbcast:13 row_mask:0xf bank_mask:0xf
    v_dot2c_f32_bf16_dpp v12, v29, v117 row_newbcast:13 row_mask:0xf bank_mask:0xf
    v_dot2c_f32_bf16_dpp v13, v37, v117 row_newbcast:13 row_mask:0xf bank_mask:0xf
    v_dot2c_f32_bf16_dpp v14, v29, v118 row_newbcast:13 row_mask:0xf bank_mask:0xf
    v_dot2c_f32_bf16_dpp v15, v37, v118 row_newbcast:13 row_mask:0xf bank_mask:0xf
    v_dot2c_f32_bf16_dpp v16, v29, v119 row_newbcast:13 row_mask:0xf bank_mask:0xf
    v_dot2c_f32_bf16_dpp v17, v37, v119 row_newbcast:13 row_mask:0xf bank_mask:0xf
    buffer_load_dwordx4 v[76:79], v1, s[36:39], s70 offen nt
    s_add_u32 s70, s70, 0x1000
    v_perm_b32 v248, v253, v249, s82
    v_perm_b32 v253, v253, v249, s83
    s_waitcnt vmcnt(5)
    v_dot2c_f32_bf16_dpp v10, v29, v120 row_newbcast:14 row_mask:0xf bank_mask:0xf
    v_dot2c_f32_bf16_dpp v11, v37, v120 row_newbcast:14 row_mask:0xf bank_mask:0xf
    v_dot2c_f32_bf16_dpp v12, v29, v121 row_newbcast:14 row_mask:0xf bank_mask:0xf
    v_dot2c_f32_bf16_dpp v13, v37, v121 row_newbcast:14 row_mask:0xf bank_mask:0xf
    v_dot2c_f32_bf16_dpp v14, v29, v122 row_newbcast:14 row_mask:0xf bank_mask:0xf
    v_dot2c_f32_bf16_dpp v15, v37, v122 row_newbcast:14 row_mask:0xf bank_mask:0xf
    v_dot2c_f32_bf16_dpp v16, v29, v123 row_newbcast:14 row_mask:0xf bank_mask:0xf
    v_dot2c_f32_bf16_dpp v17, v37, v123 row_newbcast:14 row_mask:0xf bank_mask:0xf
    buffer_load_dwordx4 v[80:83], v1, s[36:39], s70 offen nt
    s_add_u32 s70, s70, 0x1000
    v_perm_b32 v249, v254, v250, s82
    v_perm_b32 v254, v254, v250, s83
    s_waitcnt vmcnt(5)
    v_dot2c_f32_bf16_dpp v10, v29, v124 row_newbcast:15 row_mask:0xf bank_mask:0xf
    v_dot2c_f32_bf16_dpp v11, v37, v124 row_newbcast:15 row_mask:0xf bank_mask:0xf
    v_dot2c_f32_bf16_dpp v12, v29, v125 row_newbcast:15 row_mask:0xf bank_mask:0xf
    v_dot2c_f32_bf16_dpp v13, v37, v125 row_newbcast:15 row_mask:0xf bank_mask:0xf
    v_dot2c_f32_bf16_dpp v14, v29, v126 row_newbcast:15 row_mask:0xf bank_mask:0xf
    v_dot2c_f32_bf16_dpp v15, v37, v126 row_newbcast:15 row_mask:0xf bank_mask:0xf
    v_dot2c_f32_bf16_dpp v16, v29, v127 row_newbcast:15 row_mask:0xf bank_mask:0xf
    v_dot2c_f32_bf16_dpp v17, v37, v127 row_newbcast:15 row_mask:0xf bank_mask:0xf
    buffer_load_dwordx4 v[84:87], v1, s[36:39], s70 offen nt
    s_add_u32 s70, s70, 0x1000
    v_perm_b32 v250, v255, v251, s82
    v_perm_b32 v255, v255, v251, s83
    s_waitcnt vmcnt(5)
    v_dot2c_f32_bf16_dpp v10, v30, v64 row_newbcast:0 row_mask:0xf bank_mask:0xf
    v_dot2c_f32_bf16_dpp v11, v38, v64 row_newbcast:0 row_mask:0xf bank_mask:0xf
    v_dot2c_f32_bf16_dpp v12, v30, v65 row_newbcast:0 row_mask:0xf bank_mask:0xf
    v_dot2c_f32_bf16_dpp v13, v38, v65 row_newbcast:0 row_mask:0xf bank_mask:0xf
    v_dot2c_f32_bf16_dpp v14, v30, v66 row_newbcast:0 row_mask:0xf bank_mask:0xf
    v_dot2c_f32_bf16_dpp v15, v38, v66 row_newbcast:0 row_mask:0xf bank_mask:0xf
    v_dot2c_f32_bf16_dpp v16, v30, v67 row_newbcast:0 row_mask:0xf bank_mask:0xf
    v_dot2c_f32_bf16_dpp v17, v38, v67 row_newbcast:0 row_mask:0xf bank_mask:0xf
    buffer_load_dwordx4 v[88:91], v1, s[36:39], s70 offen nt
    s_add_u32 s70, s70, 0x1000
    s_waitcnt vmcnt(5)
    v_dot2c_f32_bf16_dpp v10, v30, v68 row_newbcast:1 row_mask:0xf bank_mask:0xf
    v_dot2c_f32_bf16_dpp v11, v38, v68 row_newbcast:1 row_mask:0xf bank_mask:0xf
    v_dot2c_f32_bf16_dpp v12, v30, v69 row_newbcast:1 row_mask:0xf bank_mask:0xf
    v_dot2c_f32_bf16_dpp v13, v38, v69 row_newbcast:1 row_mask:0xf bank_mask:0xf
    v_dot2c_f32_bf16_dpp v14, v30, v70 row_newbcast:1 row_mask:0xf bank_mask:0xf
    v_dot2c_f32_bf16_dpp v15, v38, v70 row_newbcast:1 row_mask:0xf bank_mask:0xf
    v_dot2c_f32_bf16_dpp v16, v30, v71 row_newbcast:1 row_mask:0xf bank_mask:0xf
    v_dot2c_f32_bf16_dpp v17, v38, v71 row_newbcast:1 row_mask:0xf bank_mask:0xf
    buffer_load_dwordx4 v[92:95], v1, s[36:39], s70 offen nt
    s_add_u32 s70, s70, 0x9000
    s_waitcnt vmcnt(5)
    v_dot2c_f32_bf16_dpp v10, v30, v72 row_newbcast:2 row_mask:0xf bank_mask:0xf
    v_dot2c_f32_bf16_dpp v11, v38, v72 row_newbcast:2 row_mask:0xf bank_mask:0xf
    v_dot2c_f32_bf16_dpp v12, v30, v73 row_newbcast:2 row_mask:0xf bank_mask:0xf
    v_dot2c_f32_bf16_dpp v13, v38, v73 row_newbcast:2 row_mask:0xf bank_mask:0xf
    v_dot2c_f32_bf16_dpp v14, v30, v74 row_newbcast:2 row_mask:0xf bank_mask:0xf
    v_dot2c_f32_bf16_dpp v15, v38, v74 row_newbcast:2 row_mask:0xf bank_mask:0xf
    v_dot2c_f32_bf16_dpp v16, v30, v75 row_newbcast:2 row_mask:0xf bank_mask:0xf
    v_dot2c_f32_bf16_dpp v17, v38, v75 row_newbcast:2 row_mask:0xf bank_mask:0xf
    buffer_load_dwordx4 v[96:99], v1, s[36:39], s70 offen nt
    s_add_u32 s70, s70, 0x1000
    s_waitcnt vmcnt(5)
    v_dot2c_f32_bf16_dpp v10, v30, v76 row_newbcast:3 row_mask:0xf bank_mask:0xf
    v_dot2c_f32_bf16_dpp v11, v38, v76 row_newbcast:3 row_mask:0xf bank_mask:0xf
    v_dot2c_f32_bf16_dpp v12, v30, v77 row_newbcast:3 row_mask:0xf bank_mask:0xf
    v_dot2c_f32_bf16_dpp v13, v38, v77 row_newbcast:3 row_mask:0xf bank_mask:0xf
    v_dot2c_f32_bf16_dpp v14, v30, v78 row_newbcast:3 row_mask:0xf bank_mask:0xf
    v_dot2c_f32_bf16_dpp v15, v38, v78 row_newbcast:3 row_mask:0xf bank_mask:0xf
    v_dot2c_f32_bf16_dpp v16, v30, v79 row_newbcast:3 row_mask:0xf bank_mask:0xf
    v_dot2c_f32_bf16_dpp v17, v38, v79 row_newbcast:3 row_mask:0xf bank_mask:0xf
    buffer_load_dwordx4 v[100:103], v1, s[36:39], s70 offen nt
    s_add_u32 s70, s70, 0x1000
    s_waitcnt vmcnt(5)
    v_dot2c_f32_bf16_dpp v10, v30, v80 row_newbcast:4 row_mask:0xf bank_mask:0xf
    v_dot2c_f32_bf16_dpp v11, v38, v80 row_newbcast:4 row_mask:0xf bank_mask:0xf
    v_dot2c_f32_bf16_dpp v12, v30, v81 row_newbcast:4 row_mask:0xf bank_mask:0xf
    v_dot2c_f32_bf16_dpp v13, v38, v81 row_newbcast:4 row_mask:0xf bank_mask:0xf
    v_dot2c_f32_bf16_dpp v14, v30, v82 row_newbcast:4 row_mask:0xf bank_mask:0xf
    v_dot2c_f32_bf16_dpp v15, v38, v82 row_newbcast:4 row_mask:0xf bank_mask:0xf
    v_dot2c_f32_bf16_dpp v16, v30, v83 row_newbcast:4 row_mask:0xf bank_mask:0xf
    v_dot2c_f32_bf16_dpp v17, v38, v83 row_newbcast:4 row_mask:0xf bank_mask:0xf
    buffer_load_dwordx4 v[104:107], v1, s[36:39], s70 offen nt
    s_add_u32 s70, s70, 0x1000
    s_waitcnt vmcnt(5)
    v_dot2c_f32_bf16_dpp v10, v30, v84 row_newbcast:5 row_mask:0xf bank_mask:0xf
    v_dot2c_f32_bf16_dpp v11, v38, v84 row_newbcast:5 row_mask:0xf bank_mask:0xf
    v_dot2c_f32_bf16_dpp v12, v30, v85 row_newbcast:5 row_mask:0xf bank_mask:0xf
    v_dot2c_f32_bf16_dpp v13, v38, v85 row_newbcast:5 row_mask:0xf bank_mask:0xf
    v_dot2c_f32_bf16_dpp v14, v30, v86 row_newbcast:5 row_mask:0xf bank_mask:0xf
    v_dot2c_f32_bf16_dpp v15, v38, v86 row_newbcast:5 row_mask:0xf bank_mask:0xf
    v_dot2c_f32_bf16_dpp v16, v30, v87 row_newbcast:5 row_mask:0xf bank_mask:0xf
    v_dot2c_f32_bf16_dpp v17, v38, v87 row_newbcast:5 row_mask:0xf bank_mask:0xf
    buffer_load_dwordx4 v[108:111], v1, s[36:39], s70 offen nt
    s_add_u32 s70, s70, 0x1000
    s_waitcnt vmcnt(5)
    v_dot2c_f32_bf16_dpp v10, v30, v88 row_newbcast:6 row_mask:0xf bank_mask:0xf
    v_dot2c_f32_bf16_dpp v11, v38, v88 row_newbcast:6 row_mask:0xf bank_mask:0xf
    v_dot2c_f32_bf16_dpp v12, v30, v89 row_newbcast:6 row_mask:0xf bank_mask:0xf
    v_dot2c_f32_bf16_dpp v13, v38, v89 row_newbcast:6 row_mask:0xf bank_mask:0xf
    v_dot2c_f32_bf16_dpp v14, v30, v90 row_newbcast:6 row_mask:0xf bank_mask:0xf
    v_dot2c_f32_bf16_dpp v15, v38, v90 row_newbcast:6 row_mask:0xf bank_mask:0xf
    v_dot2c_f32_bf16_dpp v16, v30, v91 row_newbcast:6 row_mask:0xf bank_mask:0xf
    v_dot2c_f32_bf16_dpp v17, v38, v91 row_newbcast:6 row_mask:0xf bank_mask:0xf
    buffer_load_dwordx4 v[112:115], v1, s[36:39], s70 offen nt
    s_add_u32 s70, s70, 0x1000
    s_waitcnt vmcnt(5)
    v_dot2c_f32_bf16_dpp v10, v30, v92 row_newbcast:7 row_mask:0xf bank_mask:0xf
    v_dot2c_f32_bf16_dpp v11, v38, v92 row_newbcast:7 row_mask:0xf bank_mask:0xf
    v_dot2c_f32_bf16_dpp v12, v30, v93 row_newbcast:7 row_mask:0xf bank_mask:0xf
    v_dot2c_f32_bf16_dpp v13, v38, v93 row_newbcast:7 row_mask:0xf bank_mask:0xf
    v_dot2c_f32_bf16_dpp v14, v30, v94 row_newbcast:7 row_mask:0xf bank_mask:0xf
    v_dot2c_f32_bf16_dpp v15, v38, v94 row_newbcast:7 row_mask:0xf bank_mask:0xf
    v_dot2c_f32_bf16_dpp v16, v30, v95 row_newbcast:7 row_mask:0xf bank_mask:0xf
    v_dot2c_f32_bf16_dpp v17, v38, v95 row_newbcast:7 row_mask:0xf bank_mask:0xf
    buffer_load_dwordx4 v[116:119], v1, s[36:39], s70 offen nt
    s_add_u32 s70, s70, 0x1000
    s_waitcnt vmcnt(5)
    v_dot2c_f32_bf16_dpp v10, v30, v96 row_newbcast:8 row_mask:0xf bank_mask:0xf
    v_dot2c_f32_bf16_dpp v11, v38, v96 row_newbcast:8 row_mask:0xf bank_mask:0xf
    v_dot2c_f32_bf16_dpp v12, v30, v97 row_newbcast:8 row_mask:0xf bank_mask:0xf
    v_dot2c_f32_bf16_dpp v13, v38, v97 row_newbcast:8 row_mask:0xf bank_mask:0xf
    v_dot2c_f32_bf16_dpp v14, v30, v98 row_newbcast:8 row_mask:0xf bank_mask:0xf
    v_dot2c_f32_bf16_dpp v15, v38, v98 row_newbcast:8 row_mask:0xf bank_mask:0xf
    v_dot2c_f32_bf16_dpp v16, v30, v99 row_newbcast:8 row_mask:0xf bank_mask:0xf
    v_dot2c_f32_bf16_dpp v17, v38, v99 row_newbcast:8 row_mask:0xf bank_mask:0xf
    buffer_load_dwordx4 v[120:123], v1, s[36:39], s70 offen nt
    s_add_u32 s70, s70, 0x1000
    s_waitcnt vmcnt(5)
    v_dot2c_f32_bf16_dpp v10, v30, v100 row_newbcast:9 row_mask:0xf bank_mask:0xf
    v_dot2c_f32_bf16_dpp v11, v38, v100 row_newbcast:9 row_mask:0xf bank_mask:0xf
    v_dot2c_f32_bf16_dpp v12, v30, v101 row_newbcast:9 row_mask:0xf bank_mask:0xf
    v_dot2c_f32_bf16_dpp v13, v38, v101 row_newbcast:9 row_mask:0xf bank_mask:0xf
    v_dot2c_f32_bf16_dpp v14, v30, v102 row_newbcast:9 row_mask:0xf bank_mask:0xf
    v_dot2c_f32_bf16_dpp v15, v38, v102 row_newbcast:9 row_mask:0xf bank_mask:0xf
    v_dot2c_f32_bf16_dpp v16, v30, v103 row_newbcast:9 row_mask:0xf bank_mask:0xf
    v_dot2c_f32_bf16_dpp v17, v38, v103 row_newbcast:9 row_mask:0xf bank_mask:0xf
    buffer_load_dwordx4 v[124:127], v1, s[36:39], s70 offen nt
    s_add_u32 s70, s70, 0x9000
    s_waitcnt vmcnt(5)
    v_dot2c_f32_bf16_dpp v10, v30, v104 row_newbcast:10 row_mask:0xf bank_mask:0xf
    v_dot2c_f32_bf16_dpp v11, v38, v104 row_newbcast:10 row_mask:0xf bank_mask:0xf
    v_dot2c_f32_bf16_dpp v12, v30, v105 row_newbcast:10 row_mask:0xf bank_mask:0xf
    v_dot2c_f32_bf16_dpp v13, v38, v105 row_newbcast:10 row_mask:0xf bank_mask:0xf
    v_dot2c_f32_bf16_dpp v14, v30, v106 row_newbcast:10 row_mask:0xf bank_mask:0xf
    v_dot2c_f32_bf16_dpp v15, v38, v106 row_newbcast:10 row_mask:0xf bank_mask:0xf
    v_dot2c_f32_bf16_dpp v16, v30, v107 row_newbcast:10 row_mask:0xf bank_mask:0xf
    v_dot2c_f32_bf16_dpp v17, v38, v107 row_newbcast:10 row_mask:0xf bank_mask:0xf
    buffer_load_dwordx4 v[64:67], v1, s[36:39], s70 offen nt
    s_add_u32 s70, s70, 0x1000
    s_waitcnt vmcnt(5)
    v_dot2c_f32_bf16_dpp v10, v30, v108 row_newbcast:11 row_mask:0xf bank_mask:0xf
    v_dot2c_f32_bf16_dpp v11, v38, v108 row_newbcast:11 row_mask:0xf bank_mask:0xf
    v_dot2c_f32_bf16_dpp v12, v30, v109 row_newbcast:11 row_mask:0xf bank_mask:0xf
    v_dot2c_f32_bf16_dpp v13, v38, v109 row_newbcast:11 row_mask:0xf bank_mask:0xf
    v_dot2c_f32_bf16_dpp v14, v30, v110 row_newbcast:11 row_mask:0xf bank_mask:0xf
    v_dot2c_f32_bf16_dpp v15, v38, v110 row_newbcast:11 row_mask:0xf bank_mask:0xf
    v_dot2c_f32_bf16_dpp v16, v30, v111 row_newbcast:11 row_mask:0xf bank_mask:0xf
    v_dot2c_f32_bf16_dpp v17, v38, v111 row_newbcast:11 row_mask:0xf bank_mask:0xf
    buffer_load_dwordx4 v[68:71], v1, s[36:39], s70 offen nt
    s_add_u32 s70, s70, 0x1000
    s_waitcnt vmcnt(5)
    v_dot2c_f32_bf16_dpp v10, v30, v112 row_newbcast:12 row_mask:0xf bank_mask:0xf
    v_dot2c_f32_bf16_dpp v11, v38, v112 row_newbcast:12 row_mask:0xf bank_mask:0xf
    v_dot2c_f32_bf16_dpp v12, v30, v113 row_newbcast:12 row_mask:0xf bank_mask:0xf
    v_dot2c_f32_bf16_dpp v13, v38, v113 row_newbcast:12 row_mask:0xf bank_mask:0xf
    v_dot2c_f32_bf16_dpp v14, v30, v114 row_newbcast:12 row_mask:0xf bank_mask:0xf
    v_dot2c_f32_bf16_dpp v15, v38, v114 row_newbcast:12 row_mask:0xf bank_mask:0xf
    v_dot2c_f32_bf16_dpp v16, v30, v115 row_newbcast:12 row_mask:0xf bank_mask:0xf
    v_dot2c_f32_bf16_dpp v17, v38, v115 row_newbcast:12 row_mask:0xf bank_mask:0xf
    buffer_load_dwordx4 v[72:75], v1, s[36:39], s70 offen nt
    s_add_u32 s70, s70, 0x1000
    s_waitcnt vmcnt(5)
    v_dot2c_f32_bf16_dpp v10, v30, v116 row_newbcast:13 row_mask:0xf bank_mask:0xf
    v_dot2c_f32_bf16_dpp v11, v38, v116 row_newbcast:13 row_mask:0xf bank_mask:0xf
    v_dot2c_f32_bf16_dpp v12, v30, v117 row_newbcast:13 row_mask:0xf bank_mask:0xf
    v_dot2c_f32_bf16_dpp v13, v38, v117 row_newbcast:13 row_mask:0xf bank_mask:0xf
    v_dot2c_f32_bf16_dpp v14, v30, v118 row_newbcast:13 row_mask:0xf bank_mask:0xf
    v_dot2c_f32_bf16_dpp v15, v38, v118 row_newbcast:13 row_mask:0xf bank_mask:0xf
    v_dot2c_f32_bf16_dpp v16, v30, v119 row_newbcast:13 row_mask:0xf bank_mask:0xf
    v_dot2c_f32_bf16_dpp v17, v38, v119 row_newbcast:13 row_mask:0xf bank_mask:0xf
    buffer_load_dwordx4 v[76:79], v1, s[36:39], s70 offen nt
    s_add_u32 s70, s70, 0x1000
    s_waitcnt vmcnt(5)
    v_dot2c_f32_bf16_dpp v10, v30, v120 row_newbcast:14 row_mask:0xf bank_mask:0xf
    v_dot2c_f32_bf16_dpp v11, v38, v120 row_newbcast:14 row_mask:0xf bank_mask:0xf
    v_dot2c_f32_bf16_dpp v12, v30, v121 row_newbcast:14 row_mask:0xf bank_mask:0xf
    v_dot2c_f32_bf16_dpp v13, v38, v121 row_newbcast:14 row_mask:0xf bank_mask:0xf
    v_dot2c_f32_bf16_dpp v14, v30, v122 row_newbcast:14 row_mask:0xf bank_mask:0xf
    v_dot2c_f32_bf16_dpp v15, v38, v122 row_newbcast:14 row_mask:0xf bank_mask:0xf
    v_dot2c_f32_bf16_dpp v16, v30, v123 row_newbcast:14 row_mask:0xf bank_mask:0xf
    v_dot2c_f32_bf16_dpp v17, v38, v123 row_newbcast:14 row_mask:0xf bank_mask:0xf
    buffer_load_dwordx4 v[80:83], v1, s[36:39], s70 offen nt
    s_add_u32 s70, s70, 0x1000
    s_waitcnt vmcnt(5)
    v_dot2c_f32_bf16_dpp v10, v30, v124 row_newbcast:15 row_mask:0xf bank_mask:0xf
    v_dot2c_f32_bf16_dpp v11, v38, v124 row_newbcast:15 row_mask:0xf bank_mask:0xf
    v_dot2c_f32_bf16_dpp v12, v30, v125 row_newbcast:15 row_mask:0xf bank_mask:0xf
    v_dot2c_f32_bf16_dpp v13, v38, v125 row_newbcast:15 row_mask:0xf bank_mask:0xf
    v_dot2c_f32_bf16_dpp v14, v30, v126 row_newbcast:15 row_mask:0xf bank_mask:0xf
    v_dot2c_f32_bf16_dpp v15, v38, v126 row_newbcast:15 row_mask:0xf bank_mask:0xf
    v_dot2c_f32_bf16_dpp v16, v30, v127 row_newbcast:15 row_mask:0xf bank_mask:0xf
    v_dot2c_f32_bf16_dpp v17, v38, v127 row_newbcast:15 row_mask:0xf bank_mask:0xf
    buffer_load_dwordx4 v[84:87], v1, s[36:39], s70 offen nt
    s_add_u32 s70, s70, 0x1000
    s_waitcnt vmcnt(5)
    v_dot2c_f32_bf16_dpp v10, v31, v64 row_newbcast:0 row_mask:0xf bank_mask:0xf
    v_dot2c_f32_bf16_dpp v11, v39, v64 row_newbcast:0 row_mask:0xf bank_mask:0xf
    v_dot2c_f32_bf16_dpp v12, v31, v65 row_newbcast:0 row_mask:0xf bank_mask:0xf
    v_dot2c_f32_bf16_dpp v13, v39, v65 row_newbcast:0 row_mask:0xf bank_mask:0xf
    v_dot2c_f32_bf16_dpp v14, v31, v66 row_newbcast:0 row_mask:0xf bank_mask:0xf
    v_dot2c_f32_bf16_dpp v15, v39, v66 row_newbcast:0 row_mask:0xf bank_mask:0xf
    v_dot2c_f32_bf16_dpp v16, v31, v67 row_newbcast:0 row_mask:0xf bank_mask:0xf
    v_dot2c_f32_bf16_dpp v17, v39, v67 row_newbcast:0 row_mask:0xf bank_mask:0xf
    buffer_load_dwordx4 v[88:91], v1, s[36:39], s70 offen nt
    s_add_u32 s70, s70, 0x1000
    s_waitcnt vmcnt(5)
    v_dot2c_f32_bf16_dpp v10, v31, v68 row_newbcast:1 row_mask:0xf bank_mask:0xf
    v_dot2c_f32_bf16_dpp v11, v39, v68 row_newbcast:1 row_mask:0xf bank_mask:0xf
    v_dot2c_f32_bf16_dpp v12, v31, v69 row_newbcast:1 row_mask:0xf bank_mask:0xf
    v_dot2c_f32_bf16_dpp v13, v39, v69 row_newbcast:1 row_mask:0xf bank_mask:0xf
    v_dot2c_f32_bf16_dpp v14, v31, v70 row_newbcast:1 row_mask:0xf bank_mask:0xf
    v_dot2c_f32_bf16_dpp v15, v39, v70 row_newbcast:1 row_mask:0xf bank_mask:0xf
    v_dot2c_f32_bf16_dpp v16, v31, v71 row_newbcast:1 row_mask:0xf bank_mask:0xf
    v_dot2c_f32_bf16_dpp v17, v39, v71 row_newbcast:1 row_mask:0xf bank_mask:0xf
    buffer_load_dwordx4 v[92:95], v1, s[36:39], s70 offen nt
    s_add_u32 s70, s70, 0x9000
    s_waitcnt vmcnt(5)
    v_dot2c_f32_bf16_dpp v10, v31, v72 row_newbcast:2 row_mask:0xf bank_mask:0xf
    v_dot2c_f32_bf16_dpp v11, v39, v72 row_newbcast:2 row_mask:0xf bank_mask:0xf
    v_dot2c_f32_bf16_dpp v12, v31, v73 row_newbcast:2 row_mask:0xf bank_mask:0xf
    v_dot2c_f32_bf16_dpp v13, v39, v73 row_newbcast:2 row_mask:0xf bank_mask:0xf
    v_dot2c_f32_bf16_dpp v14, v31, v74 row_newbcast:2 row_mask:0xf bank_mask:0xf
    v_dot2c_f32_bf16_dpp v15, v39, v74 row_newbcast:2 row_mask:0xf bank_mask:0xf
    v_dot2c_f32_bf16_dpp v16, v31, v75 row_newbcast:2 row_mask:0xf bank_mask:0xf
    v_dot2c_f32_bf16_dpp v17, v39, v75 row_newbcast:2 row_mask:0xf bank_mask:0xf
    buffer_load_dwordx4 v[96:99], v1, s[36:39], s70 offen nt
    s_add_u32 s70, s70, 0x1000
    s_waitcnt vmcnt(5)
    v_dot2c_f32_bf16_dpp v10, v31, v76 row_newbcast:3 row_mask:0xf bank_mask:0xf
    v_dot2c_f32_bf16_dpp v11, v39, v76 row_newbcast:3 row_mask:0xf bank_mask:0xf
    v_dot2c_f32_bf16_dpp v12, v31, v77 row_newbcast:3 row_mask:0xf bank_mask:0xf
    v_dot2c_f32_bf16_dpp v13, v39, v77 row_newbcast:3 row_mask:0xf bank_mask:0xf
    v_dot2c_f32_bf16_dpp v14, v31, v78 row_newbcast:3 row_mask:0xf bank_mask:0xf
    v_dot2c_f32_bf16_dpp v15, v39, v78 row_newbcast:3 row_mask:0xf bank_mask:0xf
    v_dot2c_f32_bf16_dpp v16, v31, v79 row_newbcast:3 row_mask:0xf bank_mask:0xf
    v_dot2c_f32_bf16_dpp v17, v39, v79 row_newbcast:3 row_mask:0xf bank_mask:0xf
    buffer_load_dwordx4 v[100:103], v1, s[36:39], s70 offen nt
    s_add_u32 s70, s70, 0x1000
    s_waitcnt vmcnt(5)
    v_dot2c_f32_bf16_dpp v10, v31, v80 row_newbcast:4 row_mask:0xf bank_mask:0xf
    v_dot2c_f32_bf16_dpp v11, v39, v80 row_newbcast:4 row_mask:0xf bank_mask:0xf
    v_dot2c_f32_bf16_dpp v12, v31, v81 row_newbcast:4 row_mask:0xf bank_mask:0xf
    v_dot2c_f32_bf16_dpp v13, v39, v81 row_newbcast:4 row_mask:0xf bank_mask:0xf
    v_dot2c_f32_bf16_dpp v14, v31, v82 row_newbcast:4 row_mask:0xf bank_mask:0xf
    v_dot2c_f32_bf16_dpp v15, v39, v82 row_newbcast:4 row_mask:0xf bank_mask:0xf
    v_dot2c_f32_bf16_dpp v16, v31, v83 row_newbcast:4 row_mask:0xf bank_mask:0xf
    v_dot2c_f32_bf16_dpp v17, v39, v83 row_newbcast:4 row_mask:0xf bank_mask:0xf
    buffer_load_dwordx4 v[104:107], v1, s[36:39], s70 offen nt
    s_add_u32 s70, s70, 0x1000
    s_waitcnt vmcnt(5)
    v_dot2c_f32_bf16_dpp v10, v31, v84 row_newbcast:5 row_mask:0xf bank_mask:0xf
    v_dot2c_f32_bf16_dpp v11, v39, v84 row_newbcast:5 row_mask:0xf bank_mask:0xf
    v_dot2c_f32_bf16_dpp v12, v31, v85 row_newbcast:5 row_mask:0xf bank_mask:0xf
    v_dot2c_f32_bf16_dpp v13, v39, v85 row_newbcast:5 row_mask:0xf bank_mask:0xf
    v_dot2c_f32_bf16_dpp v14, v31, v86 row_newbcast:5 row_mask:0xf bank_mask:0xf
    v_dot2c_f32_bf16_dpp v15, v39, v86 row_newbcast:5 row_mask:0xf bank_mask:0xf
    v_dot2c_f32_bf16_dpp v16, v31, v87 row_newbcast:5 row_mask:0xf bank_mask:0xf
    v_dot2c_f32_bf16_dpp v17, v39, v87 row_newbcast:5 row_mask:0xf bank_mask:0xf
    buffer_load_dwordx4 v[108:111], v1, s[36:39], s70 offen nt
    s_add_u32 s70, s70, 0x1000
    s_waitcnt vmcnt(5)
    v_dot2c_f32_bf16_dpp v10, v31, v88 row_newbcast:6 row_mask:0xf bank_mask:0xf
    v_dot2c_f32_bf16_dpp v11, v39, v88 row_newbcast:6 row_mask:0xf bank_mask:0xf
    v_dot2c_f32_bf16_dpp v12, v31, v89 row_newbcast:6 row_mask:0xf bank_mask:0xf
    v_dot2c_f32_bf16_dpp v13, v39, v89 row_newbcast:6 row_mask:0xf bank_mask:0xf
    v_dot2c_f32_bf16_dpp v14, v31, v90 row_newbcast:6 row_mask:0xf bank_mask:0xf
    v_dot2c_f32_bf16_dpp v15, v39, v90 row_newbcast:6 row_mask:0xf bank_mask:0xf
    v_dot2c_f32_bf16_dpp v16, v31, v91 row_newbcast:6 row_mask:0xf bank_mask:0xf
    v_dot2c_f32_bf16_dpp v17, v39, v91 row_newbcast:6 row_mask:0xf bank_mask:0xf
    buffer_load_dwordx4 v[112:115], v1, s[36:39], s70 offen nt
    s_add_u32 s70, s70, 0x1000
    s_waitcnt vmcnt(5)
    v_dot2c_f32_bf16_dpp v10, v31, v92 row_newbcast:7 row_mask:0xf bank_mask:0xf
    v_dot2c_f32_bf16_dpp v11, v39, v92 row_newbcast:7 row_mask:0xf bank_mask:0xf
    v_dot2c_f32_bf16_dpp v12, v31, v93 row_newbcast:7 row_mask:0xf bank_mask:0xf
    v_dot2c_f32_bf16_dpp v13, v39, v93 row_newbcast:7 row_mask:0xf bank_mask:0xf
    v_dot2c_f32_bf16_dpp v14, v31, v94 row_newbcast:7 row_mask:0xf bank_mask:0xf
    v_dot2c_f32_bf16_dpp v15, v39, v94 row_newbcast:7 row_mask:0xf bank_mask:0xf
    v_dot2c_f32_bf16_dpp v16, v31, v95 row_newbcast:7 row_mask:0xf bank_mask:0xf
    v_dot2c_f32_bf16_dpp v17, v39, v95 row_newbcast:7 row_mask:0xf bank_mask:0xf
    buffer_load_dwordx4 v[116:119], v1, s[36:39], s70 offen nt
    s_add_u32 s70, s70, 0x1000
    s_waitcnt vmcnt(5)
    v_dot2c_f32_bf16_dpp v10, v31, v96 row_newbcast:8 row_mask:0xf bank_mask:0xf
    v_dot2c_f32_bf16_dpp v11, v39, v96 row_newbcast:8 row_mask:0xf bank_mask:0xf
    v_dot2c_f32_bf16_dpp v12, v31, v97 row_newbcast:8 row_mask:0xf bank_mask:0xf
    v_dot2c_f32_bf16_dpp v13, v39, v97 row_newbcast:8 row_mask:0xf bank_mask:0xf
    v_dot2c_f32_bf16_dpp v14, v31, v98 row_newbcast:8 row_mask:0xf bank_mask:0xf
    v_dot2c_f32_bf16_dpp v15, v39, v98 row_newbcast:8 row_mask:0xf bank_mask:0xf
    v_dot2c_f32_bf16_dpp v16, v31, v99 row_newbcast:8 row_mask:0xf bank_mask:0xf
    v_dot2c_f32_bf16_dpp v17, v39, v99 row_newbcast:8 row_mask:0xf bank_mask:0xf
    buffer_load_dwordx4 v[120:123], v1, s[36:39], s70 offen nt
    s_add_u32 s70, s70, 0x1000
    s_waitcnt vmcnt(5)
    v_dot2c_f32_bf16_dpp v10, v31, v100 row_newbcast:9 row_mask:0xf bank_mask:0xf
    v_dot2c_f32_bf16_dpp v11, v39, v100 row_newbcast:9 row_mask:0xf bank_mask:0xf
    v_dot2c_f32_bf16_dpp v12, v31, v101 row_newbcast:9 row_mask:0xf bank_mask:0xf
    v_dot2c_f32_bf16_dpp v13, v39, v101 row_newbcast:9 row_mask:0xf bank_mask:0xf
    v_dot2c_f32_bf16_dpp v14, v31, v102 row_newbcast:9 row_mask:0xf bank_mask:0xf
    v_dot2c_f32_bf16_dpp v15, v39, v102 row_newbcast:9 row_mask:0xf bank_mask:0xf
    v_dot2c_f32_bf16_dpp v16, v31, v103 row_newbcast:9 row_mask:0xf bank_mask:0xf
    v_dot2c_f32_bf16_dpp v17, v39, v103 row_newbcast:9 row_mask:0xf bank_mask:0xf
    buffer_load_dwordx4 v[124:127], v1, s[36:39], s70 offen nt
    s_add_u32 s70, s70, 0x9000
    s_waitcnt vmcnt(5)
    v_dot2c_f32_bf16_dpp v10, v31, v104 row_newbcast:10 row_mask:0xf bank_mask:0xf
    v_dot2c_f32_bf16_dpp v11, v39, v104 row_newbcast:10 row_mask:0xf bank_mask:0xf
    v_dot2c_f32_bf16_dpp v12, v31, v105 row_newbcast:10 row_mask:0xf bank_mask:0xf
    v_dot2c_f32_bf16_dpp v13, v39, v105 row_newbcast:10 row_mask:0xf bank_mask:0xf
    v_dot2c_f32_bf16_dpp v14, v31, v106 row_newbcast:10 row_mask:0xf bank_mask:0xf
    v_dot2c_f32_bf16_dpp v15, v39, v106 row_newbcast:10 row_mask:0xf bank_mask:0xf
    v_dot2c_f32_bf16_dpp v16, v31, v107 row_newbcast:10 row_mask:0xf bank_mask:0xf
    v_dot2c_f32_bf16_dpp v17, v39, v107 row_newbcast:10 row_mask:0xf bank_mask:0xf
    buffer_load_dwordx4 v[64:67], v1, s[36:39], s70 offen nt
    s_add_u32 s70, s70, 0x1000
    s_waitcnt vmcnt(5)
    v_dot2c_f32_bf16_dpp v10, v31, v108 row_newbcast:11 row_mask:0xf bank_mask:0xf
    v_dot2c_f32_bf16_dpp v11, v39, v108 row_newbcast:11 row_mask:0xf bank_mask:0xf
    v_dot2c_f32_bf16_dpp v12, v31, v109 row_newbcast:11 row_mask:0xf bank_mask:0xf
    v_dot2c_f32_bf16_dpp v13, v39, v109 row_newbcast:11 row_mask:0xf bank_mask:0xf
    v_dot2c_f32_bf16_dpp v14, v31, v110 row_newbcast:11 row_mask:0xf bank_mask:0xf
    v_dot2c_f32_bf16_dpp v15, v39, v110 row_newbcast:11 row_mask:0xf bank_mask:0xf
    v_dot2c_f32_bf16_dpp v16, v31, v111 row_newbcast:11 row_mask:0xf bank_mask:0xf
    v_dot2c_f32_bf16_dpp v17, v39, v111 row_newbcast:11 row_mask:0xf bank_mask:0xf
    buffer_load_dwordx4 v[68:71], v1, s[36:39], s70 offen nt
    s_add_u32 s70, s70, 0x1000
    s_waitcnt vmcnt(5)
    v_dot2c_f32_bf16_dpp v10, v31, v112 row_newbcast:12 row_mask:0xf bank_mask:0xf
    v_dot2c_f32_bf16_dpp v11, v39, v112 row_newbcast:12 row_mask:0xf bank_mask:0xf
    v_dot2c_f32_bf16_dpp v12, v31, v113 row_newbcast:12 row_mask:0xf bank_mask:0xf
    v_dot2c_f32_bf16_dpp v13, v39, v113 row_newbcast:12 row_mask:0xf bank_mask:0xf
    v_dot2c_f32_bf16_dpp v14, v31, v114 row_newbcast:12 row_mask:0xf bank_mask:0xf
    v_dot2c_f32_bf16_dpp v15, v39, v114 row_newbcast:12 row_mask:0xf bank_mask:0xf
    v_dot2c_f32_bf16_dpp v16, v31, v115 row_newbcast:12 row_mask:0xf bank_mask:0xf
    v_dot2c_f32_bf16_dpp v17, v39, v115 row_newbcast:12 row_mask:0xf bank_mask:0xf
    buffer_load_dwordx4 v[72:75], v1, s[36:39], s70 offen nt
    s_add_u32 s70, s70, 0x1000
    s_waitcnt vmcnt(5)
    v_dot2c_f32_bf16_dpp v10, v31, v116 row_newbcast:13 row_mask:0xf bank_mask:0xf
    v_dot2c_f32_bf16_dpp v11, v39, v116 row_newbcast:13 row_mask:0xf bank_mask:0xf
    v_dot2c_f32_bf16_dpp v12, v31, v117 row_newbcast:13 row_mask:0xf bank_mask:0xf
    v_dot2c_f32_bf16_dpp v13, v39, v117 row_newbcast:13 row_mask:0xf bank_mask:0xf
    v_dot2c_f32_bf16_dpp v14, v31, v118 row_newbcast:13 row_mask:0xf bank_mask:0xf
    v_dot2c_f32_bf16_dpp v15, v39, v118 row_newbcast:13 row_mask:0xf bank_mask:0xf
    v_dot2c_f32_bf16_dpp v16, v31, v119 row_newbcast:13 row_mask:0xf bank_mask:0xf
    v_dot2c_f32_bf16_dpp v17, v39, v119 row_newbcast:13 row_mask:0xf bank_mask:0xf
    buffer_load_dwordx4 v[76:79], v1, s[36:39], s70 offen nt
    s_add_u32 s70, s70, 0x1000
    s_waitcnt vmcnt(5)
    v_dot2c_f32_bf16_dpp v10, v31, v120 row_newbcast:14 row_mask:0xf bank_mask:0xf
    v_dot2c_f32_bf16_dpp v11, v39, v120 row_newbcast:14 row_mask:0xf bank_mask:0xf
    v_dot2c_f32_bf16_dpp v12, v31, v121 row_newbcast:14 row_mask:0xf bank_mask:0xf
    v_dot2c_f32_bf16_dpp v13, v39, v121 row_newbcast:14 row_mask:0xf bank_mask:0xf
    v_dot2c_f32_bf16_dpp v14, v31, v122 row_newbcast:14 row_mask:0xf bank_mask:0xf
    v_dot2c_f32_bf16_dpp v15, v39, v122 row_newbcast:14 row_mask:0xf bank_mask:0xf
    v_dot2c_f32_bf16_dpp v16, v31, v123 row_newbcast:14 row_mask:0xf bank_mask:0xf
    v_dot2c_f32_bf16_dpp v17, v39, v123 row_newbcast:14 row_mask:0xf bank_mask:0xf
    buffer_load_dwordx4 v[80:83], v1, s[36:39], s70 offen nt
    s_add_u32 s70, s70, 0x1000
    s_waitcnt vmcnt(5)
    v_dot2c_f32_bf16_dpp v10, v31, v124 row_newbcast:15 row_mask:0xf bank_mask:0xf
    v_dot2c_f32_bf16_dpp v11, v39, v124 row_newbcast:15 row_mask:0xf bank_mask:0xf
    v_dot2c_f32_bf16_dpp v12, v31, v125 row_newbcast:15 row_mask:0xf bank_mask:0xf
    v_dot2c_f32_bf16_dpp v13, v39, v125 row_newbcast:15 row_mask:0xf bank_mask:0xf
    v_dot2c_f32_bf16_dpp v14, v31, v126 row_newbcast:15 row_mask:0xf bank_mask:0xf
    v_dot2c_f32_bf16_dpp v15, v39, v126 row_newbcast:15 row_mask:0xf bank_mask:0xf
    v_dot2c_f32_bf16_dpp v16, v31, v127 row_newbcast:15 row_mask:0xf bank_mask:0xf
    v_dot2c_f32_bf16_dpp v17, v39, v127 row_newbcast:15 row_mask:0xf bank_mask:0xf
    buffer_load_dwordx4 v[84:87], v1, s[36:39], s70 offen nt
    s_add_u32 s70, s70, 0x1000
    s_waitcnt vmcnt(5)
    v_dot2c_f32_bf16_dpp v10, v32, v64 row_newbcast:0 row_mask:0xf bank_mask:0xf
    v_dot2c_f32_bf16_dpp v11, v40, v64 row_newbcast:0 row_mask:0xf bank_mask:0xf
    v_dot2c_f32_bf16_dpp v12, v32, v65 row_newbcast:0 row_mask:0xf bank_mask:0xf
    v_dot2c_f32_bf16_dpp v13, v40, v65 row_newbcast:0 row_mask:0xf bank_mask:0xf
    v_dot2c_f32_bf16_dpp v14, v32, v66 row_newbcast:0 row_mask:0xf bank_mask:0xf
    v_dot2c_f32_bf16_dpp v15, v40, v66 row_newbcast:0 row_mask:0xf bank_mask:0xf
    v_dot2c_f32_bf16_dpp v16, v32, v67 row_newbcast:0 row_mask:0xf bank_mask:0xf
    v_dot2c_f32_bf16_dpp v17, v40, v67 row_newbcast:0 row_mask:0xf bank_mask:0xf
    buffer_load_dwordx4 v[88:91], v1, s[36:39], s70 offen nt
    s_add_u32 s70, s70, 0x1000
    buffer_load_dwordx4 v[92:95], v1, s[36:39], s70 offen nt
    s_add_u32 s70, s70, 0x9000
    buffer_load_dwordx4 v[96:99], v1, s[36:39], s70 offen nt
    s_add_u32 s70, s70, 0x1000
    buffer_load_dwordx4 v[100:103], v1, s[36:39], s70 offen nt
    s_add_u32 s70, s70, 0x1000
    buffer_load_dwordx4 v[104:107], v1, s[36:39], s70 offen nt
    s_add_u32 s70, s70, 0x1000
    buffer_load_dwordx4 v[108:111], v1, s[36:39], s70 offen nt
    s_add_u32 s70, s70, 0x1000
    buffer_load_dwordx4 v[112:115], v1, s[36:39], s70 offen nt
    s_add_u32 s70, s70, 0x1000
    s_waitcnt vmcnt(11)
    v_dot2c_f32_bf16_dpp v10, v32, v68 row_newbcast:1 row_mask:0xf bank_mask:0xf
    v_dot2c_f32_bf16_dpp v11, v40, v68 row_newbcast:1 row_mask:0xf bank_mask:0xf
    v_dot2c_f32_bf16_dpp v12, v32, v69 row_newbcast:1 row_mask:0xf bank_mask:0xf
    v_dot2c_f32_bf16_dpp v13, v40, v69 row_newbcast:1 row_mask:0xf bank_mask:0xf
    v_dot2c_f32_bf16_dpp v14, v32, v70 row_newbcast:1 row_mask:0xf bank_mask:0xf
    v_dot2c_f32_bf16_dpp v15, v40, v70 row_newbcast:1 row_mask:0xf bank_mask:0xf
    v_dot2c_f32_bf16_dpp v16, v32, v71 row_newbcast:1 row_mask:0xf bank_mask:0xf
    v_dot2c_f32_bf16_dpp v17, v40, v71 row_newbcast:1 row_mask:0xf bank_mask:0xf
    buffer_load_dwordx4 v[116:119], v1, s[36:39], s70 offen nt
    s_add_u32 s70, s70, 0x1000
    s_waitcnt vmcnt(11)
    v_dot2c_f32_bf16_dpp v10, v32, v72 row_newbcast:2 row_mask:0xf bank_mask:0xf
    v_dot2c_f32_bf16_dpp v11, v40, v72 row_newbcast:2 row_mask:0xf bank_mask:0xf
    v_dot2c_f32_bf16_dpp v12, v32, v73 row_newbcast:2 row_mask:0xf bank_mask:0xf
    v_dot2c_f32_bf16_dpp v13, v40, v73 row_newbcast:2 row_mask:0xf bank_mask:0xf
    v_dot2c_f32_bf16_dpp v14, v32, v74 row_newbcast:2 row_mask:0xf bank_mask:0xf
    v_dot2c_f32_bf16_dpp v15, v40, v74 row_newbcast:2 row_mask:0xf bank_mask:0xf
    v_dot2c_f32_bf16_dpp v16, v32, v75 row_newbcast:2 row_mask:0xf bank_mask:0xf
    v_dot2c_f32_bf16_dpp v17, v40, v75 row_newbcast:2 row_mask:0xf bank_mask:0xf
    buffer_load_dwordx4 v[120:123], v1, s[36:39], s70 offen nt
    s_add_u32 s70, s70, 0x1000
    s_waitcnt vmcnt(11)
    v_dot2c_f32_bf16_dpp v10, v32, v76 row_newbcast:3 row_mask:0xf bank_mask:0xf
    v_dot2c_f32_bf16_dpp v11, v40, v76 row_newbcast:3 row_mask:0xf bank_mask:0xf
    v_dot2c_f32_bf16_dpp v12, v32, v77 row_newbcast:3 row_mask:0xf bank_mask:0xf
    v_dot2c_f32_bf16_dpp v13, v40, v77 row_newbcast:3 row_mask:0xf bank_mask:0xf
    v_dot2c_f32_bf16_dpp v14, v32, v78 row_newbcast:3 row_mask:0xf bank_mask:0xf
    v_dot2c_f32_bf16_dpp v15, v40, v78 row_newbcast:3 row_mask:0xf bank_mask:0xf
    v_dot2c_f32_bf16_dpp v16, v32, v79 row_newbcast:3 row_mask:0xf bank_mask:0xf
    v_dot2c_f32_bf16_dpp v17, v40, v79 row_newbcast:3 row_mask:0xf bank_mask:0xf
    buffer_load_dwordx4 v[124:127], v1, s[36:39], s70 offen nt
    s_add_u32 s70, s70, 0x9000
    s_waitcnt vmcnt(11)
    v_dot2c_f32_bf16_dpp v10, v32, v80 row_newbcast:4 row_mask:0xf bank_mask:0xf
    v_dot2c_f32_bf16_dpp v11, v40, v80 row_newbcast:4 row_mask:0xf bank_mask:0xf
    v_dot2c_f32_bf16_dpp v12, v32, v81 row_newbcast:4 row_mask:0xf bank_mask:0xf
    v_dot2c_f32_bf16_dpp v13, v40, v81 row_newbcast:4 row_mask:0xf bank_mask:0xf
    v_dot2c_f32_bf16_dpp v14, v32, v82 row_newbcast:4 row_mask:0xf bank_mask:0xf
    v_dot2c_f32_bf16_dpp v15, v40, v82 row_newbcast:4 row_mask:0xf bank_mask:0xf
    v_dot2c_f32_bf16_dpp v16, v32, v83 row_newbcast:4 row_mask:0xf bank_mask:0xf
    v_dot2c_f32_bf16_dpp v17, v40, v83 row_newbcast:4 row_mask:0xf bank_mask:0xf
    buffer_load_dwordx4 v[64:67], v1, s[36:39], s70 offen nt
    s_add_u32 s70, s70, 0x1000
    s_waitcnt vmcnt(11)
    v_dot2c_f32_bf16_dpp v10, v32, v84 row_newbcast:5 row_mask:0xf bank_mask:0xf
    v_dot2c_f32_bf16_dpp v11, v40, v84 row_newbcast:5 row_mask:0xf bank_mask:0xf
    v_dot2c_f32_bf16_dpp v12, v32, v85 row_newbcast:5 row_mask:0xf bank_mask:0xf
    v_dot2c_f32_bf16_dpp v13, v40, v85 row_newbcast:5 row_mask:0xf bank_mask:0xf
    v_dot2c_f32_bf16_dpp v14, v32, v86 row_newbcast:5 row_mask:0xf bank_mask:0xf
    v_dot2c_f32_bf16_dpp v15, v40, v86 row_newbcast:5 row_mask:0xf bank_mask:0xf
    v_dot2c_f32_bf16_dpp v16, v32, v87 row_newbcast:5 row_mask:0xf bank_mask:0xf
    v_dot2c_f32_bf16_dpp v17, v40, v87 row_newbcast:5 row_mask:0xf bank_mask:0xf
    buffer_load_dwordx4 v[68:71], v1, s[36:39], s70 offen nt
    s_add_u32 s70, s70, 0x1000
    s_waitcnt vmcnt(11)
    v_dot2c_f32_bf16_dpp v10, v32, v88 row_newbcast:6 row_mask:0xf bank_mask:0xf
    v_dot2c_f32_bf16_dpp v11, v40, v88 row_newbcast:6 row_mask:0xf bank_mask:0xf
    v_dot2c_f32_bf16_dpp v12, v32, v89 row_newbcast:6 row_mask:0xf bank_mask:0xf
    v_dot2c_f32_bf16_dpp v13, v40, v89 row_newbcast:6 row_mask:0xf bank_mask:0xf
    v_dot2c_f32_bf16_dpp v14, v32, v90 row_newbcast:6 row_mask:0xf bank_mask:0xf
    v_dot2c_f32_bf16_dpp v15, v40, v90 row_newbcast:6 row_mask:0xf bank_mask:0xf
    v_dot2c_f32_bf16_dpp v16, v32, v91 row_newbcast:6 row_mask:0xf bank_mask:0xf
    v_dot2c_f32_bf16_dpp v17, v40, v91 row_newbcast:6 row_mask:0xf bank_mask:0xf
    buffer_load_dwordx4 v[72:75], v1, s[36:39], s70 offen nt
    s_add_u32 s70, s70, 0x1000
    s_waitcnt vmcnt(11)
    v_dot2c_f32_bf16_dpp v10, v32, v92 row_newbcast:7 row_mask:0xf bank_mask:0xf
    v_dot2c_f32_bf16_dpp v11, v40, v92 row_newbcast:7 row_mask:0xf bank_mask:0xf
    v_dot2c_f32_bf16_dpp v12, v32, v93 row_newbcast:7 row_mask:0xf bank_mask:0xf
    v_dot2c_f32_bf16_dpp v13, v40, v93 row_newbcast:7 row_mask:0xf bank_mask:0xf
    v_dot2c_f32_bf16_dpp v14, v32, v94 row_newbcast:7 row_mask:0xf bank_mask:0xf
    v_dot2c_f32_bf16_dpp v15, v40, v94 row_newbcast:7 row_mask:0xf bank_mask:0xf
    v_dot2c_f32_bf16_dpp v16, v32, v95 row_newbcast:7 row_mask:0xf bank_mask:0xf
    v_dot2c_f32_bf16_dpp v17, v40, v95 row_newbcast:7 row_mask:0xf bank_mask:0xf
    buffer_load_dwordx4 v[76:79], v1, s[36:39], s70 offen nt
    s_add_u32 s70, s70, 0x1000
    s_waitcnt vmcnt(11)
    v_dot2c_f32_bf16_dpp v10, v32, v96 row_newbcast:8 row_mask:0xf bank_mask:0xf
    v_dot2c_f32_bf16_dpp v11, v40, v96 row_newbcast:8 row_mask:0xf bank_mask:0xf
    v_dot2c_f32_bf16_dpp v12, v32, v97 row_newbcast:8 row_mask:0xf bank_mask:0xf
    v_dot2c_f32_bf16_dpp v13, v40, v97 row_newbcast:8 row_mask:0xf bank_mask:0xf
    v_dot2c_f32_bf16_dpp v14, v32, v98 row_newbcast:8 row_mask:0xf bank_mask:0xf
    v_dot2c_f32_bf16_dpp v15, v40, v98 row_newbcast:8 row_mask:0xf bank_mask:0xf
    v_dot2c_f32_bf16_dpp v16, v32, v99 row_newbcast:8 row_mask:0xf bank_mask:0xf
    v_dot2c_f32_bf16_dpp v17, v40, v99 row_newbcast:8 row_mask:0xf bank_mask:0xf
    buffer_load_dwordx4 v[80:83], v1, s[36:39], s70 offen nt
    s_add_u32 s70, s70, 0x1000
    s_waitcnt vmcnt(11)
    v_dot2c_f32_bf16_dpp v10, v32, v100 row_newbcast:9 row_mask:0xf bank_mask:0xf
    v_dot2c_f32_bf16_dpp v11, v40, v100 row_newbcast:9 row_mask:0xf bank_mask:0xf
    v_dot2c_f32_bf16_dpp v12, v32, v101 row_newbcast:9 row_mask:0xf bank_mask:0xf
    v_dot2c_f32_bf16_dpp v13, v40, v101 row_newbcast:9 row_mask:0xf bank_mask:0xf
    v_dot2c_f32_bf16_dpp v14, v32, v102 row_newbcast:9 row_mask:0xf bank_mask:0xf
    v_dot2c_f32_bf16_dpp v15, v40, v102 row_newbcast:9 row_mask:0xf bank_mask:0xf
    v_dot2c_f32_bf16_dpp v16, v32, v103 row_newbcast:9 row_mask:0xf bank_mask:0xf
    v_dot2c_f32_bf16_dpp v17, v40, v103 row_newbcast:9 row_mask:0xf bank_mask:0xf
    buffer_load_dwordx4 v[84:87], v1, s[36:39], s70 offen nt
    s_add_u32 s70, s70, 0x1000
    s_waitcnt vmcnt(11)
    v_dot2c_f32_bf16_dpp v10, v32, v104 row_newbcast:10 row_mask:0xf bank_mask:0xf
    v_dot2c_f32_bf16_dpp v11, v40, v104 row_newbcast:10 row_mask:0xf bank_mask:0xf
    v_dot2c_f32_bf16_dpp v12, v32, v105 row_newbcast:10 row_mask:0xf bank_mask:0xf
    v_dot2c_f32_bf16_dpp v13, v40, v105 row_newbcast:10 row_mask:0xf bank_mask:0xf
    v_dot2c_f32_bf16_dpp v14, v32, v106 row_newbcast:10 row_mask:0xf bank_mask:0xf
    v_dot2c_f32_bf16_dpp v15, v40, v106 row_newbcast:10 row_mask:0xf bank_mask:0xf
    v_dot2c_f32_bf16_dpp v16, v32, v107 row_newbcast:10 row_mask:0xf bank_mask:0xf
    v_dot2c_f32_bf16_dpp v17, v40, v107 row_newbcast:10 row_mask:0xf bank_mask:0xf
    buffer_load_dwordx4 v[88:91], v1, s[36:39], s70 offen nt
    s_add_u32 s70, s70, 0x1000
    s_waitcnt vmcnt(11)
    v_dot2c_f32_bf16_dpp v10, v32, v108 row_newbcast:11 row_mask:0xf bank_mask:0xf
    v_dot2c_f32_bf16_dpp v11, v40, v108 row_newbcast:11 row_mask:0xf bank_mask:0xf
    v_dot2c_f32_bf16_dpp v12, v32, v109 row_newbcast:11 row_mask:0xf bank_mask:0xf
    v_dot2c_f32_bf16_dpp v13, v40, v109 row_newbcast:11 row_mask:0xf bank_mask:0xf
    v_dot2c_f32_bf16_dpp v14, v32, v110 row_newbcast:11 row_mask:0xf bank_mask:0xf
    v_dot2c_f32_bf16_dpp v15, v40, v110 row_newbcast:11 row_mask:0xf bank_mask:0xf
    v_dot2c_f32_bf16_dpp v16, v32, v111 row_newbcast:11 row_mask:0xf bank_mask:0xf
    v_dot2c_f32_bf16_dpp v17, v40, v111 row_newbcast:11 row_mask:0xf bank_mask:0xf
    buffer_load_dwordx4 v[92:95], v1, s[36:39], s70 offen nt
    s_add_u32 s70, s70, 0x9000
    s_waitcnt vmcnt(11)
    v_dot2c_f32_bf16_dpp v10, v32, v112 row_newbcast:12 row_mask:0xf bank_mask:0xf
    v_dot2c_f32_bf16_dpp v11, v40, v112 row_newbcast:12 row_mask:0xf bank_mask:0xf
    v_dot2c_f32_bf16_dpp v12, v32, v113 row_newbcast:12 row_mask:0xf bank_mask:0xf
    v_dot2c_f32_bf16_dpp v13, v40, v113 row_newbcast:12 row_mask:0xf bank_mask:0xf
    v_dot2c_f32_bf16_dpp v14, v32, v114 row_newbcast:12 row_mask:0xf bank_mask:0xf
    v_dot2c_f32_bf16_dpp v15, v40, v114 row_newbcast:12 row_mask:0xf bank_mask:0xf
    v_dot2c_f32_bf16_dpp v16, v32, v115 row_newbcast:12 row_mask:0xf bank_mask:0xf
    v_dot2c_f32_bf16_dpp v17, v40, v115 row_newbcast:12 row_mask:0xf bank_mask:0xf
    buffer_load_dwordx4 v[96:99], v1, s[36:39], s70 offen nt
    s_add_u32 s70, s70, 0x1000
    s_waitcnt vmcnt(11)
    v_dot2c_f32_bf16_dpp v10, v32, v116 row_newbcast:13 row_mask:0xf bank_mask:0xf
    v_dot2c_f32_bf16_dpp v11, v40, v116 row_newbcast:13 row_mask:0xf bank_mask:0xf
    v_dot2c_f32_bf16_dpp v12, v32, v117 row_newbcast:13 row_mask:0xf bank_mask:0xf
    v_dot2c_f32_bf16_dpp v13, v40, v117 row_newbcast:13 row_mask:0xf bank_mask:0xf
    v_dot2c_f32_bf16_dpp v14, v32, v118 row_newbcast:13 row_mask:0xf bank_mask:0xf
    v_dot2c_f32_bf16_dpp v15, v40, v118 row_newbcast:13 row_mask:0xf bank_mask:0xf
    v_dot2c_f32_bf16_dpp v16, v32, v119 row_newbcast:13 row_mask:0xf bank_mask:0xf
    v_dot2c_f32_bf16_dpp v17, v40, v119 row_newbcast:13 row_mask:0xf bank_mask:0xf
    buffer_load_dwordx4 v[100:103], v1, s[36:39], s70 offen nt
    s_add_u32 s70, s70, 0x1000
    s_waitcnt vmcnt(11)
    v_dot2c_f32_bf16_dpp v10, v32, v120 row_newbcast:14 row_mask:0xf bank_mask:0xf
    v_dot2c_f32_bf16_dpp v11, v40, v120 row_newbcast:14 row_mask:0xf bank_mask:0xf
    v_dot2c_f32_bf16_dpp v12, v32, v121 row_newbcast:14 row_mask:0xf bank_mask:0xf
    v_dot2c_f32_bf16_dpp v13, v40, v121 row_newbcast:14 row_mask:0xf bank_mask:0xf
    v_dot2c_f32_bf16_dpp v14, v32, v122 row_newbcast:14 row_mask:0xf bank_mask:0xf
    v_dot2c_f32_bf16_dpp v15, v40, v122 row_newbcast:14 row_mask:0xf bank_mask:0xf
    v_dot2c_f32_bf16_dpp v16, v32, v123 row_newbcast:14 row_mask:0xf bank_mask:0xf
    v_dot2c_f32_bf16_dpp v17, v40, v123 row_newbcast:14 row_mask:0xf bank_mask:0xf
    buffer_load_dwordx4 v[104:107], v1, s[36:39], s70 offen nt
    s_add_u32 s70, s70, 0x1000
    s_waitcnt vmcnt(11)
    v_dot2c_f32_bf16_dpp v10, v32, v124 row_newbcast:15 row_mask:0xf bank_mask:0xf
    v_dot2c_f32_bf16_dpp v11, v40, v124 row_newbcast:15 row_mask:0xf bank_mask:0xf
    v_dot2c_f32_bf16_dpp v12, v32, v125 row_newbcast:15 row_mask:0xf bank_mask:0xf
    v_dot2c_f32_bf16_dpp v13, v40, v125 row_newbcast:15 row_mask:0xf bank_mask:0xf
    v_dot2c_f32_bf16_dpp v14, v32, v126 row_newbcast:15 row_mask:0xf bank_mask:0xf
    v_dot2c_f32_bf16_dpp v15, v40, v126 row_newbcast:15 row_mask:0xf bank_mask:0xf
    v_dot2c_f32_bf16_dpp v16, v32, v127 row_newbcast:15 row_mask:0xf bank_mask:0xf
    v_dot2c_f32_bf16_dpp v17, v40, v127 row_newbcast:15 row_mask:0xf bank_mask:0xf
    buffer_load_dwordx4 v[108:111], v1, s[36:39], s70 offen nt
    s_add_u32 s70, s70, 0x1000
    s_waitcnt vmcnt(11)
    v_dot2c_f32_bf16_dpp v10, v33, v64 row_newbcast:0 row_mask:0xf bank_mask:0xf
    v_dot2c_f32_bf16_dpp v11, v41, v64 row_newbcast:0 row_mask:0xf bank_mask:0xf
    v_dot2c_f32_bf16_dpp v12, v33, v65 row_newbcast:0 row_mask:0xf bank_mask:0xf
    v_dot2c_f32_bf16_dpp v13, v41, v65 row_newbcast:0 row_mask:0xf bank_mask:0xf
    v_dot2c_f32_bf16_dpp v14, v33, v66 row_newbcast:0 row_mask:0xf bank_mask:0xf
    v_dot2c_f32_bf16_dpp v15, v41, v66 row_newbcast:0 row_mask:0xf bank_mask:0xf
    v_dot2c_f32_bf16_dpp v16, v33, v67 row_newbcast:0 row_mask:0xf bank_mask:0xf
    v_dot2c_f32_bf16_dpp v17, v41, v67 row_newbcast:0 row_mask:0xf bank_mask:0xf
    buffer_load_dwordx4 v[112:115], v1, s[36:39], s70 offen nt
    s_add_u32 s70, s70, 0x1000
    v_and_b32 v50, 15, v0
    v_lshrrev_b32 v51, 4, v0
    v_lshlrev_b32 v50, 5, v50
    s_lshl_b32 s80, s3, 9
    v_lshl_add_u32 v52, v51, 3, v50
    v_add_u32 v52, s80, v52
    s_lshl_b32 s80, s68, 1
    v_add_u32 v50, s80, v0
    v_and_b32 v50, 15, v50
    v_lshlrev_b32 v50, 5, v50
    v_lshl_add_u32 v50, v51, 2, v50
    v_add_u32 v50, 6144, v50
    v_add_u32 v51, 1024, v50
    v_mov_b32 v53, 0
    s_waitcnt vmcnt(11)
    v_dot2c_f32_bf16_dpp v10, v33, v68 row_newbcast:1 row_mask:0xf bank_mask:0xf
    v_dot2c_f32_bf16_dpp v11, v41, v68 row_newbcast:1 row_mask:0xf bank_mask:0xf
    v_dot2c_f32_bf16_dpp v12, v33, v69 row_newbcast:1 row_mask:0xf bank_mask:0xf
    v_dot2c_f32_bf16_dpp v13, v41, v69 row_newbcast:1 row_mask:0xf bank_mask:0xf
    v_dot2c_f32_bf16_dpp v14, v33, v70 row_newbcast:1 row_mask:0xf bank_mask:0xf
    v_dot2c_f32_bf16_dpp v15, v41, v70 row_newbcast:1 row_mask:0xf bank_mask:0xf
    v_dot2c_f32_bf16_dpp v16, v33, v71 row_newbcast:1 row_mask:0xf bank_mask:0xf
    v_dot2c_f32_bf16_dpp v17, v41, v71 row_newbcast:1 row_mask:0xf bank_mask:0xf
    buffer_load_dwordx4 v[116:119], v1, s[36:39], s70 offen nt
    s_add_u32 s70, s70, 0x1000
    s_waitcnt vmcnt(11)
    v_dot2c_f32_bf16_dpp v10, v33, v72 row_newbcast:2 row_mask:0xf bank_mask:0xf
    v_dot2c_f32_bf16_dpp v11, v41, v72 row_newbcast:2 row_mask:0xf bank_mask:0xf
    v_dot2c_f32_bf16_dpp v12, v33, v73 row_newbcast:2 row_mask:0xf bank_mask:0xf
    v_dot2c_f32_bf16_dpp v13, v41, v73 row_newbcast:2 row_mask:0xf bank_mask:0xf
    v_dot2c_f32_bf16_dpp v14, v33, v74 row_newbcast:2 row_mask:0xf bank_mask:0xf
    v_dot2c_f32_bf16_dpp v15, v41, v74 row_newbcast:2 row_mask:0xf bank_mask:0xf
    v_dot2c_f32_bf16_dpp v16, v33, v75 row_newbcast:2 row_mask:0xf bank_mask:0xf
    v_dot2c_f32_bf16_dpp v17, v41, v75 row_newbcast:2 row_mask:0xf bank_mask:0xf
    buffer_load_dwordx4 v[120:123], v1, s[36:39], s70 offen nt
    s_add_u32 s70, s70, 0x1000
    s_waitcnt vmcnt(11)
    v_dot2c_f32_bf16_dpp v10, v33, v76 row_newbcast:3 row_mask:0xf bank_mask:0xf
    v_dot2c_f32_bf16_dpp v11, v41, v76 row_newbcast:3 row_mask:0xf bank_mask:0xf
    v_dot2c_f32_bf16_dpp v12, v33, v77 row_newbcast:3 row_mask:0xf bank_mask:0xf
    v_dot2c_f32_bf16_dpp v13, v41, v77 row_newbcast:3 row_mask:0xf bank_mask:0xf
    v_dot2c_f32_bf16_dpp v14, v33, v78 row_newbcast:3 row_mask:0xf bank_mask:0xf
    v_dot2c_f32_bf16_dpp v15, v41, v78 row_newbcast:3 row_mask:0xf bank_mask:0xf
    v_dot2c_f32_bf16_dpp v16, v33, v79 row_newbcast:3 row_mask:0xf bank_mask:0xf
    v_dot2c_f32_bf16_dpp v17, v41, v79 row_newbcast:3 row_mask:0xf bank_mask:0xf
    buffer_load_dwordx4 v[124:127], v1, s[36:39], s70 offen nt
    s_add_u32 s70, s70, 0x9000
    s_waitcnt vmcnt(11)
    v_dot2c_f32_bf16_dpp v10, v33, v80 row_newbcast:4 row_mask:0xf bank_mask:0xf
    v_dot2c_f32_bf16_dpp v11, v41, v80 row_newbcast:4 row_mask:0xf bank_mask:0xf
    v_dot2c_f32_bf16_dpp v12, v33, v81 row_newbcast:4 row_mask:0xf bank_mask:0xf
    v_dot2c_f32_bf16_dpp v13, v41, v81 row_newbcast:4 row_mask:0xf bank_mask:0xf
    v_dot2c_f32_bf16_dpp v14, v33, v82 row_newbcast:4 row_mask:0xf bank_mask:0xf
    v_dot2c_f32_bf16_dpp v15, v41, v82 row_newbcast:4 row_mask:0xf bank_mask:0xf
    v_dot2c_f32_bf16_dpp v16, v33, v83 row_newbcast:4 row_mask:0xf bank_mask:0xf
    v_dot2c_f32_bf16_dpp v17, v41, v83 row_newbcast:4 row_mask:0xf bank_mask:0xf
    s_waitcnt vmcnt(10)
    v_dot2c_f32_bf16_dpp v10, v33, v84 row_newbcast:5 row_mask:0xf bank_mask:0xf
    v_dot2c_f32_bf16_dpp v11, v41, v84 row_newbcast:5 row_mask:0xf bank_mask:0xf
    v_dot2c_f32_bf16_dpp v12, v33, v85 row_newbcast:5 row_mask:0xf bank_mask:0xf
    v_dot2c_f32_bf16_dpp v13, v41, v85 row_newbcast:5 row_mask:0xf bank_mask:0xf
    v_dot2c_f32_bf16_dpp v14, v33, v86 row_newbcast:5 row_mask:0xf bank_mask:0xf
    v_dot2c_f32_bf16_dpp v15, v41, v86 row_newbcast:5 row_mask:0xf bank_mask:0xf
    v_dot2c_f32_bf16_dpp v16, v33, v87 row_newbcast:5 row_mask:0xf bank_mask:0xf
    v_dot2c_f32_bf16_dpp v17, v41, v87 row_newbcast:5 row_mask:0xf bank_mask:0xf
    s_waitcnt vmcnt(9)
    v_dot2c_f32_bf16_dpp v10, v33, v88 row_newbcast:6 row_mask:0xf bank_mask:0xf
    v_dot2c_f32_bf16_dpp v11, v41, v88 row_newbcast:6 row_mask:0xf bank_mask:0xf
    v_dot2c_f32_bf16_dpp v12, v33, v89 row_newbcast:6 row_mask:0xf bank_mask:0xf
    v_dot2c_f32_bf16_dpp v13, v41, v89 row_newbcast:6 row_mask:0xf bank_mask:0xf
    v_dot2c_f32_bf16_dpp v14, v33, v90 row_newbcast:6 row_mask:0xf bank_mask:0xf
    v_dot2c_f32_bf16_dpp v15, v41, v90 row_newbcast:6 row_mask:0xf bank_mask:0xf
    v_dot2c_f32_bf16_dpp v16, v33, v91 row_newbcast:6 row_mask:0xf bank_mask:0xf
    v_dot2c_f32_bf16_dpp v17, v41, v91 row_newbcast:6 row_mask:0xf bank_mask:0xf
    s_waitcnt vmcnt(8)
    v_dot2c_f32_bf16_dpp v10, v33, v92 row_newbcast:7 row_mask:0xf bank_mask:0xf
    v_dot2c_f32_bf16_dpp v11, v41, v92 row_newbcast:7 row_mask:0xf bank_mask:0xf
    v_dot2c_f32_bf16_dpp v12, v33, v93 row_newbcast:7 row_mask:0xf bank_mask:0xf
    v_dot2c_f32_bf16_dpp v13, v41, v93 row_newbcast:7 row_mask:0xf bank_mask:0xf
    v_dot2c_f32_bf16_dpp v14, v33, v94 row_newbcast:7 row_mask:0xf bank_mask:0xf
    v_dot2c_f32_bf16_dpp v15, v41, v94 row_newbcast:7 row_mask:0xf bank_mask:0xf
    v_dot2c_f32_bf16_dpp v16, v33, v95 row_newbcast:7 row_mask:0xf bank_mask:0xf
    v_dot2c_f32_bf16_dpp v17, v41, v95 row_newbcast:7 row_mask:0xf bank_mask:0xf
    s_waitcnt vmcnt(7)
    v_dot2c_f32_bf16_dpp v10, v33, v96 row_newbcast:8 row_mask:0xf bank_mask:0xf
    v_dot2c_f32_bf16_dpp v11, v41, v96 row_newbcast:8 row_mask:0xf bank_mask:0xf
    v_dot2c_f32_bf16_dpp v12, v33, v97 row_newbcast:8 row_mask:0xf bank_mask:0xf
    v_dot2c_f32_bf16_dpp v13, v41, v97 row_newbcast:8 row_mask:0xf bank_mask:0xf
    v_dot2c_f32_bf16_dpp v14, v33, v98 row_newbcast:8 row_mask:0xf bank_mask:0xf
    v_dot2c_f32_bf16_dpp v15, v41, v98 row_newbcast:8 row_mask:0xf bank_mask:0xf
    v_dot2c_f32_bf16_dpp v16, v33, v99 row_newbcast:8 row_mask:0xf bank_mask:0xf
    v_dot2c_f32_bf16_dpp v17, v41, v99 row_newbcast:8 row_mask:0xf bank_mask:0xf
    s_waitcnt vmcnt(6)
    v_dot2c_f32_bf16_dpp v10, v33, v100 row_newbcast:9 row_mask:0xf bank_mask:0xf
    v_dot2c_f32_bf16_dpp v11, v41, v100 row_newbcast:9 row_mask:0xf bank_mask:0xf
    v_dot2c_f32_bf16_dpp v12, v33, v101 row_newbcast:9 row_mask:0xf bank_mask:0xf
    v_dot2c_f32_bf16_dpp v13, v41, v101 row_newbcast:9 row_mask:0xf bank_mask:0xf
    v_dot2c_f32_bf16_dpp v14, v33, v102 row_newbcast:9 row_mask:0xf bank_mask:0xf
    v_dot2c_f32_bf16_dpp v15, v41, v102 row_newbcast:9 row_mask:0xf bank_mask:0xf
    v_dot2c_f32_bf16_dpp v16, v33, v103 row_newbcast:9 row_mask:0xf bank_mask:0xf
    v_dot2c_f32_bf16_dpp v17, v41, v103 row_newbcast:9 row_mask:0xf bank_mask:0xf
    s_waitcnt vmcnt(5)
    v_dot2c_f32_bf16_dpp v10, v33, v104 row_newbcast:10 row_mask:0xf bank_mask:0xf
    v_dot2c_f32_bf16_dpp v11, v41, v104 row_newbcast:10 row_mask:0xf bank_mask:0xf
    v_dot2c_f32_bf16_dpp v12, v33, v105 row_newbcast:10 row_mask:0xf bank_mask:0xf
    v_dot2c_f32_bf16_dpp v13, v41, v105 row_newbcast:10 row_mask:0xf bank_mask:0xf
    v_dot2c_f32_bf16_dpp v14, v33, v106 row_newbcast:10 row_mask:0xf bank_mask:0xf
    v_dot2c_f32_bf16_dpp v15, v41, v106 row_newbcast:10 row_mask:0xf bank_mask:0xf
    v_dot2c_f32_bf16_dpp v16, v33, v107 row_newbcast:10 row_mask:0xf bank_mask:0xf
    v_dot2c_f32_bf16_dpp v17, v41, v107 row_newbcast:10 row_mask:0xf bank_mask:0xf
    s_waitcnt vmcnt(4)
    v_dot2c_f32_bf16_dpp v10, v33, v108 row_newbcast:11 row_mask:0xf bank_mask:0xf
    v_dot2c_f32_bf16_dpp v11, v41, v108 row_newbcast:11 row_mask:0xf bank_mask:0xf
    v_dot2c_f32_bf16_dpp v12, v33, v109 row_newbcast:11 row_mask:0xf bank_mask:0xf
    v_dot2c_f32_bf16_dpp v13, v41, v109 row_newbcast:11 row_mask:0xf bank_mask:0xf
    v_dot2c_f32_bf16_dpp v14, v33, v110 row_newbcast:11 row_mask:0xf bank_mask:0xf
    v_dot2c_f32_bf16_dpp v15, v41, v110 row_newbcast:11 row_mask:0xf bank_mask:0xf
    v_dot2c_f32_bf16_dpp v16, v33, v111 row_newbcast:11 row_mask:0xf bank_mask:0xf
    v_dot2c_f32_bf16_dpp v17, v41, v111 row_newbcast:11 row_mask:0xf bank_mask:0xf
    s_waitcnt vmcnt(3)
    v_dot2c_f32_bf16_dpp v10, v33, v112 row_newbcast:12 row_mask:0xf bank_mask:0xf
    v_dot2c_f32_bf16_dpp v11, v41, v112 row_newbcast:12 row_mask:0xf bank_mask:0xf
    v_dot2c_f32_bf16_dpp v12, v33, v113 row_newbcast:12 row_mask:0xf bank_mask:0xf
    v_dot2c_f32_bf16_dpp v13, v41, v113 row_newbcast:12 row_mask:0xf bank_mask:0xf
    v_dot2c_f32_bf16_dpp v14, v33, v114 row_newbcast:12 row_mask:0xf bank_mask:0xf
    v_dot2c_f32_bf16_dpp v15, v41, v114 row_newbcast:12 row_mask:0xf bank_mask:0xf
    v_dot2c_f32_bf16_dpp v16, v33, v115 row_newbcast:12 row_mask:0xf bank_mask:0xf
    v_dot2c_f32_bf16_dpp v17, v41, v115 row_newbcast:12 row_mask:0xf bank_mask:0xf
    s_waitcnt vmcnt(2)
    v_dot2c_f32_bf16_dpp v10, v33, v116 row_newbcast:13 row_mask:0xf bank_mask:0xf
    v_dot2c_f32_bf16_dpp v11, v41, v116 row_newbcast:13 row_mask:0xf bank_mask:0xf
    v_dot2c_f32_bf16_dpp v12, v33, v117 row_newbcast:13 row_mask:0xf bank_mask:0xf
    v_dot2c_f32_bf16_dpp v13, v41, v117 row_newbcast:13 row_mask:0xf bank_mask:0xf
    v_dot2c_f32_bf16_dpp v14, v33, v118 row_newbcast:13 row_mask:0xf bank_mask:0xf
    v_dot2c_f32_bf16_dpp v15, v41, v118 row_newbcast:13 row_mask:0xf bank_mask:0xf
    v_dot2c_f32_bf16_dpp v16, v33, v119 row_newbcast:13 row_mask:0xf bank_mask:0xf
    v_dot2c_f32_bf16_dpp v17, v41, v119 row_newbcast:13 row_mask:0xf bank_mask:0xf
    s_waitcnt vmcnt(1)
    v_dot2c_f32_bf16_dpp v10, v33, v120 row_newbcast:14 row_mask:0xf bank_mask:0xf
    v_dot2c_f32_bf16_dpp v11, v41, v120 row_newbcast:14 row_mask:0xf bank_mask:0xf
    v_dot2c_f32_bf16_dpp v12, v33, v121 row_newbcast:14 row_mask:0xf bank_mask:0xf
    v_dot2c_f32_bf16_dpp v13, v41, v121 row_newbcast:14 row_mask:0xf bank_mask:0xf
    v_dot2c_f32_bf16_dpp v14, v33, v122 row_newbcast:14 row_mask:0xf bank_mask:0xf
    v_dot2c_f32_bf16_dpp v15, v41, v122 row_newbcast:14 row_mask:0xf bank_mask:0xf
    v_dot2c_f32_bf16_dpp v16, v33, v123 row_newbcast:14 row_mask:0xf bank_mask:0xf
    v_dot2c_f32_bf16_dpp v17, v41, v123 row_newbcast:14 row_mask:0xf bank_mask:0xf
    s_waitcnt vmcnt(0)
    v_dot2c_f32_bf16_dpp v10, v33, v124 row_newbcast:15 row_mask:0xf bank_mask:0xf
    v_dot2c_f32_bf16_dpp v11, v41, v124 row_newbcast:15 row_mask:0xf bank_mask:0xf
    v_dot2c_f32_bf16_dpp v12, v33, v125 row_newbcast:15 row_mask:0xf bank_mask:0xf
    v_dot2c_f32_bf16_dpp v13, v41, v125 row_newbcast:15 row_mask:0xf bank_mask:0xf
    v_dot2c_f32_bf16_dpp v14, v33, v126 row_newbcast:15 row_mask:0xf bank_mask:0xf
    v_dot2c_f32_bf16_dpp v15, v41, v126 row_newbcast:15 row_mask:0xf bank_mask:0xf
    v_dot2c_f32_bf16_dpp v16, v33, v127 row_newbcast:15 row_mask:0xf bank_mask:0xf
    v_dot2c_f32_bf16_dpp v17, v41, v127 row_newbcast:15 row_mask:0xf bank_mask:0xf
    v_permlane32_swap_b32 v10, v14
    v_permlane32_swap_b32 v11, v15
    v_permlane32_swap_b32 v12, v16
    v_permlane32_swap_b32 v13, v17
    v_add_f32 v10, v10, v14
    v_add_f32 v11, v11, v15
    v_add_f32 v12, v12, v16
    v_add_f32 v13, v13, v17
    s_nop 0
    v_permlane16_swap_b32 v10, v12
    v_permlane16_swap_b32 v11, v13
    v_add_f32 v10, v10, v12
    v_add_f32 v11, v11, v13
    ds_write_b64 v52, v[10:11] offset:6144
    s_waitcnt lgkmcnt(0)
    s_barrier
    ds_read2_b32 v[42:43], v50 offset0:0 offset1:4
    ds_read2_b32 v[44:45], v50 offset0:128 offset1:132
    ds_read2_b32 v[46:47], v51 offset0:0 offset1:4
    ds_read2_b32 v[48:49], v51 offset0:128 offset1:132
    ds_read_b128 v[14:17], v53 offset:2112
    ds_read_b64 v[12:13], v52 offset:4096
    v_mov_b32 v18, 0
    v_mov_b32 v19, 0
    v_mov_b32 v20, 0
    v_mov_b32 v21, 0
    v_mov_b32 v22, 0
    v_mov_b32 v23, 0
    v_mov_b32 v24, 0
    v_mov_b32 v25, 0
    s_waitcnt lgkmcnt(0)
    v_mul_f32 v42, v14, v42
    v_mul_f32 v43, v14, v43
    v_mul_f32 v46, v16, v46
    v_mul_f32 v47, v16, v47
    v_fmac_f32 v42, v15, v44
    v_fmac_f32 v43, v15, v45
    v_fmac_f32 v46, v17, v48
    v_fmac_f32 v47, v17, v49
    v_add_f32 v42, v42, v46
    v_add_f32 v43, v43, v47
    v_cvt_pk_bf16_f32 v42, v42, v43
    s_nop 1
    v_dot2c_f32_bf16_dpp v18, v42, v57 row_newbcast:0 row_mask:0xf bank_mask:0xf
    v_dot2c_f32_bf16_dpp v19, v42, v132 row_newbcast:0 row_mask:0xf bank_mask:0xf
    v_dot2c_f32_bf16_dpp v20, v42, v128 row_newbcast:0 row_mask:0xf bank_mask:0xf
    v_dot2c_f32_bf16_dpp v21, v42, v133 row_newbcast:0 row_mask:0xf bank_mask:0xf
    v_dot2c_f32_bf16_dpp v22, v42, v129 row_newbcast:0 row_mask:0xf bank_mask:0xf
    v_dot2c_f32_bf16_dpp v23, v42, v134 row_newbcast:0 row_mask:0xf bank_mask:0xf
    v_dot2c_f32_bf16_dpp v24, v42, v130 row_newbcast:0 row_mask:0xf bank_mask:0xf
    v_dot2c_f32_bf16_dpp v25, v42, v135 row_newbcast:0 row_mask:0xf bank_mask:0xf
    v_dot2c_f32_bf16_dpp v18, v42, v131 row_newbcast:1 row_mask:0xf bank_mask:0xf
    v_dot2c_f32_bf16_dpp v19, v42, v140 row_newbcast:1 row_mask:0xf bank_mask:0xf
    v_dot2c_f32_bf16_dpp v20, v42, v136 row_newbcast:1 row_mask:0xf bank_mask:0xf
    v_dot2c_f32_bf16_dpp v21, v42, v141 row_newbcast:1 row_mask:0xf bank_mask:0xf
    v_dot2c_f32_bf16_dpp v22, v42, v137 row_newbcast:1 row_mask:0xf bank_mask:0xf
    v_dot2c_f32_bf16_dpp v23, v42, v142 row_newbcast:1 row_mask:0xf bank_mask:0xf
    v_dot2c_f32_bf16_dpp v24, v42, v138 row_newbcast:1 row_mask:0xf bank_mask:0xf
    v_dot2c_f32_bf16_dpp v25, v42, v143 row_newbcast:1 row_mask:0xf bank_mask:0xf
    v_dot2c_f32_bf16_dpp v18, v42, v139 row_newbcast:2 row_mask:0xf bank_mask:0xf
    v_dot2c_f32_bf16_dpp v19, v42, v148 row_newbcast:2 row_mask:0xf bank_mask:0xf
    v_dot2c_f32_bf16_dpp v20, v42, v144 row_newbcast:2 row_mask:0xf bank_mask:0xf
    v_dot2c_f32_bf16_dpp v21, v42, v149 row_newbcast:2 row_mask:0xf bank_mask:0xf
    v_dot2c_f32_bf16_dpp v22, v42, v145 row_newbcast:2 row_mask:0xf bank_mask:0xf
    v_dot2c_f32_bf16_dpp v23, v42, v150 row_newbcast:2 row_mask:0xf bank_mask:0xf
    v_dot2c_f32_bf16_dpp v24, v42, v146 row_newbcast:2 row_mask:0xf bank_mask:0xf
    v_dot2c_f32_bf16_dpp v25, v42, v151 row_newbcast:2 row_mask:0xf bank_mask:0xf
    v_dot2c_f32_bf16_dpp v18, v42, v147 row_newbcast:3 row_mask:0xf bank_mask:0xf
    v_dot2c_f32_bf16_dpp v19, v42, v156 row_newbcast:3 row_mask:0xf bank_mask:0xf
    v_dot2c_f32_bf16_dpp v20, v42, v152 row_newbcast:3 row_mask:0xf bank_mask:0xf
    v_dot2c_f32_bf16_dpp v21, v42, v157 row_newbcast:3 row_mask:0xf bank_mask:0xf
    v_dot2c_f32_bf16_dpp v22, v42, v153 row_newbcast:3 row_mask:0xf bank_mask:0xf
    v_dot2c_f32_bf16_dpp v23, v42, v158 row_newbcast:3 row_mask:0xf bank_mask:0xf
    v_dot2c_f32_bf16_dpp v24, v42, v154 row_newbcast:3 row_mask:0xf bank_mask:0xf
    v_dot2c_f32_bf16_dpp v25, v42, v159 row_newbcast:3 row_mask:0xf bank_mask:0xf
    v_dot2c_f32_bf16_dpp v18, v42, v155 row_newbcast:4 row_mask:0xf bank_mask:0xf
    v_dot2c_f32_bf16_dpp v19, v42, v164 row_newbcast:4 row_mask:0xf bank_mask:0xf
    v_dot2c_f32_bf16_dpp v20, v42, v160 row_newbcast:4 row_mask:0xf bank_mask:0xf
    v_dot2c_f32_bf16_dpp v21, v42, v165 row_newbcast:4 row_mask:0xf bank_mask:0xf
    v_dot2c_f32_bf16_dpp v22, v42, v161 row_newbcast:4 row_mask:0xf bank_mask:0xf
    v_dot2c_f32_bf16_dpp v23, v42, v166 row_newbcast:4 row_mask:0xf bank_mask:0xf
    v_dot2c_f32_bf16_dpp v24, v42, v162 row_newbcast:4 row_mask:0xf bank_mask:0xf
    v_dot2c_f32_bf16_dpp v25, v42, v167 row_newbcast:4 row_mask:0xf bank_mask:0xf
    v_dot2c_f32_bf16_dpp v18, v42, v163 row_newbcast:5 row_mask:0xf bank_mask:0xf
    v_dot2c_f32_bf16_dpp v19, v42, v172 row_newbcast:5 row_mask:0xf bank_mask:0xf
    v_dot2c_f32_bf16_dpp v20, v42, v168 row_newbcast:5 row_mask:0xf bank_mask:0xf
    v_dot2c_f32_bf16_dpp v21, v42, v173 row_newbcast:5 row_mask:0xf bank_mask:0xf
    v_dot2c_f32_bf16_dpp v22, v42, v169 row_newbcast:5 row_mask:0xf bank_mask:0xf
    v_dot2c_f32_bf16_dpp v23, v42, v174 row_newbcast:5 row_mask:0xf bank_mask:0xf
    v_dot2c_f32_bf16_dpp v24, v42, v170 row_newbcast:5 row_mask:0xf bank_mask:0xf
    v_dot2c_f32_bf16_dpp v25, v42, v175 row_newbcast:5 row_mask:0xf bank_mask:0xf
    v_dot2c_f32_bf16_dpp v18, v42, v171 row_newbcast:6 row_mask:0xf bank_mask:0xf
    v_dot2c_f32_bf16_dpp v19, v42, v180 row_newbcast:6 row_mask:0xf bank_mask:0xf
    v_dot2c_f32_bf16_dpp v20, v42, v176 row_newbcast:6 row_mask:0xf bank_mask:0xf
    v_dot2c_f32_bf16_dpp v21, v42, v181 row_newbcast:6 row_mask:0xf bank_mask:0xf
    v_dot2c_f32_bf16_dpp v22, v42, v177 row_newbcast:6 row_mask:0xf bank_mask:0xf
    v_dot2c_f32_bf16_dpp v23, v42, v182 row_newbcast:6 row_mask:0xf bank_mask:0xf
    v_dot2c_f32_bf16_dpp v24, v42, v178 row_newbcast:6 row_mask:0xf bank_mask:0xf
    v_dot2c_f32_bf16_dpp v25, v42, v183 row_newbcast:6 row_mask:0xf bank_mask:0xf
    v_dot2c_f32_bf16_dpp v18, v42, v179 row_newbcast:7 row_mask:0xf bank_mask:0xf
    v_dot2c_f32_bf16_dpp v19, v42, v188 row_newbcast:7 row_mask:0xf bank_mask:0xf
    v_dot2c_f32_bf16_dpp v20, v42, v184 row_newbcast:7 row_mask:0xf bank_mask:0xf
    v_dot2c_f32_bf16_dpp v21, v42, v189 row_newbcast:7 row_mask:0xf bank_mask:0xf
    v_dot2c_f32_bf16_dpp v22, v42, v185 row_newbcast:7 row_mask:0xf bank_mask:0xf
    v_dot2c_f32_bf16_dpp v23, v42, v190 row_newbcast:7 row_mask:0xf bank_mask:0xf
    v_dot2c_f32_bf16_dpp v24, v42, v186 row_newbcast:7 row_mask:0xf bank_mask:0xf
    v_dot2c_f32_bf16_dpp v25, v42, v191 row_newbcast:7 row_mask:0xf bank_mask:0xf
    v_dot2c_f32_bf16_dpp v18, v42, v187 row_newbcast:8 row_mask:0xf bank_mask:0xf
    v_dot2c_f32_bf16_dpp v19, v42, v196 row_newbcast:8 row_mask:0xf bank_mask:0xf
    v_dot2c_f32_bf16_dpp v20, v42, v192 row_newbcast:8 row_mask:0xf bank_mask:0xf
    v_dot2c_f32_bf16_dpp v21, v42, v197 row_newbcast:8 row_mask:0xf bank_mask:0xf
    v_dot2c_f32_bf16_dpp v22, v42, v193 row_newbcast:8 row_mask:0xf bank_mask:0xf
    v_dot2c_f32_bf16_dpp v23, v42, v198 row_newbcast:8 row_mask:0xf bank_mask:0xf
    v_dot2c_f32_bf16_dpp v24, v42, v194 row_newbcast:8 row_mask:0xf bank_mask:0xf
    v_dot2c_f32_bf16_dpp v25, v42, v199 row_newbcast:8 row_mask:0xf bank_mask:0xf
    v_dot2c_f32_bf16_dpp v18, v42, v195 row_newbcast:9 row_mask:0xf bank_mask:0xf
    v_dot2c_f32_bf16_dpp v19, v42, v204 row_newbcast:9 row_mask:0xf bank_mask:0xf
    v_dot2c_f32_bf16_dpp v20, v42, v200 row_newbcast:9 row_mask:0xf bank_mask:0xf
    v_dot2c_f32_bf16_dpp v21, v42, v205 row_newbcast:9 row_mask:0xf bank_mask:0xf
    v_dot2c_f32_bf16_dpp v22, v42, v201 row_newbcast:9 row_mask:0xf bank_mask:0xf
    v_dot2c_f32_bf16_dpp v23, v42, v206 row_newbcast:9 row_mask:0xf bank_mask:0xf
    v_dot2c_f32_bf16_dpp v24, v42, v202 row_newbcast:9 row_mask:0xf bank_mask:0xf
    v_dot2c_f32_bf16_dpp v25, v42, v207 row_newbcast:9 row_mask:0xf bank_mask:0xf
    v_dot2c_f32_bf16_dpp v18, v42, v203 row_newbcast:10 row_mask:0xf bank_mask:0xf
    v_dot2c_f32_bf16_dpp v19, v42, v212 row_newbcast:10 row_mask:0xf bank_mask:0xf
    v_dot2c_f32_bf16_dpp v20, v42, v208 row_newbcast:10 row_mask:0xf bank_mask:0xf
    v_dot2c_f32_bf16_dpp v21, v42, v213 row_newbcast:10 row_mask:0xf bank_mask:0xf
    v_dot2c_f32_bf16_dpp v22, v42, v209 row_newbcast:10 row_mask:0xf bank_mask:0xf
    v_dot2c_f32_bf16_dpp v23, v42, v214 row_newbcast:10 row_mask:0xf bank_mask:0xf
    v_dot2c_f32_bf16_dpp v24, v42, v210 row_newbcast:10 row_mask:0xf bank_mask:0xf
    v_dot2c_f32_bf16_dpp v25, v42, v215 row_newbcast:10 row_mask:0xf bank_mask:0xf
    v_dot2c_f32_bf16_dpp v18, v42, v211 row_newbcast:11 row_mask:0xf bank_mask:0xf
    v_dot2c_f32_bf16_dpp v19, v42, v220 row_newbcast:11 row_mask:0xf bank_mask:0xf
    v_dot2c_f32_bf16_dpp v20, v42, v216 row_newbcast:11 row_mask:0xf bank_mask:0xf
    v_dot2c_f32_bf16_dpp v21, v42, v221 row_newbcast:11 row_mask:0xf bank_mask:0xf
    v_dot2c_f32_bf16_dpp v22, v42, v217 row_newbcast:11 row_mask:0xf bank_mask:0xf
    v_dot2c_f32_bf16_dpp v23, v42, v222 row_newbcast:11 row_mask:0xf bank_mask:0xf
    v_dot2c_f32_bf16_dpp v24, v42, v218 row_newbcast:11 row_mask:0xf bank_mask:0xf
    v_dot2c_f32_bf16_dpp v25, v42, v223 row_newbcast:11 row_mask:0xf bank_mask:0xf
    v_dot2c_f32_bf16_dpp v18, v42, v219 row_newbcast:12 row_mask:0xf bank_mask:0xf
    v_dot2c_f32_bf16_dpp v19, v42, v228 row_newbcast:12 row_mask:0xf bank_mask:0xf
    v_dot2c_f32_bf16_dpp v20, v42, v224 row_newbcast:12 row_mask:0xf bank_mask:0xf
    v_dot2c_f32_bf16_dpp v21, v42, v229 row_newbcast:12 row_mask:0xf bank_mask:0xf
    v_dot2c_f32_bf16_dpp v22, v42, v225 row_newbcast:12 row_mask:0xf bank_mask:0xf
    v_dot2c_f32_bf16_dpp v23, v42, v230 row_newbcast:12 row_mask:0xf bank_mask:0xf
    v_dot2c_f32_bf16_dpp v24, v42, v226 row_newbcast:12 row_mask:0xf bank_mask:0xf
    v_dot2c_f32_bf16_dpp v25, v42, v231 row_newbcast:12 row_mask:0xf bank_mask:0xf
    v_dot2c_f32_bf16_dpp v18, v42, v227 row_newbcast:13 row_mask:0xf bank_mask:0xf
    v_dot2c_f32_bf16_dpp v19, v42, v236 row_newbcast:13 row_mask:0xf bank_mask:0xf
    v_dot2c_f32_bf16_dpp v20, v42, v232 row_newbcast:13 row_mask:0xf bank_mask:0xf
    v_dot2c_f32_bf16_dpp v21, v42, v237 row_newbcast:13 row_mask:0xf bank_mask:0xf
    v_dot2c_f32_bf16_dpp v22, v42, v233 row_newbcast:13 row_mask:0xf bank_mask:0xf
    v_dot2c_f32_bf16_dpp v23, v42, v238 row_newbcast:13 row_mask:0xf bank_mask:0xf
    v_dot2c_f32_bf16_dpp v24, v42, v234 row_newbcast:13 row_mask:0xf bank_mask:0xf
    v_dot2c_f32_bf16_dpp v25, v42, v239 row_newbcast:13 row_mask:0xf bank_mask:0xf
    v_dot2c_f32_bf16_dpp v18, v42, v235 row_newbcast:14 row_mask:0xf bank_mask:0xf
    v_dot2c_f32_bf16_dpp v19, v42, v244 row_newbcast:14 row_mask:0xf bank_mask:0xf
    v_dot2c_f32_bf16_dpp v20, v42, v240 row_newbcast:14 row_mask:0xf bank_mask:0xf
    v_dot2c_f32_bf16_dpp v21, v42, v245 row_newbcast:14 row_mask:0xf bank_mask:0xf
    v_dot2c_f32_bf16_dpp v22, v42, v241 row_newbcast:14 row_mask:0xf bank_mask:0xf
    v_dot2c_f32_bf16_dpp v23, v42, v246 row_newbcast:14 row_mask:0xf bank_mask:0xf
    v_dot2c_f32_bf16_dpp v24, v42, v242 row_newbcast:14 row_mask:0xf bank_mask:0xf
    v_dot2c_f32_bf16_dpp v25, v42, v247 row_newbcast:14 row_mask:0xf bank_mask:0xf
    v_dot2c_f32_bf16_dpp v18, v42, v243 row_newbcast:15 row_mask:0xf bank_mask:0xf
    v_dot2c_f32_bf16_dpp v19, v42, v252 row_newbcast:15 row_mask:0xf bank_mask:0xf
    v_dot2c_f32_bf16_dpp v20, v42, v248 row_newbcast:15 row_mask:0xf bank_mask:0xf
    v_dot2c_f32_bf16_dpp v21, v42, v253 row_newbcast:15 row_mask:0xf bank_mask:0xf
    v_dot2c_f32_bf16_dpp v22, v42, v249 row_newbcast:15 row_mask:0xf bank_mask:0xf
    v_dot2c_f32_bf16_dpp v23, v42, v254 row_newbcast:15 row_mask:0xf bank_mask:0xf
    v_dot2c_f32_bf16_dpp v24, v42, v250 row_newbcast:15 row_mask:0xf bank_mask:0xf
    v_dot2c_f32_bf16_dpp v25, v42, v255 row_newbcast:15 row_mask:0xf bank_mask:0xf
    v_permlane32_swap_b32 v18, v22
    v_permlane32_swap_b32 v19, v23
    v_permlane32_swap_b32 v20, v24
    v_permlane32_swap_b32 v21, v25
    v_add_f32 v18, v18, v22
    v_add_f32 v19, v19, v23
    v_add_f32 v20, v20, v24
    v_add_f32 v21, v21, v25
    s_nop 0
    v_permlane16_swap_b32 v18, v20
    v_permlane16_swap_b32 v19, v21
    v_add_f32 v18, v18, v20
    v_add_f32 v19, v19, v21
    v_add_f32 v18, v18, v12
    v_add_f32 v19, v19, v13
    global_store_dwordx2 v62, v[18:19], s[28:29] sc1
    s_branch L_fin
L_stream1:
    s_nop 1
    v_lshrrev_b32 v42, 4, v0
    v_and_b32 v43, 15, v0
    s_lshl_b32 s80, s3, 10
    v_lshlrev_b32 v1, 4, v0
    v_add_u32 v1, s80, v1
    s_lshl_b32 s80, s3, 20
    v_lshlrev_b32 v2, 13, v42
    v_lshl_add_u32 v2, v43, 4, v2
    v_add_u32 v2, s80, v2
    s_lshl_b32 s80, s64, 10
    s_lshl_b32 s81, s3, 8
    s_add_u32 s80, s80, s81
    s_lshl_b32 s81, s68, 2
    v_add_u32 v4, s81, v43
    v_add_u32 v5, 16, v4
    v_and_b32 v4, 31, v4
    v_and_b32 v5, 31, v5
    v_lshl_add_u32 v4, v4, 2, v42
    v_lshlrev_b32 v4, 1, v4
    v_add_u32 v4, s80, v4
    v_lshl_add_u32 v5, v5, 2, v42
    v_lshlrev_b32 v5, 1, v5
    v_add_u32 v5, s80, v5
    s_waitcnt lgkmcnt(0)
    global_load_ushort v58, v4, s[4:5]
    global_load_ushort v59, v5, s[4:5]
    s_lshl_b32 s80, s63, 8
    s_sub_u32 s81, 0x400000, s80
    s_add_u32 s40, s10, s80
    s_addc_u32 s41, s11, 0
    s_and_b32 s41, s41, 0xffff
    s_mov_b32 s42, s81
    s_mov_b32 s43, 0x20000
    s_lshl_b32 s71, s68, 17
    buffer_load_dwordx4 v[128:131], v2, s[40:43], s71 offen
    s_add_u32 s71, s71, 0x8000
    s_and_b32 s71, s71, 0xfffff
    buffer_load_dwordx4 v[132:135], v2, s[40:43], s71 offen
    s_add_u32 s71, s71, 0x8000
    s_and_b32 s71, s71, 0xfffff
    buffer_load_dwordx4 v[136:139], v2, s[40:43], s71 offen
    s_add_u32 s71, s71, 0x8000
    s_and_b32 s71, s71, 0xfffff
    buffer_load_dwordx4 v[140:143], v2, s[40:43], s71 offen
    s_add_u32 s71, s71, 0x8000
    s_and_b32 s71, s71, 0xfffff
    buffer_load_dwordx4 v[144:147], v2, s[40:43], s71 offen
    s_add_u32 s71, s71, 0x8000
    s_and_b32 s71, s71, 0xfffff
    buffer_load_dwordx4 v[148:151], v2, s[40:43], s71 offen
    s_add_u32 s71, s71, 0x8000
    s_and_b32 s71, s71, 0xfffff
    buffer_load_dwordx4 v[152:155], v2, s[40:43], s71 offen
    s_add_u32 s71, s71, 0x8000
    s_and_b32 s71, s71, 0xfffff
    buffer_load_dwordx4 v[156:159], v2, s[40:43], s71 offen
    s_add_u32 s71, s71, 0x8000
    s_and_b32 s71, s71, 0xfffff
    s_lshl_b32 s80, s66, 20
    s_add_u32 s32, s6, s80
    s_addc_u32 s33, s7, 0
    s_and_b32 s33, s33, 0xffff
    s_mov_b32 s34, 0x100000
    s_mov_b32 s35, 0x20000
    s_add_u32 s36, s8, s80
    s_addc_u32 s37, s9, 0
    s_and_b32 s37, s37, 0xffff
    s_mov_b32 s38, 0x100000
    s_mov_b32 s39, 0x20000
    s_mul_i32 s75, s65, 32768
    s_mov_b32 s70, s75
    s_lshl_b32 s80, s3, 8
    v_lshlrev_b32 v3, 10, v42
    v_lshl_add_u32 v3, v43, 4, v3
    v_add_u32 v3, s80, v3
    s_lshl_b32 s80, s63, 17
    s_add_u32 s44, s12, s80
    s_addc_u32 s45, s13, 0
    s_and_b32 s45, s45, 0xffff
    s_mov_b32 s46, 0x20000
    s_mov_b32 s47, 0x20000
    s_lshl_b32 s72, s68, 14
    s_mov_b32 s76, 0xcccccccc
    s_mov_b32 s77, 0xcccccccc
    s_mov_b32 s78, 0xaaaaaaaa
    s_mov_b32 s79, 0xaaaaaaaa
    s_lshl_b32 s80, s64, 6
    s_add_u32 s80, s80, s67
    s_lshl_b32 s80, s80, 11
    s_lshl_b32 s81, s3, 9
    v_lshlrev_b32 v47, 5, v43
    v_lshl_add_u32 v47, v42, 3, v47
    v_add_u32 v47, s81, v47
    v_add_u32 v62, s80, v47
    v_mov_b32 v10, 0
    v_mov_b32 v11, 0
    v_mov_b32 v12, 0
    v_mov_b32 v13, 0
    v_mov_b32 v14, 0
    v_mov_b32 v15, 0
    v_mov_b32 v16, 0
    v_mov_b32 v17, 0
    s_waitcnt vmcnt(8)
    v_lshlrev_b32 v60, 16, v58
    v_lshlrev_b32 v61, 16, v59
    s_waitcnt vmcnt(7)
    v_dot2c_f32_bf16_dpp v10, v58, v128 row_newbcast:0 row_mask:0xf bank_mask:0xf
    v_dot2c_f32_bf16_dpp v11, v60, v128 row_newbcast:0 row_mask:0xf bank_mask:0xf
    v_dot2c_f32_bf16_dpp v12, v58, v129 row_newbcast:0 row_mask:0xf bank_mask:0xf
    v_dot2c_f32_bf16_dpp v13, v60, v129 row_newbcast:0 row_mask:0xf bank_mask:0xf
    v_dot2c_f32_bf16_dpp v14, v58, v130 row_newbcast:0 row_mask:0xf bank_mask:0xf
    v_dot2c_f32_bf16_dpp v15, v60, v130 row_newbcast:0 row_mask:0xf bank_mask:0xf
    v_dot2c_f32_bf16_dpp v16, v58, v131 row_newbcast:0 row_mask:0xf bank_mask:0xf
    v_dot2c_f32_bf16_dpp v17, v60, v131 row_newbcast:0 row_mask:0xf bank_mask:0xf
    buffer_load_dwordx4 v[160:163], v2, s[40:43], s71 offen
    s_add_u32 s71, s71, 0x8000
    s_and_b32 s71, s71, 0xfffff
    s_waitcnt vmcnt(7)
    v_dot2c_f32_bf16_dpp v10, v58, v132 row_newbcast:1 row_mask:0xf bank_mask:0xf
    v_dot2c_f32_bf16_dpp v11, v60, v132 row_newbcast:1 row_mask:0xf bank_mask:0xf
    v_dot2c_f32_bf16_dpp v12, v58, v133 row_newbcast:1 row_mask:0xf bank_mask:0xf
    v_dot2c_f32_bf16_dpp v13, v60, v133 row_newbcast:1 row_mask:0xf bank_mask:0xf
    v_dot2c_f32_bf16_dpp v14, v58, v134 row_newbcast:1 row_mask:0xf bank_mask:0xf
    v_dot2c_f32_bf16_dpp v15, v60, v134 row_newbcast:1 row_mask:0xf bank_mask:0xf
    v_dot2c_f32_bf16_dpp v16, v58, v135 row_newbcast:1 row_mask:0xf bank_mask:0xf
    v_dot2c_f32_bf16_dpp v17, v60, v135 row_newbcast:1 row_mask:0xf bank_mask:0xf
    buffer_load_dwordx4 v[164:167], v2, s[40:43], s71 offen
    s_add_u32 s71, s71, 0x8000
    s_and_b32 s71, s71, 0xfffff
    s_waitcnt vmcnt(7)
    v_dot2c_f32_bf16_dpp v10, v58, v136 row_newbcast:2 row_mask:0xf bank_mask:0xf
    v_dot2c_f32_bf16_dpp v11, v60, v136 row_newbcast:2 row_mask:0xf bank_mask:0xf
    v_dot2c_f32_bf16_dpp v12, v58, v137 row_newbcast:2 row_mask:0xf bank_mask:0xf
    v_dot2c_f32_bf16_dpp v13, v60, v137 row_newbcast:2 row_mask:0xf bank_mask:0xf
    v_dot2c_f32_bf16_dpp v14, v58, v138 row_newbcast:2 row_mask:0xf bank_mask:0xf
    v_dot2c_f32_bf16_dpp v15, v60, v138 row_newbcast:2 row_mask:0xf bank_mask:0xf
    v_dot2c_f32_bf16_dpp v16, v58, v139 row_newbcast:2 row_mask:0xf bank_mask:0xf
    v_dot2c_f32_bf16_dpp v17, v60, v139 row_newbcast:2 row_mask:0xf bank_mask:0xf
    buffer_load_dwordx4 v[168:171], v2, s[40:43], s71 offen
    s_add_u32 s71, s71, 0x8000
    s_and_b32 s71, s71, 0xfffff
    s_waitcnt vmcnt(7)
    v_dot2c_f32_bf16_dpp v10, v58, v140 row_newbcast:3 row_mask:0xf bank_mask:0xf
    v_dot2c_f32_bf16_dpp v11, v60, v140 row_newbcast:3 row_mask:0xf bank_mask:0xf
    v_dot2c_f32_bf16_dpp v12, v58, v141 row_newbcast:3 row_mask:0xf bank_mask:0xf
    v_dot2c_f32_bf16_dpp v13, v60, v141 row_newbcast:3 row_mask:0xf bank_mask:0xf
    v_dot2c_f32_bf16_dpp v14, v58, v142 row_newbcast:3 row_mask:0xf bank_mask:0xf
    v_dot2c_f32_bf16_dpp v15, v60, v142 row_newbcast:3 row_mask:0xf bank_mask:0xf
    v_dot2c_f32_bf16_dpp v16, v58, v143 row_newbcast:3 row_mask:0xf bank_mask:0xf
    v_dot2c_f32_bf16_dpp v17, v60, v143 row_newbcast:3 row_mask:0xf bank_mask:0xf
    buffer_load_dwordx4 v[172:175], v2, s[40:43], s71 offen
    s_add_u32 s71, s71, 0x8000
    s_and_b32 s71, s71, 0xfffff
    s_waitcnt vmcnt(7)
    v_dot2c_f32_bf16_dpp v10, v58, v144 row_newbcast:4 row_mask:0xf bank_mask:0xf
    v_dot2c_f32_bf16_dpp v11, v60, v144 row_newbcast:4 row_mask:0xf bank_mask:0xf
    v_dot2c_f32_bf16_dpp v12, v58, v145 row_newbcast:4 row_mask:0xf bank_mask:0xf
    v_dot2c_f32_bf16_dpp v13, v60, v145 row_newbcast:4 row_mask:0xf bank_mask:0xf
    v_dot2c_f32_bf16_dpp v14, v58, v146 row_newbcast:4 row_mask:0xf bank_mask:0xf
    v_dot2c_f32_bf16_dpp v15, v60, v146 row_newbcast:4 row_mask:0xf bank_mask:0xf
    v_dot2c_f32_bf16_dpp v16, v58, v147 row_newbcast:4 row_mask:0xf bank_mask:0xf
    v_dot2c_f32_bf16_dpp v17, v60, v147 row_newbcast:4 row_mask:0xf bank_mask:0xf
    buffer_load_dwordx4 v[176:179], v2, s[40:43], s71 offen
    s_add_u32 s71, s71, 0x8000
    s_and_b32 s71, s71, 0xfffff
    s_waitcnt vmcnt(7)
    v_dot2c_f32_bf16_dpp v10, v58, v148 row_newbcast:5 row_mask:0xf bank_mask:0xf
    v_dot2c_f32_bf16_dpp v11, v60, v148 row_newbcast:5 row_mask:0xf bank_mask:0xf
    v_dot2c_f32_bf16_dpp v12, v58, v149 row_newbcast:5 row_mask:0xf bank_mask:0xf
    v_dot2c_f32_bf16_dpp v13, v60, v149 row_newbcast:5 row_mask:0xf bank_mask:0xf
    v_dot2c_f32_bf16_dpp v14, v58, v150 row_newbcast:5 row_mask:0xf bank_mask:0xf
    v_dot2c_f32_bf16_dpp v15, v60, v150 row_newbcast:5 row_mask:0xf bank_mask:0xf
    v_dot2c_f32_bf16_dpp v16, v58, v151 row_newbcast:5 row_mask:0xf bank_mask:0xf
    v_dot2c_f32_bf16_dpp v17, v60, v151 row_newbcast:5 row_mask:0xf bank_mask:0xf
    buffer_load_dwordx4 v[180:183], v2, s[40:43], s71 offen
    s_add_u32 s71, s71, 0x8000
    s_and_b32 s71, s71, 0xfffff
    s_waitcnt vmcnt(7)
    v_dot2c_f32_bf16_dpp v10, v58, v152 row_newbcast:6 row_mask:0xf bank_mask:0xf
    v_dot2c_f32_bf16_dpp v11, v60, v152 row_newbcast:6 row_mask:0xf bank_mask:0xf
    v_dot2c_f32_bf16_dpp v12, v58, v153 row_newbcast:6 row_mask:0xf bank_mask:0xf
    v_dot2c_f32_bf16_dpp v13, v60, v153 row_newbcast:6 row_mask:0xf bank_mask:0xf
    v_dot2c_f32_bf16_dpp v14, v58, v154 row_newbcast:6 row_mask:0xf bank_mask:0xf
    v_dot2c_f32_bf16_dpp v15, v60, v154 row_newbcast:6 row_mask:0xf bank_mask:0xf
    v_dot2c_f32_bf16_dpp v16, v58, v155 row_newbcast:6 row_mask:0xf bank_mask:0xf
    v_dot2c_f32_bf16_dpp v17, v60, v155 row_newbcast:6 row_mask:0xf bank_mask:0xf
    buffer_load_dwordx4 v[184:187], v2, s[40:43], s71 offen
    s_add_u32 s71, s71, 0x8000
    s_and_b32 s71, s71, 0xfffff
    s_waitcnt vmcnt(7)
    v_dot2c_f32_bf16_dpp v10, v58, v156 row_newbcast:7 row_mask:0xf bank_mask:0xf
    v_dot2c_f32_bf16_dpp v11, v60, v156 row_newbcast:7 row_mask:0xf bank_mask:0xf
    v_dot2c_f32_bf16_dpp v12, v58, v157 row_newbcast:7 row_mask:0xf bank_mask:0xf
    v_dot2c_f32_bf16_dpp v13, v60, v157 row_newbcast:7 row_mask:0xf bank_mask:0xf
    v_dot2c_f32_bf16_dpp v14, v58, v158 row_newbcast:7 row_mask:0xf bank_mask:0xf
    v_dot2c_f32_bf16_dpp v15, v60, v158 row_newbcast:7 row_mask:0xf bank_mask:0xf
    v_dot2c_f32_bf16_dpp v16, v58, v159 row_newbcast:7 row_mask:0xf bank_mask:0xf
    v_dot2c_f32_bf16_dpp v17, v60, v159 row_newbcast:7 row_mask:0xf bank_mask:0xf
    buffer_load_dwordx4 v[188:191], v2, s[40:43], s71 offen
    s_add_u32 s71, s71, 0x8000
    s_and_b32 s71, s71, 0xfffff
    s_waitcnt vmcnt(7)
    v_dot2c_f32_bf16_dpp v10, v58, v160 row_newbcast:8 row_mask:0xf bank_mask:0xf
    v_dot2c_f32_bf16_dpp v11, v60, v160 row_newbcast:8 row_mask:0xf bank_mask:0xf
    v_dot2c_f32_bf16_dpp v12, v58, v161 row_newbcast:8 row_mask:0xf bank_mask:0xf
    v_dot2c_f32_bf16_dpp v13, v60, v161 row_newbcast:8 row_mask:0xf bank_mask:0xf
    v_dot2c_f32_bf16_dpp v14, v58, v162 row_newbcast:8 row_mask:0xf bank_mask:0xf
    v_dot2c_f32_bf16_dpp v15, v60, v162 row_newbcast:8 row_mask:0xf bank_mask:0xf
    v_dot2c_f32_bf16_dpp v16, v58, v163 row_newbcast:8 row_mask:0xf bank_mask:0xf
    v_dot2c_f32_bf16_dpp v17, v60, v163 row_newbcast:8 row_mask:0xf bank_mask:0xf
    buffer_load_dwordx4 v[128:131], v2, s[40:43], s71 offen
    s_add_u32 s71, s71, 0x8000
    s_and_b32 s71, s71, 0xfffff
    s_waitcnt vmcnt(7)
    v_dot2c_f32_bf16_dpp v10, v58, v164 row_newbcast:9 row_mask:0xf bank_mask:0xf
    v_dot2c_f32_bf16_dpp v11, v60, v164 row_newbcast:9 row_mask:0xf bank_mask:0xf
    v_dot2c_f32_bf16_dpp v12, v58, v165 row_newbcast:9 row_mask:0xf bank_mask:0xf
    v_dot2c_f32_bf16_dpp v13, v60, v165 row_newbcast:9 row_mask:0xf bank_mask:0xf
    v_dot2c_f32_bf16_dpp v14, v58, v166 row_newbcast:9 row_mask:0xf bank_mask:0xf
    v_dot2c_f32_bf16_dpp v15, v60, v166 row_newbcast:9 row_mask:0xf bank_mask:0xf
    v_dot2c_f32_bf16_dpp v16, v58, v167 row_newbcast:9 row_mask:0xf bank_mask:0xf
    v_dot2c_f32_bf16_dpp v17, v60, v167 row_newbcast:9 row_mask:0xf bank_mask:0xf
    buffer_load_dwordx4 v[132:135], v2, s[40:43], s71 offen
    s_add_u32 s71, s71, 0x8000
    s_and_b32 s71, s71, 0xfffff
    s_waitcnt vmcnt(7)
    v_dot2c_f32_bf16_dpp v10, v58, v168 row_newbcast:10 row_mask:0xf bank_mask:0xf
    v_dot2c_f32_bf16_dpp v11, v60, v168 row_newbcast:10 row_mask:0xf bank_mask:0xf
    v_dot2c_f32_bf16_dpp v12, v58, v169 row_newbcast:10 row_mask:0xf bank_mask:0xf
    v_dot2c_f32_bf16_dpp v13, v60, v169 row_newbcast:10 row_mask:0xf bank_mask:0xf
    v_dot2c_f32_bf16_dpp v14, v58, v170 row_newbcast:10 row_mask:0xf bank_mask:0xf
    v_dot2c_f32_bf16_dpp v15, v60, v170 row_newbcast:10 row_mask:0xf bank_mask:0xf
    v_dot2c_f32_bf16_dpp v16, v58, v171 row_newbcast:10 row_mask:0xf bank_mask:0xf
    v_dot2c_f32_bf16_dpp v17, v60, v171 row_newbcast:10 row_mask:0xf bank_mask:0xf
    buffer_load_dwordx4 v[136:139], v2, s[40:43], s71 offen
    s_add_u32 s71, s71, 0x8000
    s_and_b32 s71, s71, 0xfffff
    s_waitcnt vmcnt(7)
    v_dot2c_f32_bf16_dpp v10, v58, v172 row_newbcast:11 row_mask:0xf bank_mask:0xf
    v_dot2c_f32_bf16_dpp v11, v60, v172 row_newbcast:11 row_mask:0xf bank_mask:0xf
    v_dot2c_f32_bf16_dpp v12, v58, v173 row_newbcast:11 row_mask:0xf bank_mask:0xf
    v_dot2c_f32_bf16_dpp v13, v60, v173 row_newbcast:11 row_mask:0xf bank_mask:0xf
    v_dot2c_f32_bf16_dpp v14, v58, v174 row_newbcast:11 row_mask:0xf bank_mask:0xf
    v_dot2c_f32_bf16_dpp v15, v60, v174 row_newbcast:11 row_mask:0xf bank_mask:0xf
    v_dot2c_f32_bf16_dpp v16, v58, v175 row_newbcast:11 row_mask:0xf bank_mask:0xf
    v_dot2c_f32_bf16_dpp v17, v60, v175 row_newbcast:11 row_mask:0xf bank_mask:0xf
    buffer_load_dwordx4 v[140:143], v2, s[40:43], s71 offen
    s_add_u32 s71, s71, 0x8000
    s_and_b32 s71, s71, 0xfffff
    s_waitcnt vmcnt(7)
    v_dot2c_f32_bf16_dpp v10, v58, v176 row_newbcast:12 row_mask:0xf bank_mask:0xf
    v_dot2c_f32_bf16_dpp v11, v60, v176 row_newbcast:12 row_mask:0xf bank_mask:0xf
    v_dot2c_f32_bf16_dpp v12, v58, v177 row_newbcast:12 row_mask:0xf bank_mask:0xf
    v_dot2c_f32_bf16_dpp v13, v60, v177 row_newbcast:12 row_mask:0xf bank_mask:0xf
    v_dot2c_f32_bf16_dpp v14, v58, v178 row_newbcast:12 row_mask:0xf bank_mask:0xf
    v_dot2c_f32_bf16_dpp v15, v60, v178 row_newbcast:12 row_mask:0xf bank_mask:0xf
    v_dot2c_f32_bf16_dpp v16, v58, v179 row_newbcast:12 row_mask:0xf bank_mask:0xf
    v_dot2c_f32_bf16_dpp v17, v60, v179 row_newbcast:12 row_mask:0xf bank_mask:0xf
    buffer_load_dwordx4 v[144:147], v2, s[40:43], s71 offen
    s_add_u32 s71, s71, 0x8000
    s_and_b32 s71, s71, 0xfffff
    s_waitcnt vmcnt(7)
    v_dot2c_f32_bf16_dpp v10, v58, v180 row_newbcast:13 row_mask:0xf bank_mask:0xf
    v_dot2c_f32_bf16_dpp v11, v60, v180 row_newbcast:13 row_mask:0xf bank_mask:0xf
    v_dot2c_f32_bf16_dpp v12, v58, v181 row_newbcast:13 row_mask:0xf bank_mask:0xf
    v_dot2c_f32_bf16_dpp v13, v60, v181 row_newbcast:13 row_mask:0xf bank_mask:0xf
    v_dot2c_f32_bf16_dpp v14, v58, v182 row_newbcast:13 row_mask:0xf bank_mask:0xf
    v_dot2c_f32_bf16_dpp v15, v60, v182 row_newbcast:13 row_mask:0xf bank_mask:0xf
    v_dot2c_f32_bf16_dpp v16, v58, v183 row_newbcast:13 row_mask:0xf bank_mask:0xf
    v_dot2c_f32_bf16_dpp v17, v60, v183 row_newbcast:13 row_mask:0xf bank_mask:0xf
    buffer_load_dwordx4 v[148:151], v2, s[40:43], s71 offen
    s_add_u32 s71, s71, 0x8000
    s_and_b32 s71, s71, 0xfffff
    s_waitcnt vmcnt(7)
    v_dot2c_f32_bf16_dpp v10, v58, v184 row_newbcast:14 row_mask:0xf bank_mask:0xf
    v_dot2c_f32_bf16_dpp v11, v60, v184 row_newbcast:14 row_mask:0xf bank_mask:0xf
    v_dot2c_f32_bf16_dpp v12, v58, v185 row_newbcast:14 row_mask:0xf bank_mask:0xf
    v_dot2c_f32_bf16_dpp v13, v60, v185 row_newbcast:14 row_mask:0xf bank_mask:0xf
    v_dot2c_f32_bf16_dpp v14, v58, v186 row_newbcast:14 row_mask:0xf bank_mask:0xf
    v_dot2c_f32_bf16_dpp v15, v60, v186 row_newbcast:14 row_mask:0xf bank_mask:0xf
    v_dot2c_f32_bf16_dpp v16, v58, v187 row_newbcast:14 row_mask:0xf bank_mask:0xf
    v_dot2c_f32_bf16_dpp v17, v60, v187 row_newbcast:14 row_mask:0xf bank_mask:0xf
    buffer_load_dwordx4 v[152:155], v2, s[40:43], s71 offen
    s_add_u32 s71, s71, 0x8000
    s_and_b32 s71, s71, 0xfffff
    s_waitcnt vmcnt(7)
    v_dot2c_f32_bf16_dpp v10, v58, v188 row_newbcast:15 row_mask:0xf bank_mask:0xf
    v_dot2c_f32_bf16_dpp v11, v60, v188 row_newbcast:15 row_mask:0xf bank_mask:0xf
    v_dot2c_f32_bf16_dpp v12, v58, v189 row_newbcast:15 row_mask:0xf bank_mask:0xf
    v_dot2c_f32_bf16_dpp v13, v60, v189 row_newbcast:15 row_mask:0xf bank_mask:0xf
    v_dot2c_f32_bf16_dpp v14, v58, v190 row_newbcast:15 row_mask:0xf bank_mask:0xf
    v_dot2c_f32_bf16_dpp v15, v60, v190 row_newbcast:15 row_mask:0xf bank_mask:0xf
    v_dot2c_f32_bf16_dpp v16, v58, v191 row_newbcast:15 row_mask:0xf bank_mask:0xf
    v_dot2c_f32_bf16_dpp v17, v60, v191 row_newbcast:15 row_mask:0xf bank_mask:0xf
    buffer_load_dwordx4 v[156:159], v2, s[40:43], s71 offen
    s_add_u32 s71, s71, 0x8000
    s_and_b32 s71, s71, 0xfffff
    s_waitcnt vmcnt(7)
    v_dot2c_f32_bf16_dpp v10, v59, v128 row_newbcast:0 row_mask:0xf bank_mask:0xf
    v_dot2c_f32_bf16_dpp v11, v61, v128 row_newbcast:0 row_mask:0xf bank_mask:0xf
    v_dot2c_f32_bf16_dpp v12, v59, v129 row_newbcast:0 row_mask:0xf bank_mask:0xf
    v_dot2c_f32_bf16_dpp v13, v61, v129 row_newbcast:0 row_mask:0xf bank_mask:0xf
    v_dot2c_f32_bf16_dpp v14, v59, v130 row_newbcast:0 row_mask:0xf bank_mask:0xf
    v_dot2c_f32_bf16_dpp v15, v61, v130 row_newbcast:0 row_mask:0xf bank_mask:0xf
    v_dot2c_f32_bf16_dpp v16, v59, v131 row_newbcast:0 row_mask:0xf bank_mask:0xf
    v_dot2c_f32_bf16_dpp v17, v61, v131 row_newbcast:0 row_mask:0xf bank_mask:0xf
    buffer_load_dwordx4 v[160:163], v2, s[40:43], s71 offen
    s_add_u32 s71, s71, 0x8000
    s_and_b32 s71, s71, 0xfffff
    s_waitcnt vmcnt(7)
    v_dot2c_f32_bf16_dpp v10, v59, v132 row_newbcast:1 row_mask:0xf bank_mask:0xf
    v_dot2c_f32_bf16_dpp v11, v61, v132 row_newbcast:1 row_mask:0xf bank_mask:0xf
    v_dot2c_f32_bf16_dpp v12, v59, v133 row_newbcast:1 row_mask:0xf bank_mask:0xf
    v_dot2c_f32_bf16_dpp v13, v61, v133 row_newbcast:1 row_mask:0xf bank_mask:0xf
    v_dot2c_f32_bf16_dpp v14, v59, v134 row_newbcast:1 row_mask:0xf bank_mask:0xf
    v_dot2c_f32_bf16_dpp v15, v61, v134 row_newbcast:1 row_mask:0xf bank_mask:0xf
    v_dot2c_f32_bf16_dpp v16, v59, v135 row_newbcast:1 row_mask:0xf bank_mask:0xf
    v_dot2c_f32_bf16_dpp v17, v61, v135 row_newbcast:1 row_mask:0xf bank_mask:0xf
    buffer_load_dwordx4 v[164:167], v2, s[40:43], s71 offen
    s_add_u32 s71, s71, 0x8000
    s_and_b32 s71, s71, 0xfffff
    s_waitcnt vmcnt(7)
    v_dot2c_f32_bf16_dpp v10, v59, v136 row_newbcast:2 row_mask:0xf bank_mask:0xf
    v_dot2c_f32_bf16_dpp v11, v61, v136 row_newbcast:2 row_mask:0xf bank_mask:0xf
    v_dot2c_f32_bf16_dpp v12, v59, v137 row_newbcast:2 row_mask:0xf bank_mask:0xf
    v_dot2c_f32_bf16_dpp v13, v61, v137 row_newbcast:2 row_mask:0xf bank_mask:0xf
    v_dot2c_f32_bf16_dpp v14, v59, v138 row_newbcast:2 row_mask:0xf bank_mask:0xf
    v_dot2c_f32_bf16_dpp v15, v61, v138 row_newbcast:2 row_mask:0xf bank_mask:0xf
    v_dot2c_f32_bf16_dpp v16, v59, v139 row_newbcast:2 row_mask:0xf bank_mask:0xf
    v_dot2c_f32_bf16_dpp v17, v61, v139 row_newbcast:2 row_mask:0xf bank_mask:0xf
    buffer_load_dwordx4 v[168:171], v2, s[40:43], s71 offen
    s_add_u32 s71, s71, 0x8000
    s_and_b32 s71, s71, 0xfffff
    s_waitcnt vmcnt(7)
    v_dot2c_f32_bf16_dpp v10, v59, v140 row_newbcast:3 row_mask:0xf bank_mask:0xf
    v_dot2c_f32_bf16_dpp v11, v61, v140 row_newbcast:3 row_mask:0xf bank_mask:0xf
    v_dot2c_f32_bf16_dpp v12, v59, v141 row_newbcast:3 row_mask:0xf bank_mask:0xf
    v_dot2c_f32_bf16_dpp v13, v61, v141 row_newbcast:3 row_mask:0xf bank_mask:0xf
    v_dot2c_f32_bf16_dpp v14, v59, v142 row_newbcast:3 row_mask:0xf bank_mask:0xf
    v_dot2c_f32_bf16_dpp v15, v61, v142 row_newbcast:3 row_mask:0xf bank_mask:0xf
    v_dot2c_f32_bf16_dpp v16, v59, v143 row_newbcast:3 row_mask:0xf bank_mask:0xf
    v_dot2c_f32_bf16_dpp v17, v61, v143 row_newbcast:3 row_mask:0xf bank_mask:0xf
    buffer_load_dwordx4 v[172:175], v2, s[40:43], s71 offen
    s_add_u32 s71, s71, 0x8000
    s_and_b32 s71, s71, 0xfffff
    s_waitcnt vmcnt(7)
    v_dot2c_f32_bf16_dpp v10, v59, v144 row_newbcast:4 row_mask:0xf bank_mask:0xf
    v_dot2c_f32_bf16_dpp v11, v61, v144 row_newbcast:4 row_mask:0xf bank_mask:0xf
    v_dot2c_f32_bf16_dpp v12, v59, v145 row_newbcast:4 row_mask:0xf bank_mask:0xf
    v_dot2c_f32_bf16_dpp v13, v61, v145 row_newbcast:4 row_mask:0xf bank_mask:0xf
    v_dot2c_f32_bf16_dpp v14, v59, v146 row_newbcast:4 row_mask:0xf bank_mask:0xf
    v_dot2c_f32_bf16_dpp v15, v61, v146 row_newbcast:4 row_mask:0xf bank_mask:0xf
    v_dot2c_f32_bf16_dpp v16, v59, v147 row_newbcast:4 row_mask:0xf bank_mask:0xf
    v_dot2c_f32_bf16_dpp v17, v61, v147 row_newbcast:4 row_mask:0xf bank_mask:0xf
    buffer_load_dwordx4 v[176:179], v2, s[40:43], s71 offen
    s_add_u32 s71, s71, 0x8000
    s_and_b32 s71, s71, 0xfffff
    s_waitcnt vmcnt(7)
    v_dot2c_f32_bf16_dpp v10, v59, v148 row_newbcast:5 row_mask:0xf bank_mask:0xf
    v_dot2c_f32_bf16_dpp v11, v61, v148 row_newbcast:5 row_mask:0xf bank_mask:0xf
    v_dot2c_f32_bf16_dpp v12, v59, v149 row_newbcast:5 row_mask:0xf bank_mask:0xf
    v_dot2c_f32_bf16_dpp v13, v61, v149 row_newbcast:5 row_mask:0xf bank_mask:0xf
    v_dot2c_f32_bf16_dpp v14, v59, v150 row_newbcast:5 row_mask:0xf bank_mask:0xf
    v_dot2c_f32_bf16_dpp v15, v61, v150 row_newbcast:5 row_mask:0xf bank_mask:0xf
    v_dot2c_f32_bf16_dpp v16, v59, v151 row_newbcast:5 row_mask:0xf bank_mask:0xf
    v_dot2c_f32_bf16_dpp v17, v61, v151 row_newbcast:5 row_mask:0xf bank_mask:0xf
    buffer_load_dwordx4 v[180:183], v2, s[40:43], s71 offen
    s_add_u32 s71, s71, 0x8000
    s_and_b32 s71, s71, 0xfffff
    s_waitcnt vmcnt(7)
    v_dot2c_f32_bf16_dpp v10, v59, v152 row_newbcast:6 row_mask:0xf bank_mask:0xf
    v_dot2c_f32_bf16_dpp v11, v61, v152 row_newbcast:6 row_mask:0xf bank_mask:0xf
    v_dot2c_f32_bf16_dpp v12, v59, v153 row_newbcast:6 row_mask:0xf bank_mask:0xf
    v_dot2c_f32_bf16_dpp v13, v61, v153 row_newbcast:6 row_mask:0xf bank_mask:0xf
    v_dot2c_f32_bf16_dpp v14, v59, v154 row_newbcast:6 row_mask:0xf bank_mask:0xf
    v_dot2c_f32_bf16_dpp v15, v61, v154 row_newbcast:6 row_mask:0xf bank_mask:0xf
    v_dot2c_f32_bf16_dpp v16, v59, v155 row_newbcast:6 row_mask:0xf bank_mask:0xf
    v_dot2c_f32_bf16_dpp v17, v61, v155 row_newbcast:6 row_mask:0xf bank_mask:0xf
    buffer_load_dwordx4 v[184:187], v2, s[40:43], s71 offen
    s_add_u32 s71, s71, 0x8000
    s_and_b32 s71, s71, 0xfffff
    s_waitcnt vmcnt(7)
    v_dot2c_f32_bf16_dpp v10, v59, v156 row_newbcast:7 row_mask:0xf bank_mask:0xf
    v_dot2c_f32_bf16_dpp v11, v61, v156 row_newbcast:7 row_mask:0xf bank_mask:0xf
    v_dot2c_f32_bf16_dpp v12, v59, v157 row_newbcast:7 row_mask:0xf bank_mask:0xf
    v_dot2c_f32_bf16_dpp v13, v61, v157 row_newbcast:7 row_mask:0xf bank_mask:0xf
    v_dot2c_f32_bf16_dpp v14, v59, v158 row_newbcast:7 row_mask:0xf bank_mask:0xf
    v_dot2c_f32_bf16_dpp v15, v61, v158 row_newbcast:7 row_mask:0xf bank_mask:0xf
    v_dot2c_f32_bf16_dpp v16, v59, v159 row_newbcast:7 row_mask:0xf bank_mask:0xf
    v_dot2c_f32_bf16_dpp v17, v61, v159 row_newbcast:7 row_mask:0xf bank_mask:0xf
    buffer_load_dwordx4 v[188:191], v2, s[40:43], s71 offen
    s_add_u32 s71, s71, 0x8000
    s_and_b32 s71, s71, 0xfffff
    s_waitcnt vmcnt(7)
    v_dot2c_f32_bf16_dpp v10, v59, v160 row_newbcast:8 row_mask:0xf bank_mask:0xf
    v_dot2c_f32_bf16_dpp v11, v61, v160 row_newbcast:8 row_mask:0xf bank_mask:0xf
    v_dot2c_f32_bf16_dpp v12, v59, v161 row_newbcast:8 row_mask:0xf bank_mask:0xf
    v_dot2c_f32_bf16_dpp v13, v61, v161 row_newbcast:8 row_mask:0xf bank_mask:0xf
    v_dot2c_f32_bf16_dpp v14, v59, v162 row_newbcast:8 row_mask:0xf bank_mask:0xf
    v_dot2c_f32_bf16_dpp v15, v61, v162 row_newbcast:8 row_mask:0xf bank_mask:0xf
    v_dot2c_f32_bf16_dpp v16, v59, v163 row_newbcast:8 row_mask:0xf bank_mask:0xf
    v_dot2c_f32_bf16_dpp v17, v61, v163 row_newbcast:8 row_mask:0xf bank_mask:0xf
    buffer_load_dwordx4 v[64:67], v1, s[32:35], s70 offen nt
    s_add_u32 s70, s70, 0x1000
    s_waitcnt vmcnt(7)
    v_dot2c_f32_bf16_dpp v10, v59, v164 row_newbcast:9 row_mask:0xf bank_mask:0xf
    v_dot2c_f32_bf16_dpp v11, v61, v164 row_newbcast:9 row_mask:0xf bank_mask:0xf
    v_dot2c_f32_bf16_dpp v12, v59, v165 row_newbcast:9 row_mask:0xf bank_mask:0xf
    v_dot2c_f32_bf16_dpp v13, v61, v165 row_newbcast:9 row_mask:0xf bank_mask:0xf
    v_dot2c_f32_bf16_dpp v14, v59, v166 row_newbcast:9 row_mask:0xf bank_mask:0xf
    v_dot2c_f32_bf16_dpp v15, v61, v166 row_newbcast:9 row_mask:0xf bank_mask:0xf
    v_dot2c_f32_bf16_dpp v16, v59, v167 row_newbcast:9 row_mask:0xf bank_mask:0xf
    v_dot2c_f32_bf16_dpp v17, v61, v167 row_newbcast:9 row_mask:0xf bank_mask:0xf
    buffer_load_dwordx4 v[68:71], v1, s[32:35], s70 offen nt
    s_add_u32 s70, s70, 0x1000
    s_waitcnt vmcnt(7)
    v_dot2c_f32_bf16_dpp v10, v59, v168 row_newbcast:10 row_mask:0xf bank_mask:0xf
    v_dot2c_f32_bf16_dpp v11, v61, v168 row_newbcast:10 row_mask:0xf bank_mask:0xf
    v_dot2c_f32_bf16_dpp v12, v59, v169 row_newbcast:10 row_mask:0xf bank_mask:0xf
    v_dot2c_f32_bf16_dpp v13, v61, v169 row_newbcast:10 row_mask:0xf bank_mask:0xf
    v_dot2c_f32_bf16_dpp v14, v59, v170 row_newbcast:10 row_mask:0xf bank_mask:0xf
    v_dot2c_f32_bf16_dpp v15, v61, v170 row_newbcast:10 row_mask:0xf bank_mask:0xf
    v_dot2c_f32_bf16_dpp v16, v59, v171 row_newbcast:10 row_mask:0xf bank_mask:0xf
    v_dot2c_f32_bf16_dpp v17, v61, v171 row_newbcast:10 row_mask:0xf bank_mask:0xf
    buffer_load_dwordx4 v[72:75], v1, s[32:35], s70 offen nt
    s_add_u32 s70, s70, 0x1000
    s_waitcnt vmcnt(7)
    v_dot2c_f32_bf16_dpp v10, v59, v172 row_newbcast:11 row_mask:0xf bank_mask:0xf
    v_dot2c_f32_bf16_dpp v11, v61, v172 row_newbcast:11 row_mask:0xf bank_mask:0xf
    v_dot2c_f32_bf16_dpp v12, v59, v173 row_newbcast:11 row_mask:0xf bank_mask:0xf
    v_dot2c_f32_bf16_dpp v13, v61, v173 row_newbcast:11 row_mask:0xf bank_mask:0xf
    v_dot2c_f32_bf16_dpp v14, v59, v174 row_newbcast:11 row_mask:0xf bank_mask:0xf
    v_dot2c_f32_bf16_dpp v15, v61, v174 row_newbcast:11 row_mask:0xf bank_mask:0xf
    v_dot2c_f32_bf16_dpp v16, v59, v175 row_newbcast:11 row_mask:0xf bank_mask:0xf
    v_dot2c_f32_bf16_dpp v17, v61, v175 row_newbcast:11 row_mask:0xf bank_mask:0xf
    buffer_load_dwordx4 v[76:79], v1, s[32:35], s70 offen nt
    s_add_u32 s70, s70, 0x1000
    s_waitcnt vmcnt(7)
    v_dot2c_f32_bf16_dpp v10, v59, v176 row_newbcast:12 row_mask:0xf bank_mask:0xf
    v_dot2c_f32_bf16_dpp v11, v61, v176 row_newbcast:12 row_mask:0xf bank_mask:0xf
    v_dot2c_f32_bf16_dpp v12, v59, v177 row_newbcast:12 row_mask:0xf bank_mask:0xf
    v_dot2c_f32_bf16_dpp v13, v61, v177 row_newbcast:12 row_mask:0xf bank_mask:0xf
    v_dot2c_f32_bf16_dpp v14, v59, v178 row_newbcast:12 row_mask:0xf bank_mask:0xf
    v_dot2c_f32_bf16_dpp v15, v61, v178 row_newbcast:12 row_mask:0xf bank_mask:0xf
    v_dot2c_f32_bf16_dpp v16, v59, v179 row_newbcast:12 row_mask:0xf bank_mask:0xf
    v_dot2c_f32_bf16_dpp v17, v61, v179 row_newbcast:12 row_mask:0xf bank_mask:0xf
    buffer_load_dwordx4 v[80:83], v1, s[32:35], s70 offen nt
    s_add_u32 s70, s70, 0x1000
    s_waitcnt vmcnt(7)
    v_dot2c_f32_bf16_dpp v10, v59, v180 row_newbcast:13 row_mask:0xf bank_mask:0xf
    v_dot2c_f32_bf16_dpp v11, v61, v180 row_newbcast:13 row_mask:0xf bank_mask:0xf
    v_dot2c_f32_bf16_dpp v12, v59, v181 row_newbcast:13 row_mask:0xf bank_mask:0xf
    v_dot2c_f32_bf16_dpp v13, v61, v181 row_newbcast:13 row_mask:0xf bank_mask:0xf
    v_dot2c_f32_bf16_dpp v14, v59, v182 row_newbcast:13 row_mask:0xf bank_mask:0xf
    v_dot2c_f32_bf16_dpp v15, v61, v182 row_newbcast:13 row_mask:0xf bank_mask:0xf
    v_dot2c_f32_bf16_dpp v16, v59, v183 row_newbcast:13 row_mask:0xf bank_mask:0xf
    v_dot2c_f32_bf16_dpp v17, v61, v183 row_newbcast:13 row_mask:0xf bank_mask:0xf
    buffer_load_dwordx4 v[84:87], v1, s[32:35], s70 offen nt
    s_add_u32 s70, s70, 0x1000
    s_waitcnt vmcnt(7)
    v_dot2c_f32_bf16_dpp v10, v59, v184 row_newbcast:14 row_mask:0xf bank_mask:0xf
    v_dot2c_f32_bf16_dpp v11, v61, v184 row_newbcast:14 row_mask:0xf bank_mask:0xf
    v_dot2c_f32_bf16_dpp v12, v59, v185 row_newbcast:14 row_mask:0xf bank_mask:0xf
    v_dot2c_f32_bf16_dpp v13, v61, v185 row_newbcast:14 row_mask:0xf bank_mask:0xf
    v_dot2c_f32_bf16_dpp v14, v59, v186 row_newbcast:14 row_mask:0xf bank_mask:0xf
    v_dot2c_f32_bf16_dpp v15, v61, v186 row_newbcast:14 row_mask:0xf bank_mask:0xf
    v_dot2c_f32_bf16_dpp v16, v59, v187 row_newbcast:14 row_mask:0xf bank_mask:0xf
    v_dot2c_f32_bf16_dpp v17, v61, v187 row_newbcast:14 row_mask:0xf bank_mask:0xf
    buffer_load_dwordx4 v[88:91], v1, s[32:35], s70 offen nt
    s_add_u32 s70, s70, 0x1000
    s_waitcnt vmcnt(7)
    v_dot2c_f32_bf16_dpp v10, v59, v188 row_newbcast:15 row_mask:0xf bank_mask:0xf
    v_dot2c_f32_bf16_dpp v11, v61, v188 row_newbcast:15 row_mask:0xf bank_mask:0xf
    v_dot2c_f32_bf16_dpp v12, v59, v189 row_newbcast:15 row_mask:0xf bank_mask:0xf
    v_dot2c_f32_bf16_dpp v13, v61, v189 row_newbcast:15 row_mask:0xf bank_mask:0xf
    v_dot2c_f32_bf16_dpp v14, v59, v190 row_newbcast:15 row_mask:0xf bank_mask:0xf
    v_dot2c_f32_bf16_dpp v15, v61, v190 row_newbcast:15 row_mask:0xf bank_mask:0xf
    v_dot2c_f32_bf16_dpp v16, v59, v191 row_newbcast:15 row_mask:0xf bank_mask:0xf
    v_dot2c_f32_bf16_dpp v17, v61, v191 row_newbcast:15 row_mask:0xf bank_mask:0xf
    buffer_load_dwordx4 v[92:95], v1, s[32:35], s70 offen nt
    s_add_u32 s70, s70, 0x9000
    v_permlane32_swap_b32 v10, v14
    v_permlane32_swap_b32 v11, v15
    v_permlane32_swap_b32 v12, v16
    v_permlane32_swap_b32 v13, v17
    v_add_f32 v10, v10, v14
    v_add_f32 v11, v11, v15
    v_add_f32 v12, v12, v16
    v_add_f32 v13, v13, v17
    s_nop 0
    v_permlane16_swap_b32 v10, v12
    v_permlane16_swap_b32 v11, v13
    v_add_f32 v10, v10, v12
    v_add_f32 v11, v11, v13
    ds_write_b64 v47, v[10:11] offset:0
    v_lshlrev_b32 v4, 5, v43
    s_waitcnt lgkmcnt(0)
    s_barrier
    ds_read_b128 v[128:131], v4 offset:0
    ds_read_b128 v[132:135], v4 offset:16
    ds_read_b128 v[136:139], v4 offset:512
    ds_read_b128 v[140:143], v4 offset:528
    ds_read_b128 v[144:147], v4 offset:1024
    ds_read_b128 v[148:151], v4 offset:1040
    ds_read_b128 v[152:155], v4 offset:1536
    ds_read_b128 v[156:159], v4 offset:1552
    v_mov_b32 v10, 0
    v_mov_b32 v11, 0
    v_mov_b32 v12, 0
    v_mov_b32 v13, 0
    v_mov_b32 v14, 0
    v_mov_b32 v15, 0
    v_mov_b32 v16, 0
    v_mov_b32 v17, 0
    s_waitcnt lgkmcnt(0)
    v_add_f32 v128, v128, v136
    v_add_f32 v144, v144, v152
    v_add_f32 v129, v129, v137
    v_add_f32 v145, v145, v153
    v_add_f32 v130, v130, v138
    v_add_f32 v146, v146, v154
    v_add_f32 v131, v131, v139
    v_add_f32 v147, v147, v155
    v_add_f32 v132, v132, v140
    v_add_f32 v148, v148, v156
    v_add_f32 v133, v133, v141
    v_add_f32 v149, v149, v157
    v_add_f32 v134, v134, v142
    v_add_f32 v150, v150, v158
    v_add_f32 v135, v135, v143
    v_add_f32 v151, v151, v159
    v_add_f32 v128, v128, v144
    v_add_f32 v129, v129, v145
    v_add_f32 v130, v130, v146
    v_add_f32 v131, v131, v147
    v_add_f32 v132, v132, v148
    v_add_f32 v133, v133, v149
    v_add_f32 v134, v134, v150
    v_add_f32 v135, v135, v151
    v_cvt_pk_bf16_f32 v6, v128, v129
    v_cvt_pk_bf16_f32 v7, v130, v131
    v_cvt_pk_bf16_f32 v8, v132, v133
    v_cvt_pk_bf16_f32 v9, v134, v135
    buffer_load_dwordx4 v[96:99], v1, s[32:35], s70 offen nt
    s_add_u32 s70, s70, 0x1000
    buffer_load_dwordx4 v[100:103], v1, s[32:35], s70 offen nt
    s_add_u32 s70, s70, 0x1000
    buffer_load_dwordx4 v[104:107], v1, s[32:35], s70 offen nt
    s_add_u32 s70, s70, 0x1000
    buffer_load_dwordx4 v[108:111], v1, s[32:35], s70 offen nt
    s_add_u32 s70, s70, 0x1000
    buffer_load_dwordx4 v[112:115], v1, s[32:35], s70 offen nt
    s_add_u32 s70, s70, 0x1000
    buffer_load_dwordx4 v[116:119], v1, s[32:35], s70 offen nt
    s_add_u32 s70, s70, 0x1000
    buffer_load_dwordx4 v[120:123], v1, s[32:35], s70 offen nt
    s_add_u32 s70, s70, 0x1000
    buffer_load_dwordx4 v[124:127], v1, s[32:35], s70 offen nt
    s_add_u32 s70, s70, 0x9000
    s_add_u32 s89, s75, 0x20000
    buffer_load_dwordx4 v[192:195], v1, s[32:35], s89 offen nt
    s_add_u32 s89, s89, 0x1000
    s_waitcnt vmcnt(16)
    v_dot2_f32_bf16 v42, v64, v6, 0
    v_dot2_f32_bf16 v42, v65, v7, v42
    v_dot2_f32_bf16 v42, v66, v8, v42
    v_dot2_f32_bf16 v42, v67, v9, v42
    buffer_load_dwordx4 v[196:199], v1, s[32:35], s89 offen nt
    s_add_u32 s89, s89, 0x1000
    s_waitcnt vmcnt(16)
    v_dot2_f32_bf16 v43, v68, v6, 0
    v_dot2_f32_bf16 v43, v69, v7, v43
    v_dot2_f32_bf16 v43, v70, v8, v43
    v_dot2_f32_bf16 v43, v71, v9, v43
    buffer_load_dwordx4 v[200:203], v1, s[32:35], s89 offen nt
    s_add_u32 s89, s89, 0x1000
    s_waitcnt vmcnt(16)
    v_dot2_f32_bf16 v44, v72, v6, 0
    v_dot2_f32_bf16 v44, v73, v7, v44
    v_dot2_f32_bf16 v44, v74, v8, v44
    v_dot2_f32_bf16 v44, v75, v9, v44
    buffer_load_dwordx4 v[204:207], v1, s[32:35], s89 offen nt
    s_add_u32 s89, s89, 0x1000
    s_waitcnt vmcnt(16)
    v_dot2_f32_bf16 v45, v76, v6, 0
    v_dot2_f32_bf16 v45, v77, v7, v45
    v_dot2_f32_bf16 v45, v78, v8, v45
    v_dot2_f32_bf16 v45, v79, v9, v45
    buffer_load_dwordx4 v[208:211], v1, s[32:35], s89 offen nt
    s_add_u32 s89, s89, 0x1000
    s_waitcnt vmcnt(16)
    v_dot2_f32_bf16 v46, v80, v6, 0
    v_dot2_f32_bf16 v46, v81, v7, v46
    v_dot2_f32_bf16 v46, v82, v8, v46
    v_dot2_f32_bf16 v46, v83, v9, v46
    buffer_load_dwordx4 v[212:215], v1, s[32:35], s89 offen nt
    s_add_u32 s89, s89, 0x1000
    s_waitcnt vmcnt(16)
    v_dot2_f32_bf16 v47, v84, v6, 0
    v_dot2_f32_bf16 v47, v85, v7, v47
    v_dot2_f32_bf16 v47, v86, v8, v47
    v_dot2_f32_bf16 v47, v87, v9, v47
    buffer_load_dwordx4 v[216:219], v1, s[32:35], s89 offen nt
    s_add_u32 s89, s89, 0x1000
    s_waitcnt vmcnt(16)
    v_dot2_f32_bf16 v48, v88, v6, 0
    v_dot2_f32_bf16 v48, v89, v7, v48
    v_dot2_f32_bf16 v48, v90, v8, v48
    v_dot2_f32_bf16 v48, v91, v9, v48
    buffer_load_dwordx4 v[220:223], v1, s[32:35], s89 offen nt
    s_add_u32 s89, s89, 0x9000
    s_waitcnt vmcnt(16)
    v_dot2_f32_bf16 v49, v92, v6, 0
    v_dot2_f32_bf16 v49, v93, v7, v49
    v_dot2_f32_bf16 v49, v94, v8, v49
    v_dot2_f32_bf16 v49, v95, v9, v49
    buffer_load_dwordx4 v[224:227], v1, s[32:35], s89 offen nt
    s_add_u32 s89, s89, 0x1000
    s_waitcnt vmcnt(16)
    v_dot2_f32_bf16 v50, v96, v6, 0
    v_dot2_f32_bf16 v50, v97, v7, v50
    v_dot2_f32_bf16 v50, v98, v8, v50
    v_dot2_f32_bf16 v50, v99, v9, v50
    buffer_load_dwordx4 v[228:231], v1, s[32:35], s89 offen nt
    s_add_u32 s89, s89, 0x1000
    s_waitcnt vmcnt(16)
    v_dot2_f32_bf16 v51, v100, v6, 0
    v_dot2_f32_bf16 v51, v101, v7, v51
    v_dot2_f32_bf16 v51, v102, v8, v51
    v_dot2_f32_bf16 v51, v103, v9, v51
    s_add_u32 s70, s75, 0x40000
    buffer_load_dwordx4 v[64:67], v1, s[32:35], s70 offen nt
    s_add_u32 s70, s70, 0x1000
    buffer_load_dwordx4 v[232:235], v1, s[32:35], s89 offen nt
    s_add_u32 s89, s89, 0x1000
    s_waitcnt vmcnt(17)
    v_dot2_f32_bf16 v52, v104, v6, 0
    v_dot2_f32_bf16 v52, v105, v7, v52
    v_dot2_f32_bf16 v52, v106, v8, v52
    v_dot2_f32_bf16 v52, v107, v9, v52
    buffer_load_dwordx4 v[68:71], v1, s[32:35], s70 offen nt
    s_add_u32 s70, s70, 0x1000
    buffer_load_dwordx4 v[236:239], v1, s[32:35], s89 offen nt
    s_add_u32 s89, s89, 0x1000
    s_waitcnt vmcnt(18)
    v_dot2_f32_bf16 v53, v108, v6, 0
    v_dot2_f32_bf16 v53, v109, v7, v53
    v_dot2_f32_bf16 v53, v110, v8, v53
    v_dot2_f32_bf16 v53, v111, v9, v53
    buffer_load_dwordx4 v[72:75], v1, s[32:35], s70 offen nt
    s_add_u32 s70, s70, 0x1000
    buffer_load_dwordx4 v[240:243], v1, s[32:35], s89 offen nt
    s_add_u32 s89, s89, 0x1000
    s_waitcnt vmcnt(19)
    v_dot2_f32_bf16 v54, v112, v6, 0
    v_dot2_f32_bf16 v54, v113, v7, v54
    v_dot2_f32_bf16 v54, v114, v8, v54
    v_dot2_f32_bf16 v54, v115, v9, v54
    buffer_load_dwordx4 v[76:79], v1, s[32:35], s70 offen nt
    s_add_u32 s70, s70, 0x1000
    buffer_load_dwordx4 v[244:247], v1, s[32:35], s89 offen nt
    s_add_u32 s89, s89, 0x1000
    s_waitcnt vmcnt(20)
    v_dot2_f32_bf16 v55, v116, v6, 0
    v_dot2_f32_bf16 v55, v117, v7, v55
    v_dot2_f32_bf16 v55, v118, v8, v55
    v_dot2_f32_bf16 v55, v119, v9, v55
    buffer_load_dwordx4 v[80:83], v1, s[32:35], s70 offen nt
    s_add_u32 s70, s70, 0x1000
    buffer_load_dwordx4 v[248:251], v1, s[32:35], s89 offen nt
    s_add_u32 s89, s89, 0x1000
    s_waitcnt vmcnt(21)
    v_dot2_f32_bf16 v56, v120, v6, 0
    v_dot2_f32_bf16 v56, v121, v7, v56
    v_dot2_f32_bf16 v56, v122, v8, v56
    v_dot2_f32_bf16 v56, v123, v9, v56
    buffer_load_dwordx4 v[84:87], v1, s[32:35], s70 offen nt
    s_add_u32 s70, s70, 0x1000
    buffer_load_dwordx4 v[252:255], v1, s[32:35], s89 offen nt
    s_add_u32 s89, s89, 0x9000
    s_waitcnt vmcnt(22)
    v_dot2_f32_bf16 v57, v124, v6, 0
    v_dot2_f32_bf16 v57, v125, v7, v57
    v_dot2_f32_bf16 v57, v126, v8, v57
    v_dot2_f32_bf16 v57, v127, v9, v57
    buffer_load_dwordx4 v[88:91], v1, s[32:35], s70 offen nt
    s_add_u32 s70, s70, 0x1000
    v_add_f32_dpp v42, v42, v42 row_ror:8 row_mask:0xf bank_mask:0x3
    s_nop 1
    v_add_f32_dpp v42, v50, v50 row_ror:8 row_mask:0xf bank_mask:0xc
    v_add_f32_dpp v43, v43, v43 row_ror:8 row_mask:0xf bank_mask:0x3
    s_nop 1
    v_add_f32_dpp v43, v51, v51 row_ror:8 row_mask:0xf bank_mask:0xc
    v_add_f32_dpp v44, v44, v44 row_ror:8 row_mask:0xf bank_mask:0x3
    s_nop 1
    v_add_f32_dpp v44, v52, v52 row_ror:8 row_mask:0xf bank_mask:0xc
    v_add_f32_dpp v45, v45, v45 row_ror:8 row_mask:0xf bank_mask:0x3
    s_nop 1
    v_add_f32_dpp v45, v53, v53 row_ror:8 row_mask:0xf bank_mask:0xc
    v_add_f32_dpp v46, v46, v46 row_ror:8 row_mask:0xf bank_mask:0x3
    s_nop 1
    v_add_f32_dpp v46, v54, v54 row_ror:8 row_mask:0xf bank_mask:0xc
    v_add_f32_dpp v47, v47, v47 row_ror:8 row_mask:0xf bank_mask:0x3
    s_nop 1
    v_add_f32_dpp v47, v55, v55 row_ror:8 row_mask:0xf bank_mask:0xc
    v_add_f32_dpp v48, v48, v48 row_ror:8 row_mask:0xf bank_mask:0x3
    s_nop 1
    v_add_f32_dpp v48, v56, v56 row_ror:8 row_mask:0xf bank_mask:0xc
    v_add_f32_dpp v49, v49, v49 row_ror:8 row_mask:0xf bank_mask:0x3
    s_nop 1
    v_add_f32_dpp v49, v57, v57 row_ror:8 row_mask:0xf bank_mask:0xc
    v_add_f32_dpp v42, v42, v42 row_shl:4 row_mask:0xf bank_mask:0x5
    s_nop 1
    v_add_f32_dpp v42, v46, v46 row_shr:4 row_mask:0xf bank_mask:0xa
    v_add_f32_dpp v43, v43, v43 row_shl:4 row_mask:0xf bank_mask:0x5
    s_nop 1
    v_add_f32_dpp v43, v47, v47 row_shr:4 row_mask:0xf bank_mask:0xa
    v_add_f32_dpp v44, v44, v44 row_shl:4 row_mask:0xf bank_mask:0x5
    s_nop 1
    v_add_f32_dpp v44, v48, v48 row_shr:4 row_mask:0xf bank_mask:0xa
    v_add_f32_dpp v45, v45, v45 row_shl:4 row_mask:0xf bank_mask:0x5
    s_nop 1
    v_add_f32_dpp v45, v49, v49 row_shr:4 row_mask:0xf bank_mask:0xa
    v_add_f32_dpp v42, v42, v42 quad_perm:[2,3,0,1] row_mask:0xf bank_mask:0xf
    v_add_f32_dpp v43, v43, v43 quad_perm:[2,3,0,1] row_mask:0xf bank_mask:0xf
    v_add_f32_dpp v44, v44, v44 quad_perm:[2,3,0,1] row_mask:0xf bank_mask:0xf
    v_add_f32_dpp v45, v45, v45 quad_perm:[2,3,0,1] row_mask:0xf bank_mask:0xf
    v_cndmask_b32 v42, v42, v44, s[76:77]
    v_cndmask_b32 v43, v43, v45, s[76:77]
    s_nop 0
    v_add_f32_dpp v42, v42, v42 quad_perm:[1,0,3,2] row_mask:0xf bank_mask:0xf
    v_add_f32_dpp v43, v43, v43 quad_perm:[1,0,3,2] row_mask:0xf bank_mask:0xf
    v_cndmask_b32 v42, v42, v43, s[78:79]
    v_cvt_pk_bf16_f32 v42, 0, v42
    v_mul_f32 v42, 0x3db504f3, v42
    v_cvt_pk_bf16_f32 v26, 0, v42
    s_waitcnt vmcnt(22)
    v_dot2_f32_bf16 v42, v192, v6, 0
    v_dot2_f32_bf16 v42, v193, v7, v42
    v_dot2_f32_bf16 v42, v194, v8, v42
    v_dot2_f32_bf16 v42, v195, v9, v42
    buffer_load_dwordx4 v[92:95], v1, s[32:35], s70 offen nt
    s_add_u32 s70, s70, 0x9000
    s_waitcnt vmcnt(22)
    v_dot2_f32_bf16 v43, v196, v6, 0
    v_dot2_f32_bf16 v43, v197, v7, v43
    v_dot2_f32_bf16 v43, v198, v8, v43
    v_dot2_f32_bf16 v43, v199, v9, v43
    s_waitcnt vmcnt(21)
    v_dot2_f32_bf16 v44, v200, v6, 0
    v_dot2_f32_bf16 v44, v201, v7, v44
    v_dot2_f32_bf16 v44, v202, v8, v44
    v_dot2_f32_bf16 v44, v203, v9, v44
    s_waitcnt vmcnt(20)
    v_dot2_f32_bf16 v45, v204, v6, 0
    v_dot2_f32_bf16 v45, v205, v7, v45
    v_dot2_f32_bf16 v45, v206, v8, v45
    v_dot2_f32_bf16 v45, v207, v9, v45
    s_waitcnt vmcnt(19)
    v_dot2_f32_bf16 v46, v208, v6, 0
    v_dot2_f32_bf16 v46, v209, v7, v46
    v_dot2_f32_bf16 v46, v210, v8, v46
    v_dot2_f32_bf16 v46, v211, v9, v46
    s_waitcnt vmcnt(18)
    v_dot2_f32_bf16 v47, v212, v6, 0
    v_dot2_f32_bf16 v47, v213, v7, v47
    v_dot2_f32_bf16 v47, v214, v8, v47
    v_dot2_f32_bf16 v47, v215, v9, v47
    s_waitcnt vmcnt(17)
    v_dot2_f32_bf16 v48, v216, v6, 0
    v_dot2_f32_bf16 v48, v217, v7, v48
    v_dot2_f32_bf16 v48, v218, v8, v48
    v_dot2_f32_bf16 v48, v219, v9, v48
    s_waitcnt vmcnt(16)
    v_dot2_f32_bf16 v49, v220, v6, 0
    v_dot2_f32_bf16 v49, v221, v7, v49
    v_dot2_f32_bf16 v49, v222, v8, v49
    v_dot2_f32_bf16 v49, v223, v9, v49
    s_waitcnt vmcnt(15)
    v_dot2_f32_bf16 v50, v224, v6, 0
    v_dot2_f32_bf16 v50, v225, v7, v50
    v_dot2_f32_bf16 v50, v226, v8, v50
    v_dot2_f32_bf16 v50, v227, v9, v50
    s_waitcnt vmcnt(14)
    v_dot2_f32_bf16 v51, v228, v6, 0
    v_dot2_f32_bf16 v51, v229, v7, v51
    v_dot2_f32_bf16 v51, v230, v8, v51
    v_dot2_f32_bf16 v51, v231, v9, v51
    s_waitcnt vmcnt(12)
    v_dot2_f32_bf16 v52, v232, v6, 0
    v_dot2_f32_bf16 v52, v233, v7, v52
    v_dot2_f32_bf16 v52, v234, v8, v52
    v_dot2_f32_bf16 v52, v235, v9, v52
    s_waitcnt vmcnt(10)
    v_dot2_f32_bf16 v53, v236, v6, 0
    v_dot2_f32_bf16 v53, v237, v7, v53
    v_dot2_f32_bf16 v53, v238, v8, v53
    v_dot2_f32_bf16 v53, v239, v9, v53
    s_waitcnt vmcnt(8)
    v_dot2_f32_bf16 v54, v240, v6, 0
    v_dot2_f32_bf16 v54, v241, v7, v54
    v_dot2_f32_bf16 v54, v242, v8, v54
    v_dot2_f32_bf16 v54, v243, v9, v54
    s_waitcnt vmcnt(6)
    v_dot2_f32_bf16 v55, v244, v6, 0
    v_dot2_f32_bf16 v55, v245, v7, v55
    v_dot2_f32_bf16 v55, v246, v8, v55
    v_dot2_f32_bf16 v55, v247, v9, v55
    s_waitcnt vmcnt(4)
    v_dot2_f32_bf16 v56, v248, v6, 0
    v_dot2_f32_bf16 v56, v249, v7, v56
    v_dot2_f32_bf16 v56, v250, v8, v56
    v_dot2_f32_bf16 v56, v251, v9, v56
    s_waitcnt vmcnt(2)
    v_dot2_f32_bf16 v57, v252, v6, 0
    v_dot2_f32_bf16 v57, v253, v7, v57
    v_dot2_f32_bf16 v57, v254, v8, v57
    v_dot2_f32_bf16 v57, v255, v9, v57
    v_add_f32_dpp v42, v42, v42 row_ror:8 row_mask:0xf bank_mask:0x3
    s_nop 1
    v_add_f32_dpp v42, v50, v50 row_ror:8 row_mask:0xf bank_mask:0xc
    v_add_f32_dpp v43, v43, v43 row_ror:8 row_mask:0xf bank_mask:0x3
    s_nop 1
    v_add_f32_dpp v43, v51, v51 row_ror:8 row_mask:0xf bank_mask:0xc
    v_add_f32_dpp v44, v44, v44 row_ror:8 row_mask:0xf bank_mask:0x3
    s_nop 1
    v_add_f32_dpp v44, v52, v52 row_ror:8 row_mask:0xf bank_mask:0xc
    v_add_f32_dpp v45, v45, v45 row_ror:8 row_mask:0xf bank_mask:0x3
    s_nop 1
    v_add_f32_dpp v45, v53, v53 row_ror:8 row_mask:0xf bank_mask:0xc
    v_add_f32_dpp v46, v46, v46 row_ror:8 row_mask:0xf bank_mask:0x3
    s_nop 1
    v_add_f32_dpp v46, v54, v54 row_ror:8 row_mask:0xf bank_mask:0xc
    v_add_f32_dpp v47, v47, v47 row_ror:8 row_mask:0xf bank_mask:0x3
    s_nop 1
    v_add_f32_dpp v47, v55, v55 row_ror:8 row_mask:0xf bank_mask:0xc
    v_add_f32_dpp v48, v48, v48 row_ror:8 row_mask:0xf bank_mask:0x3
    s_nop 1
    v_add_f32_dpp v48, v56, v56 row_ror:8 row_mask:0xf bank_mask:0xc
    v_add_f32_dpp v49, v49, v49 row_ror:8 row_mask:0xf bank_mask:0x3
    s_nop 1
    v_add_f32_dpp v49, v57, v57 row_ror:8 row_mask:0xf bank_mask:0xc
    v_add_f32_dpp v42, v42, v42 row_shl:4 row_mask:0xf bank_mask:0x5
    s_nop 1
    v_add_f32_dpp v42, v46, v46 row_shr:4 row_mask:0xf bank_mask:0xa
    v_add_f32_dpp v43, v43, v43 row_shl:4 row_mask:0xf bank_mask:0x5
    s_nop 1
    v_add_f32_dpp v43, v47, v47 row_shr:4 row_mask:0xf bank_mask:0xa
    v_add_f32_dpp v44, v44, v44 row_shl:4 row_mask:0xf bank_mask:0x5
    s_nop 1
    v_add_f32_dpp v44, v48, v48 row_shr:4 row_mask:0xf bank_mask:0xa
    v_add_f32_dpp v45, v45, v45 row_shl:4 row_mask:0xf bank_mask:0x5
    s_nop 1
    v_add_f32_dpp v45, v49, v49 row_shr:4 row_mask:0xf bank_mask:0xa
    v_add_f32_dpp v42, v42, v42 quad_perm:[2,3,0,1] row_mask:0xf bank_mask:0xf
    v_add_f32_dpp v43, v43, v43 quad_perm:[2,3,0,1] row_mask:0xf bank_mask:0xf
    v_add_f32_dpp v44, v44, v44 quad_perm:[2,3,0,1] row_mask:0xf bank_mask:0xf
    v_add_f32_dpp v45, v45, v45 quad_perm:[2,3,0,1] row_mask:0xf bank_mask:0xf
    v_cndmask_b32 v42, v42, v44, s[76:77]
    v_cndmask_b32 v43, v43, v45, s[76:77]
    s_nop 0
    v_add_f32_dpp v42, v42, v42 quad_perm:[1,0,3,2] row_mask:0xf bank_mask:0xf
    v_add_f32_dpp v43, v43, v43 quad_perm:[1,0,3,2] row_mask:0xf bank_mask:0xf
    v_cndmask_b32 v42, v42, v43, s[78:79]
    v_cvt_pk_bf16_f32 v42, 0, v42
    v_mul_f32 v42, 0x3db504f3, v42
    v_cvt_pk_bf16_f32 v27, 0, v42
    v_dot2_f32_bf16 v42, v64, v6, 0
    v_dot2_f32_bf16 v42, v65, v7, v42
    v_dot2_f32_bf16 v42, v66, v8, v42
    v_dot2_f32_bf16 v42, v67, v9, v42
    v_dot2_f32_bf16 v43, v68, v6, 0
    v_dot2_f32_bf16 v43, v69, v7, v43
    v_dot2_f32_bf16 v43, v70, v8, v43
    v_dot2_f32_bf16 v43, v71, v9, v43
    buffer_load_dwordx4 v[96:99], v1, s[32:35], s70 offen nt
    s_add_u32 s70, s70, 0x1000
    v_dot2_f32_bf16 v44, v72, v6, 0
    v_dot2_f32_bf16 v44, v73, v7, v44
    v_dot2_f32_bf16 v44, v74, v8, v44
    v_dot2_f32_bf16 v44, v75, v9, v44
    buffer_load_dwordx4 v[100:103], v1, s[32:35], s70 offen nt
    s_add_u32 s70, s70, 0x1000
    v_dot2_f32_bf16 v45, v76, v6, 0
    v_dot2_f32_bf16 v45, v77, v7, v45
    v_dot2_f32_bf16 v45, v78, v8, v45
    v_dot2_f32_bf16 v45, v79, v9, v45
    buffer_load_dwordx4 v[104:107], v1, s[32:35], s70 offen nt
    s_add_u32 s70, s70, 0x1000
    v_dot2_f32_bf16 v46, v80, v6, 0
    v_dot2_f32_bf16 v46, v81, v7, v46
    v_dot2_f32_bf16 v46, v82, v8, v46
    v_dot2_f32_bf16 v46, v83, v9, v46
    buffer_load_dwordx4 v[108:111], v1, s[32:35], s70 offen nt
    s_add_u32 s70, s70, 0x1000
    v_dot2_f32_bf16 v47, v84, v6, 0
    v_dot2_f32_bf16 v47, v85, v7, v47
    v_dot2_f32_bf16 v47, v86, v8, v47
    v_dot2_f32_bf16 v47, v87, v9, v47
    buffer_load_dwordx4 v[112:115], v1, s[32:35], s70 offen nt
    s_add_u32 s70, s70, 0x1000
    s_waitcnt vmcnt(6)
    v_dot2_f32_bf16 v48, v88, v6, 0
    v_dot2_f32_bf16 v48, v89, v7, v48
    v_dot2_f32_bf16 v48, v90, v8, v48
    v_dot2_f32_bf16 v48, v91, v9, v48
    buffer_load_dwordx4 v[116:119], v1, s[32:35], s70 offen nt
    s_add_u32 s70, s70, 0x1000
    s_waitcnt vmcnt(6)
    v_dot2_f32_bf16 v49, v92, v6, 0
    v_dot2_f32_bf16 v49, v93, v7, v49
    v_dot2_f32_bf16 v49, v94, v8, v49
    v_dot2_f32_bf16 v49, v95, v9, v49
    buffer_load_dwordx4 v[120:123], v1, s[32:35], s70 offen nt
    s_add_u32 s70, s70, 0x1000
    s_waitcnt vmcnt(6)
    v_dot2_f32_bf16 v50, v96, v6, 0
    v_dot2_f32_bf16 v50, v97, v7, v50
    v_dot2_f32_bf16 v50, v98, v8, v50
    v_dot2_f32_bf16 v50, v99, v9, v50
    buffer_load_dwordx4 v[124:127], v1, s[32:35], s70 offen nt
    s_add_u32 s70, s70, 0x9000
    s_waitcnt vmcnt(6)
    v_dot2_f32_bf16 v51, v100, v6, 0
    v_dot2_f32_bf16 v51, v101, v7, v51
    v_dot2_f32_bf16 v51, v102, v8, v51
    v_dot2_f32_bf16 v51, v103, v9, v51
    buffer_load_dwordx4 v[64:67], v1, s[32:35], s70 offen nt
    s_add_u32 s70, s70, 0x1000
    s_waitcnt vmcnt(6)
    v_dot2_f32_bf16 v52, v104, v6, 0
    v_dot2_f32_bf16 v52, v105, v7, v52
    v_dot2_f32_bf16 v52, v106, v8, v52
    v_dot2_f32_bf16 v52, v107, v9, v52
    buffer_load_dwordx4 v[68:71], v1, s[32:35], s70 offen nt
    s_add_u32 s70, s70, 0x1000
    s_waitcnt vmcnt(6)
    v_dot2_f32_bf16 v53, v108, v6, 0
    v_dot2_f32_bf16 v53, v109, v7, v53
    v_dot2_f32_bf16 v53, v110, v8, v53
    v_dot2_f32_bf16 v53, v111, v9, v53
    buffer_load_dwordx4 v[72:75], v1, s[32:35], s70 offen nt
    s_add_u32 s70, s70, 0x1000
    s_waitcnt vmcnt(6)
    v_dot2_f32_bf16 v54, v112, v6, 0
    v_dot2_f32_bf16 v54, v113, v7, v54
    v_dot2_f32_bf16 v54, v114, v8, v54
    v_dot2_f32_bf16 v54, v115, v9, v54
    buffer_load_dwordx4 v[76:79], v1, s[32:35], s70 offen nt
    s_add_u32 s70, s70, 0x1000
    s_waitcnt vmcnt(6)
    v_dot2_f32_bf16 v55, v116, v6, 0
    v_dot2_f32_bf16 v55, v117, v7, v55
    v_dot2_f32_bf16 v55, v118, v8, v55
    v_dot2_f32_bf16 v55, v119, v9, v55
    buffer_load_dwordx4 v[80:83], v1, s[32:35], s70 offen nt
    s_add_u32 s70, s70, 0x1000
    s_waitcnt vmcnt(6)
    v_dot2_f32_bf16 v56, v120, v6, 0
    v_dot2_f32_bf16 v56, v121, v7, v56
    v_dot2_f32_bf16 v56, v122, v8, v56
    v_dot2_f32_bf16 v56, v123, v9, v56
    buffer_load_dwordx4 v[84:87], v1, s[32:35], s70 offen nt
    s_add_u32 s70, s70, 0x1000
    s_waitcnt vmcnt(6)
    v_dot2_f32_bf16 v57, v124, v6, 0
    v_dot2_f32_bf16 v57, v125, v7, v57
    v_dot2_f32_bf16 v57, v126, v8, v57
    v_dot2_f32_bf16 v57, v127, v9, v57
    buffer_load_dwordx4 v[88:91], v1, s[32:35], s70 offen nt
    s_add_u32 s70, s70, 0x1000
    v_add_f32_dpp v42, v42, v42 row_ror:8 row_mask:0xf bank_mask:0x3
    s_nop 1
    v_add_f32_dpp v42, v50, v50 row_ror:8 row_mask:0xf bank_mask:0xc
    v_add_f32_dpp v43, v43, v43 row_ror:8 row_mask:0xf bank_mask:0x3
    s_nop 1
    v_add_f32_dpp v43, v51, v51 row_ror:8 row_mask:0xf bank_mask:0xc
    v_add_f32_dpp v44, v44, v44 row_ror:8 row_mask:0xf bank_mask:0x3
    s_nop 1
    v_add_f32_dpp v44, v52, v52 row_ror:8 row_mask:0xf bank_mask:0xc
    v_add_f32_dpp v45, v45, v45 row_ror:8 row_mask:0xf bank_mask:0x3
    s_nop 1
    v_add_f32_dpp v45, v53, v53 row_ror:8 row_mask:0xf bank_mask:0xc
    v_add_f32_dpp v46, v46, v46 row_ror:8 row_mask:0xf bank_mask:0x3
    s_nop 1
    v_add_f32_dpp v46, v54, v54 row_ror:8 row_mask:0xf bank_mask:0xc
    v_add_f32_dpp v47, v47, v47 row_ror:8 row_mask:0xf bank_mask:0x3
    s_nop 1
    v_add_f32_dpp v47, v55, v55 row_ror:8 row_mask:0xf bank_mask:0xc
    v_add_f32_dpp v48, v48, v48 row_ror:8 row_mask:0xf bank_mask:0x3
    s_nop 1
    v_add_f32_dpp v48, v56, v56 row_ror:8 row_mask:0xf bank_mask:0xc
    v_add_f32_dpp v49, v49, v49 row_ror:8 row_mask:0xf bank_mask:0x3
    s_nop 1
    v_add_f32_dpp v49, v57, v57 row_ror:8 row_mask:0xf bank_mask:0xc
    v_add_f32_dpp v42, v42, v42 row_shl:4 row_mask:0xf bank_mask:0x5
    s_nop 1
    v_add_f32_dpp v42, v46, v46 row_shr:4 row_mask:0xf bank_mask:0xa
    v_add_f32_dpp v43, v43, v43 row_shl:4 row_mask:0xf bank_mask:0x5
    s_nop 1
    v_add_f32_dpp v43, v47, v47 row_shr:4 row_mask:0xf bank_mask:0xa
    v_add_f32_dpp v44, v44, v44 row_shl:4 row_mask:0xf bank_mask:0x5
    s_nop 1
    v_add_f32_dpp v44, v48, v48 row_shr:4 row_mask:0xf bank_mask:0xa
    v_add_f32_dpp v45, v45, v45 row_shl:4 row_mask:0xf bank_mask:0x5
    s_nop 1
    v_add_f32_dpp v45, v49, v49 row_shr:4 row_mask:0xf bank_mask:0xa
    v_add_f32_dpp v42, v42, v42 quad_perm:[2,3,0,1] row_mask:0xf bank_mask:0xf
    v_add_f32_dpp v43, v43, v43 quad_perm:[2,3,0,1] row_mask:0xf bank_mask:0xf
    v_add_f32_dpp v44, v44, v44 quad_perm:[2,3,0,1] row_mask:0xf bank_mask:0xf
    v_add_f32_dpp v45, v45, v45 quad_perm:[2,3,0,1] row_mask:0xf bank_mask:0xf
    v_cndmask_b32 v42, v42, v44, s[76:77]
    v_cndmask_b32 v43, v43, v45, s[76:77]
    s_nop 0
    v_add_f32_dpp v42, v42, v42 quad_perm:[1,0,3,2] row_mask:0xf bank_mask:0xf
    v_add_f32_dpp v43, v43, v43 quad_perm:[1,0,3,2] row_mask:0xf bank_mask:0xf
    v_cndmask_b32 v42, v42, v43, s[78:79]
    v_cvt_pk_bf16_f32 v42, 0, v42
    v_mul_f32 v42, 0x3db504f3, v42
    v_cvt_pk_bf16_f32 v28, 0, v42
    s_waitcnt vmcnt(6)
    v_dot2_f32_bf16 v42, v64, v6, 0
    v_dot2_f32_bf16 v42, v65, v7, v42
    v_dot2_f32_bf16 v42, v66, v8, v42
    v_dot2_f32_bf16 v42, v67, v9, v42
    buffer_load_dwordx4 v[92:95], v1, s[32:35], s70 offen nt
    s_add_u32 s70, s70, 0x9000
    buffer_load_dwordx4 v[128:131], v3, s[44:47], s72 offen
    s_add_u32 s72, s72, 0x1000
    s_and_b32 s72, s72, 0x1ffff
    s_waitcnt vmcnt(7)
    v_dot2_f32_bf16 v43, v68, v6, 0
    v_dot2_f32_bf16 v43, v69, v7, v43
    v_dot2_f32_bf16 v43, v70, v8, v43
    v_dot2_f32_bf16 v43, v71, v9, v43
    buffer_load_dwordx4 v[96:99], v1, s[32:35], s70 offen nt
    s_add_u32 s70, s70, 0x1000
    s_waitcnt vmcnt(7)
    v_dot2_f32_bf16 v44, v72, v6, 0
    v_dot2_f32_bf16 v44, v73, v7, v44
    v_dot2_f32_bf16 v44, v74, v8, v44
    v_dot2_f32_bf16 v44, v75, v9, v44
    buffer_load_dwordx4 v[100:103], v1, s[32:35], s70 offen nt
    s_add_u32 s70, s70, 0x1000
    buffer_load_dwordx4 v[132:135], v3, s[44:47], s72 offen
    s_add_u32 s72, s72, 0x1000
    s_and_b32 s72, s72, 0x1ffff
    s_waitcnt vmcnt(8)
    v_dot2_f32_bf16 v45, v76, v6, 0
    v_dot2_f32_bf16 v45, v77, v7, v45
    v_dot2_f32_bf16 v45, v78, v8, v45
    v_dot2_f32_bf16 v45, v79, v9, v45
    buffer_load_dwordx4 v[104:107], v1, s[32:35], s70 offen nt
    s_add_u32 s70, s70, 0x1000
    s_waitcnt vmcnt(8)
    v_dot2_f32_bf16 v46, v80, v6, 0
    v_dot2_f32_bf16 v46, v81, v7, v46
    v_dot2_f32_bf16 v46, v82, v8, v46
    v_dot2_f32_bf16 v46, v83, v9, v46
    buffer_load_dwordx4 v[108:111], v1, s[32:35], s70 offen nt
    s_add_u32 s70, s70, 0x1000
    buffer_load_dwordx4 v[136:139], v3, s[44:47], s72 offen
    s_add_u32 s72, s72, 0x1000
    s_and_b32 s72, s72, 0x1ffff
    s_waitcnt vmcnt(9)
    v_dot2_f32_bf16 v47, v84, v6, 0
    v_dot2_f32_bf16 v47, v85, v7, v47
    v_dot2_f32_bf16 v47, v86, v8, v47
    v_dot2_f32_bf16 v47, v87, v9, v47
    buffer_load_dwordx4 v[112:115], v1, s[32:35], s70 offen nt
    s_add_u32 s70, s70, 0x1000
    s_waitcnt vmcnt(9)
    v_dot2_f32_bf16 v48, v88, v6, 0
    v_dot2_f32_bf16 v48, v89, v7, v48
    v_dot2_f32_bf16 v48, v90, v8, v48
    v_dot2_f32_bf16 v48, v91, v9, v48
    buffer_load_dwordx4 v[116:119], v1, s[32:35], s70 offen nt
    s_add_u32 s70, s70, 0x1000
    buffer_load_dwordx4 v[140:143], v3, s[44:47], s72 offen
    s_add_u32 s72, s72, 0x1000
    s_and_b32 s72, s72, 0x1ffff
    s_waitcnt vmcnt(10)
    v_dot2_f32_bf16 v49, v92, v6, 0
    v_dot2_f32_bf16 v49, v93, v7, v49
    v_dot2_f32_bf16 v49, v94, v8, v49
    v_dot2_f32_bf16 v49, v95, v9, v49
    buffer_load_dwordx4 v[120:123], v1, s[32:35], s70 offen nt
    s_add_u32 s70, s70, 0x1000
    s_waitcnt vmcnt(9)
    v_dot2_f32_bf16 v50, v96, v6, 0
    v_dot2_f32_bf16 v50, v97, v7, v50
    v_dot2_f32_bf16 v50, v98, v8, v50
    v_dot2_f32_bf16 v50, v99, v9, v50
    buffer_load_dwordx4 v[124:127], v1, s[32:35], s70 offen nt
    s_add_u32 s70, s70, 0x9000
    buffer_load_dwordx4 v[144:147], v3, s[44:47], s72 offen
    s_add_u32 s72, s72, 0x1000
    s_and_b32 s72, s72, 0x1ffff
    s_waitcnt vmcnt(10)
    v_dot2_f32_bf16 v51, v100, v6, 0
    v_dot2_f32_bf16 v51, v101, v7, v51
    v_dot2_f32_bf16 v51, v102, v8, v51
    v_dot2_f32_bf16 v51, v103, v9, v51
    buffer_load_dwordx4 v[64:67], v1, s[32:35], s70 offen nt
    s_add_u32 s70, s70, 0x1000
    s_waitcnt vmcnt(9)
    v_dot2_f32_bf16 v52, v104, v6, 0
    v_dot2_f32_bf16 v52, v105, v7, v52
    v_dot2_f32_bf16 v52, v106, v8, v52
    v_dot2_f32_bf16 v52, v107, v9, v52
    buffer_load_dwordx4 v[68:71], v1, s[32:35], s70 offen nt
    s_add_u32 s70, s70, 0x1000
    buffer_load_dwordx4 v[148:151], v3, s[44:47], s72 offen
    s_add_u32 s72, s72, 0x1000
    s_and_b32 s72, s72, 0x1ffff
    s_waitcnt vmcnt(10)
    v_dot2_f32_bf16 v53, v108, v6, 0
    v_dot2_f32_bf16 v53, v109, v7, v53
    v_dot2_f32_bf16 v53, v110, v8, v53
    v_dot2_f32_bf16 v53, v111, v9, v53
    buffer_load_dwordx4 v[72:75], v1, s[32:35], s70 offen nt
    s_add_u32 s70, s70, 0x1000
    s_waitcnt vmcnt(9)
    v_dot2_f32_bf16 v54, v112, v6, 0
    v_dot2_f32_bf16 v54, v113, v7, v54
    v_dot2_f32_bf16 v54, v114, v8, v54
    v_dot2_f32_bf16 v54, v115, v9, v54
    buffer_load_dwordx4 v[76:79], v1, s[32:35], s70 offen nt
    s_add_u32 s70, s70, 0x1000
    buffer_load_dwordx4 v[152:155], v3, s[44:47], s72 offen
    s_add_u32 s72, s72, 0x1000
    s_and_b32 s72, s72, 0x1ffff
    s_waitcnt vmcnt(10)
    v_dot2_f32_bf16 v55, v116, v6, 0
    v_dot2_f32_bf16 v55, v117, v7, v55
    v_dot2_f32_bf16 v55, v118, v8, v55
    v_dot2_f32_bf16 v55, v119, v9, v55
    buffer_load_dwordx4 v[80:83], v1, s[32:35], s70 offen nt
    s_add_u32 s70, s70, 0x1000
    s_waitcnt vmcnt(9)
    v_dot2_f32_bf16 v56, v120, v6, 0
    v_dot2_f32_bf16 v56, v121, v7, v56
    v_dot2_f32_bf16 v56, v122, v8, v56
    v_dot2_f32_bf16 v56, v123, v9, v56
    buffer_load_dwordx4 v[84:87], v1, s[32:35], s70 offen nt
    s_add_u32 s70, s70, 0x1000
    buffer_load_dwordx4 v[156:159], v3, s[44:47], s72 offen
    s_add_u32 s72, s72, 0x1000
    s_and_b32 s72, s72, 0x1ffff
    s_waitcnt vmcnt(10)
    v_dot2_f32_bf16 v57, v124, v6, 0
    v_dot2_f32_bf16 v57, v125, v7, v57
    v_dot2_f32_bf16 v57, v126, v8, v57
    v_dot2_f32_bf16 v57, v127, v9, v57
    buffer_load_dwordx4 v[88:91], v1, s[32:35], s70 offen nt
    s_add_u32 s70, s70, 0x1000
    v_add_f32_dpp v42, v42, v42 row_ror:8 row_mask:0xf bank_mask:0x3
    s_nop 1
    v_add_f32_dpp v42, v50, v50 row_ror:8 row_mask:0xf bank_mask:0xc
    v_add_f32_dpp v43, v43, v43 row_ror:8 row_mask:0xf bank_mask:0x3
    s_nop 1
    v_add_f32_dpp v43, v51, v51 row_ror:8 row_mask:0xf bank_mask:0xc
    v_add_f32_dpp v44, v44, v44 row_ror:8 row_mask:0xf bank_mask:0x3
    s_nop 1
    v_add_f32_dpp v44, v52, v52 row_ror:8 row_mask:0xf bank_mask:0xc
    v_add_f32_dpp v45, v45, v45 row_ror:8 row_mask:0xf bank_mask:0x3
    s_nop 1
    v_add_f32_dpp v45, v53, v53 row_ror:8 row_mask:0xf bank_mask:0xc
    v_add_f32_dpp v46, v46, v46 row_ror:8 row_mask:0xf bank_mask:0x3
    s_nop 1
    v_add_f32_dpp v46, v54, v54 row_ror:8 row_mask:0xf bank_mask:0xc
    v_add_f32_dpp v47, v47, v47 row_ror:8 row_mask:0xf bank_mask:0x3
    s_nop 1
    v_add_f32_dpp v47, v55, v55 row_ror:8 row_mask:0xf bank_mask:0xc
    v_add_f32_dpp v48, v48, v48 row_ror:8 row_mask:0xf bank_mask:0x3
    s_nop 1
    v_add_f32_dpp v48, v56, v56 row_ror:8 row_mask:0xf bank_mask:0xc
    v_add_f32_dpp v49, v49, v49 row_ror:8 row_mask:0xf bank_mask:0x3
    s_nop 1
    v_add_f32_dpp v49, v57, v57 row_ror:8 row_mask:0xf bank_mask:0xc
    v_add_f32_dpp v42, v42, v42 row_shl:4 row_mask:0xf bank_mask:0x5
    s_nop 1
    v_add_f32_dpp v42, v46, v46 row_shr:4 row_mask:0xf bank_mask:0xa
    v_add_f32_dpp v43, v43, v43 row_shl:4 row_mask:0xf bank_mask:0x5
    s_nop 1
    v_add_f32_dpp v43, v47, v47 row_shr:4 row_mask:0xf bank_mask:0xa
    v_add_f32_dpp v44, v44, v44 row_shl:4 row_mask:0xf bank_mask:0x5
    s_nop 1
    v_add_f32_dpp v44, v48, v48 row_shr:4 row_mask:0xf bank_mask:0xa
    v_add_f32_dpp v45, v45, v45 row_shl:4 row_mask:0xf bank_mask:0x5
    s_nop 1
    v_add_f32_dpp v45, v49, v49 row_shr:4 row_mask:0xf bank_mask:0xa
    v_add_f32_dpp v42, v42, v42 quad_perm:[2,3,0,1] row_mask:0xf bank_mask:0xf
    v_add_f32_dpp v43, v43, v43 quad_perm:[2,3,0,1] row_mask:0xf bank_mask:0xf
    v_add_f32_dpp v44, v44, v44 quad_perm:[2,3,0,1] row_mask:0xf bank_mask:0xf
    v_add_f32_dpp v45, v45, v45 quad_perm:[2,3,0,1] row_mask:0xf bank_mask:0xf
    v_cndmask_b32 v42, v42, v44, s[76:77]
    v_cndmask_b32 v43, v43, v45, s[76:77]
    s_nop 0
    v_add_f32_dpp v42, v42, v42 quad_perm:[1,0,3,2] row_mask:0xf bank_mask:0xf
    v_add_f32_dpp v43, v43, v43 quad_perm:[1,0,3,2] row_mask:0xf bank_mask:0xf
    v_cndmask_b32 v42, v42, v43, s[78:79]
    v_cvt_pk_bf16_f32 v42, 0, v42
    v_mul_f32 v42, 0x3db504f3, v42
    v_cvt_pk_bf16_f32 v29, 0, v42
    s_waitcnt vmcnt(9)
    v_dot2_f32_bf16 v42, v64, v6, 0
    v_dot2_f32_bf16 v42, v65, v7, v42
    v_dot2_f32_bf16 v42, v66, v8, v42
    v_dot2_f32_bf16 v42, v67, v9, v42
    buffer_load_dwordx4 v[92:95], v1, s[32:35], s70 offen nt
    s_add_u32 s70, s70, 0x9000
    buffer_load_dwordx4 v[160:163], v3, s[44:47], s72 offen
    s_add_u32 s72, s72, 0x1000
    s_and_b32 s72, s72, 0x1ffff
    s_waitcnt vmcnt(10)
    v_dot2_f32_bf16 v43, v68, v6, 0
    v_dot2_f32_bf16 v43, v69, v7, v43
    v_dot2_f32_bf16 v43, v70, v8, v43
    v_dot2_f32_bf16 v43, v71, v9, v43
    buffer_load_dwordx4 v[96:99], v1, s[32:35], s70 offen nt
    s_add_u32 s70, s70, 0x1000
    s_waitcnt vmcnt(9)
    v_dot2_f32_bf16 v44, v72, v6, 0
    v_dot2_f32_bf16 v44, v73, v7, v44
    v_dot2_f32_bf16 v44, v74, v8, v44
    v_dot2_f32_bf16 v44, v75, v9, v44
    buffer_load_dwordx4 v[100:103], v1, s[32:35], s70 offen nt
    s_add_u32 s70, s70, 0x1000
    buffer_load_dwordx4 v[164:167], v3, s[44:47], s72 offen
    s_add_u32 s72, s72, 0x1000
    s_and_b32 s72, s72, 0x1ffff
    s_waitcnt vmcnt(10)
    v_dot2_f32_bf16 v45, v76, v6, 0
    v_dot2_f32_bf16 v45, v77, v7, v45
    v_dot2_f32_bf16 v45, v78, v8, v45
    v_dot2_f32_bf16 v45, v79, v9, v45
    buffer_load_dwordx4 v[104:107], v1, s[32:35], s70 offen nt
    s_add_u32 s70, s70, 0x1000
    s_waitcnt vmcnt(9)
    v_dot2_f32_bf16 v46, v80, v6, 0
    v_dot2_f32_bf16 v46, v81, v7, v46
    v_dot2_f32_bf16 v46, v82, v8, v46
    v_dot2_f32_bf16 v46, v83, v9, v46
    buffer_load_dwordx4 v[108:111], v1, s[32:35], s70 offen nt
    s_add_u32 s70, s70, 0x1000
    buffer_load_dwordx4 v[168:171], v3, s[44:47], s72 offen
    s_add_u32 s72, s72, 0x1000
    s_and_b32 s72, s72, 0x1ffff
    s_waitcnt vmcnt(10)
    v_dot2_f32_bf16 v47, v84, v6, 0
    v_dot2_f32_bf16 v47, v85, v7, v47
    v_dot2_f32_bf16 v47, v86, v8, v47
    v_dot2_f32_bf16 v47, v87, v9, v47
    buffer_load_dwordx4 v[112:115], v1, s[32:35], s70 offen nt
    s_add_u32 s70, s70, 0x1000
    s_waitcnt vmcnt(9)
    v_dot2_f32_bf16 v48, v88, v6, 0
    v_dot2_f32_bf16 v48, v89, v7, v48
    v_dot2_f32_bf16 v48, v90, v8, v48
    v_dot2_f32_bf16 v48, v91, v9, v48
    buffer_load_dwordx4 v[116:119], v1, s[32:35], s70 offen nt
    s_add_u32 s70, s70, 0x1000
    buffer_load_dwordx4 v[172:175], v3, s[44:47], s72 offen
    s_add_u32 s72, s72, 0x1000
    s_and_b32 s72, s72, 0x1ffff
    s_waitcnt vmcnt(10)
    v_dot2_f32_bf16 v49, v92, v6, 0
    v_dot2_f32_bf16 v49, v93, v7, v49
    v_dot2_f32_bf16 v49, v94, v8, v49
    v_dot2_f32_bf16 v49, v95, v9, v49
    buffer_load_dwordx4 v[120:123], v1, s[32:35], s70 offen nt
    s_add_u32 s70, s70, 0x1000
    s_waitcnt vmcnt(9)
    v_dot2_f32_bf16 v50, v96, v6, 0
    v_dot2_f32_bf16 v50, v97, v7, v50
    v_dot2_f32_bf16 v50, v98, v8, v50
    v_dot2_f32_bf16 v50, v99, v9, v50
    buffer_load_dwordx4 v[124:127], v1, s[32:35], s70 offen nt
    s_add_u32 s70, s70, 0x9000
    buffer_load_dwordx4 v[176:179], v3, s[44:47], s72 offen
    s_add_u32 s72, s72, 0x1000
    s_and_b32 s72, s72, 0x1ffff
    s_waitcnt vmcnt(10)
    v_dot2_f32_bf16 v51, v100, v6, 0
    v_dot2_f32_bf16 v51, v101, v7, v51
    v_dot2_f32_bf16 v51, v102, v8, v51
    v_dot2_f32_bf16 v51, v103, v9, v51
    buffer_load_dwordx4 v[64:67], v1, s[32:35], s70 offen nt
    s_add_u32 s70, s70, 0x1000
    s_waitcnt vmcnt(9)
    v_dot2_f32_bf16 v52, v104, v6, 0
    v_dot2_f32_bf16 v52, v105, v7, v52
    v_dot2_f32_bf16 v52, v106, v8, v52
    v_dot2_f32_bf16 v52, v107, v9, v52
    buffer_load_dwordx4 v[68:71], v1, s[32:35], s70 offen nt
    s_add_u32 s70, s70, 0x1000
    buffer_load_dwordx4 v[180:183], v3, s[44:47], s72 offen
    s_add_u32 s72, s72, 0x1000
    s_and_b32 s72, s72, 0x1ffff
    s_waitcnt vmcnt(10)
    v_dot2_f32_bf16 v53, v108, v6, 0
    v_dot2_f32_bf16 v53, v109, v7, v53
    v_dot2_f32_bf16 v53, v110, v8, v53
    v_dot2_f32_bf16 v53, v111, v9, v53
    buffer_load_dwordx4 v[72:75], v1, s[32:35], s70 offen nt
    s_add_u32 s70, s70, 0x1000
    s_waitcnt vmcnt(9)
    v_dot2_f32_bf16 v54, v112, v6, 0
    v_dot2_f32_bf16 v54, v113, v7, v54
    v_dot2_f32_bf16 v54, v114, v8, v54
    v_dot2_f32_bf16 v54, v115, v9, v54
    buffer_load_dwordx4 v[76:79], v1, s[32:35], s70 offen nt
    s_add_u32 s70, s70, 0x1000
    buffer_load_dwordx4 v[184:187], v3, s[44:47], s72 offen
    s_add_u32 s72, s72, 0x1000
    s_and_b32 s72, s72, 0x1ffff
    s_waitcnt vmcnt(10)
    v_dot2_f32_bf16 v55, v116, v6, 0
    v_dot2_f32_bf16 v55, v117, v7, v55
    v_dot2_f32_bf16 v55, v118, v8, v55
    v_dot2_f32_bf16 v55, v119, v9, v55
    buffer_load_dwordx4 v[80:83], v1, s[32:35], s70 offen nt
    s_add_u32 s70, s70, 0x1000
    s_waitcnt vmcnt(9)
    v_dot2_f32_bf16 v56, v120, v6, 0
    v_dot2_f32_bf16 v56, v121, v7, v56
    v_dot2_f32_bf16 v56, v122, v8, v56
    v_dot2_f32_bf16 v56, v123, v9, v56
    buffer_load_dwordx4 v[84:87], v1, s[32:35], s70 offen nt
    s_add_u32 s70, s70, 0x1000
    buffer_load_dwordx4 v[188:191], v3, s[44:47], s72 offen
    s_add_u32 s72, s72, 0x1000
    s_and_b32 s72, s72, 0x1ffff
    s_waitcnt vmcnt(10)
    v_dot2_f32_bf16 v57, v124, v6, 0
    v_dot2_f32_bf16 v57, v125, v7, v57
    v_dot2_f32_bf16 v57, v126, v8, v57
    v_dot2_f32_bf16 v57, v127, v9, v57
    buffer_load_dwordx4 v[88:91], v1, s[32:35], s70 offen nt
    s_add_u32 s70, s70, 0x1000
    v_add_f32_dpp v42, v42, v42 row_ror:8 row_mask:0xf bank_mask:0x3
    s_nop 1
    v_add_f32_dpp v42, v50, v50 row_ror:8 row_mask:0xf bank_mask:0xc
    v_add_f32_dpp v43, v43, v43 row_ror:8 row_mask:0xf bank_mask:0x3
    s_nop 1
    v_add_f32_dpp v43, v51, v51 row_ror:8 row_mask:0xf bank_mask:0xc
    v_add_f32_dpp v44, v44, v44 row_ror:8 row_mask:0xf bank_mask:0x3
    s_nop 1
    v_add_f32_dpp v44, v52, v52 row_ror:8 row_mask:0xf bank_mask:0xc
    v_add_f32_dpp v45, v45, v45 row_ror:8 row_mask:0xf bank_mask:0x3
    s_nop 1
    v_add_f32_dpp v45, v53, v53 row_ror:8 row_mask:0xf bank_mask:0xc
    v_add_f32_dpp v46, v46, v46 row_ror:8 row_mask:0xf bank_mask:0x3
    s_nop 1
    v_add_f32_dpp v46, v54, v54 row_ror:8 row_mask:0xf bank_mask:0xc
    v_add_f32_dpp v47, v47, v47 row_ror:8 row_mask:0xf bank_mask:0x3
    s_nop 1
    v_add_f32_dpp v47, v55, v55 row_ror:8 row_mask:0xf bank_mask:0xc
    v_add_f32_dpp v48, v48, v48 row_ror:8 row_mask:0xf bank_mask:0x3
    s_nop 1
    v_add_f32_dpp v48, v56, v56 row_ror:8 row_mask:0xf bank_mask:0xc
    v_add_f32_dpp v49, v49, v49 row_ror:8 row_mask:0xf bank_mask:0x3
    s_nop 1
    v_add_f32_dpp v49, v57, v57 row_ror:8 row_mask:0xf bank_mask:0xc
    v_add_f32_dpp v42, v42, v42 row_shl:4 row_mask:0xf bank_mask:0x5
    s_nop 1
    v_add_f32_dpp v42, v46, v46 row_shr:4 row_mask:0xf bank_mask:0xa
    v_add_f32_dpp v43, v43, v43 row_shl:4 row_mask:0xf bank_mask:0x5
    s_nop 1
    v_add_f32_dpp v43, v47, v47 row_shr:4 row_mask:0xf bank_mask:0xa
    v_add_f32_dpp v44, v44, v44 row_shl:4 row_mask:0xf bank_mask:0x5
    s_nop 1
    v_add_f32_dpp v44, v48, v48 row_shr:4 row_mask:0xf bank_mask:0xa
    v_add_f32_dpp v45, v45, v45 row_shl:4 row_mask:0xf bank_mask:0x5
    s_nop 1
    v_add_f32_dpp v45, v49, v49 row_shr:4 row_mask:0xf bank_mask:0xa
    v_add_f32_dpp v42, v42, v42 quad_perm:[2,3,0,1] row_mask:0xf bank_mask:0xf
    v_add_f32_dpp v43, v43, v43 quad_perm:[2,3,0,1] row_mask:0xf bank_mask:0xf
    v_add_f32_dpp v44, v44, v44 quad_perm:[2,3,0,1] row_mask:0xf bank_mask:0xf
    v_add_f32_dpp v45, v45, v45 quad_perm:[2,3,0,1] row_mask:0xf bank_mask:0xf
    v_cndmask_b32 v42, v42, v44, s[76:77]
    v_cndmask_b32 v43, v43, v45, s[76:77]
    s_nop 0
    v_add_f32_dpp v42, v42, v42 quad_perm:[1,0,3,2] row_mask:0xf bank_mask:0xf
    v_add_f32_dpp v43, v43, v43 quad_perm:[1,0,3,2] row_mask:0xf bank_mask:0xf
    v_cndmask_b32 v42, v42, v43, s[78:79]
    v_cvt_pk_bf16_f32 v42, 0, v42
    v_mul_f32 v42, 0x3db504f3, v42
    v_cvt_pk_bf16_f32 v30, 0, v42
    s_waitcnt vmcnt(9)
    v_dot2_f32_bf16 v42, v64, v6, 0
    v_dot2_f32_bf16 v42, v65, v7, v42
    v_dot2_f32_bf16 v42, v66, v8, v42
    v_dot2_f32_bf16 v42, v67, v9, v42
    buffer_load_dwordx4 v[92:95], v1, s[32:35], s70 offen nt
    s_add_u32 s70, s70, 0x9000
    buffer_load_dwordx4 v[192:195], v3, s[44:47], s72 offen
    s_add_u32 s72, s72, 0x1000
    s_and_b32 s72, s72, 0x1ffff
    s_waitcnt vmcnt(10)
    v_dot2_f32_bf16 v43, v68, v6, 0
    v_dot2_f32_bf16 v43, v69, v7, v43
    v_dot2_f32_bf16 v43, v70, v8, v43
    v_dot2_f32_bf16 v43, v71, v9, v43
    buffer_load_dwordx4 v[96:99], v1, s[32:35], s70 offen nt
    s_add_u32 s70, s70, 0x1000
    s_waitcnt vmcnt(9)
    v_dot2_f32_bf16 v44, v72, v6, 0
    v_dot2_f32_bf16 v44, v73, v7, v44
    v_dot2_f32_bf16 v44, v74, v8, v44
    v_dot2_f32_bf16 v44, v75, v9, v44
    buffer_load_dwordx4 v[100:103], v1, s[32:35], s70 offen nt
    s_add_u32 s70, s70, 0x1000
    buffer_load_dwordx4 v[196:199], v3, s[44:47], s72 offen
    s_add_u32 s72, s72, 0x1000
    s_and_b32 s72, s72, 0x1ffff
    s_waitcnt vmcnt(10)
    v_dot2_f32_bf16 v45, v76, v6, 0
    v_dot2_f32_bf16 v45, v77, v7, v45
    v_dot2_f32_bf16 v45, v78, v8, v45
    v_dot2_f32_bf16 v45, v79, v9, v45
    buffer_load_dwordx4 v[104:107], v1, s[32:35], s70 offen nt
    s_add_u32 s70, s70, 0x1000
    s_waitcnt vmcnt(9)
    v_dot2_f32_bf16 v46, v80, v6, 0
    v_dot2_f32_bf16 v46, v81, v7, v46
    v_dot2_f32_bf16 v46, v82, v8, v46
    v_dot2_f32_bf16 v46, v83, v9, v46
    buffer_load_dwordx4 v[108:111], v1, s[32:35], s70 offen nt
    s_add_u32 s70, s70, 0x1000
    buffer_load_dwordx4 v[200:203], v3, s[44:47], s72 offen
    s_add_u32 s72, s72, 0x1000
    s_and_b32 s72, s72, 0x1ffff
    s_waitcnt vmcnt(10)
    v_dot2_f32_bf16 v47, v84, v6, 0
    v_dot2_f32_bf16 v47, v85, v7, v47
    v_dot2_f32_bf16 v47, v86, v8, v47
    v_dot2_f32_bf16 v47, v87, v9, v47
    buffer_load_dwordx4 v[112:115], v1, s[32:35], s70 offen nt
    s_add_u32 s70, s70, 0x1000
    s_waitcnt vmcnt(9)
    v_dot2_f32_bf16 v48, v88, v6, 0
    v_dot2_f32_bf16 v48, v89, v7, v48
    v_dot2_f32_bf16 v48, v90, v8, v48
    v_dot2_f32_bf16 v48, v91, v9, v48
    buffer_load_dwordx4 v[116:119], v1, s[32:35], s70 offen nt
    s_add_u32 s70, s70, 0x1000
    buffer_load_dwordx4 v[204:207], v3, s[44:47], s72 offen
    s_add_u32 s72, s72, 0x1000
    s_and_b32 s72, s72, 0x1ffff
    s_waitcnt vmcnt(10)
    v_dot2_f32_bf16 v49, v92, v6, 0
    v_dot2_f32_bf16 v49, v93, v7, v49
    v_dot2_f32_bf16 v49, v94, v8, v49
    v_dot2_f32_bf16 v49, v95, v9, v49
    buffer_load_dwordx4 v[120:123], v1, s[32:35], s70 offen nt
    s_add_u32 s70, s70, 0x1000
    s_waitcnt vmcnt(9)
    v_dot2_f32_bf16 v50, v96, v6, 0
    v_dot2_f32_bf16 v50, v97, v7, v50
    v_dot2_f32_bf16 v50, v98, v8, v50
    v_dot2_f32_bf16 v50, v99, v9, v50
    buffer_load_dwordx4 v[124:127], v1, s[32:35], s70 offen nt
    s_add_u32 s70, s70, 0x9000
    buffer_load_dwordx4 v[208:211], v3, s[44:47], s72 offen
    s_add_u32 s72, s72, 0x1000
    s_and_b32 s72, s72, 0x1ffff
    s_waitcnt vmcnt(10)
    v_dot2_f32_bf16 v51, v100, v6, 0
    v_dot2_f32_bf16 v51, v101, v7, v51
    v_dot2_f32_bf16 v51, v102, v8, v51
    v_dot2_f32_bf16 v51, v103, v9, v51
    buffer_load_dwordx4 v[64:67], v1, s[32:35], s70 offen nt
    s_add_u32 s70, s70, 0x1000
    s_waitcnt vmcnt(9)
    v_dot2_f32_bf16 v52, v104, v6, 0
    v_dot2_f32_bf16 v52, v105, v7, v52
    v_dot2_f32_bf16 v52, v106, v8, v52
    v_dot2_f32_bf16 v52, v107, v9, v52
    buffer_load_dwordx4 v[68:71], v1, s[32:35], s70 offen nt
    s_add_u32 s70, s70, 0x1000
    buffer_load_dwordx4 v[212:215], v3, s[44:47], s72 offen
    s_add_u32 s72, s72, 0x1000
    s_and_b32 s72, s72, 0x1ffff
    s_waitcnt vmcnt(10)
    v_dot2_f32_bf16 v53, v108, v6, 0
    v_dot2_f32_bf16 v53, v109, v7, v53
    v_dot2_f32_bf16 v53, v110, v8, v53
    v_dot2_f32_bf16 v53, v111, v9, v53
    buffer_load_dwordx4 v[72:75], v1, s[32:35], s70 offen nt
    s_add_u32 s70, s70, 0x1000
    s_waitcnt vmcnt(9)
    v_dot2_f32_bf16 v54, v112, v6, 0
    v_dot2_f32_bf16 v54, v113, v7, v54
    v_dot2_f32_bf16 v54, v114, v8, v54
    v_dot2_f32_bf16 v54, v115, v9, v54
    buffer_load_dwordx4 v[76:79], v1, s[32:35], s70 offen nt
    s_add_u32 s70, s70, 0x1000
    buffer_load_dwordx4 v[216:219], v3, s[44:47], s72 offen
    s_add_u32 s72, s72, 0x1000
    s_and_b32 s72, s72, 0x1ffff
    s_waitcnt vmcnt(10)
    v_dot2_f32_bf16 v55, v116, v6, 0
    v_dot2_f32_bf16 v55, v117, v7, v55
    v_dot2_f32_bf16 v55, v118, v8, v55
    v_dot2_f32_bf16 v55, v119, v9, v55
    buffer_load_dwordx4 v[80:83], v1, s[32:35], s70 offen nt
    s_add_u32 s70, s70, 0x1000
    s_waitcnt vmcnt(9)
    v_dot2_f32_bf16 v56, v120, v6, 0
    v_dot2_f32_bf16 v56, v121, v7, v56
    v_dot2_f32_bf16 v56, v122, v8, v56
    v_dot2_f32_bf16 v56, v123, v9, v56
    buffer_load_dwordx4 v[84:87], v1, s[32:35], s70 offen nt
    s_add_u32 s70, s70, 0x1000
    buffer_load_dwordx4 v[220:223], v3, s[44:47], s72 offen
    s_add_u32 s72, s72, 0x1000
    s_and_b32 s72, s72, 0x1ffff
    s_waitcnt vmcnt(10)
    v_dot2_f32_bf16 v57, v124, v6, 0
    v_dot2_f32_bf16 v57, v125, v7, v57
    v_dot2_f32_bf16 v57, v126, v8, v57
    v_dot2_f32_bf16 v57, v127, v9, v57
    buffer_load_dwordx4 v[88:91], v1, s[32:35], s70 offen nt
    s_add_u32 s70, s70, 0x1000
    v_add_f32_dpp v42, v42, v42 row_ror:8 row_mask:0xf bank_mask:0x3
    s_nop 1
    v_add_f32_dpp v42, v50, v50 row_ror:8 row_mask:0xf bank_mask:0xc
    v_add_f32_dpp v43, v43, v43 row_ror:8 row_mask:0xf bank_mask:0x3
    s_nop 1
    v_add_f32_dpp v43, v51, v51 row_ror:8 row_mask:0xf bank_mask:0xc
    v_add_f32_dpp v44, v44, v44 row_ror:8 row_mask:0xf bank_mask:0x3
    s_nop 1
    v_add_f32_dpp v44, v52, v52 row_ror:8 row_mask:0xf bank_mask:0xc
    v_add_f32_dpp v45, v45, v45 row_ror:8 row_mask:0xf bank_mask:0x3
    s_nop 1
    v_add_f32_dpp v45, v53, v53 row_ror:8 row_mask:0xf bank_mask:0xc
    v_add_f32_dpp v46, v46, v46 row_ror:8 row_mask:0xf bank_mask:0x3
    s_nop 1
    v_add_f32_dpp v46, v54, v54 row_ror:8 row_mask:0xf bank_mask:0xc
    v_add_f32_dpp v47, v47, v47 row_ror:8 row_mask:0xf bank_mask:0x3
    s_nop 1
    v_add_f32_dpp v47, v55, v55 row_ror:8 row_mask:0xf bank_mask:0xc
    v_add_f32_dpp v48, v48, v48 row_ror:8 row_mask:0xf bank_mask:0x3
    s_nop 1
    v_add_f32_dpp v48, v56, v56 row_ror:8 row_mask:0xf bank_mask:0xc
    v_add_f32_dpp v49, v49, v49 row_ror:8 row_mask:0xf bank_mask:0x3
    s_nop 1
    v_add_f32_dpp v49, v57, v57 row_ror:8 row_mask:0xf bank_mask:0xc
    v_add_f32_dpp v42, v42, v42 row_shl:4 row_mask:0xf bank_mask:0x5
    s_nop 1
    v_add_f32_dpp v42, v46, v46 row_shr:4 row_mask:0xf bank_mask:0xa
    v_add_f32_dpp v43, v43, v43 row_shl:4 row_mask:0xf bank_mask:0x5
    s_nop 1
    v_add_f32_dpp v43, v47, v47 row_shr:4 row_mask:0xf bank_mask:0xa
    v_add_f32_dpp v44, v44, v44 row_shl:4 row_mask:0xf bank_mask:0x5
    s_nop 1
    v_add_f32_dpp v44, v48, v48 row_shr:4 row_mask:0xf bank_mask:0xa
    v_add_f32_dpp v45, v45, v45 row_shl:4 row_mask:0xf bank_mask:0x5
    s_nop 1
    v_add_f32_dpp v45, v49, v49 row_shr:4 row_mask:0xf bank_mask:0xa
    v_add_f32_dpp v42, v42, v42 quad_perm:[2,3,0,1] row_mask:0xf bank_mask:0xf
    v_add_f32_dpp v43, v43, v43 quad_perm:[2,3,0,1] row_mask:0xf bank_mask:0xf
    v_add_f32_dpp v44, v44, v44 quad_perm:[2,3,0,1] row_mask:0xf bank_mask:0xf
    v_add_f32_dpp v45, v45, v45 quad_perm:[2,3,0,1] row_mask:0xf bank_mask:0xf
    v_cndmask_b32 v42, v42, v44, s[76:77]
    v_cndmask_b32 v43, v43, v45, s[76:77]
    s_nop 0
    v_add_f32_dpp v42, v42, v42 quad_perm:[1,0,3,2] row_mask:0xf bank_mask:0xf
    v_add_f32_dpp v43, v43, v43 quad_perm:[1,0,3,2] row_mask:0xf bank_mask:0xf
    v_cndmask_b32 v42, v42, v43, s[78:79]
    v_cvt_pk_bf16_f32 v42, 0, v42
    v_mul_f32 v42, 0x3db504f3, v42
    v_cvt_pk_bf16_f32 v31, 0, v42
    s_waitcnt vmcnt(9)
    v_dot2_f32_bf16 v42, v64, v6, 0
    v_dot2_f32_bf16 v42, v65, v7, v42
    v_dot2_f32_bf16 v42, v66, v8, v42
    v_dot2_f32_bf16 v42, v67, v9, v42
    buffer_load_dwordx4 v[92:95], v1, s[32:35], s70 offen nt
    s_add_u32 s70, s70, 0x9000
    buffer_load_dwordx4 v[224:227], v3, s[44:47], s72 offen
    s_add_u32 s72, s72, 0x1000
    s_and_b32 s72, s72, 0x1ffff
    s_waitcnt vmcnt(10)
    v_dot2_f32_bf16 v43, v68, v6, 0
    v_dot2_f32_bf16 v43, v69, v7, v43
    v_dot2_f32_bf16 v43, v70, v8, v43
    v_dot2_f32_bf16 v43, v71, v9, v43
    buffer_load_dwordx4 v[96:99], v1, s[32:35], s70 offen nt
    s_add_u32 s70, s70, 0x1000
    s_waitcnt vmcnt(9)
    v_dot2_f32_bf16 v44, v72, v6, 0
    v_dot2_f32_bf16 v44, v73, v7, v44
    v_dot2_f32_bf16 v44, v74, v8, v44
    v_dot2_f32_bf16 v44, v75, v9, v44
    buffer_load_dwordx4 v[100:103], v1, s[32:35], s70 offen nt
    s_add_u32 s70, s70, 0x1000
    buffer_load_dwordx4 v[228:231], v3, s[44:47], s72 offen
    s_add_u32 s72, s72, 0x1000
    s_and_b32 s72, s72, 0x1ffff
    s_waitcnt vmcnt(10)
    v_dot2_f32_bf16 v45, v76, v6, 0
    v_dot2_f32_bf16 v45, v77, v7, v45
    v_dot2_f32_bf16 v45, v78, v8, v45
    v_dot2_f32_bf16 v45, v79, v9, v45
    buffer_load_dwordx4 v[104:107], v1, s[32:35], s70 offen nt
    s_add_u32 s70, s70, 0x1000
    s_waitcnt vmcnt(9)
    v_dot2_f32_bf16 v46, v80, v6, 0
    v_dot2_f32_bf16 v46, v81, v7, v46
    v_dot2_f32_bf16 v46, v82, v8, v46
    v_dot2_f32_bf16 v46, v83, v9, v46
    buffer_load_dwordx4 v[108:111], v1, s[32:35], s70 offen nt
    s_add_u32 s70, s70, 0x1000
    buffer_load_dwordx4 v[232:235], v3, s[44:47], s72 offen
    s_add_u32 s72, s72, 0x1000
    s_and_b32 s72, s72, 0x1ffff
    s_waitcnt vmcnt(10)
    v_dot2_f32_bf16 v47, v84, v6, 0
    v_dot2_f32_bf16 v47, v85, v7, v47
    v_dot2_f32_bf16 v47, v86, v8, v47
    v_dot2_f32_bf16 v47, v87, v9, v47
    buffer_load_dwordx4 v[112:115], v1, s[32:35], s70 offen nt
    s_add_u32 s70, s70, 0x1000
    s_waitcnt vmcnt(9)
    v_dot2_f32_bf16 v48, v88, v6, 0
    v_dot2_f32_bf16 v48, v89, v7, v48
    v_dot2_f32_bf16 v48, v90, v8, v48
    v_dot2_f32_bf16 v48, v91, v9, v48
    buffer_load_dwordx4 v[116:119], v1, s[32:35], s70 offen nt
    s_add_u32 s70, s70, 0x1000
    buffer_load_dwordx4 v[236:239], v3, s[44:47], s72 offen
    s_add_u32 s72, s72, 0x1000
    s_and_b32 s72, s72, 0x1ffff
    s_waitcnt vmcnt(10)
    v_dot2_f32_bf16 v49, v92, v6, 0
    v_dot2_f32_bf16 v49, v93, v7, v49
    v_dot2_f32_bf16 v49, v94, v8, v49
    v_dot2_f32_bf16 v49, v95, v9, v49
    buffer_load_dwordx4 v[120:123], v1, s[32:35], s70 offen nt
    s_add_u32 s70, s70, 0x1000
    s_waitcnt vmcnt(9)
    v_dot2_f32_bf16 v50, v96, v6, 0
    v_dot2_f32_bf16 v50, v97, v7, v50
    v_dot2_f32_bf16 v50, v98, v8, v50
    v_dot2_f32_bf16 v50, v99, v9, v50
    buffer_load_dwordx4 v[124:127], v1, s[32:35], s70 offen nt
    s_add_u32 s70, s70, 0x9000
    buffer_load_dwordx4 v[240:243], v3, s[44:47], s72 offen
    s_add_u32 s72, s72, 0x1000
    s_and_b32 s72, s72, 0x1ffff
    s_waitcnt vmcnt(10)
    v_dot2_f32_bf16 v51, v100, v6, 0
    v_dot2_f32_bf16 v51, v101, v7, v51
    v_dot2_f32_bf16 v51, v102, v8, v51
    v_dot2_f32_bf16 v51, v103, v9, v51
    buffer_load_dwordx4 v[64:67], v1, s[32:35], s70 offen nt
    s_add_u32 s70, s70, 0x1000
    s_waitcnt vmcnt(9)
    v_dot2_f32_bf16 v52, v104, v6, 0
    v_dot2_f32_bf16 v52, v105, v7, v52
    v_dot2_f32_bf16 v52, v106, v8, v52
    v_dot2_f32_bf16 v52, v107, v9, v52
    buffer_load_dwordx4 v[68:71], v1, s[32:35], s70 offen nt
    s_add_u32 s70, s70, 0x1000
    buffer_load_dwordx4 v[244:247], v3, s[44:47], s72 offen
    s_add_u32 s72, s72, 0x1000
    s_and_b32 s72, s72, 0x1ffff
    s_waitcnt vmcnt(10)
    v_dot2_f32_bf16 v53, v108, v6, 0
    v_dot2_f32_bf16 v53, v109, v7, v53
    v_dot2_f32_bf16 v53, v110, v8, v53
    v_dot2_f32_bf16 v53, v111, v9, v53
    buffer_load_dwordx4 v[72:75], v1, s[32:35], s70 offen nt
    s_add_u32 s70, s70, 0x1000
    s_waitcnt vmcnt(9)
    v_dot2_f32_bf16 v54, v112, v6, 0
    v_dot2_f32_bf16 v54, v113, v7, v54
    v_dot2_f32_bf16 v54, v114, v8, v54
    v_dot2_f32_bf16 v54, v115, v9, v54
    buffer_load_dwordx4 v[76:79], v1, s[32:35], s70 offen nt
    s_add_u32 s70, s70, 0x1000
    buffer_load_dwordx4 v[248:251], v3, s[44:47], s72 offen
    s_add_u32 s72, s72, 0x1000
    s_and_b32 s72, s72, 0x1ffff
    s_waitcnt vmcnt(10)
    v_dot2_f32_bf16 v55, v116, v6, 0
    v_dot2_f32_bf16 v55, v117, v7, v55
    v_dot2_f32_bf16 v55, v118, v8, v55
    v_dot2_f32_bf16 v55, v119, v9, v55
    buffer_load_dwordx4 v[80:83], v1, s[32:35], s70 offen nt
    s_add_u32 s70, s70, 0x1000
    s_waitcnt vmcnt(9)
    v_dot2_f32_bf16 v56, v120, v6, 0
    v_dot2_f32_bf16 v56, v121, v7, v56
    v_dot2_f32_bf16 v56, v122, v8, v56
    v_dot2_f32_bf16 v56, v123, v9, v56
    buffer_load_dwordx4 v[84:87], v1, s[32:35], s70 offen nt
    s_add_u32 s70, s70, 0x1000
    buffer_load_dwordx4 v[252:255], v3, s[44:47], s72 offen
    s_add_u32 s72, s72, 0x1000
    s_and_b32 s72, s72, 0x1ffff
    s_waitcnt vmcnt(10)
    v_dot2_f32_bf16 v57, v124, v6, 0
    v_dot2_f32_bf16 v57, v125, v7, v57
    v_dot2_f32_bf16 v57, v126, v8, v57
    v_dot2_f32_bf16 v57, v127, v9, v57
    buffer_load_dwordx4 v[88:91], v1, s[32:35], s70 offen nt
    s_add_u32 s70, s70, 0x1000
    v_add_f32_dpp v42, v42, v42 row_ror:8 row_mask:0xf bank_mask:0x3
    s_nop 1
    v_add_f32_dpp v42, v50, v50 row_ror:8 row_mask:0xf bank_mask:0xc
    v_add_f32_dpp v43, v43, v43 row_ror:8 row_mask:0xf bank_mask:0x3
    s_nop 1
    v_add_f32_dpp v43, v51, v51 row_ror:8 row_mask:0xf bank_mask:0xc
    v_add_f32_dpp v44, v44, v44 row_ror:8 row_mask:0xf bank_mask:0x3
    s_nop 1
    v_add_f32_dpp v44, v52, v52 row_ror:8 row_mask:0xf bank_mask:0xc
    v_add_f32_dpp v45, v45, v45 row_ror:8 row_mask:0xf bank_mask:0x3
    s_nop 1
    v_add_f32_dpp v45, v53, v53 row_ror:8 row_mask:0xf bank_mask:0xc
    v_add_f32_dpp v46, v46, v46 row_ror:8 row_mask:0xf bank_mask:0x3
    s_nop 1
    v_add_f32_dpp v46, v54, v54 row_ror:8 row_mask:0xf bank_mask:0xc
    v_add_f32_dpp v47, v47, v47 row_ror:8 row_mask:0xf bank_mask:0x3
    s_nop 1
    v_add_f32_dpp v47, v55, v55 row_ror:8 row_mask:0xf bank_mask:0xc
    v_add_f32_dpp v48, v48, v48 row_ror:8 row_mask:0xf bank_mask:0x3
    s_nop 1
    v_add_f32_dpp v48, v56, v56 row_ror:8 row_mask:0xf bank_mask:0xc
    v_add_f32_dpp v49, v49, v49 row_ror:8 row_mask:0xf bank_mask:0x3
    s_nop 1
    v_add_f32_dpp v49, v57, v57 row_ror:8 row_mask:0xf bank_mask:0xc
    v_add_f32_dpp v42, v42, v42 row_shl:4 row_mask:0xf bank_mask:0x5
    s_nop 1
    v_add_f32_dpp v42, v46, v46 row_shr:4 row_mask:0xf bank_mask:0xa
    v_add_f32_dpp v43, v43, v43 row_shl:4 row_mask:0xf bank_mask:0x5
    s_nop 1
    v_add_f32_dpp v43, v47, v47 row_shr:4 row_mask:0xf bank_mask:0xa
    v_add_f32_dpp v44, v44, v44 row_shl:4 row_mask:0xf bank_mask:0x5
    s_nop 1
    v_add_f32_dpp v44, v48, v48 row_shr:4 row_mask:0xf bank_mask:0xa
    v_add_f32_dpp v45, v45, v45 row_shl:4 row_mask:0xf bank_mask:0x5
    s_nop 1
    v_add_f32_dpp v45, v49, v49 row_shr:4 row_mask:0xf bank_mask:0xa
    v_add_f32_dpp v42, v42, v42 quad_perm:[2,3,0,1] row_mask:0xf bank_mask:0xf
    v_add_f32_dpp v43, v43, v43 quad_perm:[2,3,0,1] row_mask:0xf bank_mask:0xf
    v_add_f32_dpp v44, v44, v44 quad_perm:[2,3,0,1] row_mask:0xf bank_mask:0xf
    v_add_f32_dpp v45, v45, v45 quad_perm:[2,3,0,1] row_mask:0xf bank_mask:0xf
    v_cndmask_b32 v42, v42, v44, s[76:77]
    v_cndmask_b32 v43, v43, v45, s[76:77]
    s_nop 0
    v_add_f32_dpp v42, v42, v42 quad_perm:[1,0,3,2] row_mask:0xf bank_mask:0xf
    v_add_f32_dpp v43, v43, v43 quad_perm:[1,0,3,2] row_mask:0xf bank_mask:0xf
    v_cndmask_b32 v42, v42, v43, s[78:79]
    v_cvt_pk_bf16_f32 v42, 0, v42
    v_mul_f32 v42, 0x3db504f3, v42
    v_cvt_pk_bf16_f32 v32, 0, v42
    s_waitcnt vmcnt(9)
    v_dot2_f32_bf16 v42, v64, v6, 0
    v_dot2_f32_bf16 v42, v65, v7, v42
    v_dot2_f32_bf16 v42, v66, v8, v42
    v_dot2_f32_bf16 v42, v67, v9, v42
    buffer_load_dwordx4 v[92:95], v1, s[32:35], s70 offen nt
    s_add_u32 s70, s70, 0x9000
    s_waitcnt vmcnt(9)
    v_dot2_f32_bf16 v43, v68, v6, 0
    v_dot2_f32_bf16 v43, v69, v7, v43
    v_dot2_f32_bf16 v43, v70, v8, v43
    v_dot2_f32_bf16 v43, v71, v9, v43
    buffer_load_dwordx4 v[96:99], v1, s[32:35], s70 offen nt
    s_add_u32 s70, s70, 0x1000
    s_waitcnt vmcnt(8)
    v_dot2_f32_bf16 v44, v72, v6, 0
    v_dot2_f32_bf16 v44, v73, v7, v44
    v_dot2_f32_bf16 v44, v74, v8, v44
    v_dot2_f32_bf16 v44, v75, v9, v44
    buffer_load_dwordx4 v[100:103], v1, s[32:35], s70 offen nt
    s_add_u32 s70, s70, 0x1000
    s_waitcnt vmcnt(8)
    v_dot2_f32_bf16 v45, v76, v6, 0
    v_dot2_f32_bf16 v45, v77, v7, v45
    v_dot2_f32_bf16 v45, v78, v8, v45
    v_dot2_f32_bf16 v45, v79, v9, v45
    buffer_load_dwordx4 v[104:107], v1, s[32:35], s70 offen nt
    s_add_u32 s70, s70, 0x1000
    s_waitcnt vmcnt(7)
    v_dot2_f32_bf16 v46, v80, v6, 0
    v_dot2_f32_bf16 v46, v81, v7, v46
    v_dot2_f32_bf16 v46, v82, v8, v46
    v_dot2_f32_bf16 v46, v83, v9, v46
    buffer_load_dwordx4 v[108:111], v1, s[32:35], s70 offen nt
    s_add_u32 s70, s70, 0x1000
    s_waitcnt vmcnt(7)
    v_dot2_f32_bf16 v47, v84, v6, 0
    v_dot2_f32_bf16 v47, v85, v7, v47
    v_dot2_f32_bf16 v47, v86, v8, v47
    v_dot2_f32_bf16 v47, v87, v9, v47
    buffer_load_dwordx4 v[112:115], v1, s[32:35], s70 offen nt
    s_add_u32 s70, s70, 0x1000
    s_waitcnt vmcnt(6)
    v_dot2_f32_bf16 v48, v88, v6, 0
    v_dot2_f32_bf16 v48, v89, v7, v48
    v_dot2_f32_bf16 v48, v90, v8, v48
    v_dot2_f32_bf16 v48, v91, v9, v48
    buffer_load_dwordx4 v[116:119], v1, s[32:35], s70 offen nt
    s_add_u32 s70, s70, 0x1000
    s_waitcnt vmcnt(6)
    v_dot2_f32_bf16 v49, v92, v6, 0
    v_dot2_f32_bf16 v49, v93, v7, v49
    v_dot2_f32_bf16 v49, v94, v8, v49
    v_dot2_f32_bf16 v49, v95, v9, v49
    buffer_load_dwordx4 v[120:123], v1, s[32:35], s70 offen nt
    s_add_u32 s70, s70, 0x1000
    s_waitcnt vmcnt(6)
    v_dot2_f32_bf16 v50, v96, v6, 0
    v_dot2_f32_bf16 v50, v97, v7, v50
    v_dot2_f32_bf16 v50, v98, v8, v50
    v_dot2_f32_bf16 v50, v99, v9, v50
    buffer_load_dwordx4 v[124:127], v1, s[32:35], s70 offen nt
    s_add_u32 s70, s70, 0x9000
    s_waitcnt vmcnt(6)
    v_dot2_f32_bf16 v51, v100, v6, 0
    v_dot2_f32_bf16 v51, v101, v7, v51
    v_dot2_f32_bf16 v51, v102, v8, v51
    v_dot2_f32_bf16 v51, v103, v9, v51
    s_mov_b32 s70, s75
    buffer_load_dwordx4 v[64:67], v1, s[36:39], s70 offen nt
    s_add_u32 s70, s70, 0x1000
    s_waitcnt vmcnt(6)
    v_dot2_f32_bf16 v52, v104, v6, 0
    v_dot2_f32_bf16 v52, v105, v7, v52
    v_dot2_f32_bf16 v52, v106, v8, v52
    v_dot2_f32_bf16 v52, v107, v9, v52
    buffer_load_dwordx4 v[68:71], v1, s[36:39], s70 offen nt
    s_add_u32 s70, s70, 0x1000
    s_waitcnt vmcnt(6)
    v_dot2_f32_bf16 v53, v108, v6, 0
    v_dot2_f32_bf16 v53, v109, v7, v53
    v_dot2_f32_bf16 v53, v110, v8, v53
    v_dot2_f32_bf16 v53, v111, v9, v53
    buffer_load_dwordx4 v[72:75], v1, s[36:39], s70 offen nt
    s_add_u32 s70, s70, 0x1000
    s_waitcnt vmcnt(6)
    v_dot2_f32_bf16 v54, v112, v6, 0
    v_dot2_f32_bf16 v54, v113, v7, v54
    v_dot2_f32_bf16 v54, v114, v8, v54
    v_dot2_f32_bf16 v54, v115, v9, v54
    buffer_load_dwordx4 v[76:79], v1, s[36:39], s70 offen nt
    s_add_u32 s70, s70, 0x1000
    s_waitcnt vmcnt(6)
    v_dot2_f32_bf16 v55, v116, v6, 0
    v_dot2_f32_bf16 v55, v117, v7, v55
    v_dot2_f32_bf16 v55, v118, v8, v55
    v_dot2_f32_bf16 v55, v119, v9, v55
    buffer_load_dwordx4 v[80:83], v1, s[36:39], s70 offen nt
    s_add_u32 s70, s70, 0x1000
    s_waitcnt vmcnt(6)
    v_dot2_f32_bf16 v56, v120, v6, 0
    v_dot2_f32_bf16 v56, v121, v7, v56
    v_dot2_f32_bf16 v56, v122, v8, v56
    v_dot2_f32_bf16 v56, v123, v9, v56
    buffer_load_dwordx4 v[84:87], v1, s[36:39], s70 offen nt
    s_add_u32 s70, s70, 0x1000
    s_waitcnt vmcnt(6)
    v_dot2_f32_bf16 v57, v124, v6, 0
    v_dot2_f32_bf16 v57, v125, v7, v57
    v_dot2_f32_bf16 v57, v126, v8, v57
    v_dot2_f32_bf16 v57, v127, v9, v57
    buffer_load_dwordx4 v[88:91], v1, s[36:39], s70 offen nt
    s_add_u32 s70, s70, 0x1000
    v_add_f32_dpp v42, v42, v42 row_ror:8 row_mask:0xf bank_mask:0x3
    s_nop 1
    v_add_f32_dpp v42, v50, v50 row_ror:8 row_mask:0xf bank_mask:0xc
    v_add_f32_dpp v43, v43, v43 row_ror:8 row_mask:0xf bank_mask:0x3
    s_nop 1
    v_add_f32_dpp v43, v51, v51 row_ror:8 row_mask:0xf bank_mask:0xc
    v_add_f32_dpp v44, v44, v44 row_ror:8 row_mask:0xf bank_mask:0x3
    s_nop 1
    v_add_f32_dpp v44, v52, v52 row_ror:8 row_mask:0xf bank_mask:0xc
    v_add_f32_dpp v45, v45, v45 row_ror:8 row_mask:0xf bank_mask:0x3
    s_nop 1
    v_add_f32_dpp v45, v53, v53 row_ror:8 row_mask:0xf bank_mask:0xc
    v_add_f32_dpp v46, v46, v46 row_ror:8 row_mask:0xf bank_mask:0x3
    s_nop 1
    v_add_f32_dpp v46, v54, v54 row_ror:8 row_mask:0xf bank_mask:0xc
    v_add_f32_dpp v47, v47, v47 row_ror:8 row_mask:0xf bank_mask:0x3
    s_nop 1
    v_add_f32_dpp v47, v55, v55 row_ror:8 row_mask:0xf bank_mask:0xc
    v_add_f32_dpp v48, v48, v48 row_ror:8 row_mask:0xf bank_mask:0x3
    s_nop 1
    v_add_f32_dpp v48, v56, v56 row_ror:8 row_mask:0xf bank_mask:0xc
    v_add_f32_dpp v49, v49, v49 row_ror:8 row_mask:0xf bank_mask:0x3
    s_nop 1
    v_add_f32_dpp v49, v57, v57 row_ror:8 row_mask:0xf bank_mask:0xc
    v_add_f32_dpp v42, v42, v42 row_shl:4 row_mask:0xf bank_mask:0x5
    s_nop 1
    v_add_f32_dpp v42, v46, v46 row_shr:4 row_mask:0xf bank_mask:0xa
    v_add_f32_dpp v43, v43, v43 row_shl:4 row_mask:0xf bank_mask:0x5
    s_nop 1
    v_add_f32_dpp v43, v47, v47 row_shr:4 row_mask:0xf bank_mask:0xa
    v_add_f32_dpp v44, v44, v44 row_shl:4 row_mask:0xf bank_mask:0x5
    s_nop 1
    v_add_f32_dpp v44, v48, v48 row_shr:4 row_mask:0xf bank_mask:0xa
    v_add_f32_dpp v45, v45, v45 row_shl:4 row_mask:0xf bank_mask:0x5
    s_nop 1
    v_add_f32_dpp v45, v49, v49 row_shr:4 row_mask:0xf bank_mask:0xa
    v_add_f32_dpp v42, v42, v42 quad_perm:[2,3,0,1] row_mask:0xf bank_mask:0xf
    v_add_f32_dpp v43, v43, v43 quad_perm:[2,3,0,1] row_mask:0xf bank_mask:0xf
    v_add_f32_dpp v44, v44, v44 quad_perm:[2,3,0,1] row_mask:0xf bank_mask:0xf
    v_add_f32_dpp v45, v45, v45 quad_perm:[2,3,0,1] row_mask:0xf bank_mask:0xf
    v_cndmask_b32 v42, v42, v44, s[76:77]
    v_cndmask_b32 v43, v43, v45, s[76:77]
    s_nop 0
    v_add_f32_dpp v42, v42, v42 quad_perm:[1,0,3,2] row_mask:0xf bank_mask:0xf
    v_add_f32_dpp v43, v43, v43 quad_perm:[1,0,3,2] row_mask:0xf bank_mask:0xf
    v_cndmask_b32 v42, v42, v43, s[78:79]
    v_cvt_pk_bf16_f32 v42, 0, v42
    v_mul_f32 v42, 0x3db504f3, v42
    v_cvt_pk_bf16_f32 v33, 0, v42
    v_max3_f32 v42, v26, v27, v28
    v_max3_f32 v44, v29, v30, v31
    v_max3_f32 v42, v42, v32, v33
    v_max_f32 v42, v42, v44
    s_nop 1
    v_max_f32_dpp v42, v42, v42 quad_perm:[1,0,3,2] row_mask:0xf bank_mask:0xf
    s_nop 1
    v_max_f32_dpp v42, v42, v42 quad_perm:[2,3,0,1] row_mask:0xf bank_mask:0xf
    s_nop 1
    v_max_f32_dpp v42, v42, v42 row_half_mirror row_mask:0xf bank_mask:0xf
    s_nop 1
    v_max_f32_dpp v42, v42, v42 row_mirror row_mask:0xf bank_mask:0xf
    v_mov_b32 v44, v42
    s_nop 1
    v_permlane16_swap_b32 v42, v44
    v_max_f32 v42, v42, v44
    v_mov_b32 v44, v42
    s_nop 1
    v_permlane32_swap_b32 v42, v44
    v_max_f32 v42, v42, v44
    v_sub_f32 v26, v26, v42
    v_sub_f32 v27, v27, v42
    v_sub_f32 v28, v28, v42
    v_sub_f32 v29, v29, v42
    v_sub_f32 v30, v30, v42
    v_sub_f32 v31, v31, v42
    v_sub_f32 v32, v32, v42
    v_sub_f32 v33, v33, v42
    v_mul_f32 v26, 0x3fb8aa3b, v26
    v_mul_f32 v27, 0x3fb8aa3b, v27
    v_mul_f32 v28, 0x3fb8aa3b, v28
    v_mul_f32 v29, 0x3fb8aa3b, v29
    v_mul_f32 v30, 0x3fb8aa3b, v30
    v_mul_f32 v31, 0x3fb8aa3b, v31
    v_mul_f32 v32, 0x3fb8aa3b, v32
    v_mul_f32 v33, 0x3fb8aa3b, v33
    v_exp_f32 v26, v26
    v_exp_f32 v27, v27
    v_exp_f32 v28, v28
    v_exp_f32 v29, v29
    v_exp_f32 v30, v30
    v_exp_f32 v31, v31
    v_exp_f32 v32, v32
    v_exp_f32 v33, v33
    v_add_f32 v43, v26, v27
    v_add_f32 v44, v28, v29
    v_add_f32 v45, v30, v31
    v_add_f32 v46, v32, v33
    v_add_f32 v43, v43, v44
    v_add_f32 v45, v45, v46
    v_add_f32 v43, v43, v45
    v_cvt_pk_bf16_f32 v34, 0, v26
    v_cvt_pk_bf16_f32 v26, v26, 0
    v_cvt_pk_bf16_f32 v35, 0, v27
    v_cvt_pk_bf16_f32 v27, v27, 0
    v_cvt_pk_bf16_f32 v36, 0, v28
    v_cvt_pk_bf16_f32 v28, v28, 0
    v_cvt_pk_bf16_f32 v37, 0, v29
    v_cvt_pk_bf16_f32 v29, v29, 0
    v_cvt_pk_bf16_f32 v38, 0, v30
    v_cvt_pk_bf16_f32 v30, v30, 0
    v_cvt_pk_bf16_f32 v39, 0, v31
    v_cvt_pk_bf16_f32 v31, v31, 0
    v_cvt_pk_bf16_f32 v40, 0, v32
    v_cvt_pk_bf16_f32 v32, v32, 0
    v_cvt_pk_bf16_f32 v41, 0, v33
    v_cvt_pk_bf16_f32 v33, v33, 0
    v_add_f32_dpp v43, v43, v43 quad_perm:[1,0,3,2] row_mask:0xf bank_mask:0xf
    s_nop 1
    v_add_f32_dpp v43, v43, v43 quad_perm:[2,3,0,1] row_mask:0xf bank_mask:0xf
    s_nop 1
    v_add_f32_dpp v43, v43, v43 row_half_mirror row_mask:0xf bank_mask:0xf
    s_nop 1
    v_add_f32_dpp v43, v43, v43 row_mirror row_mask:0xf bank_mask:0xf
    v_mov_b32 v44, v43
    s_nop 1
    v_permlane16_swap_b32 v43, v44
    v_add_f32 v43, v43, v44
    v_mov_b32 v44, v43
    s_nop 1
    v_permlane32_swap_b32 v43, v44
    v_add_f32 v43, v43, v44
    s_lshl_b32 s80, s3, 3
    v_mov_b32 v44, s80
    s_mov_b64 exec, 1
    ds_write_b64 v44, v[42:43] offset:2048
    s_mov_b64 exec, -1
    s_mov_b32 s82, 0x05040100
    s_mov_b32 s83, 0x07060302
    s_waitcnt vmcnt(6)
    v_dot2c_f32_bf16_dpp v10, v26, v64 row_newbcast:0 row_mask:0xf bank_mask:0xf
    v_dot2c_f32_bf16_dpp v11, v34, v64 row_newbcast:0 row_mask:0xf bank_mask:0xf
    v_dot2c_f32_bf16_dpp v12, v26, v65 row_newbcast:0 row_mask:0xf bank_mask:0xf
    v_dot2c_f32_bf16_dpp v13, v34, v65 row_newbcast:0 row_mask:0xf bank_mask:0xf
    v_dot2c_f32_bf16_dpp v14, v26, v66 row_newbcast:0 row_mask:0xf bank_mask:0xf
    v_dot2c_f32_bf16_dpp v15, v34, v66 row_newbcast:0 row_mask:0xf bank_mask:0xf
    v_dot2c_f32_bf16_dpp v16, v26, v67 row_newbcast:0 row_mask:0xf bank_mask:0xf
    v_dot2c_f32_bf16_dpp v17, v34, v67 row_newbcast:0 row_mask:0xf bank_mask:0xf
    buffer_load_dwordx4 v[92:95], v1, s[36:39], s70 offen nt
    s_add_u32 s70, s70, 0x9000
    v_perm_b32 v57, v132, v128, s82
    v_perm_b32 v132, v132, v128, s83
    s_waitcnt vmcnt(6)
    v_dot2c_f32_bf16_dpp v10, v26, v68 row_newbcast:1 row_mask:0xf bank_mask:0xf
    v_dot2c_f32_bf16_dpp v11, v34, v68 row_newbcast:1 row_mask:0xf bank_mask:0xf
    v_dot2c_f32_bf16_dpp v12, v26, v69 row_newbcast:1 row_mask:0xf bank_mask:0xf
    v_dot2c_f32_bf16_dpp v13, v34, v69 row_newbcast:1 row_mask:0xf bank_mask:0xf
    v_dot2c_f32_bf16_dpp v14, v26, v70 row_newbcast:1 row_mask:0xf bank_mask:0xf
    v_dot2c_f32_bf16_dpp v15, v34, v70 row_newbcast:1 row_mask:0xf bank_mask:0xf
    v_dot2c_f32_bf16_dpp v16, v26, v71 row_newbcast:1 row_mask:0xf bank_mask:0xf
    v_dot2c_f32_bf16_dpp v17, v34, v71 row_newbcast:1 row_mask:0xf bank_mask:0xf
    buffer_load_dwordx4 v[96:99], v1, s[36:39], s70 offen nt
    s_add_u32 s70, s70, 0x1000
    v_perm_b32 v128, v133, v129, s82
    v_perm_b32 v133, v133, v129, s83
    s_waitcnt vmcnt(6)
    v_dot2c_f32_bf16_dpp v10, v26, v72 row_newbcast:2 row_mask:0xf bank_mask:0xf
    v_dot2c_f32_bf16_dpp v11, v34, v72 row_newbcast:2 row_mask:0xf bank_mask:0xf
    v_dot2c_f32_bf16_dpp v12, v26, v73 row_newbcast:2 row_mask:0xf bank_mask:0xf
    v_dot2c_f32_bf16_dpp v13, v34, v73 row_newbcast:2 row_mask:0xf bank_mask:0xf
    v_dot2c_f32_bf16_dpp v14, v26, v74 row_newbcast:2 row_mask:0xf bank_mask:0xf
    v_dot2c_f32_bf16_dpp v15, v34, v74 row_newbcast:2 row_mask:0xf bank_mask:0xf
    v_dot2c_f32_bf16_dpp v16, v26, v75 row_newbcast:2 row_mask:0xf bank_mask:0xf
    v_dot2c_f32_bf16_dpp v17, v34, v75 row_newbcast:2 row_mask:0xf bank_mask:0xf
    buffer_load_dwordx4 v[100:103], v1, s[36:39], s70 offen nt
    s_add_u32 s70, s70, 0x1000
    v_perm_b32 v129, v134, v130, s82
    v_perm_b32 v134, v134, v130, s83
    s_waitcnt vmcnt(6)
    v_dot2c_f32_bf16_dpp v10, v26, v76 row_newbcast:3 row_mask:0xf bank_mask:0xf
    v_dot2c_f32_bf16_dpp v11, v34, v76 row_newbcast:3 row_mask:0xf bank_mask:0xf
    v_dot2c_f32_bf16_dpp v12, v26, v77 row_newbcast:3 row_mask:0xf bank_mask:0xf
    v_dot2c_f32_bf16_dpp v13, v34, v77 row_newbcast:3 row_mask:0xf bank_mask:0xf
    v_dot2c_f32_bf16_dpp v14, v26, v78 row_newbcast:3 row_mask:0xf bank_mask:0xf
    v_dot2c_f32_bf16_dpp v15, v34, v78 row_newbcast:3 row_mask:0xf bank_mask:0xf
    v_dot2c_f32_bf16_dpp v16, v26, v79 row_newbcast:3 row_mask:0xf bank_mask:0xf
    v_dot2c_f32_bf16_dpp v17, v34, v79 row_newbcast:3 row_mask:0xf bank_mask:0xf
    buffer_load_dwordx4 v[104:107], v1, s[36:39], s70 offen nt
    s_add_u32 s70, s70, 0x1000
    v_perm_b32 v130, v135, v131, s82
    v_perm_b32 v135, v135, v131, s83
    s_waitcnt vmcnt(6)
    v_dot2c_f32_bf16_dpp v10, v26, v80 row_newbcast:4 row_mask:0xf bank_mask:0xf
    v_dot2c_f32_bf16_dpp v11, v34, v80 row_newbcast:4 row_mask:0xf bank_mask:0xf
    v_dot2c_f32_bf16_dpp v12, v26, v81 row_newbcast:4 row_mask:0xf bank_mask:0xf
    v_dot2c_f32_bf16_dpp v13, v34, v81 row_newbcast:4 row_mask:0xf bank_mask:0xf
    v_dot2c_f32_bf16_dpp v14, v26, v82 row_newbcast:4 row_mask:0xf bank_mask:0xf
    v_dot2c_f32_bf16_dpp v15, v34, v82 row_newbcast:4 row_mask:0xf bank_mask:0xf
    v_dot2c_f32_bf16_dpp v16, v26, v83 row_newbcast:4 row_mask:0xf bank_mask:0xf
    v_dot2c_f32_bf16_dpp v17, v34, v83 row_newbcast:4 row_mask:0xf bank_mask:0xf
    buffer_load_dwordx4 v[108:111], v1, s[36:39], s70 offen nt
    s_add_u32 s70, s70, 0x1000
    v_perm_b32 v131, v140, v136, s82
    v_perm_b32 v140, v140, v136, s83
    s_waitcnt vmcnt(6)
    v_dot2c_f32_bf16_dpp v10, v26, v84 row_newbcast:5 row_mask:0xf bank_mask:0xf
    v_dot2c_f32_bf16_dpp v11, v34, v84 row_newbcast:5 row_mask:0xf bank_mask:0xf
    v_dot2c_f32_bf16_dpp v12, v26, v85 row_newbcast:5 row_mask:0xf bank_mask:0xf
    v_dot2c_f32_bf16_dpp v13, v34, v85 row_newbcast:5 row_mask:0xf bank_mask:0xf
    v_dot2c_f32_bf16_dpp v14, v26, v86 row_newbcast:5 row_mask:0xf bank_mask:0xf
    v_dot2c_f32_bf16_dpp v15, v34, v86 row_newbcast:5 row_mask:0xf bank_mask:0xf
    v_dot2c_f32_bf16_dpp v16, v26, v87 row_newbcast:5 row_mask:0xf bank_mask:0xf
    v_dot2c_f32_bf16_dpp v17, v34, v87 row_newbcast:5 row_mask:0xf bank_mask:0xf
    buffer_load_dwordx4 v[112:115], v1, s[36:39], s70 offen nt
    s_add_u32 s70, s70, 0x1000
    v_perm_b32 v136, v141, v137, s82
    v_perm_b32 v141, v141, v137, s83
    s_waitcnt vmcnt(6)
    v_dot2c_f32_bf16_dpp v10, v26, v88 row_newbcast:6 row_mask:0xf bank_mask:0xf
    v_dot2c_f32_bf16_dpp v11, v34, v88 row_newbcast:6 row_mask:0xf bank_mask:0xf
    v_dot2c_f32_bf16_dpp v12, v26, v89 row_newbcast:6 row_mask:0xf bank_mask:0xf
    v_dot2c_f32_bf16_dpp v13, v34, v89 row_newbcast:6 row_mask:0xf bank_mask:0xf
    v_dot2c_f32_bf16_dpp v14, v26, v90 row_newbcast:6 row_mask:0xf bank_mask:0xf
    v_dot2c_f32_bf16_dpp v15, v34, v90 row_newbcast:6 row_mask:0xf bank_mask:0xf
    v_dot2c_f32_bf16_dpp v16, v26, v91 row_newbcast:6 row_mask:0xf bank_mask:0xf
    v_dot2c_f32_bf16_dpp v17, v34, v91 row_newbcast:6 row_mask:0xf bank_mask:0xf
    buffer_load_dwordx4 v[116:119], v1, s[36:39], s70 offen nt
    s_add_u32 s70, s70, 0x1000
    v_perm_b32 v137, v142, v138, s82
    v_perm_b32 v142, v142, v138, s83
    s_waitcnt vmcnt(6)
    v_dot2c_f32_bf16_dpp v10, v26, v92 row_newbcast:7 row_mask:0xf bank_mask:0xf
    v_dot2c_f32_bf16_dpp v11, v34, v92 row_newbcast:7 row_mask:0xf bank_mask:0xf
    v_dot2c_f32_bf16_dpp v12, v26, v93 row_newbcast:7 row_mask:0xf bank_mask:0xf
    v_dot2c_f32_bf16_dpp v13, v34, v93 row_newbcast:7 row_mask:0xf bank_mask:0xf
    v_dot2c_f32_bf16_dpp v14, v26, v94 row_newbcast:7 row_mask:0xf bank_mask:0xf
    v_dot2c_f32_bf16_dpp v15, v34, v94 row_newbcast:7 row_mask:0xf bank_mask:0xf
    v_dot2c_f32_bf16_dpp v16, v26, v95 row_newbcast:7 row_mask:0xf bank_mask:0xf
    v_dot2c_f32_bf16_dpp v17, v34, v95 row_newbcast:7 row_mask:0xf bank_mask:0xf
    buffer_load_dwordx4 v[120:123], v1, s[36:39], s70 offen nt
    s_add_u32 s70, s70, 0x1000
    v_perm_b32 v138, v143, v139, s82
    v_perm_b32 v143, v143, v139, s83
    s_waitcnt vmcnt(6)
    v_dot2c_f32_bf16_dpp v10, v26, v96 row_newbcast:8 row_mask:0xf bank_mask:0xf
    v_dot2c_f32_bf16_dpp v11, v34, v96 row_newbcast:8 row_mask:0xf bank_mask:0xf
    v_dot2c_f32_bf16_dpp v12, v26, v97 row_newbcast:8 row_mask:0xf bank_mask:0xf
    v_dot2c_f32_bf16_dpp v13, v34, v97 row_newbcast:8 row_mask:0xf bank_mask:0xf
    v_dot2c_f32_bf16_dpp v14, v26, v98 row_newbcast:8 row_mask:0xf bank_mask:0xf
    v_dot2c_f32_bf16_dpp v15, v34, v98 row_newbcast:8 row_mask:0xf bank_mask:0xf
    v_dot2c_f32_bf16_dpp v16, v26, v99 row_newbcast:8 row_mask:0xf bank_mask:0xf
    v_dot2c_f32_bf16_dpp v17, v34, v99 row_newbcast:8 row_mask:0xf bank_mask:0xf
    buffer_load_dwordx4 v[124:127], v1, s[36:39], s70 offen nt
    s_add_u32 s70, s70, 0x9000
    v_perm_b32 v139, v148, v144, s82
    v_perm_b32 v148, v148, v144, s83
    s_waitcnt vmcnt(6)
    v_dot2c_f32_bf16_dpp v10, v26, v100 row_newbcast:9 row_mask:0xf bank_mask:0xf
    v_dot2c_f32_bf16_dpp v11, v34, v100 row_newbcast:9 row_mask:0xf bank_mask:0xf
    v_dot2c_f32_bf16_dpp v12, v26, v101 row_newbcast:9 row_mask:0xf bank_mask:0xf
    v_dot2c_f32_bf16_dpp v13, v34, v101 row_newbcast:9 row_mask:0xf bank_mask:0xf
    v_dot2c_f32_bf16_dpp v14, v26, v102 row_newbcast:9 row_mask:0xf bank_mask:0xf
    v_dot2c_f32_bf16_dpp v15, v34, v102 row_newbcast:9 row_mask:0xf bank_mask:0xf
    v_dot2c_f32_bf16_dpp v16, v26, v103 row_newbcast:9 row_mask:0xf bank_mask:0xf
    v_dot2c_f32_bf16_dpp v17, v34, v103 row_newbcast:9 row_mask:0xf bank_mask:0xf
    buffer_load_dwordx4 v[64:67], v1, s[36:39], s70 offen nt
    s_add_u32 s70, s70, 0x1000
    v_perm_b32 v144, v149, v145, s82
    v_perm_b32 v149, v149, v145, s83
    s_waitcnt vmcnt(6)
    v_dot2c_f32_bf16_dpp v10, v26, v104 row_newbcast:10 row_mask:0xf bank_mask:0xf
    v_dot2c_f32_bf16_dpp v11, v34, v104 row_newbcast:10 row_mask:0xf bank_mask:0xf
    v_dot2c_f32_bf16_dpp v12, v26, v105 row_newbcast:10 row_mask:0xf bank_mask:0xf
    v_dot2c_f32_bf16_dpp v13, v34, v105 row_newbcast:10 row_mask:0xf bank_mask:0xf
    v_dot2c_f32_bf16_dpp v14, v26, v106 row_newbcast:10 row_mask:0xf bank_mask:0xf
    v_dot2c_f32_bf16_dpp v15, v34, v106 row_newbcast:10 row_mask:0xf bank_mask:0xf
    v_dot2c_f32_bf16_dpp v16, v26, v107 row_newbcast:10 row_mask:0xf bank_mask:0xf
    v_dot2c_f32_bf16_dpp v17, v34, v107 row_newbcast:10 row_mask:0xf bank_mask:0xf
    buffer_load_dwordx4 v[68:71], v1, s[36:39], s70 offen nt
    s_add_u32 s70, s70, 0x1000
    v_perm_b32 v145, v150, v146, s82
    v_perm_b32 v150, v150, v146, s83
    s_waitcnt vmcnt(6)
    v_dot2c_f32_bf16_dpp v10, v26, v108 row_newbcast:11 row_mask:0xf bank_mask:0xf
    v_dot2c_f32_bf16_dpp v11, v34, v108 row_newbcast:11 row_mask:0xf bank_mask:0xf
    v_dot2c_f32_bf16_dpp v12, v26, v109 row_newbcast:11 row_mask:0xf bank_mask:0xf
    v_dot2c_f32_bf16_dpp v13, v34, v109 row_newbcast:11 row_mask:0xf bank_mask:0xf
    v_dot2c_f32_bf16_dpp v14, v26, v110 row_newbcast:11 row_mask:0xf bank_mask:0xf
    v_dot2c_f32_bf16_dpp v15, v34, v110 row_newbcast:11 row_mask:0xf bank_mask:0xf
    v_dot2c_f32_bf16_dpp v16, v26, v111 row_newbcast:11 row_mask:0xf bank_mask:0xf
    v_dot2c_f32_bf16_dpp v17, v34, v111 row_newbcast:11 row_mask:0xf bank_mask:0xf
    buffer_load_dwordx4 v[72:75], v1, s[36:39], s70 offen nt
    s_add_u32 s70, s70, 0x1000
    v_perm_b32 v146, v151, v147, s82
    v_perm_b32 v151, v151, v147, s83
    s_waitcnt vmcnt(6)
    v_dot2c_f32_bf16_dpp v10, v26, v112 row_newbcast:12 row_mask:0xf bank_mask:0xf
    v_dot2c_f32_bf16_dpp v11, v34, v112 row_newbcast:12 row_mask:0xf bank_mask:0xf
    v_dot2c_f32_bf16_dpp v12, v26, v113 row_newbcast:12 row_mask:0xf bank_mask:0xf
    v_dot2c_f32_bf16_dpp v13, v34, v113 row_newbcast:12 row_mask:0xf bank_mask:0xf
    v_dot2c_f32_bf16_dpp v14, v26, v114 row_newbcast:12 row_mask:0xf bank_mask:0xf
    v_dot2c_f32_bf16_dpp v15, v34, v114 row_newbcast:12 row_mask:0xf bank_mask:0xf
    v_dot2c_f32_bf16_dpp v16, v26, v115 row_newbcast:12 row_mask:0xf bank_mask:0xf
    v_dot2c_f32_bf16_dpp v17, v34, v115 row_newbcast:12 row_mask:0xf bank_mask:0xf
    buffer_load_dwordx4 v[76:79], v1, s[36:39], s70 offen nt
    s_add_u32 s70, s70, 0x1000
    v_perm_b32 v147, v156, v152, s82
    v_perm_b32 v156, v156, v152, s83
    s_waitcnt vmcnt(6)
    v_dot2c_f32_bf16_dpp v10, v26, v116 row_newbcast:13 row_mask:0xf bank_mask:0xf
    v_dot2c_f32_bf16_dpp v11, v34, v116 row_newbcast:13 row_mask:0xf bank_mask:0xf
    v_dot2c_f32_bf16_dpp v12, v26, v117 row_newbcast:13 row_mask:0xf bank_mask:0xf
    v_dot2c_f32_bf16_dpp v13, v34, v117 row_newbcast:13 row_mask:0xf bank_mask:0xf
    v_dot2c_f32_bf16_dpp v14, v26, v118 row_newbcast:13 row_mask:0xf bank_mask:0xf
    v_dot2c_f32_bf16_dpp v15, v34, v118 row_newbcast:13 row_mask:0xf bank_mask:0xf
    v_dot2c_f32_bf16_dpp v16, v26, v119 row_newbcast:13 row_mask:0xf bank_mask:0xf
    v_dot2c_f32_bf16_dpp v17, v34, v119 row_newbcast:13 row_mask:0xf bank_mask:0xf
    buffer_load_dwordx4 v[80:83], v1, s[36:39], s70 offen nt
    s_add_u32 s70, s70, 0x1000
    v_perm_b32 v152, v157, v153, s82
    v_perm_b32 v157, v157, v153, s83
    s_waitcnt vmcnt(6)
    v_dot2c_f32_bf16_dpp v10, v26, v120 row_newbcast:14 row_mask:0xf bank_mask:0xf
    v_dot2c_f32_bf16_dpp v11, v34, v120 row_newbcast:14 row_mask:0xf bank_mask:0xf
    v_dot2c_f32_bf16_dpp v12, v26, v121 row_newbcast:14 row_mask:0xf bank_mask:0xf
    v_dot2c_f32_bf16_dpp v13, v34, v121 row_newbcast:14 row_mask:0xf bank_mask:0xf
    v_dot2c_f32_bf16_dpp v14, v26, v122 row_newbcast:14 row_mask:0xf bank_mask:0xf
    v_dot2c_f32_bf16_dpp v15, v34, v122 row_newbcast:14 row_mask:0xf bank_mask:0xf
    v_dot2c_f32_bf16_dpp v16, v26, v123 row_newbcast:14 row_mask:0xf bank_mask:0xf
    v_dot2c_f32_bf16_dpp v17, v34, v123 row_newbcast:14 row_mask:0xf bank_mask:0xf
    buffer_load_dwordx4 v[84:87], v1, s[36:39], s70 offen nt
    s_add_u32 s70, s70, 0x1000
    v_perm_b32 v153, v158, v154, s82
    v_perm_b32 v158, v158, v154, s83
    s_waitcnt vmcnt(6)
    v_dot2c_f32_bf16_dpp v10, v26, v124 row_newbcast:15 row_mask:0xf bank_mask:0xf
    v_dot2c_f32_bf16_dpp v11, v34, v124 row_newbcast:15 row_mask:0xf bank_mask:0xf
    v_dot2c_f32_bf16_dpp v12, v26, v125 row_newbcast:15 row_mask:0xf bank_mask:0xf
    v_dot2c_f32_bf16_dpp v13, v34, v125 row_newbcast:15 row_mask:0xf bank_mask:0xf
    v_dot2c_f32_bf16_dpp v14, v26, v126 row_newbcast:15 row_mask:0xf bank_mask:0xf
    v_dot2c_f32_bf16_dpp v15, v34, v126 row_newbcast:15 row_mask:0xf bank_mask:0xf
    v_dot2c_f32_bf16_dpp v16, v26, v127 row_newbcast:15 row_mask:0xf bank_mask:0xf
    v_dot2c_f32_bf16_dpp v17, v34, v127 row_newbcast:15 row_mask:0xf bank_mask:0xf
    buffer_load_dwordx4 v[88:91], v1, s[36:39], s70 offen nt
    s_add_u32 s70, s70, 0x1000
    v_perm_b32 v154, v159, v155, s82
    v_perm_b32 v159, v159, v155, s83
    s_waitcnt vmcnt(6)
    v_dot2c_f32_bf16_dpp v10, v27, v64 row_newbcast:0 row_mask:0xf bank_mask:0xf
    v_dot2c_f32_bf16_dpp v11, v35, v64 row_newbcast:0 row_mask:0xf bank_mask:0xf
    v_dot2c_f32_bf16_dpp v12, v27, v65 row_newbcast:0 row_mask:0xf bank_mask:0xf
    v_dot2c_f32_bf16_dpp v13, v35, v65 row_newbcast:0 row_mask:0xf bank_mask:0xf
    v_dot2c_f32_bf16_dpp v14, v27, v66 row_newbcast:0 row_mask:0xf bank_mask:0xf
    v_dot2c_f32_bf16_dpp v15, v35, v66 row_newbcast:0 row_mask:0xf bank_mask:0xf
    v_dot2c_f32_bf16_dpp v16, v27, v67 row_newbcast:0 row_mask:0xf bank_mask:0xf
    v_dot2c_f32_bf16_dpp v17, v35, v67 row_newbcast:0 row_mask:0xf bank_mask:0xf
    buffer_load_dwordx4 v[92:95], v1, s[36:39], s70 offen nt
    s_add_u32 s70, s70, 0x9000
    v_perm_b32 v155, v164, v160, s82
    v_perm_b32 v164, v164, v160, s83
    s_waitcnt vmcnt(6)
    v_dot2c_f32_bf16_dpp v10, v27, v68 row_newbcast:1 row_mask:0xf bank_mask:0xf
    v_dot2c_f32_bf16_dpp v11, v35, v68 row_newbcast:1 row_mask:0xf bank_mask:0xf
    v_dot2c_f32_bf16_dpp v12, v27, v69 row_newbcast:1 row_mask:0xf bank_mask:0xf
    v_dot2c_f32_bf16_dpp v13, v35, v69 row_newbcast:1 row_mask:0xf bank_mask:0xf
    v_dot2c_f32_bf16_dpp v14, v27, v70 row_newbcast:1 row_mask:0xf bank_mask:0xf
    v_dot2c_f32_bf16_dpp v15, v35, v70 row_newbcast:1 row_mask:0xf bank_mask:0xf
    v_dot2c_f32_bf16_dpp v16, v27, v71 row_newbcast:1 row_mask:0xf bank_mask:0xf
    v_dot2c_f32_bf16_dpp v17, v35, v71 row_newbcast:1 row_mask:0xf bank_mask:0xf
    buffer_load_dwordx4 v[96:99], v1, s[36:39], s70 offen nt
    s_add_u32 s70, s70, 0x1000
    v_perm_b32 v160, v165, v161, s82
    v_perm_b32 v165, v165, v161, s83
    s_waitcnt vmcnt(6)
    v_dot2c_f32_bf16_dpp v10, v27, v72 row_newbcast:2 row_mask:0xf bank_mask:0xf
    v_dot2c_f32_bf16_dpp v11, v35, v72 row_newbcast:2 row_mask:0xf bank_mask:0xf
    v_dot2c_f32_bf16_dpp v12, v27, v73 row_newbcast:2 row_mask:0xf bank_mask:0xf
    v_dot2c_f32_bf16_dpp v13, v35, v73 row_newbcast:2 row_mask:0xf bank_mask:0xf
    v_dot2c_f32_bf16_dpp v14, v27, v74 row_newbcast:2 row_mask:0xf bank_mask:0xf
    v_dot2c_f32_bf16_dpp v15, v35, v74 row_newbcast:2 row_mask:0xf bank_mask:0xf
    v_dot2c_f32_bf16_dpp v16, v27, v75 row_newbcast:2 row_mask:0xf bank_mask:0xf
    v_dot2c_f32_bf16_dpp v17, v35, v75 row_newbcast:2 row_mask:0xf bank_mask:0xf
    buffer_load_dwordx4 v[100:103], v1, s[36:39], s70 offen nt
    s_add_u32 s70, s70, 0x1000
    v_perm_b32 v161, v166, v162, s82
    v_perm_b32 v166, v166, v162, s83
    s_waitcnt vmcnt(6)
    v_dot2c_f32_bf16_dpp v10, v27, v76 row_newbcast:3 row_mask:0xf bank_mask:0xf
    v_dot2c_f32_bf16_dpp v11, v35, v76 row_newbcast:3 row_mask:0xf bank_mask:0xf
    v_dot2c_f32_bf16_dpp v12, v27, v77 row_newbcast:3 row_mask:0xf bank_mask:0xf
    v_dot2c_f32_bf16_dpp v13, v35, v77 row_newbcast:3 row_mask:0xf bank_mask:0xf
    v_dot2c_f32_bf16_dpp v14, v27, v78 row_newbcast:3 row_mask:0xf bank_mask:0xf
    v_dot2c_f32_bf16_dpp v15, v35, v78 row_newbcast:3 row_mask:0xf bank_mask:0xf
    v_dot2c_f32_bf16_dpp v16, v27, v79 row_newbcast:3 row_mask:0xf bank_mask:0xf
    v_dot2c_f32_bf16_dpp v17, v35, v79 row_newbcast:3 row_mask:0xf bank_mask:0xf
    buffer_load_dwordx4 v[104:107], v1, s[36:39], s70 offen nt
    s_add_u32 s70, s70, 0x1000
    v_perm_b32 v162, v167, v163, s82
    v_perm_b32 v167, v167, v163, s83
    s_waitcnt vmcnt(6)
    v_dot2c_f32_bf16_dpp v10, v27, v80 row_newbcast:4 row_mask:0xf bank_mask:0xf
    v_dot2c_f32_bf16_dpp v11, v35, v80 row_newbcast:4 row_mask:0xf bank_mask:0xf
    v_dot2c_f32_bf16_dpp v12, v27, v81 row_newbcast:4 row_mask:0xf bank_mask:0xf
    v_dot2c_f32_bf16_dpp v13, v35, v81 row_newbcast:4 row_mask:0xf bank_mask:0xf
    v_dot2c_f32_bf16_dpp v14, v27, v82 row_newbcast:4 row_mask:0xf bank_mask:0xf
    v_dot2c_f32_bf16_dpp v15, v35, v82 row_newbcast:4 row_mask:0xf bank_mask:0xf
    v_dot2c_f32_bf16_dpp v16, v27, v83 row_newbcast:4 row_mask:0xf bank_mask:0xf
    v_dot2c_f32_bf16_dpp v17, v35, v83 row_newbcast:4 row_mask:0xf bank_mask:0xf
    buffer_load_dwordx4 v[108:111], v1, s[36:39], s70 offen nt
    s_add_u32 s70, s70, 0x1000
    v_perm_b32 v163, v172, v168, s82
    v_perm_b32 v172, v172, v168, s83
    s_waitcnt vmcnt(6)
    v_dot2c_f32_bf16_dpp v10, v27, v84 row_newbcast:5 row_mask:0xf bank_mask:0xf
    v_dot2c_f32_bf16_dpp v11, v35, v84 row_newbcast:5 row_mask:0xf bank_mask:0xf
    v_dot2c_f32_bf16_dpp v12, v27, v85 row_newbcast:5 row_mask:0xf bank_mask:0xf
    v_dot2c_f32_bf16_dpp v13, v35, v85 row_newbcast:5 row_mask:0xf bank_mask:0xf
    v_dot2c_f32_bf16_dpp v14, v27, v86 row_newbcast:5 row_mask:0xf bank_mask:0xf
    v_dot2c_f32_bf16_dpp v15, v35, v86 row_newbcast:5 row_mask:0xf bank_mask:0xf
    v_dot2c_f32_bf16_dpp v16, v27, v87 row_newbcast:5 row_mask:0xf bank_mask:0xf
    v_dot2c_f32_bf16_dpp v17, v35, v87 row_newbcast:5 row_mask:0xf bank_mask:0xf
    buffer_load_dwordx4 v[112:115], v1, s[36:39], s70 offen nt
    s_add_u32 s70, s70, 0x1000
    v_perm_b32 v168, v173, v169, s82
    v_perm_b32 v173, v173, v169, s83
    s_waitcnt vmcnt(6)
    v_dot2c_f32_bf16_dpp v10, v27, v88 row_newbcast:6 row_mask:0xf bank_mask:0xf
    v_dot2c_f32_bf16_dpp v11, v35, v88 row_newbcast:6 row_mask:0xf bank_mask:0xf
    v_dot2c_f32_bf16_dpp v12, v27, v89 row_newbcast:6 row_mask:0xf bank_mask:0xf
    v_dot2c_f32_bf16_dpp v13, v35, v89 row_newbcast:6 row_mask:0xf bank_mask:0xf
    v_dot2c_f32_bf16_dpp v14, v27, v90 row_newbcast:6 row_mask:0xf bank_mask:0xf
    v_dot2c_f32_bf16_dpp v15, v35, v90 row_newbcast:6 row_mask:0xf bank_mask:0xf
    v_dot2c_f32_bf16_dpp v16, v27, v91 row_newbcast:6 row_mask:0xf bank_mask:0xf
    v_dot2c_f32_bf16_dpp v17, v35, v91 row_newbcast:6 row_mask:0xf bank_mask:0xf
    buffer_load_dwordx4 v[116:119], v1, s[36:39], s70 offen nt
    s_add_u32 s70, s70, 0x1000
    v_perm_b32 v169, v174, v170, s82
    v_perm_b32 v174, v174, v170, s83
    s_waitcnt vmcnt(6)
    v_dot2c_f32_bf16_dpp v10, v27, v92 row_newbcast:7 row_mask:0xf bank_mask:0xf
    v_dot2c_f32_bf16_dpp v11, v35, v92 row_newbcast:7 row_mask:0xf bank_mask:0xf
    v_dot2c_f32_bf16_dpp v12, v27, v93 row_newbcast:7 row_mask:0xf bank_mask:0xf
    v_dot2c_f32_bf16_dpp v13, v35, v93 row_newbcast:7 row_mask:0xf bank_mask:0xf
    v_dot2c_f32_bf16_dpp v14, v27, v94 row_newbcast:7 row_mask:0xf bank_mask:0xf
    v_dot2c_f32_bf16_dpp v15, v35, v94 row_newbcast:7 row_mask:0xf bank_mask:0xf
    v_dot2c_f32_bf16_dpp v16, v27, v95 row_newbcast:7 row_mask:0xf bank_mask:0xf
    v_dot2c_f32_bf16_dpp v17, v35, v95 row_newbcast:7 row_mask:0xf bank_mask:0xf
    buffer_load_dwordx4 v[120:123], v1, s[36:39], s70 offen nt
    s_add_u32 s70, s70, 0x1000
    v_perm_b32 v170, v175, v171, s82
    v_perm_b32 v175, v175, v171, s83
    s_waitcnt vmcnt(6)
    v_dot2c_f32_bf16_dpp v10, v27, v96 row_newbcast:8 row_mask:0xf bank_mask:0xf
    v_dot2c_f32_bf16_dpp v11, v35, v96 row_newbcast:8 row_mask:0xf bank_mask:0xf
    v_dot2c_f32_bf16_dpp v12, v27, v97 row_newbcast:8 row_mask:0xf bank_mask:0xf
    v_dot2c_f32_bf16_dpp v13, v35, v97 row_newbcast:8 row_mask:0xf bank_mask:0xf
    v_dot2c_f32_bf16_dpp v14, v27, v98 row_newbcast:8 row_mask:0xf bank_mask:0xf
    v_dot2c_f32_bf16_dpp v15, v35, v98 row_newbcast:8 row_mask:0xf bank_mask:0xf
    v_dot2c_f32_bf16_dpp v16, v27, v99 row_newbcast:8 row_mask:0xf bank_mask:0xf
    v_dot2c_f32_bf16_dpp v17, v35, v99 row_newbcast:8 row_mask:0xf bank_mask:0xf
    buffer_load_dwordx4 v[124:127], v1, s[36:39], s70 offen nt
    s_add_u32 s70, s70, 0x9000
    v_perm_b32 v171, v180, v176, s82
    v_perm_b32 v180, v180, v176, s83
    s_waitcnt vmcnt(6)
    v_dot2c_f32_bf16_dpp v10, v27, v100 row_newbcast:9 row_mask:0xf bank_mask:0xf
    v_dot2c_f32_bf16_dpp v11, v35, v100 row_newbcast:9 row_mask:0xf bank_mask:0xf
    v_dot2c_f32_bf16_dpp v12, v27, v101 row_newbcast:9 row_mask:0xf bank_mask:0xf
    v_dot2c_f32_bf16_dpp v13, v35, v101 row_newbcast:9 row_mask:0xf bank_mask:0xf
    v_dot2c_f32_bf16_dpp v14, v27, v102 row_newbcast:9 row_mask:0xf bank_mask:0xf
    v_dot2c_f32_bf16_dpp v15, v35, v102 row_newbcast:9 row_mask:0xf bank_mask:0xf
    v_dot2c_f32_bf16_dpp v16, v27, v103 row_newbcast:9 row_mask:0xf bank_mask:0xf
    v_dot2c_f32_bf16_dpp v17, v35, v103 row_newbcast:9 row_mask:0xf bank_mask:0xf
    buffer_load_dwordx4 v[64:67], v1, s[36:39], s70 offen nt
    s_add_u32 s70, s70, 0x1000
    v_perm_b32 v176, v181, v177, s82
    v_perm_b32 v181, v181, v177, s83
    s_waitcnt vmcnt(6)
    v_dot2c_f32_bf16_dpp v10, v27, v104 row_newbcast:10 row_mask:0xf bank_mask:0xf
    v_dot2c_f32_bf16_dpp v11, v35, v104 row_newbcast:10 row_mask:0xf bank_mask:0xf
    v_dot2c_f32_bf16_dpp v12, v27, v105 row_newbcast:10 row_mask:0xf bank_mask:0xf
    v_dot2c_f32_bf16_dpp v13, v35, v105 row_newbcast:10 row_mask:0xf bank_mask:0xf
    v_dot2c_f32_bf16_dpp v14, v27, v106 row_newbcast:10 row_mask:0xf bank_mask:0xf
    v_dot2c_f32_bf16_dpp v15, v35, v106 row_newbcast:10 row_mask:0xf bank_mask:0xf
    v_dot2c_f32_bf16_dpp v16, v27, v107 row_newbcast:10 row_mask:0xf bank_mask:0xf
    v_dot2c_f32_bf16_dpp v17, v35, v107 row_newbcast:10 row_mask:0xf bank_mask:0xf
    buffer_load_dwordx4 v[68:71], v1, s[36:39], s70 offen nt
    s_add_u32 s70, s70, 0x1000
    v_perm_b32 v177, v182, v178, s82
    v_perm_b32 v182, v182, v178, s83
    s_waitcnt vmcnt(6)
    v_dot2c_f32_bf16_dpp v10, v27, v108 row_newbcast:11 row_mask:0xf bank_mask:0xf
    v_dot2c_f32_bf16_dpp v11, v35, v108 row_newbcast:11 row_mask:0xf bank_mask:0xf
    v_dot2c_f32_bf16_dpp v12, v27, v109 row_newbcast:11 row_mask:0xf bank_mask:0xf
    v_dot2c_f32_bf16_dpp v13, v35, v109 row_newbcast:11 row_mask:0xf bank_mask:0xf
    v_dot2c_f32_bf16_dpp v14, v27, v110 row_newbcast:11 row_mask:0xf bank_mask:0xf
    v_dot2c_f32_bf16_dpp v15, v35, v110 row_newbcast:11 row_mask:0xf bank_mask:0xf
    v_dot2c_f32_bf16_dpp v16, v27, v111 row_newbcast:11 row_mask:0xf bank_mask:0xf
    v_dot2c_f32_bf16_dpp v17, v35, v111 row_newbcast:11 row_mask:0xf bank_mask:0xf
    buffer_load_dwordx4 v[72:75], v1, s[36:39], s70 offen nt
    s_add_u32 s70, s70, 0x1000
    v_perm_b32 v178, v183, v179, s82
    v_perm_b32 v183, v183, v179, s83
    s_waitcnt vmcnt(6)
    v_dot2c_f32_bf16_dpp v10, v27, v112 row_newbcast:12 row_mask:0xf bank_mask:0xf
    v_dot2c_f32_bf16_dpp v11, v35, v112 row_newbcast:12 row_mask:0xf bank_mask:0xf
    v_dot2c_f32_bf16_dpp v12, v27, v113 row_newbcast:12 row_mask:0xf bank_mask:0xf
    v_dot2c_f32_bf16_dpp v13, v35, v113 row_newbcast:12 row_mask:0xf bank_mask:0xf
    v_dot2c_f32_bf16_dpp v14, v27, v114 row_newbcast:12 row_mask:0xf bank_mask:0xf
    v_dot2c_f32_bf16_dpp v15, v35, v114 row_newbcast:12 row_mask:0xf bank_mask:0xf
    v_dot2c_f32_bf16_dpp v16, v27, v115 row_newbcast:12 row_mask:0xf bank_mask:0xf
    v_dot2c_f32_bf16_dpp v17, v35, v115 row_newbcast:12 row_mask:0xf bank_mask:0xf
    buffer_load_dwordx4 v[76:79], v1, s[36:39], s70 offen nt
    s_add_u32 s70, s70, 0x1000
    v_perm_b32 v179, v188, v184, s82
    v_perm_b32 v188, v188, v184, s83
    s_waitcnt vmcnt(6)
    v_dot2c_f32_bf16_dpp v10, v27, v116 row_newbcast:13 row_mask:0xf bank_mask:0xf
    v_dot2c_f32_bf16_dpp v11, v35, v116 row_newbcast:13 row_mask:0xf bank_mask:0xf
    v_dot2c_f32_bf16_dpp v12, v27, v117 row_newbcast:13 row_mask:0xf bank_mask:0xf
    v_dot2c_f32_bf16_dpp v13, v35, v117 row_newbcast:13 row_mask:0xf bank_mask:0xf
    v_dot2c_f32_bf16_dpp v14, v27, v118 row_newbcast:13 row_mask:0xf bank_mask:0xf
    v_dot2c_f32_bf16_dpp v15, v35, v118 row_newbcast:13 row_mask:0xf bank_mask:0xf
    v_dot2c_f32_bf16_dpp v16, v27, v119 row_newbcast:13 row_mask:0xf bank_mask:0xf
    v_dot2c_f32_bf16_dpp v17, v35, v119 row_newbcast:13 row_mask:0xf bank_mask:0xf
    buffer_load_dwordx4 v[80:83], v1, s[36:39], s70 offen nt
    s_add_u32 s70, s70, 0x1000
    v_perm_b32 v184, v189, v185, s82
    v_perm_b32 v189, v189, v185, s83
    s_waitcnt vmcnt(6)
    v_dot2c_f32_bf16_dpp v10, v27, v120 row_newbcast:14 row_mask:0xf bank_mask:0xf
    v_dot2c_f32_bf16_dpp v11, v35, v120 row_newbcast:14 row_mask:0xf bank_mask:0xf
    v_dot2c_f32_bf16_dpp v12, v27, v121 row_newbcast:14 row_mask:0xf bank_mask:0xf
    v_dot2c_f32_bf16_dpp v13, v35, v121 row_newbcast:14 row_mask:0xf bank_mask:0xf
    v_dot2c_f32_bf16_dpp v14, v27, v122 row_newbcast:14 row_mask:0xf bank_mask:0xf
    v_dot2c_f32_bf16_dpp v15, v35, v122 row_newbcast:14 row_mask:0xf bank_mask:0xf
    v_dot2c_f32_bf16_dpp v16, v27, v123 row_newbcast:14 row_mask:0xf bank_mask:0xf
    v_dot2c_f32_bf16_dpp v17, v35, v123 row_newbcast:14 row_mask:0xf bank_mask:0xf
    buffer_load_dwordx4 v[84:87], v1, s[36:39], s70 offen nt
    s_add_u32 s70, s70, 0x1000
    v_perm_b32 v185, v190, v186, s82
    v_perm_b32 v190, v190, v186, s83
    s_waitcnt vmcnt(6)
    v_dot2c_f32_bf16_dpp v10, v27, v124 row_newbcast:15 row_mask:0xf bank_mask:0xf
    v_dot2c_f32_bf16_dpp v11, v35, v124 row_newbcast:15 row_mask:0xf bank_mask:0xf
    v_dot2c_f32_bf16_dpp v12, v27, v125 row_newbcast:15 row_mask:0xf bank_mask:0xf
    v_dot2c_f32_bf16_dpp v13, v35, v125 row_newbcast:15 row_mask:0xf bank_mask:0xf
    v_dot2c_f32_bf16_dpp v14, v27, v126 row_newbcast:15 row_mask:0xf bank_mask:0xf
    v_dot2c_f32_bf16_dpp v15, v35, v126 row_newbcast:15 row_mask:0xf bank_mask:0xf
    v_dot2c_f32_bf16_dpp v16, v27, v127 row_newbcast:15 row_mask:0xf bank_mask:0xf
    v_dot2c_f32_bf16_dpp v17, v35, v127 row_newbcast:15 row_mask:0xf bank_mask:0xf
    buffer_load_dwordx4 v[88:91], v1, s[36:39], s70 offen nt
    s_add_u32 s70, s70, 0x1000
    v_perm_b32 v186, v191, v187, s82
    v_perm_b32 v191, v191, v187, s83
    s_waitcnt vmcnt(6)
    v_dot2c_f32_bf16_dpp v10, v28, v64 row_newbcast:0 row_mask:0xf bank_mask:0xf
    v_dot2c_f32_bf16_dpp v11, v36, v64 row_newbcast:0 row_mask:0xf bank_mask:0xf
    v_dot2c_f32_bf16_dpp v12, v28, v65 row_newbcast:0 row_mask:0xf bank_mask:0xf
    v_dot2c_f32_bf16_dpp v13, v36, v65 row_newbcast:0 row_mask:0xf bank_mask:0xf
    v_dot2c_f32_bf16_dpp v14, v28, v66 row_newbcast:0 row_mask:0xf bank_mask:0xf
    v_dot2c_f32_bf16_dpp v15, v36, v66 row_newbcast:0 row_mask:0xf bank_mask:0xf
    v_dot2c_f32_bf16_dpp v16, v28, v67 row_newbcast:0 row_mask:0xf bank_mask:0xf
    v_dot2c_f32_bf16_dpp v17, v36, v67 row_newbcast:0 row_mask:0xf bank_mask:0xf
    buffer_load_dwordx4 v[92:95], v1, s[36:39], s70 offen nt
    s_add_u32 s70, s70, 0x9000
    v_perm_b32 v187, v196, v192, s82
    v_perm_b32 v196, v196, v192, s83
    s_waitcnt vmcnt(6)
    v_dot2c_f32_bf16_dpp v10, v28, v68 row_newbcast:1 row_mask:0xf bank_mask:0xf
    v_dot2c_f32_bf16_dpp v11, v36, v68 row_newbcast:1 row_mask:0xf bank_mask:0xf
    v_dot2c_f32_bf16_dpp v12, v28, v69 row_newbcast:1 row_mask:0xf bank_mask:0xf
    v_dot2c_f32_bf16_dpp v13, v36, v69 row_newbcast:1 row_mask:0xf bank_mask:0xf
    v_dot2c_f32_bf16_dpp v14, v28, v70 row_newbcast:1 row_mask:0xf bank_mask:0xf
    v_dot2c_f32_bf16_dpp v15, v36, v70 row_newbcast:1 row_mask:0xf bank_mask:0xf
    v_dot2c_f32_bf16_dpp v16, v28, v71 row_newbcast:1 row_mask:0xf bank_mask:0xf
    v_dot2c_f32_bf16_dpp v17, v36, v71 row_newbcast:1 row_mask:0xf bank_mask:0xf
    buffer_load_dwordx4 v[96:99], v1, s[36:39], s70 offen nt
    s_add_u32 s70, s70, 0x1000
    v_perm_b32 v192, v197, v193, s82
    v_perm_b32 v197, v197, v193, s83
    s_waitcnt vmcnt(6)
    v_dot2c_f32_bf16_dpp v10, v28, v72 row_newbcast:2 row_mask:0xf bank_mask:0xf
    v_dot2c_f32_bf16_dpp v11, v36, v72 row_newbcast:2 row_mask:0xf bank_mask:0xf
    v_dot2c_f32_bf16_dpp v12, v28, v73 row_newbcast:2 row_mask:0xf bank_mask:0xf
    v_dot2c_f32_bf16_dpp v13, v36, v73 row_newbcast:2 row_mask:0xf bank_mask:0xf
    v_dot2c_f32_bf16_dpp v14, v28, v74 row_newbcast:2 row_mask:0xf bank_mask:0xf
    v_dot2c_f32_bf16_dpp v15, v36, v74 row_newbcast:2 row_mask:0xf bank_mask:0xf
    v_dot2c_f32_bf16_dpp v16, v28, v75 row_newbcast:2 row_mask:0xf bank_mask:0xf
    v_dot2c_f32_bf16_dpp v17, v36, v75 row_newbcast:2 row_mask:0xf bank_mask:0xf
    buffer_load_dwordx4 v[100:103], v1, s[36:39], s70 offen nt
    s_add_u32 s70, s70, 0x1000
    v_perm_b32 v193, v198, v194, s82
    v_perm_b32 v198, v198, v194, s83
    s_waitcnt vmcnt(6)
    v_dot2c_f32_bf16_dpp v10, v28, v76 row_newbcast:3 row_mask:0xf bank_mask:0xf
    v_dot2c_f32_bf16_dpp v11, v36, v76 row_newbcast:3 row_mask:0xf bank_mask:0xf
    v_dot2c_f32_bf16_dpp v12, v28, v77 row_newbcast:3 row_mask:0xf bank_mask:0xf
    v_dot2c_f32_bf16_dpp v13, v36, v77 row_newbcast:3 row_mask:0xf bank_mask:0xf
    v_dot2c_f32_bf16_dpp v14, v28, v78 row_newbcast:3 row_mask:0xf bank_mask:0xf
    v_dot2c_f32_bf16_dpp v15, v36, v78 row_newbcast:3 row_mask:0xf bank_mask:0xf
    v_dot2c_f32_bf16_dpp v16, v28, v79 row_newbcast:3 row_mask:0xf bank_mask:0xf
    v_dot2c_f32_bf16_dpp v17, v36, v79 row_newbcast:3 row_mask:0xf bank_mask:0xf
    buffer_load_dwordx4 v[104:107], v1, s[36:39], s70 offen nt
    s_add_u32 s70, s70, 0x1000
    v_perm_b32 v194, v199, v195, s82
    v_perm_b32 v199, v199, v195, s83
    s_waitcnt vmcnt(6)
    v_dot2c_f32_bf16_dpp v10, v28, v80 row_newbcast:4 row_mask:0xf bank_mask:0xf
    v_dot2c_f32_bf16_dpp v11, v36, v80 row_newbcast:4 row_mask:0xf bank_mask:0xf
    v_dot2c_f32_bf16_dpp v12, v28, v81 row_newbcast:4 row_mask:0xf bank_mask:0xf
    v_dot2c_f32_bf16_dpp v13, v36, v81 row_newbcast:4 row_mask:0xf bank_mask:0xf
    v_dot2c_f32_bf16_dpp v14, v28, v82 row_newbcast:4 row_mask:0xf bank_mask:0xf
    v_dot2c_f32_bf16_dpp v15, v36, v82 row_newbcast:4 row_mask:0xf bank_mask:0xf
    v_dot2c_f32_bf16_dpp v16, v28, v83 row_newbcast:4 row_mask:0xf bank_mask:0xf
    v_dot2c_f32_bf16_dpp v17, v36, v83 row_newbcast:4 row_mask:0xf bank_mask:0xf
    buffer_load_dwordx4 v[108:111], v1, s[36:39], s70 offen nt
    s_add_u32 s70, s70, 0x1000
    v_perm_b32 v195, v204, v200, s82
    v_perm_b32 v204, v204, v200, s83
    s_waitcnt vmcnt(6)
    v_dot2c_f32_bf16_dpp v10, v28, v84 row_newbcast:5 row_mask:0xf bank_mask:0xf
    v_dot2c_f32_bf16_dpp v11, v36, v84 row_newbcast:5 row_mask:0xf bank_mask:0xf
    v_dot2c_f32_bf16_dpp v12, v28, v85 row_newbcast:5 row_mask:0xf bank_mask:0xf
    v_dot2c_f32_bf16_dpp v13, v36, v85 row_newbcast:5 row_mask:0xf bank_mask:0xf
    v_dot2c_f32_bf16_dpp v14, v28, v86 row_newbcast:5 row_mask:0xf bank_mask:0xf
    v_dot2c_f32_bf16_dpp v15, v36, v86 row_newbcast:5 row_mask:0xf bank_mask:0xf
    v_dot2c_f32_bf16_dpp v16, v28, v87 row_newbcast:5 row_mask:0xf bank_mask:0xf
    v_dot2c_f32_bf16_dpp v17, v36, v87 row_newbcast:5 row_mask:0xf bank_mask:0xf
    buffer_load_dwordx4 v[112:115], v1, s[36:39], s70 offen nt
    s_add_u32 s70, s70, 0x1000
    v_perm_b32 v200, v205, v201, s82
    v_perm_b32 v205, v205, v201, s83
    s_waitcnt vmcnt(6)
    v_dot2c_f32_bf16_dpp v10, v28, v88 row_newbcast:6 row_mask:0xf bank_mask:0xf
    v_dot2c_f32_bf16_dpp v11, v36, v88 row_newbcast:6 row_mask:0xf bank_mask:0xf
    v_dot2c_f32_bf16_dpp v12, v28, v89 row_newbcast:6 row_mask:0xf bank_mask:0xf
    v_dot2c_f32_bf16_dpp v13, v36, v89 row_newbcast:6 row_mask:0xf bank_mask:0xf
    v_dot2c_f32_bf16_dpp v14, v28, v90 row_newbcast:6 row_mask:0xf bank_mask:0xf
    v_dot2c_f32_bf16_dpp v15, v36, v90 row_newbcast:6 row_mask:0xf bank_mask:0xf
    v_dot2c_f32_bf16_dpp v16, v28, v91 row_newbcast:6 row_mask:0xf bank_mask:0xf
    v_dot2c_f32_bf16_dpp v17, v36, v91 row_newbcast:6 row_mask:0xf bank_mask:0xf
    buffer_load_dwordx4 v[116:119], v1, s[36:39], s70 offen nt
    s_add_u32 s70, s70, 0x1000
    v_perm_b32 v201, v206, v202, s82
    v_perm_b32 v206, v206, v202, s83
    s_waitcnt vmcnt(6)
    v_dot2c_f32_bf16_dpp v10, v28, v92 row_newbcast:7 row_mask:0xf bank_mask:0xf
    v_dot2c_f32_bf16_dpp v11, v36, v92 row_newbcast:7 row_mask:0xf bank_mask:0xf
    v_dot2c_f32_bf16_dpp v12, v28, v93 row_newbcast:7 row_mask:0xf bank_mask:0xf
    v_dot2c_f32_bf16_dpp v13, v36, v93 row_newbcast:7 row_mask:0xf bank_mask:0xf
    v_dot2c_f32_bf16_dpp v14, v28, v94 row_newbcast:7 row_mask:0xf bank_mask:0xf
    v_dot2c_f32_bf16_dpp v15, v36, v94 row_newbcast:7 row_mask:0xf bank_mask:0xf
    v_dot2c_f32_bf16_dpp v16, v28, v95 row_newbcast:7 row_mask:0xf bank_mask:0xf
    v_dot2c_f32_bf16_dpp v17, v36, v95 row_newbcast:7 row_mask:0xf bank_mask:0xf
    buffer_load_dwordx4 v[120:123], v1, s[36:39], s70 offen nt
    s_add_u32 s70, s70, 0x1000
    v_perm_b32 v202, v207, v203, s82
    v_perm_b32 v207, v207, v203, s83
    s_waitcnt vmcnt(6)
    v_dot2c_f32_bf16_dpp v10, v28, v96 row_newbcast:8 row_mask:0xf bank_mask:0xf
    v_dot2c_f32_bf16_dpp v11, v36, v96 row_newbcast:8 row_mask:0xf bank_mask:0xf
    v_dot2c_f32_bf16_dpp v12, v28, v97 row_newbcast:8 row_mask:0xf bank_mask:0xf
    v_dot2c_f32_bf16_dpp v13, v36, v97 row_newbcast:8 row_mask:0xf bank_mask:0xf
    v_dot2c_f32_bf16_dpp v14, v28, v98 row_newbcast:8 row_mask:0xf bank_mask:0xf
    v_dot2c_f32_bf16_dpp v15, v36, v98 row_newbcast:8 row_mask:0xf bank_mask:0xf
    v_dot2c_f32_bf16_dpp v16, v28, v99 row_newbcast:8 row_mask:0xf bank_mask:0xf
    v_dot2c_f32_bf16_dpp v17, v36, v99 row_newbcast:8 row_mask:0xf bank_mask:0xf
    buffer_load_dwordx4 v[124:127], v1, s[36:39], s70 offen nt
    s_add_u32 s70, s70, 0x9000
    v_perm_b32 v203, v212, v208, s82
    v_perm_b32 v212, v212, v208, s83
    s_waitcnt vmcnt(6)
    v_dot2c_f32_bf16_dpp v10, v28, v100 row_newbcast:9 row_mask:0xf bank_mask:0xf
    v_dot2c_f32_bf16_dpp v11, v36, v100 row_newbcast:9 row_mask:0xf bank_mask:0xf
    v_dot2c_f32_bf16_dpp v12, v28, v101 row_newbcast:9 row_mask:0xf bank_mask:0xf
    v_dot2c_f32_bf16_dpp v13, v36, v101 row_newbcast:9 row_mask:0xf bank_mask:0xf
    v_dot2c_f32_bf16_dpp v14, v28, v102 row_newbcast:9 row_mask:0xf bank_mask:0xf
    v_dot2c_f32_bf16_dpp v15, v36, v102 row_newbcast:9 row_mask:0xf bank_mask:0xf
    v_dot2c_f32_bf16_dpp v16, v28, v103 row_newbcast:9 row_mask:0xf bank_mask:0xf
    v_dot2c_f32_bf16_dpp v17, v36, v103 row_newbcast:9 row_mask:0xf bank_mask:0xf
    buffer_load_dwordx4 v[64:67], v1, s[36:39], s70 offen nt
    s_add_u32 s70, s70, 0x1000
    v_perm_b32 v208, v213, v209, s82
    v_perm_b32 v213, v213, v209, s83
    s_waitcnt vmcnt(6)
    v_dot2c_f32_bf16_dpp v10, v28, v104 row_newbcast:10 row_mask:0xf bank_mask:0xf
    v_dot2c_f32_bf16_dpp v11, v36, v104 row_newbcast:10 row_mask:0xf bank_mask:0xf
    v_dot2c_f32_bf16_dpp v12, v28, v105 row_newbcast:10 row_mask:0xf bank_mask:0xf
    v_dot2c_f32_bf16_dpp v13, v36, v105 row_newbcast:10 row_mask:0xf bank_mask:0xf
    v_dot2c_f32_bf16_dpp v14, v28, v106 row_newbcast:10 row_mask:0xf bank_mask:0xf
    v_dot2c_f32_bf16_dpp v15, v36, v106 row_newbcast:10 row_mask:0xf bank_mask:0xf
    v_dot2c_f32_bf16_dpp v16, v28, v107 row_newbcast:10 row_mask:0xf bank_mask:0xf
    v_dot2c_f32_bf16_dpp v17, v36, v107 row_newbcast:10 row_mask:0xf bank_mask:0xf
    buffer_load_dwordx4 v[68:71], v1, s[36:39], s70 offen nt
    s_add_u32 s70, s70, 0x1000
    v_perm_b32 v209, v214, v210, s82
    v_perm_b32 v214, v214, v210, s83
    s_waitcnt vmcnt(6)
    v_dot2c_f32_bf16_dpp v10, v28, v108 row_newbcast:11 row_mask:0xf bank_mask:0xf
    v_dot2c_f32_bf16_dpp v11, v36, v108 row_newbcast:11 row_mask:0xf bank_mask:0xf
    v_dot2c_f32_bf16_dpp v12, v28, v109 row_newbcast:11 row_mask:0xf bank_mask:0xf
    v_dot2c_f32_bf16_dpp v13, v36, v109 row_newbcast:11 row_mask:0xf bank_mask:0xf
    v_dot2c_f32_bf16_dpp v14, v28, v110 row_newbcast:11 row_mask:0xf bank_mask:0xf
    v_dot2c_f32_bf16_dpp v15, v36, v110 row_newbcast:11 row_mask:0xf bank_mask:0xf
    v_dot2c_f32_bf16_dpp v16, v28, v111 row_newbcast:11 row_mask:0xf bank_mask:0xf
    v_dot2c_f32_bf16_dpp v17, v36, v111 row_newbcast:11 row_mask:0xf bank_mask:0xf
    buffer_load_dwordx4 v[72:75], v1, s[36:39], s70 offen nt
    s_add_u32 s70, s70, 0x1000
    v_perm_b32 v210, v215, v211, s82
    v_perm_b32 v215, v215, v211, s83
    s_waitcnt vmcnt(6)
    v_dot2c_f32_bf16_dpp v10, v28, v112 row_newbcast:12 row_mask:0xf bank_mask:0xf
    v_dot2c_f32_bf16_dpp v11, v36, v112 row_newbcast:12 row_mask:0xf bank_mask:0xf
    v_dot2c_f32_bf16_dpp v12, v28, v113 row_newbcast:12 row_mask:0xf bank_mask:0xf
    v_dot2c_f32_bf16_dpp v13, v36, v113 row_newbcast:12 row_mask:0xf bank_mask:0xf
    v_dot2c_f32_bf16_dpp v14, v28, v114 row_newbcast:12 row_mask:0xf bank_mask:0xf
    v_dot2c_f32_bf16_dpp v15, v36, v114 row_newbcast:12 row_mask:0xf bank_mask:0xf
    v_dot2c_f32_bf16_dpp v16, v28, v115 row_newbcast:12 row_mask:0xf bank_mask:0xf
    v_dot2c_f32_bf16_dpp v17, v36, v115 row_newbcast:12 row_mask:0xf bank_mask:0xf
    buffer_load_dwordx4 v[76:79], v1, s[36:39], s70 offen nt
    s_add_u32 s70, s70, 0x1000
    v_perm_b32 v211, v220, v216, s82
    v_perm_b32 v220, v220, v216, s83
    s_waitcnt vmcnt(6)
    v_dot2c_f32_bf16_dpp v10, v28, v116 row_newbcast:13 row_mask:0xf bank_mask:0xf
    v_dot2c_f32_bf16_dpp v11, v36, v116 row_newbcast:13 row_mask:0xf bank_mask:0xf
    v_dot2c_f32_bf16_dpp v12, v28, v117 row_newbcast:13 row_mask:0xf bank_mask:0xf
    v_dot2c_f32_bf16_dpp v13, v36, v117 row_newbcast:13 row_mask:0xf bank_mask:0xf
    v_dot2c_f32_bf16_dpp v14, v28, v118 row_newbcast:13 row_mask:0xf bank_mask:0xf
    v_dot2c_f32_bf16_dpp v15, v36, v118 row_newbcast:13 row_mask:0xf bank_mask:0xf
    v_dot2c_f32_bf16_dpp v16, v28, v119 row_newbcast:13 row_mask:0xf bank_mask:0xf
    v_dot2c_f32_bf16_dpp v17, v36, v119 row_newbcast:13 row_mask:0xf bank_mask:0xf
    buffer_load_dwordx4 v[80:83], v1, s[36:39], s70 offen nt
    s_add_u32 s70, s70, 0x1000
    v_perm_b32 v216, v221, v217, s82
    v_perm_b32 v221, v221, v217, s83
    s_waitcnt vmcnt(6)
    v_dot2c_f32_bf16_dpp v10, v28, v120 row_newbcast:14 row_mask:0xf bank_mask:0xf
    v_dot2c_f32_bf16_dpp v11, v36, v120 row_newbcast:14 row_mask:0xf bank_mask:0xf
    v_dot2c_f32_bf16_dpp v12, v28, v121 row_newbcast:14 row_mask:0xf bank_mask:0xf
    v_dot2c_f32_bf16_dpp v13, v36, v121 row_newbcast:14 row_mask:0xf bank_mask:0xf
    v_dot2c_f32_bf16_dpp v14, v28, v122 row_newbcast:14 row_mask:0xf bank_mask:0xf
    v_dot2c_f32_bf16_dpp v15, v36, v122 row_newbcast:14 row_mask:0xf bank_mask:0xf
    v_dot2c_f32_bf16_dpp v16, v28, v123 row_newbcast:14 row_mask:0xf bank_mask:0xf
    v_dot2c_f32_bf16_dpp v17, v36, v123 row_newbcast:14 row_mask:0xf bank_mask:0xf
    buffer_load_dwordx4 v[84:87], v1, s[36:39], s70 offen nt
    s_add_u32 s70, s70, 0x1000
    v_perm_b32 v217, v222, v218, s82
    v_perm_b32 v222, v222, v218, s83
    s_waitcnt vmcnt(6)
    v_dot2c_f32_bf16_dpp v10, v28, v124 row_newbcast:15 row_mask:0xf bank_mask:0xf
    v_dot2c_f32_bf16_dpp v11, v36, v124 row_newbcast:15 row_mask:0xf bank_mask:0xf
    v_dot2c_f32_bf16_dpp v12, v28, v125 row_newbcast:15 row_mask:0xf bank_mask:0xf
    v_dot2c_f32_bf16_dpp v13, v36, v125 row_newbcast:15 row_mask:0xf bank_mask:0xf
    v_dot2c_f32_bf16_dpp v14, v28, v126 row_newbcast:15 row_mask:0xf bank_mask:0xf
    v_dot2c_f32_bf16_dpp v15, v36, v126 row_newbcast:15 row_mask:0xf bank_mask:0xf
    v_dot2c_f32_bf16_dpp v16, v28, v127 row_newbcast:15 row_mask:0xf bank_mask:0xf
    v_dot2c_f32_bf16_dpp v17, v36, v127 row_newbcast:15 row_mask:0xf bank_mask:0xf
    buffer_load_dwordx4 v[88:91], v1, s[36:39], s70 offen nt
    s_add_u32 s70, s70, 0x1000
    v_perm_b32 v218, v223, v219, s82
    v_perm_b32 v223, v223, v219, s83
    s_waitcnt vmcnt(6)
    v_dot2c_f32_bf16_dpp v10, v29, v64 row_newbcast:0 row_mask:0xf bank_mask:0xf
    v_dot2c_f32_bf16_dpp v11, v37, v64 row_newbcast:0 row_mask:0xf bank_mask:0xf
    v_dot2c_f32_bf16_dpp v12, v29, v65 row_newbcast:0 row_mask:0xf bank_mask:0xf
    v_dot2c_f32_bf16_dpp v13, v37, v65 row_newbcast:0 row_mask:0xf bank_mask:0xf
    v_dot2c_f32_bf16_dpp v14, v29, v66 row_newbcast:0 row_mask:0xf bank_mask:0xf
    v_dot2c_f32_bf16_dpp v15, v37, v66 row_newbcast:0 row_mask:0xf bank_mask:0xf
    v_dot2c_f32_bf16_dpp v16, v29, v67 row_newbcast:0 row_mask:0xf bank_mask:0xf
    v_dot2c_f32_bf16_dpp v17, v37, v67 row_newbcast:0 row_mask:0xf bank_mask:0xf
    buffer_load_dwordx4 v[92:95], v1, s[36:39], s70 offen nt
    s_add_u32 s70, s70, 0x9000
    v_perm_b32 v219, v228, v224, s82
    v_perm_b32 v228, v228, v224, s83
    s_waitcnt vmcnt(6)
    v_dot2c_f32_bf16_dpp v10, v29, v68 row_newbcast:1 row_mask:0xf bank_mask:0xf
    v_dot2c_f32_bf16_dpp v11, v37, v68 row_newbcast:1 row_mask:0xf bank_mask:0xf
    v_dot2c_f32_bf16_dpp v12, v29, v69 row_newbcast:1 row_mask:0xf bank_mask:0xf
    v_dot2c_f32_bf16_dpp v13, v37, v69 row_newbcast:1 row_mask:0xf bank_mask:0xf
    v_dot2c_f32_bf16_dpp v14, v29, v70 row_newbcast:1 row_mask:0xf bank_mask:0xf
    v_dot2c_f32_bf16_dpp v15, v37, v70 row_newbcast:1 row_mask:0xf bank_mask:0xf
    v_dot2c_f32_bf16_dpp v16, v29, v71 row_newbcast:1 row_mask:0xf bank_mask:0xf
    v_dot2c_f32_bf16_dpp v17, v37, v71 row_newbcast:1 row_mask:0xf bank_mask:0xf
    buffer_load_dwordx4 v[96:99], v1, s[36:39], s70 offen nt
    s_add_u32 s70, s70, 0x1000
    v_perm_b32 v224, v229, v225, s82
    v_perm_b32 v229, v229, v225, s83
    s_waitcnt vmcnt(6)
    v_dot2c_f32_bf16_dpp v10, v29, v72 row_newbcast:2 row_mask:0xf bank_mask:0xf
    v_dot2c_f32_bf16_dpp v11, v37, v72 row_newbcast:2 row_mask:0xf bank_mask:0xf
    v_dot2c_f32_bf16_dpp v12, v29, v73 row_newbcast:2 row_mask:0xf bank_mask:0xf
    v_dot2c_f32_bf16_dpp v13, v37, v73 row_newbcast:2 row_mask:0xf bank_mask:0xf
    v_dot2c_f32_bf16_dpp v14, v29, v74 row_newbcast:2 row_mask:0xf bank_mask:0xf
    v_dot2c_f32_bf16_dpp v15, v37, v74 row_newbcast:2 row_mask:0xf bank_mask:0xf
    v_dot2c_f32_bf16_dpp v16, v29, v75 row_newbcast:2 row_mask:0xf bank_mask:0xf
    v_dot2c_f32_bf16_dpp v17, v37, v75 row_newbcast:2 row_mask:0xf bank_mask:0xf
    buffer_load_dwordx4 v[100:103], v1, s[36:39], s70 offen nt
    s_add_u32 s70, s70, 0x1000
    v_perm_b32 v225, v230, v226, s82
    v_perm_b32 v230, v230, v226, s83
    s_waitcnt vmcnt(6)
    v_dot2c_f32_bf16_dpp v10, v29, v76 row_newbcast:3 row_mask:0xf bank_mask:0xf
    v_dot2c_f32_bf16_dpp v11, v37, v76 row_newbcast:3 row_mask:0xf bank_mask:0xf
    v_dot2c_f32_bf16_dpp v12, v29, v77 row_newbcast:3 row_mask:0xf bank_mask:0xf
    v_dot2c_f32_bf16_dpp v13, v37, v77 row_newbcast:3 row_mask:0xf bank_mask:0xf
    v_dot2c_f32_bf16_dpp v14, v29, v78 row_newbcast:3 row_mask:0xf bank_mask:0xf
    v_dot2c_f32_bf16_dpp v15, v37, v78 row_newbcast:3 row_mask:0xf bank_mask:0xf
    v_dot2c_f32_bf16_dpp v16, v29, v79 row_newbcast:3 row_mask:0xf bank_mask:0xf
    v_dot2c_f32_bf16_dpp v17, v37, v79 row_newbcast:3 row_mask:0xf bank_mask:0xf
    buffer_load_dwordx4 v[104:107], v1, s[36:39], s70 offen nt
    s_add_u32 s70, s70, 0x1000
    v_perm_b32 v226, v231, v227, s82
    v_perm_b32 v231, v231, v227, s83
    s_waitcnt vmcnt(6)
    v_dot2c_f32_bf16_dpp v10, v29, v80 row_newbcast:4 row_mask:0xf bank_mask:0xf
    v_dot2c_f32_bf16_dpp v11, v37, v80 row_newbcast:4 row_mask:0xf bank_mask:0xf
    v_dot2c_f32_bf16_dpp v12, v29, v81 row_newbcast:4 row_mask:0xf bank_mask:0xf
    v_dot2c_f32_bf16_dpp v13, v37, v81 row_newbcast:4 row_mask:0xf bank_mask:0xf
    v_dot2c_f32_bf16_dpp v14, v29, v82 row_newbcast:4 row_mask:0xf bank_mask:0xf
    v_dot2c_f32_bf16_dpp v15, v37, v82 row_newbcast:4 row_mask:0xf bank_mask:0xf
    v_dot2c_f32_bf16_dpp v16, v29, v83 row_newbcast:4 row_mask:0xf bank_mask:0xf
    v_dot2c_f32_bf16_dpp v17, v37, v83 row_newbcast:4 row_mask:0xf bank_mask:0xf
    buffer_load_dwordx4 v[108:111], v1, s[36:39], s70 offen nt
    s_add_u32 s70, s70, 0x1000
    v_perm_b32 v227, v236, v232, s82
    v_perm_b32 v236, v236, v232, s83
    s_waitcnt vmcnt(6)
    v_dot2c_f32_bf16_dpp v10, v29, v84 row_newbcast:5 row_mask:0xf bank_mask:0xf
    v_dot2c_f32_bf16_dpp v11, v37, v84 row_newbcast:5 row_mask:0xf bank_mask:0xf
    v_dot2c_f32_bf16_dpp v12, v29, v85 row_newbcast:5 row_mask:0xf bank_mask:0xf
    v_dot2c_f32_bf16_dpp v13, v37, v85 row_newbcast:5 row_mask:0xf bank_mask:0xf
    v_dot2c_f32_bf16_dpp v14, v29, v86 row_newbcast:5 row_mask:0xf bank_mask:0xf
    v_dot2c_f32_bf16_dpp v15, v37, v86 row_newbcast:5 row_mask:0xf bank_mask:0xf
    v_dot2c_f32_bf16_dpp v16, v29, v87 row_newbcast:5 row_mask:0xf bank_mask:0xf
    v_dot2c_f32_bf16_dpp v17, v37, v87 row_newbcast:5 row_mask:0xf bank_mask:0xf
    buffer_load_dwordx4 v[112:115], v1, s[36:39], s70 offen nt
    s_add_u32 s70, s70, 0x1000
    v_perm_b32 v232, v237, v233, s82
    v_perm_b32 v237, v237, v233, s83
    s_waitcnt vmcnt(6)
    v_dot2c_f32_bf16_dpp v10, v29, v88 row_newbcast:6 row_mask:0xf bank_mask:0xf
    v_dot2c_f32_bf16_dpp v11, v37, v88 row_newbcast:6 row_mask:0xf bank_mask:0xf
    v_dot2c_f32_bf16_dpp v12, v29, v89 row_newbcast:6 row_mask:0xf bank_mask:0xf
    v_dot2c_f32_bf16_dpp v13, v37, v89 row_newbcast:6 row_mask:0xf bank_mask:0xf
    v_dot2c_f32_bf16_dpp v14, v29, v90 row_newbcast:6 row_mask:0xf bank_mask:0xf
    v_dot2c_f32_bf16_dpp v15, v37, v90 row_newbcast:6 row_mask:0xf bank_mask:0xf
    v_dot2c_f32_bf16_dpp v16, v29, v91 row_newbcast:6 row_mask:0xf bank_mask:0xf
    v_dot2c_f32_bf16_dpp v17, v37, v91 row_newbcast:6 row_mask:0xf bank_mask:0xf
    buffer_load_dwordx4 v[116:119], v1, s[36:39], s70 offen nt
    s_add_u32 s70, s70, 0x1000
    v_perm_b32 v233, v238, v234, s82
    v_perm_b32 v238, v238, v234, s83
    s_waitcnt vmcnt(6)
    v_dot2c_f32_bf16_dpp v10, v29, v92 row_newbcast:7 row_mask:0xf bank_mask:0xf
    v_dot2c_f32_bf16_dpp v11, v37, v92 row_newbcast:7 row_mask:0xf bank_mask:0xf
    v_dot2c_f32_bf16_dpp v12, v29, v93 row_newbcast:7 row_mask:0xf bank_mask:0xf
    v_dot2c_f32_bf16_dpp v13, v37, v93 row_newbcast:7 row_mask:0xf bank_mask:0xf
    v_dot2c_f32_bf16_dpp v14, v29, v94 row_newbcast:7 row_mask:0xf bank_mask:0xf
    v_dot2c_f32_bf16_dpp v15, v37, v94 row_newbcast:7 row_mask:0xf bank_mask:0xf
    v_dot2c_f32_bf16_dpp v16, v29, v95 row_newbcast:7 row_mask:0xf bank_mask:0xf
    v_dot2c_f32_bf16_dpp v17, v37, v95 row_newbcast:7 row_mask:0xf bank_mask:0xf
    buffer_load_dwordx4 v[120:123], v1, s[36:39], s70 offen nt
    s_add_u32 s70, s70, 0x1000
    v_perm_b32 v234, v239, v235, s82
    v_perm_b32 v239, v239, v235, s83
    s_waitcnt vmcnt(6)
    v_dot2c_f32_bf16_dpp v10, v29, v96 row_newbcast:8 row_mask:0xf bank_mask:0xf
    v_dot2c_f32_bf16_dpp v11, v37, v96 row_newbcast:8 row_mask:0xf bank_mask:0xf
    v_dot2c_f32_bf16_dpp v12, v29, v97 row_newbcast:8 row_mask:0xf bank_mask:0xf
    v_dot2c_f32_bf16_dpp v13, v37, v97 row_newbcast:8 row_mask:0xf bank_mask:0xf
    v_dot2c_f32_bf16_dpp v14, v29, v98 row_newbcast:8 row_mask:0xf bank_mask:0xf
    v_dot2c_f32_bf16_dpp v15, v37, v98 row_newbcast:8 row_mask:0xf bank_mask:0xf
    v_dot2c_f32_bf16_dpp v16, v29, v99 row_newbcast:8 row_mask:0xf bank_mask:0xf
    v_dot2c_f32_bf16_dpp v17, v37, v99 row_newbcast:8 row_mask:0xf bank_mask:0xf
    buffer_load_dwordx4 v[124:127], v1, s[36:39], s70 offen nt
    s_add_u32 s70, s70, 0x9000
    v_perm_b32 v235, v244, v240, s82
    v_perm_b32 v244, v244, v240, s83
    s_waitcnt vmcnt(6)
    v_dot2c_f32_bf16_dpp v10, v29, v100 row_newbcast:9 row_mask:0xf bank_mask:0xf
    v_dot2c_f32_bf16_dpp v11, v37, v100 row_newbcast:9 row_mask:0xf bank_mask:0xf
    v_dot2c_f32_bf16_dpp v12, v29, v101 row_newbcast:9 row_mask:0xf bank_mask:0xf
    v_dot2c_f32_bf16_dpp v13, v37, v101 row_newbcast:9 row_mask:0xf bank_mask:0xf
    v_dot2c_f32_bf16_dpp v14, v29, v102 row_newbcast:9 row_mask:0xf bank_mask:0xf
    v_dot2c_f32_bf16_dpp v15, v37, v102 row_newbcast:9 row_mask:0xf bank_mask:0xf
    v_dot2c_f32_bf16_dpp v16, v29, v103 row_newbcast:9 row_mask:0xf bank_mask:0xf
    v_dot2c_f32_bf16_dpp v17, v37, v103 row_newbcast:9 row_mask:0xf bank_mask:0xf
    buffer_load_dwordx4 v[64:67], v1, s[36:39], s70 offen nt
    s_add_u32 s70, s70, 0x1000
    v_perm_b32 v240, v245, v241, s82
    v_perm_b32 v245, v245, v241, s83
    s_waitcnt vmcnt(6)
    v_dot2c_f32_bf16_dpp v10, v29, v104 row_newbcast:10 row_mask:0xf bank_mask:0xf
    v_dot2c_f32_bf16_dpp v11, v37, v104 row_newbcast:10 row_mask:0xf bank_mask:0xf
    v_dot2c_f32_bf16_dpp v12, v29, v105 row_newbcast:10 row_mask:0xf bank_mask:0xf
    v_dot2c_f32_bf16_dpp v13, v37, v105 row_newbcast:10 row_mask:0xf bank_mask:0xf
    v_dot2c_f32_bf16_dpp v14, v29, v106 row_newbcast:10 row_mask:0xf bank_mask:0xf
    v_dot2c_f32_bf16_dpp v15, v37, v106 row_newbcast:10 row_mask:0xf bank_mask:0xf
    v_dot2c_f32_bf16_dpp v16, v29, v107 row_newbcast:10 row_mask:0xf bank_mask:0xf
    v_dot2c_f32_bf16_dpp v17, v37, v107 row_newbcast:10 row_mask:0xf bank_mask:0xf
    buffer_load_dwordx4 v[68:71], v1, s[36:39], s70 offen nt
    s_add_u32 s70, s70, 0x1000
    v_perm_b32 v241, v246, v242, s82
    v_perm_b32 v246, v246, v242, s83
    s_waitcnt vmcnt(6)
    v_dot2c_f32_bf16_dpp v10, v29, v108 row_newbcast:11 row_mask:0xf bank_mask:0xf
    v_dot2c_f32_bf16_dpp v11, v37, v108 row_newbcast:11 row_mask:0xf bank_mask:0xf
    v_dot2c_f32_bf16_dpp v12, v29, v109 row_newbcast:11 row_mask:0xf bank_mask:0xf
    v_dot2c_f32_bf16_dpp v13, v37, v109 row_newbcast:11 row_mask:0xf bank_mask:0xf
    v_dot2c_f32_bf16_dpp v14, v29, v110 row_newbcast:11 row_mask:0xf bank_mask:0xf
    v_dot2c_f32_bf16_dpp v15, v37, v110 row_newbcast:11 row_mask:0xf bank_mask:0xf
    v_dot2c_f32_bf16_dpp v16, v29, v111 row_newbcast:11 row_mask:0xf bank_mask:0xf
    v_dot2c_f32_bf16_dpp v17, v37, v111 row_newbcast:11 row_mask:0xf bank_mask:0xf
    buffer_load_dwordx4 v[72:75], v1, s[36:39], s70 offen nt
    s_add_u32 s70, s70, 0x1000
    v_perm_b32 v242, v247, v243, s82
    v_perm_b32 v247, v247, v243, s83
    s_waitcnt vmcnt(6)
    v_dot2c_f32_bf16_dpp v10, v29, v112 row_newbcast:12 row_mask:0xf bank_mask:0xf
    v_dot2c_f32_bf16_dpp v11, v37, v112 row_newbcast:12 row_mask:0xf bank_mask:0xf
    v_dot2c_f32_bf16_dpp v12, v29, v113 row_newbcast:12 row_mask:0xf bank_mask:0xf
    v_dot2c_f32_bf16_dpp v13, v37, v113 row_newbcast:12 row_mask:0xf bank_mask:0xf
    v_dot2c_f32_bf16_dpp v14, v29, v114 row_newbcast:12 row_mask:0xf bank_mask:0xf
    v_dot2c_f32_bf16_dpp v15, v37, v114 row_newbcast:12 row_mask:0xf bank_mask:0xf
    v_dot2c_f32_bf16_dpp v16, v29, v115 row_newbcast:12 row_mask:0xf bank_mask:0xf
    v_dot2c_f32_bf16_dpp v17, v37, v115 row_newbcast:12 row_mask:0xf bank_mask:0xf
    buffer_load_dwordx4 v[76:79], v1, s[36:39], s70 offen nt
    s_add_u32 s70, s70, 0x1000
    v_perm_b32 v243, v252, v248, s82
    v_perm_b32 v252, v252, v248, s83
    s_waitcnt vmcnt(6)
    v_dot2c_f32_bf16_dpp v10, v29, v116 row_newbcast:13 row_mask:0xf bank_mask:0xf
    v_dot2c_f32_bf16_dpp v11, v37, v116 row_newbcast:13 row_mask:0xf bank_mask:0xf
    v_dot2c_f32_bf16_dpp v12, v29, v117 row_newbcast:13 row_mask:0xf bank_mask:0xf
    v_dot2c_f32_bf16_dpp v13, v37, v117 row_newbcast:13 row_mask:0xf bank_mask:0xf
    v_dot2c_f32_bf16_dpp v14, v29, v118 row_newbcast:13 row_mask:0xf bank_mask:0xf
    v_dot2c_f32_bf16_dpp v15, v37, v118 row_newbcast:13 row_mask:0xf bank_mask:0xf
    v_dot2c_f32_bf16_dpp v16, v29, v119 row_newbcast:13 row_mask:0xf bank_mask:0xf
    v_dot2c_f32_bf16_dpp v17, v37, v119 row_newbcast:13 row_mask:0xf bank_mask:0xf
    buffer_load_dwordx4 v[80:83], v1, s[36:39], s70 offen nt
    s_add_u32 s70, s70, 0x1000
    v_perm_b32 v248, v253, v249, s82
    v_perm_b32 v253, v253, v249, s83
    s_waitcnt vmcnt(6)
    v_dot2c_f32_bf16_dpp v10, v29, v120 row_newbcast:14 row_mask:0xf bank_mask:0xf
    v_dot2c_f32_bf16_dpp v11, v37, v120 row_newbcast:14 row_mask:0xf bank_mask:0xf
    v_dot2c_f32_bf16_dpp v12, v29, v121 row_newbcast:14 row_mask:0xf bank_mask:0xf
    v_dot2c_f32_bf16_dpp v13, v37, v121 row_newbcast:14 row_mask:0xf bank_mask:0xf
    v_dot2c_f32_bf16_dpp v14, v29, v122 row_newbcast:14 row_mask:0xf bank_mask:0xf
    v_dot2c_f32_bf16_dpp v15, v37, v122 row_newbcast:14 row_mask:0xf bank_mask:0xf
    v_dot2c_f32_bf16_dpp v16, v29, v123 row_newbcast:14 row_mask:0xf bank_mask:0xf
    v_dot2c_f32_bf16_dpp v17, v37, v123 row_newbcast:14 row_mask:0xf bank_mask:0xf
    buffer_load_dwordx4 v[84:87], v1, s[36:39], s70 offen nt
    s_add_u32 s70, s70, 0x1000
    v_perm_b32 v249, v254, v250, s82
    v_perm_b32 v254, v254, v250, s83
    s_waitcnt vmcnt(6)
    v_dot2c_f32_bf16_dpp v10, v29, v124 row_newbcast:15 row_mask:0xf bank_mask:0xf
    v_dot2c_f32_bf16_dpp v11, v37, v124 row_newbcast:15 row_mask:0xf bank_mask:0xf
    v_dot2c_f32_bf16_dpp v12, v29, v125 row_newbcast:15 row_mask:0xf bank_mask:0xf
    v_dot2c_f32_bf16_dpp v13, v37, v125 row_newbcast:15 row_mask:0xf bank_mask:0xf
    v_dot2c_f32_bf16_dpp v14, v29, v126 row_newbcast:15 row_mask:0xf bank_mask:0xf
    v_dot2c_f32_bf16_dpp v15, v37, v126 row_newbcast:15 row_mask:0xf bank_mask:0xf
    v_dot2c_f32_bf16_dpp v16, v29, v127 row_newbcast:15 row_mask:0xf bank_mask:0xf
    v_dot2c_f32_bf16_dpp v17, v37, v127 row_newbcast:15 row_mask:0xf bank_mask:0xf
    buffer_load_dwordx4 v[88:91], v1, s[36:39], s70 offen nt
    s_add_u32 s70, s70, 0x1000
    v_perm_b32 v250, v255, v251, s82
    v_perm_b32 v255, v255, v251, s83
    s_waitcnt vmcnt(6)
    v_dot2c_f32_bf16_dpp v10, v30, v64 row_newbcast:0 row_mask:0xf bank_mask:0xf
    v_dot2c_f32_bf16_dpp v11, v38, v64 row_newbcast:0 row_mask:0xf bank_mask:0xf
    v_dot2c_f32_bf16_dpp v12, v30, v65 row_newbcast:0 row_mask:0xf bank_mask:0xf
    v_dot2c_f32_bf16_dpp v13, v38, v65 row_newbcast:0 row_mask:0xf bank_mask:0xf
    v_dot2c_f32_bf16_dpp v14, v30, v66 row_newbcast:0 row_mask:0xf bank_mask:0xf
    v_dot2c_f32_bf16_dpp v15, v38, v66 row_newbcast:0 row_mask:0xf bank_mask:0xf
    v_dot2c_f32_bf16_dpp v16, v30, v67 row_newbcast:0 row_mask:0xf bank_mask:0xf
    v_dot2c_f32_bf16_dpp v17, v38, v67 row_newbcast:0 row_mask:0xf bank_mask:0xf
    buffer_load_dwordx4 v[92:95], v1, s[36:39], s70 offen nt
    s_add_u32 s70, s70, 0x9000
    s_waitcnt vmcnt(6)
    v_dot2c_f32_bf16_dpp v10, v30, v68 row_newbcast:1 row_mask:0xf bank_mask:0xf
    v_dot2c_f32_bf16_dpp v11, v38, v68 row_newbcast:1 row_mask:0xf bank_mask:0xf
    v_dot2c_f32_bf16_dpp v12, v30, v69 row_newbcast:1 row_mask:0xf bank_mask:0xf
    v_dot2c_f32_bf16_dpp v13, v38, v69 row_newbcast:1 row_mask:0xf bank_mask:0xf
    v_dot2c_f32_bf16_dpp v14, v30, v70 row_newbcast:1 row_mask:0xf bank_mask:0xf
    v_dot2c_f32_bf16_dpp v15, v38, v70 row_newbcast:1 row_mask:0xf bank_mask:0xf
    v_dot2c_f32_bf16_dpp v16, v30, v71 row_newbcast:1 row_mask:0xf bank_mask:0xf
    v_dot2c_f32_bf16_dpp v17, v38, v71 row_newbcast:1 row_mask:0xf bank_mask:0xf
    buffer_load_dwordx4 v[96:99], v1, s[36:39], s70 offen nt
    s_add_u32 s70, s70, 0x1000
    s_waitcnt vmcnt(6)
    v_dot2c_f32_bf16_dpp v10, v30, v72 row_newbcast:2 row_mask:0xf bank_mask:0xf
    v_dot2c_f32_bf16_dpp v11, v38, v72 row_newbcast:2 row_mask:0xf bank_mask:0xf
    v_dot2c_f32_bf16_dpp v12, v30, v73 row_newbcast:2 row_mask:0xf bank_mask:0xf
    v_dot2c_f32_bf16_dpp v13, v38, v73 row_newbcast:2 row_mask:0xf bank_mask:0xf
    v_dot2c_f32_bf16_dpp v14, v30, v74 row_newbcast:2 row_mask:0xf bank_mask:0xf
    v_dot2c_f32_bf16_dpp v15, v38, v74 row_newbcast:2 row_mask:0xf bank_mask:0xf
    v_dot2c_f32_bf16_dpp v16, v30, v75 row_newbcast:2 row_mask:0xf bank_mask:0xf
    v_dot2c_f32_bf16_dpp v17, v38, v75 row_newbcast:2 row_mask:0xf bank_mask:0xf
    buffer_load_dwordx4 v[100:103], v1, s[36:39], s70 offen nt
    s_add_u32 s70, s70, 0x1000
    s_waitcnt vmcnt(6)
    v_dot2c_f32_bf16_dpp v10, v30, v76 row_newbcast:3 row_mask:0xf bank_mask:0xf
    v_dot2c_f32_bf16_dpp v11, v38, v76 row_newbcast:3 row_mask:0xf bank_mask:0xf
    v_dot2c_f32_bf16_dpp v12, v30, v77 row_newbcast:3 row_mask:0xf bank_mask:0xf
    v_dot2c_f32_bf16_dpp v13, v38, v77 row_newbcast:3 row_mask:0xf bank_mask:0xf
    v_dot2c_f32_bf16_dpp v14, v30, v78 row_newbcast:3 row_mask:0xf bank_mask:0xf
    v_dot2c_f32_bf16_dpp v15, v38, v78 row_newbcast:3 row_mask:0xf bank_mask:0xf
    v_dot2c_f32_bf16_dpp v16, v30, v79 row_newbcast:3 row_mask:0xf bank_mask:0xf
    v_dot2c_f32_bf16_dpp v17, v38, v79 row_newbcast:3 row_mask:0xf bank_mask:0xf
    buffer_load_dwordx4 v[104:107], v1, s[36:39], s70 offen nt
    s_add_u32 s70, s70, 0x1000
    s_waitcnt vmcnt(6)
    v_dot2c_f32_bf16_dpp v10, v30, v80 row_newbcast:4 row_mask:0xf bank_mask:0xf
    v_dot2c_f32_bf16_dpp v11, v38, v80 row_newbcast:4 row_mask:0xf bank_mask:0xf
    v_dot2c_f32_bf16_dpp v12, v30, v81 row_newbcast:4 row_mask:0xf bank_mask:0xf
    v_dot2c_f32_bf16_dpp v13, v38, v81 row_newbcast:4 row_mask:0xf bank_mask:0xf
    v_dot2c_f32_bf16_dpp v14, v30, v82 row_newbcast:4 row_mask:0xf bank_mask:0xf
    v_dot2c_f32_bf16_dpp v15, v38, v82 row_newbcast:4 row_mask:0xf bank_mask:0xf
    v_dot2c_f32_bf16_dpp v16, v30, v83 row_newbcast:4 row_mask:0xf bank_mask:0xf
    v_dot2c_f32_bf16_dpp v17, v38, v83 row_newbcast:4 row_mask:0xf bank_mask:0xf
    buffer_load_dwordx4 v[108:111], v1, s[36:39], s70 offen nt
    s_add_u32 s70, s70, 0x1000
    s_waitcnt vmcnt(6)
    v_dot2c_f32_bf16_dpp v10, v30, v84 row_newbcast:5 row_mask:0xf bank_mask:0xf
    v_dot2c_f32_bf16_dpp v11, v38, v84 row_newbcast:5 row_mask:0xf bank_mask:0xf
    v_dot2c_f32_bf16_dpp v12, v30, v85 row_newbcast:5 row_mask:0xf bank_mask:0xf
    v_dot2c_f32_bf16_dpp v13, v38, v85 row_newbcast:5 row_mask:0xf bank_mask:0xf
    v_dot2c_f32_bf16_dpp v14, v30, v86 row_newbcast:5 row_mask:0xf bank_mask:0xf
    v_dot2c_f32_bf16_dpp v15, v38, v86 row_newbcast:5 row_mask:0xf bank_mask:0xf
    v_dot2c_f32_bf16_dpp v16, v30, v87 row_newbcast:5 row_mask:0xf bank_mask:0xf
    v_dot2c_f32_bf16_dpp v17, v38, v87 row_newbcast:5 row_mask:0xf bank_mask:0xf
    buffer_load_dwordx4 v[112:115], v1, s[36:39], s70 offen nt
    s_add_u32 s70, s70, 0x1000
    s_waitcnt vmcnt(6)
    v_dot2c_f32_bf16_dpp v10, v30, v88 row_newbcast:6 row_mask:0xf bank_mask:0xf
    v_dot2c_f32_bf16_dpp v11, v38, v88 row_newbcast:6 row_mask:0xf bank_mask:0xf
    v_dot2c_f32_bf16_dpp v12, v30, v89 row_newbcast:6 row_mask:0xf bank_mask:0xf
    v_dot2c_f32_bf16_dpp v13, v38, v89 row_newbcast:6 row_mask:0xf bank_mask:0xf
    v_dot2c_f32_bf16_dpp v14, v30, v90 row_newbcast:6 row_mask:0xf bank_mask:0xf
    v_dot2c_f32_bf16_dpp v15, v38, v90 row_newbcast:6 row_mask:0xf bank_mask:0xf
    v_dot2c_f32_bf16_dpp v16, v30, v91 row_newbcast:6 row_mask:0xf bank_mask:0xf
    v_dot2c_f32_bf16_dpp v17, v38, v91 row_newbcast:6 row_mask:0xf bank_mask:0xf
    buffer_load_dwordx4 v[116:119], v1, s[36:39], s70 offen nt
    s_add_u32 s70, s70, 0x1000
    s_waitcnt vmcnt(6)
    v_dot2c_f32_bf16_dpp v10, v30, v92 row_newbcast:7 row_mask:0xf bank_mask:0xf
    v_dot2c_f32_bf16_dpp v11, v38, v92 row_newbcast:7 row_mask:0xf bank_mask:0xf
    v_dot2c_f32_bf16_dpp v12, v30, v93 row_newbcast:7 row_mask:0xf bank_mask:0xf
    v_dot2c_f32_bf16_dpp v13, v38, v93 row_newbcast:7 row_mask:0xf bank_mask:0xf
    v_dot2c_f32_bf16_dpp v14, v30, v94 row_newbcast:7 row_mask:0xf bank_mask:0xf
    v_dot2c_f32_bf16_dpp v15, v38, v94 row_newbcast:7 row_mask:0xf bank_mask:0xf
    v_dot2c_f32_bf16_dpp v16, v30, v95 row_newbcast:7 row_mask:0xf bank_mask:0xf
    v_dot2c_f32_bf16_dpp v17, v38, v95 row_newbcast:7 row_mask:0xf bank_mask:0xf
    buffer_load_dwordx4 v[120:123], v1, s[36:39], s70 offen nt
    s_add_u32 s70, s70, 0x1000
    s_waitcnt vmcnt(6)
    v_dot2c_f32_bf16_dpp v10, v30, v96 row_newbcast:8 row_mask:0xf bank_mask:0xf
    v_dot2c_f32_bf16_dpp v11, v38, v96 row_newbcast:8 row_mask:0xf bank_mask:0xf
    v_dot2c_f32_bf16_dpp v12, v30, v97 row_newbcast:8 row_mask:0xf bank_mask:0xf
    v_dot2c_f32_bf16_dpp v13, v38, v97 row_newbcast:8 row_mask:0xf bank_mask:0xf
    v_dot2c_f32_bf16_dpp v14, v30, v98 row_newbcast:8 row_mask:0xf bank_mask:0xf
    v_dot2c_f32_bf16_dpp v15, v38, v98 row_newbcast:8 row_mask:0xf bank_mask:0xf
    v_dot2c_f32_bf16_dpp v16, v30, v99 row_newbcast:8 row_mask:0xf bank_mask:0xf
    v_dot2c_f32_bf16_dpp v17, v38, v99 row_newbcast:8 row_mask:0xf bank_mask:0xf
    buffer_load_dwordx4 v[124:127], v1, s[36:39], s70 offen nt
    s_add_u32 s70, s70, 0x9000
    s_waitcnt vmcnt(6)
    v_dot2c_f32_bf16_dpp v10, v30, v100 row_newbcast:9 row_mask:0xf bank_mask:0xf
    v_dot2c_f32_bf16_dpp v11, v38, v100 row_newbcast:9 row_mask:0xf bank_mask:0xf
    v_dot2c_f32_bf16_dpp v12, v30, v101 row_newbcast:9 row_mask:0xf bank_mask:0xf
    v_dot2c_f32_bf16_dpp v13, v38, v101 row_newbcast:9 row_mask:0xf bank_mask:0xf
    v_dot2c_f32_bf16_dpp v14, v30, v102 row_newbcast:9 row_mask:0xf bank_mask:0xf
    v_dot2c_f32_bf16_dpp v15, v38, v102 row_newbcast:9 row_mask:0xf bank_mask:0xf
    v_dot2c_f32_bf16_dpp v16, v30, v103 row_newbcast:9 row_mask:0xf bank_mask:0xf
    v_dot2c_f32_bf16_dpp v17, v38, v103 row_newbcast:9 row_mask:0xf bank_mask:0xf
    buffer_load_dwordx4 v[64:67], v1, s[36:39], s70 offen nt
    s_add_u32 s70, s70, 0x1000
    s_waitcnt vmcnt(6)
    v_dot2c_f32_bf16_dpp v10, v30, v104 row_newbcast:10 row_mask:0xf bank_mask:0xf
    v_dot2c_f32_bf16_dpp v11, v38, v104 row_newbcast:10 row_mask:0xf bank_mask:0xf
    v_dot2c_f32_bf16_dpp v12, v30, v105 row_newbcast:10 row_mask:0xf bank_mask:0xf
    v_dot2c_f32_bf16_dpp v13, v38, v105 row_newbcast:10 row_mask:0xf bank_mask:0xf
    v_dot2c_f32_bf16_dpp v14, v30, v106 row_newbcast:10 row_mask:0xf bank_mask:0xf
    v_dot2c_f32_bf16_dpp v15, v38, v106 row_newbcast:10 row_mask:0xf bank_mask:0xf
    v_dot2c_f32_bf16_dpp v16, v30, v107 row_newbcast:10 row_mask:0xf bank_mask:0xf
    v_dot2c_f32_bf16_dpp v17, v38, v107 row_newbcast:10 row_mask:0xf bank_mask:0xf
    buffer_load_dwordx4 v[68:71], v1, s[36:39], s70 offen nt
    s_add_u32 s70, s70, 0x1000
    s_waitcnt vmcnt(6)
    v_dot2c_f32_bf16_dpp v10, v30, v108 row_newbcast:11 row_mask:0xf bank_mask:0xf
    v_dot2c_f32_bf16_dpp v11, v38, v108 row_newbcast:11 row_mask:0xf bank_mask:0xf
    v_dot2c_f32_bf16_dpp v12, v30, v109 row_newbcast:11 row_mask:0xf bank_mask:0xf
    v_dot2c_f32_bf16_dpp v13, v38, v109 row_newbcast:11 row_mask:0xf bank_mask:0xf
    v_dot2c_f32_bf16_dpp v14, v30, v110 row_newbcast:11 row_mask:0xf bank_mask:0xf
    v_dot2c_f32_bf16_dpp v15, v38, v110 row_newbcast:11 row_mask:0xf bank_mask:0xf
    v_dot2c_f32_bf16_dpp v16, v30, v111 row_newbcast:11 row_mask:0xf bank_mask:0xf
    v_dot2c_f32_bf16_dpp v17, v38, v111 row_newbcast:11 row_mask:0xf bank_mask:0xf
    buffer_load_dwordx4 v[72:75], v1, s[36:39], s70 offen nt
    s_add_u32 s70, s70, 0x1000
    s_waitcnt vmcnt(6)
    v_dot2c_f32_bf16_dpp v10, v30, v112 row_newbcast:12 row_mask:0xf bank_mask:0xf
    v_dot2c_f32_bf16_dpp v11, v38, v112 row_newbcast:12 row_mask:0xf bank_mask:0xf
    v_dot2c_f32_bf16_dpp v12, v30, v113 row_newbcast:12 row_mask:0xf bank_mask:0xf
    v_dot2c_f32_bf16_dpp v13, v38, v113 row_newbcast:12 row_mask:0xf bank_mask:0xf
    v_dot2c_f32_bf16_dpp v14, v30, v114 row_newbcast:12 row_mask:0xf bank_mask:0xf
    v_dot2c_f32_bf16_dpp v15, v38, v114 row_newbcast:12 row_mask:0xf bank_mask:0xf
    v_dot2c_f32_bf16_dpp v16, v30, v115 row_newbcast:12 row_mask:0xf bank_mask:0xf
    v_dot2c_f32_bf16_dpp v17, v38, v115 row_newbcast:12 row_mask:0xf bank_mask:0xf
    buffer_load_dwordx4 v[76:79], v1, s[36:39], s70 offen nt
    s_add_u32 s70, s70, 0x1000
    s_waitcnt vmcnt(6)
    v_dot2c_f32_bf16_dpp v10, v30, v116 row_newbcast:13 row_mask:0xf bank_mask:0xf
    v_dot2c_f32_bf16_dpp v11, v38, v116 row_newbcast:13 row_mask:0xf bank_mask:0xf
    v_dot2c_f32_bf16_dpp v12, v30, v117 row_newbcast:13 row_mask:0xf bank_mask:0xf
    v_dot2c_f32_bf16_dpp v13, v38, v117 row_newbcast:13 row_mask:0xf bank_mask:0xf
    v_dot2c_f32_bf16_dpp v14, v30, v118 row_newbcast:13 row_mask:0xf bank_mask:0xf
    v_dot2c_f32_bf16_dpp v15, v38, v118 row_newbcast:13 row_mask:0xf bank_mask:0xf
    v_dot2c_f32_bf16_dpp v16, v30, v119 row_newbcast:13 row_mask:0xf bank_mask:0xf
    v_dot2c_f32_bf16_dpp v17, v38, v119 row_newbcast:13 row_mask:0xf bank_mask:0xf
    buffer_load_dwordx4 v[80:83], v1, s[36:39], s70 offen nt
    s_add_u32 s70, s70, 0x1000
    s_waitcnt vmcnt(6)
    v_dot2c_f32_bf16_dpp v10, v30, v120 row_newbcast:14 row_mask:0xf bank_mask:0xf
    v_dot2c_f32_bf16_dpp v11, v38, v120 row_newbcast:14 row_mask:0xf bank_mask:0xf
    v_dot2c_f32_bf16_dpp v12, v30, v121 row_newbcast:14 row_mask:0xf bank_mask:0xf
    v_dot2c_f32_bf16_dpp v13, v38, v121 row_newbcast:14 row_mask:0xf bank_mask:0xf
    v_dot2c_f32_bf16_dpp v14, v30, v122 row_newbcast:14 row_mask:0xf bank_mask:0xf
    v_dot2c_f32_bf16_dpp v15, v38, v122 row_newbcast:14 row_mask:0xf bank_mask:0xf
    v_dot2c_f32_bf16_dpp v16, v30, v123 row_newbcast:14 row_mask:0xf bank_mask:0xf
    v_dot2c_f32_bf16_dpp v17, v38, v123 row_newbcast:14 row_mask:0xf bank_mask:0xf
    buffer_load_dwordx4 v[84:87], v1, s[36:39], s70 offen nt
    s_add_u32 s70, s70, 0x1000
    s_waitcnt vmcnt(6)
    v_dot2c_f32_bf16_dpp v10, v30, v124 row_newbcast:15 row_mask:0xf bank_mask:0xf
    v_dot2c_f32_bf16_dpp v11, v38, v124 row_newbcast:15 row_mask:0xf bank_mask:0xf
    v_dot2c_f32_bf16_dpp v12, v30, v125 row_newbcast:15 row_mask:0xf bank_mask:0xf
    v_dot2c_f32_bf16_dpp v13, v38, v125 row_newbcast:15 row_mask:0xf bank_mask:0xf
    v_dot2c_f32_bf16_dpp v14, v30, v126 row_newbcast:15 row_mask:0xf bank_mask:0xf
    v_dot2c_f32_bf16_dpp v15, v38, v126 row_newbcast:15 row_mask:0xf bank_mask:0xf
    v_dot2c_f32_bf16_dpp v16, v30, v127 row_newbcast:15 row_mask:0xf bank_mask:0xf
    v_dot2c_f32_bf16_dpp v17, v38, v127 row_newbcast:15 row_mask:0xf bank_mask:0xf
    buffer_load_dwordx4 v[88:91], v1, s[36:39], s70 offen nt
    s_add_u32 s70, s70, 0x1000
    s_waitcnt vmcnt(6)
    v_dot2c_f32_bf16_dpp v10, v31, v64 row_newbcast:0 row_mask:0xf bank_mask:0xf
    v_dot2c_f32_bf16_dpp v11, v39, v64 row_newbcast:0 row_mask:0xf bank_mask:0xf
    v_dot2c_f32_bf16_dpp v12, v31, v65 row_newbcast:0 row_mask:0xf bank_mask:0xf
    v_dot2c_f32_bf16_dpp v13, v39, v65 row_newbcast:0 row_mask:0xf bank_mask:0xf
    v_dot2c_f32_bf16_dpp v14, v31, v66 row_newbcast:0 row_mask:0xf bank_mask:0xf
    v_dot2c_f32_bf16_dpp v15, v39, v66 row_newbcast:0 row_mask:0xf bank_mask:0xf
    v_dot2c_f32_bf16_dpp v16, v31, v67 row_newbcast:0 row_mask:0xf bank_mask:0xf
    v_dot2c_f32_bf16_dpp v17, v39, v67 row_newbcast:0 row_mask:0xf bank_mask:0xf
    buffer_load_dwordx4 v[92:95], v1, s[36:39], s70 offen nt
    s_add_u32 s70, s70, 0x9000
    s_waitcnt vmcnt(6)
    v_dot2c_f32_bf16_dpp v10, v31, v68 row_newbcast:1 row_mask:0xf bank_mask:0xf
    v_dot2c_f32_bf16_dpp v11, v39, v68 row_newbcast:1 row_mask:0xf bank_mask:0xf
    v_dot2c_f32_bf16_dpp v12, v31, v69 row_newbcast:1 row_mask:0xf bank_mask:0xf
    v_dot2c_f32_bf16_dpp v13, v39, v69 row_newbcast:1 row_mask:0xf bank_mask:0xf
    v_dot2c_f32_bf16_dpp v14, v31, v70 row_newbcast:1 row_mask:0xf bank_mask:0xf
    v_dot2c_f32_bf16_dpp v15, v39, v70 row_newbcast:1 row_mask:0xf bank_mask:0xf
    v_dot2c_f32_bf16_dpp v16, v31, v71 row_newbcast:1 row_mask:0xf bank_mask:0xf
    v_dot2c_f32_bf16_dpp v17, v39, v71 row_newbcast:1 row_mask:0xf bank_mask:0xf
    buffer_load_dwordx4 v[96:99], v1, s[36:39], s70 offen nt
    s_add_u32 s70, s70, 0x1000
    s_waitcnt vmcnt(6)
    v_dot2c_f32_bf16_dpp v10, v31, v72 row_newbcast:2 row_mask:0xf bank_mask:0xf
    v_dot2c_f32_bf16_dpp v11, v39, v72 row_newbcast:2 row_mask:0xf bank_mask:0xf
    v_dot2c_f32_bf16_dpp v12, v31, v73 row_newbcast:2 row_mask:0xf bank_mask:0xf
    v_dot2c_f32_bf16_dpp v13, v39, v73 row_newbcast:2 row_mask:0xf bank_mask:0xf
    v_dot2c_f32_bf16_dpp v14, v31, v74 row_newbcast:2 row_mask:0xf bank_mask:0xf
    v_dot2c_f32_bf16_dpp v15, v39, v74 row_newbcast:2 row_mask:0xf bank_mask:0xf
    v_dot2c_f32_bf16_dpp v16, v31, v75 row_newbcast:2 row_mask:0xf bank_mask:0xf
    v_dot2c_f32_bf16_dpp v17, v39, v75 row_newbcast:2 row_mask:0xf bank_mask:0xf
    buffer_load_dwordx4 v[100:103], v1, s[36:39], s70 offen nt
    s_add_u32 s70, s70, 0x1000
    s_waitcnt vmcnt(6)
    v_dot2c_f32_bf16_dpp v10, v31, v76 row_newbcast:3 row_mask:0xf bank_mask:0xf
    v_dot2c_f32_bf16_dpp v11, v39, v76 row_newbcast:3 row_mask:0xf bank_mask:0xf
    v_dot2c_f32_bf16_dpp v12, v31, v77 row_newbcast:3 row_mask:0xf bank_mask:0xf
    v_dot2c_f32_bf16_dpp v13, v39, v77 row_newbcast:3 row_mask:0xf bank_mask:0xf
    v_dot2c_f32_bf16_dpp v14, v31, v78 row_newbcast:3 row_mask:0xf bank_mask:0xf
    v_dot2c_f32_bf16_dpp v15, v39, v78 row_newbcast:3 row_mask:0xf bank_mask:0xf
    v_dot2c_f32_bf16_dpp v16, v31, v79 row_newbcast:3 row_mask:0xf bank_mask:0xf
    v_dot2c_f32_bf16_dpp v17, v39, v79 row_newbcast:3 row_mask:0xf bank_mask:0xf
    buffer_load_dwordx4 v[104:107], v1, s[36:39], s70 offen nt
    s_add_u32 s70, s70, 0x1000
    s_waitcnt vmcnt(6)
    v_dot2c_f32_bf16_dpp v10, v31, v80 row_newbcast:4 row_mask:0xf bank_mask:0xf
    v_dot2c_f32_bf16_dpp v11, v39, v80 row_newbcast:4 row_mask:0xf bank_mask:0xf
    v_dot2c_f32_bf16_dpp v12, v31, v81 row_newbcast:4 row_mask:0xf bank_mask:0xf
    v_dot2c_f32_bf16_dpp v13, v39, v81 row_newbcast:4 row_mask:0xf bank_mask:0xf
    v_dot2c_f32_bf16_dpp v14, v31, v82 row_newbcast:4 row_mask:0xf bank_mask:0xf
    v_dot2c_f32_bf16_dpp v15, v39, v82 row_newbcast:4 row_mask:0xf bank_mask:0xf
    v_dot2c_f32_bf16_dpp v16, v31, v83 row_newbcast:4 row_mask:0xf bank_mask:0xf
    v_dot2c_f32_bf16_dpp v17, v39, v83 row_newbcast:4 row_mask:0xf bank_mask:0xf
    buffer_load_dwordx4 v[108:111], v1, s[36:39], s70 offen nt
    s_add_u32 s70, s70, 0x1000
    s_waitcnt vmcnt(6)
    v_dot2c_f32_bf16_dpp v10, v31, v84 row_newbcast:5 row_mask:0xf bank_mask:0xf
    v_dot2c_f32_bf16_dpp v11, v39, v84 row_newbcast:5 row_mask:0xf bank_mask:0xf
    v_dot2c_f32_bf16_dpp v12, v31, v85 row_newbcast:5 row_mask:0xf bank_mask:0xf
    v_dot2c_f32_bf16_dpp v13, v39, v85 row_newbcast:5 row_mask:0xf bank_mask:0xf
    v_dot2c_f32_bf16_dpp v14, v31, v86 row_newbcast:5 row_mask:0xf bank_mask:0xf
    v_dot2c_f32_bf16_dpp v15, v39, v86 row_newbcast:5 row_mask:0xf bank_mask:0xf
    v_dot2c_f32_bf16_dpp v16, v31, v87 row_newbcast:5 row_mask:0xf bank_mask:0xf
    v_dot2c_f32_bf16_dpp v17, v39, v87 row_newbcast:5 row_mask:0xf bank_mask:0xf
    buffer_load_dwordx4 v[112:115], v1, s[36:39], s70 offen nt
    s_add_u32 s70, s70, 0x1000
    s_waitcnt vmcnt(6)
    v_dot2c_f32_bf16_dpp v10, v31, v88 row_newbcast:6 row_mask:0xf bank_mask:0xf
    v_dot2c_f32_bf16_dpp v11, v39, v88 row_newbcast:6 row_mask:0xf bank_mask:0xf
    v_dot2c_f32_bf16_dpp v12, v31, v89 row_newbcast:6 row_mask:0xf bank_mask:0xf
    v_dot2c_f32_bf16_dpp v13, v39, v89 row_newbcast:6 row_mask:0xf bank_mask:0xf
    v_dot2c_f32_bf16_dpp v14, v31, v90 row_newbcast:6 row_mask:0xf bank_mask:0xf
    v_dot2c_f32_bf16_dpp v15, v39, v90 row_newbcast:6 row_mask:0xf bank_mask:0xf
    v_dot2c_f32_bf16_dpp v16, v31, v91 row_newbcast:6 row_mask:0xf bank_mask:0xf
    v_dot2c_f32_bf16_dpp v17, v39, v91 row_newbcast:6 row_mask:0xf bank_mask:0xf
    buffer_load_dwordx4 v[116:119], v1, s[36:39], s70 offen nt
    s_add_u32 s70, s70, 0x1000
    s_waitcnt vmcnt(6)
    v_dot2c_f32_bf16_dpp v10, v31, v92 row_newbcast:7 row_mask:0xf bank_mask:0xf
    v_dot2c_f32_bf16_dpp v11, v39, v92 row_newbcast:7 row_mask:0xf bank_mask:0xf
    v_dot2c_f32_bf16_dpp v12, v31, v93 row_newbcast:7 row_mask:0xf bank_mask:0xf
    v_dot2c_f32_bf16_dpp v13, v39, v93 row_newbcast:7 row_mask:0xf bank_mask:0xf
    v_dot2c_f32_bf16_dpp v14, v31, v94 row_newbcast:7 row_mask:0xf bank_mask:0xf
    v_dot2c_f32_bf16_dpp v15, v39, v94 row_newbcast:7 row_mask:0xf bank_mask:0xf
    v_dot2c_f32_bf16_dpp v16, v31, v95 row_newbcast:7 row_mask:0xf bank_mask:0xf
    v_dot2c_f32_bf16_dpp v17, v39, v95 row_newbcast:7 row_mask:0xf bank_mask:0xf
    buffer_load_dwordx4 v[120:123], v1, s[36:39], s70 offen nt
    s_add_u32 s70, s70, 0x1000
    s_waitcnt vmcnt(6)
    v_dot2c_f32_bf16_dpp v10, v31, v96 row_newbcast:8 row_mask:0xf bank_mask:0xf
    v_dot2c_f32_bf16_dpp v11, v39, v96 row_newbcast:8 row_mask:0xf bank_mask:0xf
    v_dot2c_f32_bf16_dpp v12, v31, v97 row_newbcast:8 row_mask:0xf bank_mask:0xf
    v_dot2c_f32_bf16_dpp v13, v39, v97 row_newbcast:8 row_mask:0xf bank_mask:0xf
    v_dot2c_f32_bf16_dpp v14, v31, v98 row_newbcast:8 row_mask:0xf bank_mask:0xf
    v_dot2c_f32_bf16_dpp v15, v39, v98 row_newbcast:8 row_mask:0xf bank_mask:0xf
    v_dot2c_f32_bf16_dpp v16, v31, v99 row_newbcast:8 row_mask:0xf bank_mask:0xf
    v_dot2c_f32_bf16_dpp v17, v39, v99 row_newbcast:8 row_mask:0xf bank_mask:0xf
    buffer_load_dwordx4 v[124:127], v1, s[36:39], s70 offen nt
    s_add_u32 s70, s70, 0x9000
    s_waitcnt vmcnt(6)
    v_dot2c_f32_bf16_dpp v10, v31, v100 row_newbcast:9 row_mask:0xf bank_mask:0xf
    v_dot2c_f32_bf16_dpp v11, v39, v100 row_newbcast:9 row_mask:0xf bank_mask:0xf
    v_dot2c_f32_bf16_dpp v12, v31, v101 row_newbcast:9 row_mask:0xf bank_mask:0xf
    v_dot2c_f32_bf16_dpp v13, v39, v101 row_newbcast:9 row_mask:0xf bank_mask:0xf
    v_dot2c_f32_bf16_dpp v14, v31, v102 row_newbcast:9 row_mask:0xf bank_mask:0xf
    v_dot2c_f32_bf16_dpp v15, v39, v102 row_newbcast:9 row_mask:0xf bank_mask:0xf
    v_dot2c_f32_bf16_dpp v16, v31, v103 row_newbcast:9 row_mask:0xf bank_mask:0xf
    v_dot2c_f32_bf16_dpp v17, v39, v103 row_newbcast:9 row_mask:0xf bank_mask:0xf
    buffer_load_dwordx4 v[64:67], v1, s[36:39], s70 offen nt
    s_add_u32 s70, s70, 0x1000
    s_waitcnt vmcnt(6)
    v_dot2c_f32_bf16_dpp v10, v31, v104 row_newbcast:10 row_mask:0xf bank_mask:0xf
    v_dot2c_f32_bf16_dpp v11, v39, v104 row_newbcast:10 row_mask:0xf bank_mask:0xf
    v_dot2c_f32_bf16_dpp v12, v31, v105 row_newbcast:10 row_mask:0xf bank_mask:0xf
    v_dot2c_f32_bf16_dpp v13, v39, v105 row_newbcast:10 row_mask:0xf bank_mask:0xf
    v_dot2c_f32_bf16_dpp v14, v31, v106 row_newbcast:10 row_mask:0xf bank_mask:0xf
    v_dot2c_f32_bf16_dpp v15, v39, v106 row_newbcast:10 row_mask:0xf bank_mask:0xf
    v_dot2c_f32_bf16_dpp v16, v31, v107 row_newbcast:10 row_mask:0xf bank_mask:0xf
    v_dot2c_f32_bf16_dpp v17, v39, v107 row_newbcast:10 row_mask:0xf bank_mask:0xf
    buffer_load_dwordx4 v[68:71], v1, s[36:39], s70 offen nt
    s_add_u32 s70, s70, 0x1000
    s_waitcnt vmcnt(6)
    v_dot2c_f32_bf16_dpp v10, v31, v108 row_newbcast:11 row_mask:0xf bank_mask:0xf
    v_dot2c_f32_bf16_dpp v11, v39, v108 row_newbcast:11 row_mask:0xf bank_mask:0xf
    v_dot2c_f32_bf16_dpp v12, v31, v109 row_newbcast:11 row_mask:0xf bank_mask:0xf
    v_dot2c_f32_bf16_dpp v13, v39, v109 row_newbcast:11 row_mask:0xf bank_mask:0xf
    v_dot2c_f32_bf16_dpp v14, v31, v110 row_newbcast:11 row_mask:0xf bank_mask:0xf
    v_dot2c_f32_bf16_dpp v15, v39, v110 row_newbcast:11 row_mask:0xf bank_mask:0xf
    v_dot2c_f32_bf16_dpp v16, v31, v111 row_newbcast:11 row_mask:0xf bank_mask:0xf
    v_dot2c_f32_bf16_dpp v17, v39, v111 row_newbcast:11 row_mask:0xf bank_mask:0xf
    buffer_load_dwordx4 v[72:75], v1, s[36:39], s70 offen nt
    s_add_u32 s70, s70, 0x1000
    s_waitcnt vmcnt(6)
    v_dot2c_f32_bf16_dpp v10, v31, v112 row_newbcast:12 row_mask:0xf bank_mask:0xf
    v_dot2c_f32_bf16_dpp v11, v39, v112 row_newbcast:12 row_mask:0xf bank_mask:0xf
    v_dot2c_f32_bf16_dpp v12, v31, v113 row_newbcast:12 row_mask:0xf bank_mask:0xf
    v_dot2c_f32_bf16_dpp v13, v39, v113 row_newbcast:12 row_mask:0xf bank_mask:0xf
    v_dot2c_f32_bf16_dpp v14, v31, v114 row_newbcast:12 row_mask:0xf bank_mask:0xf
    v_dot2c_f32_bf16_dpp v15, v39, v114 row_newbcast:12 row_mask:0xf bank_mask:0xf
    v_dot2c_f32_bf16_dpp v16, v31, v115 row_newbcast:12 row_mask:0xf bank_mask:0xf
    v_dot2c_f32_bf16_dpp v17, v39, v115 row_newbcast:12 row_mask:0xf bank_mask:0xf
    buffer_load_dwordx4 v[76:79], v1, s[36:39], s70 offen nt
    s_add_u32 s70, s70, 0x1000
    s_waitcnt vmcnt(6)
    v_dot2c_f32_bf16_dpp v10, v31, v116 row_newbcast:13 row_mask:0xf bank_mask:0xf
    v_dot2c_f32_bf16_dpp v11, v39, v116 row_newbcast:13 row_mask:0xf bank_mask:0xf
    v_dot2c_f32_bf16_dpp v12, v31, v117 row_newbcast:13 row_mask:0xf bank_mask:0xf
    v_dot2c_f32_bf16_dpp v13, v39, v117 row_newbcast:13 row_mask:0xf bank_mask:0xf
    v_dot2c_f32_bf16_dpp v14, v31, v118 row_newbcast:13 row_mask:0xf bank_mask:0xf
    v_dot2c_f32_bf16_dpp v15, v39, v118 row_newbcast:13 row_mask:0xf bank_mask:0xf
    v_dot2c_f32_bf16_dpp v16, v31, v119 row_newbcast:13 row_mask:0xf bank_mask:0xf
    v_dot2c_f32_bf16_dpp v17, v39, v119 row_newbcast:13 row_mask:0xf bank_mask:0xf
    buffer_load_dwordx4 v[80:83], v1, s[36:39], s70 offen nt
    s_add_u32 s70, s70, 0x1000
    s_waitcnt vmcnt(6)
    v_dot2c_f32_bf16_dpp v10, v31, v120 row_newbcast:14 row_mask:0xf bank_mask:0xf
    v_dot2c_f32_bf16_dpp v11, v39, v120 row_newbcast:14 row_mask:0xf bank_mask:0xf
    v_dot2c_f32_bf16_dpp v12, v31, v121 row_newbcast:14 row_mask:0xf bank_mask:0xf
    v_dot2c_f32_bf16_dpp v13, v39, v121 row_newbcast:14 row_mask:0xf bank_mask:0xf
    v_dot2c_f32_bf16_dpp v14, v31, v122 row_newbcast:14 row_mask:0xf bank_mask:0xf
    v_dot2c_f32_bf16_dpp v15, v39, v122 row_newbcast:14 row_mask:0xf bank_mask:0xf
    v_dot2c_f32_bf16_dpp v16, v31, v123 row_newbcast:14 row_mask:0xf bank_mask:0xf
    v_dot2c_f32_bf16_dpp v17, v39, v123 row_newbcast:14 row_mask:0xf bank_mask:0xf
    buffer_load_dwordx4 v[84:87], v1, s[36:39], s70 offen nt
    s_add_u32 s70, s70, 0x1000
    s_waitcnt vmcnt(6)
    v_dot2c_f32_bf16_dpp v10, v31, v124 row_newbcast:15 row_mask:0xf bank_mask:0xf
    v_dot2c_f32_bf16_dpp v11, v39, v124 row_newbcast:15 row_mask:0xf bank_mask:0xf
    v_dot2c_f32_bf16_dpp v12, v31, v125 row_newbcast:15 row_mask:0xf bank_mask:0xf
    v_dot2c_f32_bf16_dpp v13, v39, v125 row_newbcast:15 row_mask:0xf bank_mask:0xf
    v_dot2c_f32_bf16_dpp v14, v31, v126 row_newbcast:15 row_mask:0xf bank_mask:0xf
    v_dot2c_f32_bf16_dpp v15, v39, v126 row_newbcast:15 row_mask:0xf bank_mask:0xf
    v_dot2c_f32_bf16_dpp v16, v31, v127 row_newbcast:15 row_mask:0xf bank_mask:0xf
    v_dot2c_f32_bf16_dpp v17, v39, v127 row_newbcast:15 row_mask:0xf bank_mask:0xf
    buffer_load_dwordx4 v[88:91], v1, s[36:39], s70 offen nt
    s_add_u32 s70, s70, 0x1000
    s_waitcnt vmcnt(6)
    v_dot2c_f32_bf16_dpp v10, v32, v64 row_newbcast:0 row_mask:0xf bank_mask:0xf
    v_dot2c_f32_bf16_dpp v11, v40, v64 row_newbcast:0 row_mask:0xf bank_mask:0xf
    v_dot2c_f32_bf16_dpp v12, v32, v65 row_newbcast:0 row_mask:0xf bank_mask:0xf
    v_dot2c_f32_bf16_dpp v13, v40, v65 row_newbcast:0 row_mask:0xf bank_mask:0xf
    v_dot2c_f32_bf16_dpp v14, v32, v66 row_newbcast:0 row_mask:0xf bank_mask:0xf
    v_dot2c_f32_bf16_dpp v15, v40, v66 row_newbcast:0 row_mask:0xf bank_mask:0xf
    v_dot2c_f32_bf16_dpp v16, v32, v67 row_newbcast:0 row_mask:0xf bank_mask:0xf
    v_dot2c_f32_bf16_dpp v17, v40, v67 row_newbcast:0 row_mask:0xf bank_mask:0xf
    buffer_load_dwordx4 v[92:95], v1, s[36:39], s70 offen nt
    s_add_u32 s70, s70, 0x9000
    buffer_load_dwordx4 v[96:99], v1, s[36:39], s70 offen nt
    s_add_u32 s70, s70, 0x1000
    buffer_load_dwordx4 v[100:103], v1, s[36:39], s70 offen nt
    s_add_u32 s70, s70, 0x1000
    buffer_load_dwordx4 v[104:107], v1, s[36:39], s70 offen nt
    s_add_u32 s70, s70, 0x1000
    buffer_load_dwordx4 v[108:111], v1, s[36:39], s70 offen nt
    s_add_u32 s70, s70, 0x1000
    buffer_load_dwordx4 v[112:115], v1, s[36:39], s70 offen nt
    s_add_u32 s70, s70, 0x1000
    s_waitcnt vmcnt(11)
    v_dot2c_f32_bf16_dpp v10, v32, v68 row_newbcast:1 row_mask:0xf bank_mask:0xf
    v_dot2c_f32_bf16_dpp v11, v40, v68 row_newbcast:1 row_mask:0xf bank_mask:0xf
    v_dot2c_f32_bf16_dpp v12, v32, v69 row_newbcast:1 row_mask:0xf bank_mask:0xf
    v_dot2c_f32_bf16_dpp v13, v40, v69 row_newbcast:1 row_mask:0xf bank_mask:0xf
    v_dot2c_f32_bf16_dpp v14, v32, v70 row_newbcast:1 row_mask:0xf bank_mask:0xf
    v_dot2c_f32_bf16_dpp v15, v40, v70 row_newbcast:1 row_mask:0xf bank_mask:0xf
    v_dot2c_f32_bf16_dpp v16, v32, v71 row_newbcast:1 row_mask:0xf bank_mask:0xf
    v_dot2c_f32_bf16_dpp v17, v40, v71 row_newbcast:1 row_mask:0xf bank_mask:0xf
    buffer_load_dwordx4 v[116:119], v1, s[36:39], s70 offen nt
    s_add_u32 s70, s70, 0x1000
    s_waitcnt vmcnt(11)
    v_dot2c_f32_bf16_dpp v10, v32, v72 row_newbcast:2 row_mask:0xf bank_mask:0xf
    v_dot2c_f32_bf16_dpp v11, v40, v72 row_newbcast:2 row_mask:0xf bank_mask:0xf
    v_dot2c_f32_bf16_dpp v12, v32, v73 row_newbcast:2 row_mask:0xf bank_mask:0xf
    v_dot2c_f32_bf16_dpp v13, v40, v73 row_newbcast:2 row_mask:0xf bank_mask:0xf
    v_dot2c_f32_bf16_dpp v14, v32, v74 row_newbcast:2 row_mask:0xf bank_mask:0xf
    v_dot2c_f32_bf16_dpp v15, v40, v74 row_newbcast:2 row_mask:0xf bank_mask:0xf
    v_dot2c_f32_bf16_dpp v16, v32, v75 row_newbcast:2 row_mask:0xf bank_mask:0xf
    v_dot2c_f32_bf16_dpp v17, v40, v75 row_newbcast:2 row_mask:0xf bank_mask:0xf
    buffer_load_dwordx4 v[120:123], v1, s[36:39], s70 offen nt
    s_add_u32 s70, s70, 0x1000
    s_waitcnt vmcnt(11)
    v_dot2c_f32_bf16_dpp v10, v32, v76 row_newbcast:3 row_mask:0xf bank_mask:0xf
    v_dot2c_f32_bf16_dpp v11, v40, v76 row_newbcast:3 row_mask:0xf bank_mask:0xf
    v_dot2c_f32_bf16_dpp v12, v32, v77 row_newbcast:3 row_mask:0xf bank_mask:0xf
    v_dot2c_f32_bf16_dpp v13, v40, v77 row_newbcast:3 row_mask:0xf bank_mask:0xf
    v_dot2c_f32_bf16_dpp v14, v32, v78 row_newbcast:3 row_mask:0xf bank_mask:0xf
    v_dot2c_f32_bf16_dpp v15, v40, v78 row_newbcast:3 row_mask:0xf bank_mask:0xf
    v_dot2c_f32_bf16_dpp v16, v32, v79 row_newbcast:3 row_mask:0xf bank_mask:0xf
    v_dot2c_f32_bf16_dpp v17, v40, v79 row_newbcast:3 row_mask:0xf bank_mask:0xf
    buffer_load_dwordx4 v[124:127], v1, s[36:39], s70 offen nt
    s_add_u32 s70, s70, 0x9000
    s_waitcnt vmcnt(11)
    v_dot2c_f32_bf16_dpp v10, v32, v80 row_newbcast:4 row_mask:0xf bank_mask:0xf
    v_dot2c_f32_bf16_dpp v11, v40, v80 row_newbcast:4 row_mask:0xf bank_mask:0xf
    v_dot2c_f32_bf16_dpp v12, v32, v81 row_newbcast:4 row_mask:0xf bank_mask:0xf
    v_dot2c_f32_bf16_dpp v13, v40, v81 row_newbcast:4 row_mask:0xf bank_mask:0xf
    v_dot2c_f32_bf16_dpp v14, v32, v82 row_newbcast:4 row_mask:0xf bank_mask:0xf
    v_dot2c_f32_bf16_dpp v15, v40, v82 row_newbcast:4 row_mask:0xf bank_mask:0xf
    v_dot2c_f32_bf16_dpp v16, v32, v83 row_newbcast:4 row_mask:0xf bank_mask:0xf
    v_dot2c_f32_bf16_dpp v17, v40, v83 row_newbcast:4 row_mask:0xf bank_mask:0xf
    buffer_load_dwordx4 v[64:67], v1, s[36:39], s70 offen nt
    s_add_u32 s70, s70, 0x1000
    s_waitcnt vmcnt(11)
    v_dot2c_f32_bf16_dpp v10, v32, v84 row_newbcast:5 row_mask:0xf bank_mask:0xf
    v_dot2c_f32_bf16_dpp v11, v40, v84 row_newbcast:5 row_mask:0xf bank_mask:0xf
    v_dot2c_f32_bf16_dpp v12, v32, v85 row_newbcast:5 row_mask:0xf bank_mask:0xf
    v_dot2c_f32_bf16_dpp v13, v40, v85 row_newbcast:5 row_mask:0xf bank_mask:0xf
    v_dot2c_f32_bf16_dpp v14, v32, v86 row_newbcast:5 row_mask:0xf bank_mask:0xf
    v_dot2c_f32_bf16_dpp v15, v40, v86 row_newbcast:5 row_mask:0xf bank_mask:0xf
    v_dot2c_f32_bf16_dpp v16, v32, v87 row_newbcast:5 row_mask:0xf bank_mask:0xf
    v_dot2c_f32_bf16_dpp v17, v40, v87 row_newbcast:5 row_mask:0xf bank_mask:0xf
    buffer_load_dwordx4 v[68:71], v1, s[36:39], s70 offen nt
    s_add_u32 s70, s70, 0x1000
    s_waitcnt vmcnt(11)
    v_dot2c_f32_bf16_dpp v10, v32, v88 row_newbcast:6 row_mask:0xf bank_mask:0xf
    v_dot2c_f32_bf16_dpp v11, v40, v88 row_newbcast:6 row_mask:0xf bank_mask:0xf
    v_dot2c_f32_bf16_dpp v12, v32, v89 row_newbcast:6 row_mask:0xf bank_mask:0xf
    v_dot2c_f32_bf16_dpp v13, v40, v89 row_newbcast:6 row_mask:0xf bank_mask:0xf
    v_dot2c_f32_bf16_dpp v14, v32, v90 row_newbcast:6 row_mask:0xf bank_mask:0xf
    v_dot2c_f32_bf16_dpp v15, v40, v90 row_newbcast:6 row_mask:0xf bank_mask:0xf
    v_dot2c_f32_bf16_dpp v16, v32, v91 row_newbcast:6 row_mask:0xf bank_mask:0xf
    v_dot2c_f32_bf16_dpp v17, v40, v91 row_newbcast:6 row_mask:0xf bank_mask:0xf
    buffer_load_dwordx4 v[72:75], v1, s[36:39], s70 offen nt
    s_add_u32 s70, s70, 0x1000
    s_waitcnt vmcnt(11)
    v_dot2c_f32_bf16_dpp v10, v32, v92 row_newbcast:7 row_mask:0xf bank_mask:0xf
    v_dot2c_f32_bf16_dpp v11, v40, v92 row_newbcast:7 row_mask:0xf bank_mask:0xf
    v_dot2c_f32_bf16_dpp v12, v32, v93 row_newbcast:7 row_mask:0xf bank_mask:0xf
    v_dot2c_f32_bf16_dpp v13, v40, v93 row_newbcast:7 row_mask:0xf bank_mask:0xf
    v_dot2c_f32_bf16_dpp v14, v32, v94 row_newbcast:7 row_mask:0xf bank_mask:0xf
    v_dot2c_f32_bf16_dpp v15, v40, v94 row_newbcast:7 row_mask:0xf bank_mask:0xf
    v_dot2c_f32_bf16_dpp v16, v32, v95 row_newbcast:7 row_mask:0xf bank_mask:0xf
    v_dot2c_f32_bf16_dpp v17, v40, v95 row_newbcast:7 row_mask:0xf bank_mask:0xf
    buffer_load_dwordx4 v[76:79], v1, s[36:39], s70 offen nt
    s_add_u32 s70, s70, 0x1000
    s_waitcnt vmcnt(11)
    v_dot2c_f32_bf16_dpp v10, v32, v96 row_newbcast:8 row_mask:0xf bank_mask:0xf
    v_dot2c_f32_bf16_dpp v11, v40, v96 row_newbcast:8 row_mask:0xf bank_mask:0xf
    v_dot2c_f32_bf16_dpp v12, v32, v97 row_newbcast:8 row_mask:0xf bank_mask:0xf
    v_dot2c_f32_bf16_dpp v13, v40, v97 row_newbcast:8 row_mask:0xf bank_mask:0xf
    v_dot2c_f32_bf16_dpp v14, v32, v98 row_newbcast:8 row_mask:0xf bank_mask:0xf
    v_dot2c_f32_bf16_dpp v15, v40, v98 row_newbcast:8 row_mask:0xf bank_mask:0xf
    v_dot2c_f32_bf16_dpp v16, v32, v99 row_newbcast:8 row_mask:0xf bank_mask:0xf
    v_dot2c_f32_bf16_dpp v17, v40, v99 row_newbcast:8 row_mask:0xf bank_mask:0xf
    buffer_load_dwordx4 v[80:83], v1, s[36:39], s70 offen nt
    s_add_u32 s70, s70, 0x1000
    s_waitcnt vmcnt(11)
    v_dot2c_f32_bf16_dpp v10, v32, v100 row_newbcast:9 row_mask:0xf bank_mask:0xf
    v_dot2c_f32_bf16_dpp v11, v40, v100 row_newbcast:9 row_mask:0xf bank_mask:0xf
    v_dot2c_f32_bf16_dpp v12, v32, v101 row_newbcast:9 row_mask:0xf bank_mask:0xf
    v_dot2c_f32_bf16_dpp v13, v40, v101 row_newbcast:9 row_mask:0xf bank_mask:0xf
    v_dot2c_f32_bf16_dpp v14, v32, v102 row_newbcast:9 row_mask:0xf bank_mask:0xf
    v_dot2c_f32_bf16_dpp v15, v40, v102 row_newbcast:9 row_mask:0xf bank_mask:0xf
    v_dot2c_f32_bf16_dpp v16, v32, v103 row_newbcast:9 row_mask:0xf bank_mask:0xf
    v_dot2c_f32_bf16_dpp v17, v40, v103 row_newbcast:9 row_mask:0xf bank_mask:0xf
    buffer_load_dwordx4 v[84:87], v1, s[36:39], s70 offen nt
    s_add_u32 s70, s70, 0x1000
    s_waitcnt vmcnt(11)
    v_dot2c_f32_bf16_dpp v10, v32, v104 row_newbcast:10 row_mask:0xf bank_mask:0xf
    v_dot2c_f32_bf16_dpp v11, v40, v104 row_newbcast:10 row_mask:0xf bank_mask:0xf
    v_dot2c_f32_bf16_dpp v12, v32, v105 row_newbcast:10 row_mask:0xf bank_mask:0xf
    v_dot2c_f32_bf16_dpp v13, v40, v105 row_newbcast:10 row_mask:0xf bank_mask:0xf
    v_dot2c_f32_bf16_dpp v14, v32, v106 row_newbcast:10 row_mask:0xf bank_mask:0xf
    v_dot2c_f32_bf16_dpp v15, v40, v106 row_newbcast:10 row_mask:0xf bank_mask:0xf
    v_dot2c_f32_bf16_dpp v16, v32, v107 row_newbcast:10 row_mask:0xf bank_mask:0xf
    v_dot2c_f32_bf16_dpp v17, v40, v107 row_newbcast:10 row_mask:0xf bank_mask:0xf
    buffer_load_dwordx4 v[88:91], v1, s[36:39], s70 offen nt
    s_add_u32 s70, s70, 0x1000
    s_waitcnt vmcnt(11)
    v_dot2c_f32_bf16_dpp v10, v32, v108 row_newbcast:11 row_mask:0xf bank_mask:0xf
    v_dot2c_f32_bf16_dpp v11, v40, v108 row_newbcast:11 row_mask:0xf bank_mask:0xf
    v_dot2c_f32_bf16_dpp v12, v32, v109 row_newbcast:11 row_mask:0xf bank_mask:0xf
    v_dot2c_f32_bf16_dpp v13, v40, v109 row_newbcast:11 row_mask:0xf bank_mask:0xf
    v_dot2c_f32_bf16_dpp v14, v32, v110 row_newbcast:11 row_mask:0xf bank_mask:0xf
    v_dot2c_f32_bf16_dpp v15, v40, v110 row_newbcast:11 row_mask:0xf bank_mask:0xf
    v_dot2c_f32_bf16_dpp v16, v32, v111 row_newbcast:11 row_mask:0xf bank_mask:0xf
    v_dot2c_f32_bf16_dpp v17, v40, v111 row_newbcast:11 row_mask:0xf bank_mask:0xf
    buffer_load_dwordx4 v[92:95], v1, s[36:39], s70 offen nt
    s_add_u32 s70, s70, 0x9000
    s_waitcnt vmcnt(11)
    v_dot2c_f32_bf16_dpp v10, v32, v112 row_newbcast:12 row_mask:0xf bank_mask:0xf
    v_dot2c_f32_bf16_dpp v11, v40, v112 row_newbcast:12 row_mask:0xf bank_mask:0xf
    v_dot2c_f32_bf16_dpp v12, v32, v113 row_newbcast:12 row_mask:0xf bank_mask:0xf
    v_dot2c_f32_bf16_dpp v13, v40, v113 row_newbcast:12 row_mask:0xf bank_mask:0xf
    v_dot2c_f32_bf16_dpp v14, v32, v114 row_newbcast:12 row_mask:0xf bank_mask:0xf
    v_dot2c_f32_bf16_dpp v15, v40, v114 row_newbcast:12 row_mask:0xf bank_mask:0xf
    v_dot2c_f32_bf16_dpp v16, v32, v115 row_newbcast:12 row_mask:0xf bank_mask:0xf
    v_dot2c_f32_bf16_dpp v17, v40, v115 row_newbcast:12 row_mask:0xf bank_mask:0xf
    buffer_load_dwordx4 v[96:99], v1, s[36:39], s70 offen nt
    s_add_u32 s70, s70, 0x1000
    s_waitcnt vmcnt(11)
    v_dot2c_f32_bf16_dpp v10, v32, v116 row_newbcast:13 row_mask:0xf bank_mask:0xf
    v_dot2c_f32_bf16_dpp v11, v40, v116 row_newbcast:13 row_mask:0xf bank_mask:0xf
    v_dot2c_f32_bf16_dpp v12, v32, v117 row_newbcast:13 row_mask:0xf bank_mask:0xf
    v_dot2c_f32_bf16_dpp v13, v40, v117 row_newbcast:13 row_mask:0xf bank_mask:0xf
    v_dot2c_f32_bf16_dpp v14, v32, v118 row_newbcast:13 row_mask:0xf bank_mask:0xf
    v_dot2c_f32_bf16_dpp v15, v40, v118 row_newbcast:13 row_mask:0xf bank_mask:0xf
    v_dot2c_f32_bf16_dpp v16, v32, v119 row_newbcast:13 row_mask:0xf bank_mask:0xf
    v_dot2c_f32_bf16_dpp v17, v40, v119 row_newbcast:13 row_mask:0xf bank_mask:0xf
    buffer_load_dwordx4 v[100:103], v1, s[36:39], s70 offen nt
    s_add_u32 s70, s70, 0x1000
    s_waitcnt vmcnt(11)
    v_dot2c_f32_bf16_dpp v10, v32, v120 row_newbcast:14 row_mask:0xf bank_mask:0xf
    v_dot2c_f32_bf16_dpp v11, v40, v120 row_newbcast:14 row_mask:0xf bank_mask:0xf
    v_dot2c_f32_bf16_dpp v12, v32, v121 row_newbcast:14 row_mask:0xf bank_mask:0xf
    v_dot2c_f32_bf16_dpp v13, v40, v121 row_newbcast:14 row_mask:0xf bank_mask:0xf
    v_dot2c_f32_bf16_dpp v14, v32, v122 row_newbcast:14 row_mask:0xf bank_mask:0xf
    v_dot2c_f32_bf16_dpp v15, v40, v122 row_newbcast:14 row_mask:0xf bank_mask:0xf
    v_dot2c_f32_bf16_dpp v16, v32, v123 row_newbcast:14 row_mask:0xf bank_mask:0xf
    v_dot2c_f32_bf16_dpp v17, v40, v123 row_newbcast:14 row_mask:0xf bank_mask:0xf
    buffer_load_dwordx4 v[104:107], v1, s[36:39], s70 offen nt
    s_add_u32 s70, s70, 0x1000
    s_waitcnt vmcnt(11)
    v_dot2c_f32_bf16_dpp v10, v32, v124 row_newbcast:15 row_mask:0xf bank_mask:0xf
    v_dot2c_f32_bf16_dpp v11, v40, v124 row_newbcast:15 row_mask:0xf bank_mask:0xf
    v_dot2c_f32_bf16_dpp v12, v32, v125 row_newbcast:15 row_mask:0xf bank_mask:0xf
    v_dot2c_f32_bf16_dpp v13, v40, v125 row_newbcast:15 row_mask:0xf bank_mask:0xf
    v_dot2c_f32_bf16_dpp v14, v32, v126 row_newbcast:15 row_mask:0xf bank_mask:0xf
    v_dot2c_f32_bf16_dpp v15, v40, v126 row_newbcast:15 row_mask:0xf bank_mask:0xf
    v_dot2c_f32_bf16_dpp v16, v32, v127 row_newbcast:15 row_mask:0xf bank_mask:0xf
    v_dot2c_f32_bf16_dpp v17, v40, v127 row_newbcast:15 row_mask:0xf bank_mask:0xf
    buffer_load_dwordx4 v[108:111], v1, s[36:39], s70 offen nt
    s_add_u32 s70, s70, 0x1000
    s_waitcnt vmcnt(11)
    v_dot2c_f32_bf16_dpp v10, v33, v64 row_newbcast:0 row_mask:0xf bank_mask:0xf
    v_dot2c_f32_bf16_dpp v11, v41, v64 row_newbcast:0 row_mask:0xf bank_mask:0xf
    v_dot2c_f32_bf16_dpp v12, v33, v65 row_newbcast:0 row_mask:0xf bank_mask:0xf
    v_dot2c_f32_bf16_dpp v13, v41, v65 row_newbcast:0 row_mask:0xf bank_mask:0xf
    v_dot2c_f32_bf16_dpp v14, v33, v66 row_newbcast:0 row_mask:0xf bank_mask:0xf
    v_dot2c_f32_bf16_dpp v15, v41, v66 row_newbcast:0 row_mask:0xf bank_mask:0xf
    v_dot2c_f32_bf16_dpp v16, v33, v67 row_newbcast:0 row_mask:0xf bank_mask:0xf
    v_dot2c_f32_bf16_dpp v17, v41, v67 row_newbcast:0 row_mask:0xf bank_mask:0xf
    buffer_load_dwordx4 v[112:115], v1, s[36:39], s70 offen nt
    s_add_u32 s70, s70, 0x1000
    v_and_b32 v50, 15, v0
    v_lshrrev_b32 v51, 4, v0
    v_lshlrev_b32 v50, 5, v50
    s_lshl_b32 s80, s3, 9
    v_lshl_add_u32 v52, v51, 3, v50
    v_add_u32 v52, s80, v52
    s_lshl_b32 s80, s68, 1
    v_add_u32 v50, s80, v0
    v_and_b32 v50, 15, v50
    v_lshlrev_b32 v50, 5, v50
    v_lshl_add_u32 v50, v51, 2, v50
    v_add_u32 v50, 6144, v50
    v_add_u32 v51, 1024, v50
    v_mov_b32 v53, 0
    s_waitcnt vmcnt(11)
    v_dot2c_f32_bf16_dpp v10, v33, v68 row_newbcast:1 row_mask:0xf bank_mask:0xf
    v_dot2c_f32_bf16_dpp v11, v41, v68 row_newbcast:1 row_mask:0xf bank_mask:0xf
    v_dot2c_f32_bf16_dpp v12, v33, v69 row_newbcast:1 row_mask:0xf bank_mask:0xf
    v_dot2c_f32_bf16_dpp v13, v41, v69 row_newbcast:1 row_mask:0xf bank_mask:0xf
    v_dot2c_f32_bf16_dpp v14, v33, v70 row_newbcast:1 row_mask:0xf bank_mask:0xf
    v_dot2c_f32_bf16_dpp v15, v41, v70 row_newbcast:1 row_mask:0xf bank_mask:0xf
    v_dot2c_f32_bf16_dpp v16, v33, v71 row_newbcast:1 row_mask:0xf bank_mask:0xf
    v_dot2c_f32_bf16_dpp v17, v41, v71 row_newbcast:1 row_mask:0xf bank_mask:0xf
    buffer_load_dwordx4 v[116:119], v1, s[36:39], s70 offen nt
    s_add_u32 s70, s70, 0x1000
    s_waitcnt vmcnt(11)
    v_dot2c_f32_bf16_dpp v10, v33, v72 row_newbcast:2 row_mask:0xf bank_mask:0xf
    v_dot2c_f32_bf16_dpp v11, v41, v72 row_newbcast:2 row_mask:0xf bank_mask:0xf
    v_dot2c_f32_bf16_dpp v12, v33, v73 row_newbcast:2 row_mask:0xf bank_mask:0xf
    v_dot2c_f32_bf16_dpp v13, v41, v73 row_newbcast:2 row_mask:0xf bank_mask:0xf
    v_dot2c_f32_bf16_dpp v14, v33, v74 row_newbcast:2 row_mask:0xf bank_mask:0xf
    v_dot2c_f32_bf16_dpp v15, v41, v74 row_newbcast:2 row_mask:0xf bank_mask:0xf
    v_dot2c_f32_bf16_dpp v16, v33, v75 row_newbcast:2 row_mask:0xf bank_mask:0xf
    v_dot2c_f32_bf16_dpp v17, v41, v75 row_newbcast:2 row_mask:0xf bank_mask:0xf
    buffer_load_dwordx4 v[120:123], v1, s[36:39], s70 offen nt
    s_add_u32 s70, s70, 0x1000
    s_waitcnt vmcnt(11)
    v_dot2c_f32_bf16_dpp v10, v33, v76 row_newbcast:3 row_mask:0xf bank_mask:0xf
    v_dot2c_f32_bf16_dpp v11, v41, v76 row_newbcast:3 row_mask:0xf bank_mask:0xf
    v_dot2c_f32_bf16_dpp v12, v33, v77 row_newbcast:3 row_mask:0xf bank_mask:0xf
    v_dot2c_f32_bf16_dpp v13, v41, v77 row_newbcast:3 row_mask:0xf bank_mask:0xf
    v_dot2c_f32_bf16_dpp v14, v33, v78 row_newbcast:3 row_mask:0xf bank_mask:0xf
    v_dot2c_f32_bf16_dpp v15, v41, v78 row_newbcast:3 row_mask:0xf bank_mask:0xf
    v_dot2c_f32_bf16_dpp v16, v33, v79 row_newbcast:3 row_mask:0xf bank_mask:0xf
    v_dot2c_f32_bf16_dpp v17, v41, v79 row_newbcast:3 row_mask:0xf bank_mask:0xf
    buffer_load_dwordx4 v[124:127], v1, s[36:39], s70 offen nt
    s_add_u32 s70, s70, 0x9000
    s_waitcnt vmcnt(11)
    v_dot2c_f32_bf16_dpp v10, v33, v80 row_newbcast:4 row_mask:0xf bank_mask:0xf
    v_dot2c_f32_bf16_dpp v11, v41, v80 row_newbcast:4 row_mask:0xf bank_mask:0xf
    v_dot2c_f32_bf16_dpp v12, v33, v81 row_newbcast:4 row_mask:0xf bank_mask:0xf
    v_dot2c_f32_bf16_dpp v13, v41, v81 row_newbcast:4 row_mask:0xf bank_mask:0xf
    v_dot2c_f32_bf16_dpp v14, v33, v82 row_newbcast:4 row_mask:0xf bank_mask:0xf
    v_dot2c_f32_bf16_dpp v15, v41, v82 row_newbcast:4 row_mask:0xf bank_mask:0xf
    v_dot2c_f32_bf16_dpp v16, v33, v83 row_newbcast:4 row_mask:0xf bank_mask:0xf
    v_dot2c_f32_bf16_dpp v17, v41, v83 row_newbcast:4 row_mask:0xf bank_mask:0xf
    s_waitcnt vmcnt(10)
    v_dot2c_f32_bf16_dpp v10, v33, v84 row_newbcast:5 row_mask:0xf bank_mask:0xf
    v_dot2c_f32_bf16_dpp v11, v41, v84 row_newbcast:5 row_mask:0xf bank_mask:0xf
    v_dot2c_f32_bf16_dpp v12, v33, v85 row_newbcast:5 row_mask:0xf bank_mask:0xf
    v_dot2c_f32_bf16_dpp v13, v41, v85 row_newbcast:5 row_mask:0xf bank_mask:0xf
    v_dot2c_f32_bf16_dpp v14, v33, v86 row_newbcast:5 row_mask:0xf bank_mask:0xf
    v_dot2c_f32_bf16_dpp v15, v41, v86 row_newbcast:5 row_mask:0xf bank_mask:0xf
    v_dot2c_f32_bf16_dpp v16, v33, v87 row_newbcast:5 row_mask:0xf bank_mask:0xf
    v_dot2c_f32_bf16_dpp v17, v41, v87 row_newbcast:5 row_mask:0xf bank_mask:0xf
    s_waitcnt vmcnt(9)
    v_dot2c_f32_bf16_dpp v10, v33, v88 row_newbcast:6 row_mask:0xf bank_mask:0xf
    v_dot2c_f32_bf16_dpp v11, v41, v88 row_newbcast:6 row_mask:0xf bank_mask:0xf
    v_dot2c_f32_bf16_dpp v12, v33, v89 row_newbcast:6 row_mask:0xf bank_mask:0xf
    v_dot2c_f32_bf16_dpp v13, v41, v89 row_newbcast:6 row_mask:0xf bank_mask:0xf
    v_dot2c_f32_bf16_dpp v14, v33, v90 row_newbcast:6 row_mask:0xf bank_mask:0xf
    v_dot2c_f32_bf16_dpp v15, v41, v90 row_newbcast:6 row_mask:0xf bank_mask:0xf
    v_dot2c_f32_bf16_dpp v16, v33, v91 row_newbcast:6 row_mask:0xf bank_mask:0xf
    v_dot2c_f32_bf16_dpp v17, v41, v91 row_newbcast:6 row_mask:0xf bank_mask:0xf
    s_waitcnt vmcnt(8)
    v_dot2c_f32_bf16_dpp v10, v33, v92 row_newbcast:7 row_mask:0xf bank_mask:0xf
    v_dot2c_f32_bf16_dpp v11, v41, v92 row_newbcast:7 row_mask:0xf bank_mask:0xf
    v_dot2c_f32_bf16_dpp v12, v33, v93 row_newbcast:7 row_mask:0xf bank_mask:0xf
    v_dot2c_f32_bf16_dpp v13, v41, v93 row_newbcast:7 row_mask:0xf bank_mask:0xf
    v_dot2c_f32_bf16_dpp v14, v33, v94 row_newbcast:7 row_mask:0xf bank_mask:0xf
    v_dot2c_f32_bf16_dpp v15, v41, v94 row_newbcast:7 row_mask:0xf bank_mask:0xf
    v_dot2c_f32_bf16_dpp v16, v33, v95 row_newbcast:7 row_mask:0xf bank_mask:0xf
    v_dot2c_f32_bf16_dpp v17, v41, v95 row_newbcast:7 row_mask:0xf bank_mask:0xf
    s_waitcnt vmcnt(7)
    v_dot2c_f32_bf16_dpp v10, v33, v96 row_newbcast:8 row_mask:0xf bank_mask:0xf
    v_dot2c_f32_bf16_dpp v11, v41, v96 row_newbcast:8 row_mask:0xf bank_mask:0xf
    v_dot2c_f32_bf16_dpp v12, v33, v97 row_newbcast:8 row_mask:0xf bank_mask:0xf
    v_dot2c_f32_bf16_dpp v13, v41, v97 row_newbcast:8 row_mask:0xf bank_mask:0xf
    v_dot2c_f32_bf16_dpp v14, v33, v98 row_newbcast:8 row_mask:0xf bank_mask:0xf
    v_dot2c_f32_bf16_dpp v15, v41, v98 row_newbcast:8 row_mask:0xf bank_mask:0xf
    v_dot2c_f32_bf16_dpp v16, v33, v99 row_newbcast:8 row_mask:0xf bank_mask:0xf
    v_dot2c_f32_bf16_dpp v17, v41, v99 row_newbcast:8 row_mask:0xf bank_mask:0xf
    s_waitcnt vmcnt(6)
    v_dot2c_f32_bf16_dpp v10, v33, v100 row_newbcast:9 row_mask:0xf bank_mask:0xf
    v_dot2c_f32_bf16_dpp v11, v41, v100 row_newbcast:9 row_mask:0xf bank_mask:0xf
    v_dot2c_f32_bf16_dpp v12, v33, v101 row_newbcast:9 row_mask:0xf bank_mask:0xf
    v_dot2c_f32_bf16_dpp v13, v41, v101 row_newbcast:9 row_mask:0xf bank_mask:0xf
    v_dot2c_f32_bf16_dpp v14, v33, v102 row_newbcast:9 row_mask:0xf bank_mask:0xf
    v_dot2c_f32_bf16_dpp v15, v41, v102 row_newbcast:9 row_mask:0xf bank_mask:0xf
    v_dot2c_f32_bf16_dpp v16, v33, v103 row_newbcast:9 row_mask:0xf bank_mask:0xf
    v_dot2c_f32_bf16_dpp v17, v41, v103 row_newbcast:9 row_mask:0xf bank_mask:0xf
    s_waitcnt vmcnt(5)
    v_dot2c_f32_bf16_dpp v10, v33, v104 row_newbcast:10 row_mask:0xf bank_mask:0xf
    v_dot2c_f32_bf16_dpp v11, v41, v104 row_newbcast:10 row_mask:0xf bank_mask:0xf
    v_dot2c_f32_bf16_dpp v12, v33, v105 row_newbcast:10 row_mask:0xf bank_mask:0xf
    v_dot2c_f32_bf16_dpp v13, v41, v105 row_newbcast:10 row_mask:0xf bank_mask:0xf
    v_dot2c_f32_bf16_dpp v14, v33, v106 row_newbcast:10 row_mask:0xf bank_mask:0xf
    v_dot2c_f32_bf16_dpp v15, v41, v106 row_newbcast:10 row_mask:0xf bank_mask:0xf
    v_dot2c_f32_bf16_dpp v16, v33, v107 row_newbcast:10 row_mask:0xf bank_mask:0xf
    v_dot2c_f32_bf16_dpp v17, v41, v107 row_newbcast:10 row_mask:0xf bank_mask:0xf
    s_waitcnt vmcnt(4)
    v_dot2c_f32_bf16_dpp v10, v33, v108 row_newbcast:11 row_mask:0xf bank_mask:0xf
    v_dot2c_f32_bf16_dpp v11, v41, v108 row_newbcast:11 row_mask:0xf bank_mask:0xf
    v_dot2c_f32_bf16_dpp v12, v33, v109 row_newbcast:11 row_mask:0xf bank_mask:0xf
    v_dot2c_f32_bf16_dpp v13, v41, v109 row_newbcast:11 row_mask:0xf bank_mask:0xf
    v_dot2c_f32_bf16_dpp v14, v33, v110 row_newbcast:11 row_mask:0xf bank_mask:0xf
    v_dot2c_f32_bf16_dpp v15, v41, v110 row_newbcast:11 row_mask:0xf bank_mask:0xf
    v_dot2c_f32_bf16_dpp v16, v33, v111 row_newbcast:11 row_mask:0xf bank_mask:0xf
    v_dot2c_f32_bf16_dpp v17, v41, v111 row_newbcast:11 row_mask:0xf bank_mask:0xf
    s_waitcnt vmcnt(3)
    v_dot2c_f32_bf16_dpp v10, v33, v112 row_newbcast:12 row_mask:0xf bank_mask:0xf
    v_dot2c_f32_bf16_dpp v11, v41, v112 row_newbcast:12 row_mask:0xf bank_mask:0xf
    v_dot2c_f32_bf16_dpp v12, v33, v113 row_newbcast:12 row_mask:0xf bank_mask:0xf
    v_dot2c_f32_bf16_dpp v13, v41, v113 row_newbcast:12 row_mask:0xf bank_mask:0xf
    v_dot2c_f32_bf16_dpp v14, v33, v114 row_newbcast:12 row_mask:0xf bank_mask:0xf
    v_dot2c_f32_bf16_dpp v15, v41, v114 row_newbcast:12 row_mask:0xf bank_mask:0xf
    v_dot2c_f32_bf16_dpp v16, v33, v115 row_newbcast:12 row_mask:0xf bank_mask:0xf
    v_dot2c_f32_bf16_dpp v17, v41, v115 row_newbcast:12 row_mask:0xf bank_mask:0xf
    s_waitcnt vmcnt(2)
    v_dot2c_f32_bf16_dpp v10, v33, v116 row_newbcast:13 row_mask:0xf bank_mask:0xf
    v_dot2c_f32_bf16_dpp v11, v41, v116 row_newbcast:13 row_mask:0xf bank_mask:0xf
    v_dot2c_f32_bf16_dpp v12, v33, v117 row_newbcast:13 row_mask:0xf bank_mask:0xf
    v_dot2c_f32_bf16_dpp v13, v41, v117 row_newbcast:13 row_mask:0xf bank_mask:0xf
    v_dot2c_f32_bf16_dpp v14, v33, v118 row_newbcast:13 row_mask:0xf bank_mask:0xf
    v_dot2c_f32_bf16_dpp v15, v41, v118 row_newbcast:13 row_mask:0xf bank_mask:0xf
    v_dot2c_f32_bf16_dpp v16, v33, v119 row_newbcast:13 row_mask:0xf bank_mask:0xf
    v_dot2c_f32_bf16_dpp v17, v41, v119 row_newbcast:13 row_mask:0xf bank_mask:0xf
    s_waitcnt vmcnt(1)
    v_dot2c_f32_bf16_dpp v10, v33, v120 row_newbcast:14 row_mask:0xf bank_mask:0xf
    v_dot2c_f32_bf16_dpp v11, v41, v120 row_newbcast:14 row_mask:0xf bank_mask:0xf
    v_dot2c_f32_bf16_dpp v12, v33, v121 row_newbcast:14 row_mask:0xf bank_mask:0xf
    v_dot2c_f32_bf16_dpp v13, v41, v121 row_newbcast:14 row_mask:0xf bank_mask:0xf
    v_dot2c_f32_bf16_dpp v14, v33, v122 row_newbcast:14 row_mask:0xf bank_mask:0xf
    v_dot2c_f32_bf16_dpp v15, v41, v122 row_newbcast:14 row_mask:0xf bank_mask:0xf
    v_dot2c_f32_bf16_dpp v16, v33, v123 row_newbcast:14 row_mask:0xf bank_mask:0xf
    v_dot2c_f32_bf16_dpp v17, v41, v123 row_newbcast:14 row_mask:0xf bank_mask:0xf
    s_waitcnt vmcnt(0)
    v_dot2c_f32_bf16_dpp v10, v33, v124 row_newbcast:15 row_mask:0xf bank_mask:0xf
    v_dot2c_f32_bf16_dpp v11, v41, v124 row_newbcast:15 row_mask:0xf bank_mask:0xf
    v_dot2c_f32_bf16_dpp v12, v33, v125 row_newbcast:15 row_mask:0xf bank_mask:0xf
    v_dot2c_f32_bf16_dpp v13, v41, v125 row_newbcast:15 row_mask:0xf bank_mask:0xf
    v_dot2c_f32_bf16_dpp v14, v33, v126 row_newbcast:15 row_mask:0xf bank_mask:0xf
    v_dot2c_f32_bf16_dpp v15, v41, v126 row_newbcast:15 row_mask:0xf bank_mask:0xf
    v_dot2c_f32_bf16_dpp v16, v33, v127 row_newbcast:15 row_mask:0xf bank_mask:0xf
    v_dot2c_f32_bf16_dpp v17, v41, v127 row_newbcast:15 row_mask:0xf bank_mask:0xf
    v_permlane32_swap_b32 v10, v14
    v_permlane32_swap_b32 v11, v15
    v_permlane32_swap_b32 v12, v16
    v_permlane32_swap_b32 v13, v17
    v_add_f32 v10, v10, v14
    v_add_f32 v11, v11, v15
    v_add_f32 v12, v12, v16
    v_add_f32 v13, v13, v17
    s_nop 0
    v_permlane16_swap_b32 v10, v12
    v_permlane16_swap_b32 v11, v13
    v_add_f32 v10, v10, v12
    v_add_f32 v11, v11, v13
    ds_write_b64 v52, v[10:11] offset:6144
    s_waitcnt lgkmcnt(0)
    s_barrier
    ds_read2_b32 v[42:43], v50 offset0:0 offset1:4
    ds_read2_b32 v[44:45], v50 offset0:128 offset1:132
    ds_read2_b32 v[46:47], v51 offset0:0 offset1:4
    ds_read2_b32 v[48:49], v51 offset0:128 offset1:132
    ds_read_b128 v[14:17], v53 offset:2112
    ds_read_b64 v[12:13], v52 offset:4096
    v_mov_b32 v18, 0
    v_mov_b32 v19, 0
    v_mov_b32 v20, 0
    v_mov_b32 v21, 0
    v_mov_b32 v22, 0
    v_mov_b32 v23, 0
    v_mov_b32 v24, 0
    v_mov_b32 v25, 0
    s_waitcnt lgkmcnt(0)
    v_mul_f32 v42, v14, v42
    v_mul_f32 v43, v14, v43
    v_mul_f32 v46, v16, v46
    v_mul_f32 v47, v16, v47
    v_fmac_f32 v42, v15, v44
    v_fmac_f32 v43, v15, v45
    v_fmac_f32 v46, v17, v48
    v_fmac_f32 v47, v17, v49
    v_add_f32 v42, v42, v46
    v_add_f32 v43, v43, v47
    v_cvt_pk_bf16_f32 v42, v42, v43
    s_nop 1
    v_dot2c_f32_bf16_dpp v18, v42, v57 row_newbcast:0 row_mask:0xf bank_mask:0xf
    v_dot2c_f32_bf16_dpp v19, v42, v132 row_newbcast:0 row_mask:0xf bank_mask:0xf
    v_dot2c_f32_bf16_dpp v20, v42, v128 row_newbcast:0 row_mask:0xf bank_mask:0xf
    v_dot2c_f32_bf16_dpp v21, v42, v133 row_newbcast:0 row_mask:0xf bank_mask:0xf
    v_dot2c_f32_bf16_dpp v22, v42, v129 row_newbcast:0 row_mask:0xf bank_mask:0xf
    v_dot2c_f32_bf16_dpp v23, v42, v134 row_newbcast:0 row_mask:0xf bank_mask:0xf
    v_dot2c_f32_bf16_dpp v24, v42, v130 row_newbcast:0 row_mask:0xf bank_mask:0xf
    v_dot2c_f32_bf16_dpp v25, v42, v135 row_newbcast:0 row_mask:0xf bank_mask:0xf
    v_dot2c_f32_bf16_dpp v18, v42, v131 row_newbcast:1 row_mask:0xf bank_mask:0xf
    v_dot2c_f32_bf16_dpp v19, v42, v140 row_newbcast:1 row_mask:0xf bank_mask:0xf
    v_dot2c_f32_bf16_dpp v20, v42, v136 row_newbcast:1 row_mask:0xf bank_mask:0xf
    v_dot2c_f32_bf16_dpp v21, v42, v141 row_newbcast:1 row_mask:0xf bank_mask:0xf
    v_dot2c_f32_bf16_dpp v22, v42, v137 row_newbcast:1 row_mask:0xf bank_mask:0xf
    v_dot2c_f32_bf16_dpp v23, v42, v142 row_newbcast:1 row_mask:0xf bank_mask:0xf
    v_dot2c_f32_bf16_dpp v24, v42, v138 row_newbcast:1 row_mask:0xf bank_mask:0xf
    v_dot2c_f32_bf16_dpp v25, v42, v143 row_newbcast:1 row_mask:0xf bank_mask:0xf
    v_dot2c_f32_bf16_dpp v18, v42, v139 row_newbcast:2 row_mask:0xf bank_mask:0xf
    v_dot2c_f32_bf16_dpp v19, v42, v148 row_newbcast:2 row_mask:0xf bank_mask:0xf
    v_dot2c_f32_bf16_dpp v20, v42, v144 row_newbcast:2 row_mask:0xf bank_mask:0xf
    v_dot2c_f32_bf16_dpp v21, v42, v149 row_newbcast:2 row_mask:0xf bank_mask:0xf
    v_dot2c_f32_bf16_dpp v22, v42, v145 row_newbcast:2 row_mask:0xf bank_mask:0xf
    v_dot2c_f32_bf16_dpp v23, v42, v150 row_newbcast:2 row_mask:0xf bank_mask:0xf
    v_dot2c_f32_bf16_dpp v24, v42, v146 row_newbcast:2 row_mask:0xf bank_mask:0xf
    v_dot2c_f32_bf16_dpp v25, v42, v151 row_newbcast:2 row_mask:0xf bank_mask:0xf
    v_dot2c_f32_bf16_dpp v18, v42, v147 row_newbcast:3 row_mask:0xf bank_mask:0xf
    v_dot2c_f32_bf16_dpp v19, v42, v156 row_newbcast:3 row_mask:0xf bank_mask:0xf
    v_dot2c_f32_bf16_dpp v20, v42, v152 row_newbcast:3 row_mask:0xf bank_mask:0xf
    v_dot2c_f32_bf16_dpp v21, v42, v157 row_newbcast:3 row_mask:0xf bank_mask:0xf
    v_dot2c_f32_bf16_dpp v22, v42, v153 row_newbcast:3 row_mask:0xf bank_mask:0xf
    v_dot2c_f32_bf16_dpp v23, v42, v158 row_newbcast:3 row_mask:0xf bank_mask:0xf
    v_dot2c_f32_bf16_dpp v24, v42, v154 row_newbcast:3 row_mask:0xf bank_mask:0xf
    v_dot2c_f32_bf16_dpp v25, v42, v159 row_newbcast:3 row_mask:0xf bank_mask:0xf
    v_dot2c_f32_bf16_dpp v18, v42, v155 row_newbcast:4 row_mask:0xf bank_mask:0xf
    v_dot2c_f32_bf16_dpp v19, v42, v164 row_newbcast:4 row_mask:0xf bank_mask:0xf
    v_dot2c_f32_bf16_dpp v20, v42, v160 row_newbcast:4 row_mask:0xf bank_mask:0xf
    v_dot2c_f32_bf16_dpp v21, v42, v165 row_newbcast:4 row_mask:0xf bank_mask:0xf
    v_dot2c_f32_bf16_dpp v22, v42, v161 row_newbcast:4 row_mask:0xf bank_mask:0xf
    v_dot2c_f32_bf16_dpp v23, v42, v166 row_newbcast:4 row_mask:0xf bank_mask:0xf
    v_dot2c_f32_bf16_dpp v24, v42, v162 row_newbcast:4 row_mask:0xf bank_mask:0xf
    v_dot2c_f32_bf16_dpp v25, v42, v167 row_newbcast:4 row_mask:0xf bank_mask:0xf
    v_dot2c_f32_bf16_dpp v18, v42, v163 row_newbcast:5 row_mask:0xf bank_mask:0xf
    v_dot2c_f32_bf16_dpp v19, v42, v172 row_newbcast:5 row_mask:0xf bank_mask:0xf
    v_dot2c_f32_bf16_dpp v20, v42, v168 row_newbcast:5 row_mask:0xf bank_mask:0xf
    v_dot2c_f32_bf16_dpp v21, v42, v173 row_newbcast:5 row_mask:0xf bank_mask:0xf
    v_dot2c_f32_bf16_dpp v22, v42, v169 row_newbcast:5 row_mask:0xf bank_mask:0xf
    v_dot2c_f32_bf16_dpp v23, v42, v174 row_newbcast:5 row_mask:0xf bank_mask:0xf
    v_dot2c_f32_bf16_dpp v24, v42, v170 row_newbcast:5 row_mask:0xf bank_mask:0xf
    v_dot2c_f32_bf16_dpp v25, v42, v175 row_newbcast:5 row_mask:0xf bank_mask:0xf
    v_dot2c_f32_bf16_dpp v18, v42, v171 row_newbcast:6 row_mask:0xf bank_mask:0xf
    v_dot2c_f32_bf16_dpp v19, v42, v180 row_newbcast:6 row_mask:0xf bank_mask:0xf
    v_dot2c_f32_bf16_dpp v20, v42, v176 row_newbcast:6 row_mask:0xf bank_mask:0xf
    v_dot2c_f32_bf16_dpp v21, v42, v181 row_newbcast:6 row_mask:0xf bank_mask:0xf
    v_dot2c_f32_bf16_dpp v22, v42, v177 row_newbcast:6 row_mask:0xf bank_mask:0xf
    v_dot2c_f32_bf16_dpp v23, v42, v182 row_newbcast:6 row_mask:0xf bank_mask:0xf
    v_dot2c_f32_bf16_dpp v24, v42, v178 row_newbcast:6 row_mask:0xf bank_mask:0xf
    v_dot2c_f32_bf16_dpp v25, v42, v183 row_newbcast:6 row_mask:0xf bank_mask:0xf
    v_dot2c_f32_bf16_dpp v18, v42, v179 row_newbcast:7 row_mask:0xf bank_mask:0xf
    v_dot2c_f32_bf16_dpp v19, v42, v188 row_newbcast:7 row_mask:0xf bank_mask:0xf
    v_dot2c_f32_bf16_dpp v20, v42, v184 row_newbcast:7 row_mask:0xf bank_mask:0xf
    v_dot2c_f32_bf16_dpp v21, v42, v189 row_newbcast:7 row_mask:0xf bank_mask:0xf
    v_dot2c_f32_bf16_dpp v22, v42, v185 row_newbcast:7 row_mask:0xf bank_mask:0xf
    v_dot2c_f32_bf16_dpp v23, v42, v190 row_newbcast:7 row_mask:0xf bank_mask:0xf
    v_dot2c_f32_bf16_dpp v24, v42, v186 row_newbcast:7 row_mask:0xf bank_mask:0xf
    v_dot2c_f32_bf16_dpp v25, v42, v191 row_newbcast:7 row_mask:0xf bank_mask:0xf
    v_dot2c_f32_bf16_dpp v18, v42, v187 row_newbcast:8 row_mask:0xf bank_mask:0xf
    v_dot2c_f32_bf16_dpp v19, v42, v196 row_newbcast:8 row_mask:0xf bank_mask:0xf
    v_dot2c_f32_bf16_dpp v20, v42, v192 row_newbcast:8 row_mask:0xf bank_mask:0xf
    v_dot2c_f32_bf16_dpp v21, v42, v197 row_newbcast:8 row_mask:0xf bank_mask:0xf
    v_dot2c_f32_bf16_dpp v22, v42, v193 row_newbcast:8 row_mask:0xf bank_mask:0xf
    v_dot2c_f32_bf16_dpp v23, v42, v198 row_newbcast:8 row_mask:0xf bank_mask:0xf
    v_dot2c_f32_bf16_dpp v24, v42, v194 row_newbcast:8 row_mask:0xf bank_mask:0xf
    v_dot2c_f32_bf16_dpp v25, v42, v199 row_newbcast:8 row_mask:0xf bank_mask:0xf
    v_dot2c_f32_bf16_dpp v18, v42, v195 row_newbcast:9 row_mask:0xf bank_mask:0xf
    v_dot2c_f32_bf16_dpp v19, v42, v204 row_newbcast:9 row_mask:0xf bank_mask:0xf
    v_dot2c_f32_bf16_dpp v20, v42, v200 row_newbcast:9 row_mask:0xf bank_mask:0xf
    v_dot2c_f32_bf16_dpp v21, v42, v205 row_newbcast:9 row_mask:0xf bank_mask:0xf
    v_dot2c_f32_bf16_dpp v22, v42, v201 row_newbcast:9 row_mask:0xf bank_mask:0xf
    v_dot2c_f32_bf16_dpp v23, v42, v206 row_newbcast:9 row_mask:0xf bank_mask:0xf
    v_dot2c_f32_bf16_dpp v24, v42, v202 row_newbcast:9 row_mask:0xf bank_mask:0xf
    v_dot2c_f32_bf16_dpp v25, v42, v207 row_newbcast:9 row_mask:0xf bank_mask:0xf
    v_dot2c_f32_bf16_dpp v18, v42, v203 row_newbcast:10 row_mask:0xf bank_mask:0xf
    v_dot2c_f32_bf16_dpp v19, v42, v212 row_newbcast:10 row_mask:0xf bank_mask:0xf
    v_dot2c_f32_bf16_dpp v20, v42, v208 row_newbcast:10 row_mask:0xf bank_mask:0xf
    v_dot2c_f32_bf16_dpp v21, v42, v213 row_newbcast:10 row_mask:0xf bank_mask:0xf
    v_dot2c_f32_bf16_dpp v22, v42, v209 row_newbcast:10 row_mask:0xf bank_mask:0xf
    v_dot2c_f32_bf16_dpp v23, v42, v214 row_newbcast:10 row_mask:0xf bank_mask:0xf
    v_dot2c_f32_bf16_dpp v24, v42, v210 row_newbcast:10 row_mask:0xf bank_mask:0xf
    v_dot2c_f32_bf16_dpp v25, v42, v215 row_newbcast:10 row_mask:0xf bank_mask:0xf
    v_dot2c_f32_bf16_dpp v18, v42, v211 row_newbcast:11 row_mask:0xf bank_mask:0xf
    v_dot2c_f32_bf16_dpp v19, v42, v220 row_newbcast:11 row_mask:0xf bank_mask:0xf
    v_dot2c_f32_bf16_dpp v20, v42, v216 row_newbcast:11 row_mask:0xf bank_mask:0xf
    v_dot2c_f32_bf16_dpp v21, v42, v221 row_newbcast:11 row_mask:0xf bank_mask:0xf
    v_dot2c_f32_bf16_dpp v22, v42, v217 row_newbcast:11 row_mask:0xf bank_mask:0xf
    v_dot2c_f32_bf16_dpp v23, v42, v222 row_newbcast:11 row_mask:0xf bank_mask:0xf
    v_dot2c_f32_bf16_dpp v24, v42, v218 row_newbcast:11 row_mask:0xf bank_mask:0xf
    v_dot2c_f32_bf16_dpp v25, v42, v223 row_newbcast:11 row_mask:0xf bank_mask:0xf
    v_dot2c_f32_bf16_dpp v18, v42, v219 row_newbcast:12 row_mask:0xf bank_mask:0xf
    v_dot2c_f32_bf16_dpp v19, v42, v228 row_newbcast:12 row_mask:0xf bank_mask:0xf
    v_dot2c_f32_bf16_dpp v20, v42, v224 row_newbcast:12 row_mask:0xf bank_mask:0xf
    v_dot2c_f32_bf16_dpp v21, v42, v229 row_newbcast:12 row_mask:0xf bank_mask:0xf
    v_dot2c_f32_bf16_dpp v22, v42, v225 row_newbcast:12 row_mask:0xf bank_mask:0xf
    v_dot2c_f32_bf16_dpp v23, v42, v230 row_newbcast:12 row_mask:0xf bank_mask:0xf
    v_dot2c_f32_bf16_dpp v24, v42, v226 row_newbcast:12 row_mask:0xf bank_mask:0xf
    v_dot2c_f32_bf16_dpp v25, v42, v231 row_newbcast:12 row_mask:0xf bank_mask:0xf
    v_dot2c_f32_bf16_dpp v18, v42, v227 row_newbcast:13 row_mask:0xf bank_mask:0xf
    v_dot2c_f32_bf16_dpp v19, v42, v236 row_newbcast:13 row_mask:0xf bank_mask:0xf
    v_dot2c_f32_bf16_dpp v20, v42, v232 row_newbcast:13 row_mask:0xf bank_mask:0xf
    v_dot2c_f32_bf16_dpp v21, v42, v237 row_newbcast:13 row_mask:0xf bank_mask:0xf
    v_dot2c_f32_bf16_dpp v22, v42, v233 row_newbcast:13 row_mask:0xf bank_mask:0xf
    v_dot2c_f32_bf16_dpp v23, v42, v238 row_newbcast:13 row_mask:0xf bank_mask:0xf
    v_dot2c_f32_bf16_dpp v24, v42, v234 row_newbcast:13 row_mask:0xf bank_mask:0xf
    v_dot2c_f32_bf16_dpp v25, v42, v239 row_newbcast:13 row_mask:0xf bank_mask:0xf
    v_dot2c_f32_bf16_dpp v18, v42, v235 row_newbcast:14 row_mask:0xf bank_mask:0xf
    v_dot2c_f32_bf16_dpp v19, v42, v244 row_newbcast:14 row_mask:0xf bank_mask:0xf
    v_dot2c_f32_bf16_dpp v20, v42, v240 row_newbcast:14 row_mask:0xf bank_mask:0xf
    v_dot2c_f32_bf16_dpp v21, v42, v245 row_newbcast:14 row_mask:0xf bank_mask:0xf
    v_dot2c_f32_bf16_dpp v22, v42, v241 row_newbcast:14 row_mask:0xf bank_mask:0xf
    v_dot2c_f32_bf16_dpp v23, v42, v246 row_newbcast:14 row_mask:0xf bank_mask:0xf
    v_dot2c_f32_bf16_dpp v24, v42, v242 row_newbcast:14 row_mask:0xf bank_mask:0xf
    v_dot2c_f32_bf16_dpp v25, v42, v247 row_newbcast:14 row_mask:0xf bank_mask:0xf
    v_dot2c_f32_bf16_dpp v18, v42, v243 row_newbcast:15 row_mask:0xf bank_mask:0xf
    v_dot2c_f32_bf16_dpp v19, v42, v252 row_newbcast:15 row_mask:0xf bank_mask:0xf
    v_dot2c_f32_bf16_dpp v20, v42, v248 row_newbcast:15 row_mask:0xf bank_mask:0xf
    v_dot2c_f32_bf16_dpp v21, v42, v253 row_newbcast:15 row_mask:0xf bank_mask:0xf
    v_dot2c_f32_bf16_dpp v22, v42, v249 row_newbcast:15 row_mask:0xf bank_mask:0xf
    v_dot2c_f32_bf16_dpp v23, v42, v254 row_newbcast:15 row_mask:0xf bank_mask:0xf
    v_dot2c_f32_bf16_dpp v24, v42, v250 row_newbcast:15 row_mask:0xf bank_mask:0xf
    v_dot2c_f32_bf16_dpp v25, v42, v255 row_newbcast:15 row_mask:0xf bank_mask:0xf
    v_permlane32_swap_b32 v18, v22
    v_permlane32_swap_b32 v19, v23
    v_permlane32_swap_b32 v20, v24
    v_permlane32_swap_b32 v21, v25
    v_add_f32 v18, v18, v22
    v_add_f32 v19, v19, v23
    v_add_f32 v20, v20, v24
    v_add_f32 v21, v21, v25
    s_nop 0
    v_permlane16_swap_b32 v18, v20
    v_permlane16_swap_b32 v19, v21
    v_add_f32 v18, v18, v20
    v_add_f32 v19, v19, v21
    v_add_f32 v18, v18, v12
    v_add_f32 v19, v19, v13
    global_store_dwordx2 v62, v[18:19], s[28:29] sc1
    s_branch L_fin
L_helper:
    s_nop 1
    s_waitcnt lgkmcnt(0)
    s_lshl_b32 s80, s66, 7
    s_add_u32 s80, s80, 0x80000
    s_add_u32 s84, s28, s80
    s_addc_u32 s85, s29, 0
    v_mov_b32 v20, -1
    v_mov_b32 v21, -1
    v_mov_b32 v22, -1
    v_mov_b32 v23, -1
    s_cmp_ge_u32 s2, 32
    s_cbranch_scc1 L_noinit
    s_mul_i32 s80, s2, 14336
    s_add_u32 s80, s80, 0x90000
    v_lshlrev_b32 v18, 4, v0
    v_add_u32 v18, s80, v18
    global_store_dwordx4 v18, v[20:23], s[28:29] offset:0 sc1
    global_store_dwordx4 v18, v[20:23], s[28:29] offset:1024 sc1
    global_store_dwordx4 v18, v[20:23], s[28:29] offset:2048 sc1
    global_store_dwordx4 v18, v[20:23], s[28:29] offset:3072 sc1
    v_add_u32 v18, 0x1000, v18
    global_store_dwordx4 v18, v[20:23], s[28:29] offset:0 sc1
    global_store_dwordx4 v18, v[20:23], s[28:29] offset:1024 sc1
    global_store_dwordx4 v18, v[20:23], s[28:29] offset:2048 sc1
    global_store_dwordx4 v18, v[20:23], s[28:29] offset:3072 sc1
    v_add_u32 v18, 0x1000, v18
    global_store_dwordx4 v18, v[20:23], s[28:29] offset:0 sc1
    global_store_dwordx4 v18, v[20:23], s[28:29] offset:1024 sc1
    global_store_dwordx4 v18, v[20:23], s[28:29] offset:2048 sc1
    global_store_dwordx4 v18, v[20:23], s[28:29] offset:3072 sc1
    v_add_u32 v18, 0x1000, v18
    global_store_dwordx4 v18, v[20:23], s[28:29] offset:0 sc1
    global_store_dwordx4 v18, v[20:23], s[28:29] offset:1024 sc1
    s_mul_i32 s80, s2, 512
    s_add_u32 s80, s80, 0x80000
    v_lshlrev_b32 v18, 4, v0
    v_add_u32 v18, s80, v18
    s_mov_b32 exec_lo, 0xffffffff
    s_mov_b32 exec_hi, 0x0
    global_store_dwordx4 v18, v[20:23], s[28:29] offset:0 sc1
    s_mov_b64 exec, -1
    s_mul_i32 s80, s2, 16384
    s_add_u32 s80, s80, 0x0
    v_lshlrev_b32 v18, 4, v0
    v_add_u32 v18, s80, v18
    global_store_dwordx4 v18, v[20:23], s[28:29] offset:0 sc1
    global_store_dwordx4 v18, v[20:23], s[28:29] offset:1024 sc1
    global_store_dwordx4 v18, v[20:23], s[28:29] offset:2048 sc1
    global_store_dwordx4 v18, v[20:23], s[28:29] offset:3072 sc1
    v_add_u32 v18, 0x1000, v18
    global_store_dwordx4 v18, v[20:23], s[28:29] offset:0 sc1
    global_store_dwordx4 v18, v[20:23], s[28:29] offset:1024 sc1
    global_store_dwordx4 v18, v[20:23], s[28:29] offset:2048 sc1
    global_store_dwordx4 v18, v[20:23], s[28:29] offset:3072 sc1
    v_add_u32 v18, 0x1000, v18
    global_store_dwordx4 v18, v[20:23], s[28:29] offset:0 sc1
    global_store_dwordx4 v18, v[20:23], s[28:29] offset:1024 sc1
    global_store_dwordx4 v18, v[20:23], s[28:29] offset:2048 sc1
    global_store_dwordx4 v18, v[20:23], s[28:29] offset:3072 sc1
    v_add_u32 v18, 0x1000, v18
    global_store_dwordx4 v18, v[20:23], s[28:29] offset:0 sc1
    global_store_dwordx4 v18, v[20:23], s[28:29] offset:1024 sc1
    global_store_dwordx4 v18, v[20:23], s[28:29] offset:2048 sc1
    global_store_dwordx4 v18, v[20:23], s[28:29] offset:3072 sc1
    s_mov_b64 exec, 1
    v_mov_b32 v34, 0
    v_mov_b32 v35, 1
    s_waitcnt vmcnt(0)
    global_atomic_add v34, v35, s[26:27]
    s_mov_b64 exec, -1
L_noinit:
    s_nop 1
    s_sub_u32 s69, s2, 32
    s_cmp_ge_u32 s2, 32
    s_cselect_b32 s69, s69, 0
    s_cselect_b32 s83, 1, 0
    s_mul_hi_u32 s72, s69, 153391690
    s_mul_i32 s80, s72, 28
    s_sub_u32 s71, s69, s80
    s_lshl_b32 s80, s64, 10
    v_lshlrev_b32 v24, 4, v0
    v_add_u32 v25, s80, v24
    v_lshrrev_b32 v26, 4, v0
    v_lshlrev_b32 v26, 10, v26
    v_and_b32 v27, 15, v0
    v_lshl_add_u32 v26, v27, 3, v26
    s_lshl_b32 s80, s72, 7
    v_add_u32 v26, s80, v26
    global_load_dwordx2 v[36:37], v26, s[4:5]
    s_lshl_b32 s80, s71, 7
    s_sub_u32 s82, 1835008, s80
    s_mul_i32 s82, s82, s83
    s_add_u32 s48, s16, s80
    s_addc_u32 s49, s17, 0
    s_and_b32 s49, s49, 0xffff
    s_mov_b32 s50, s82
    s_mov_b32 s51, 0x20000
    s_add_u32 s52, s18, s80
    s_addc_u32 s53, s19, 0
    s_and_b32 s53, s53, 0xffff
    s_mov_b32 s54, s82
    s_mov_b32 s55, 0x20000
    v_lshrrev_b32 v58, 3, v0
    s_movk_i32 s81, 3584
    v_mul_lo_u32 v58, v58, s81
    v_and_b32 v27, 7, v0
    v_lshl_add_u32 v58, v27, 4, v58
    s_mul_i32 s73, s72, 229376
    buffer_load_dwordx4 v[64:67], v58, s[48:51], s73 offen
    buffer_load_dwordx4 v[68:71], v58, s[52:55], s73 offen
    s_add_u32 s73, s73, 28672
    buffer_load_dwordx4 v[72:75], v58, s[48:51], s73 offen
    buffer_load_dwordx4 v[76:79], v58, s[52:55], s73 offen
    s_add_u32 s73, s73, 28672
    buffer_load_dwordx4 v[80:83], v58, s[48:51], s73 offen
    buffer_load_dwordx4 v[84:87], v58, s[52:55], s73 offen
    s_add_u32 s73, s73, 28672
    buffer_load_dwordx4 v[88:91], v58, s[48:51], s73 offen
    buffer_load_dwordx4 v[92:95], v58, s[52:55], s73 offen
    s_add_u32 s73, s73, 28672
    buffer_load_dwordx4 v[96:99], v58, s[48:51], s73 offen
    buffer_load_dwordx4 v[100:103], v58, s[52:55], s73 offen
    s_add_u32 s73, s73, 28672
    buffer_load_dwordx4 v[104:107], v58, s[48:51], s73 offen
    buffer_load_dwordx4 v[108:111], v58, s[52:55], s73 offen
    s_add_u32 s73, s73, 28672
    buffer_load_dwordx4 v[112:115], v58, s[48:51], s73 offen
    buffer_load_dwordx4 v[116:119], v58, s[52:55], s73 offen
    s_add_u32 s73, s73, 28672
    buffer_load_dwordx4 v[120:123], v58, s[48:51], s73 offen
    buffer_load_dwordx4 v[124:127], v58, s[52:55], s73 offen
    s_add_u32 s73, s73, 28672
    global_load_dwordx4 v[40:43], v25, s[4:5]
    global_load_dwordx4 v[44:47], v24, s[22:23]
    s_mul_i32 s80, s67, 28672
    s_add_u32 s56, s20, s80
    s_addc_u32 s57, s21, 0
    s_and_b32 s57, s57, 0xffff
    s_mov_b32 s58, 28672
    s_mov_b32 s59, 0x20000
    v_lshlrev_b32 v59, 4, v0
    v_mov_b32 v20, -1
    v_mov_b32 v21, -1
    v_lshlrev_b32 v26, 3, v0
    s_mov_b64 exec, 0xf
    ds_write_b64 v26, v[20:21] offset:2048
    s_mov_b64 exec, -1
    s_waitcnt lgkmcnt(0)
    s_barrier
    s_waitcnt vmcnt(18)
    v_lshlrev_b32 v26, 3, v0
    ds_write_b64 v26, v[36:37] offset:2304
    v_lshrrev_b32 v27, 3, v0
    v_lshlrev_b32 v27, 1, v27
    ds_read_u16 v192, v27 offset:2304
    ds_read_u16 v193, v27 offset:2432
    ds_read_u16 v194, v27 offset:2560
    ds_read_u16 v195, v27 offset:2688
    ds_read_u16 v196, v27 offset:2320
    ds_read_u16 v197, v27 offset:2448
    ds_read_u16 v198, v27 offset:2576
    ds_read_u16 v199, v27 offset:2704
    ds_read_u16 v200, v27 offset:2336
    ds_read_u16 v201, v27 offset:2464
    ds_read_u16 v202, v27 offset:2592
    ds_read_u16 v203, v27 offset:2720
    ds_read_u16 v204, v27 offset:2352
    ds_read_u16 v205, v27 offset:2480
    ds_read_u16 v206, v27 offset:2608
    ds_read_u16 v207, v27 offset:2736
    ds_read_u16 v208, v27 offset:2368
    ds_read_u16 v209, v27 offset:2496
    ds_read_u16 v210, v27 offset:2624
    ds_read_u16 v211, v27 offset:2752
    ds_read_u16 v212, v27 offset:2384
    ds_read_u16 v213, v27 offset:2512
    ds_read_u16 v214, v27 offset:2640
    ds_read_u16 v215, v27 offset:2768
    ds_read_u16 v216, v27 offset:2400
    ds_read_u16 v217, v27 offset:2528
    ds_read_u16 v218, v27 offset:2656
    ds_read_u16 v219, v27 offset:2784
    ds_read_u16 v220, v27 offset:2416
    ds_read_u16 v221, v27 offset:2544
    ds_read_u16 v222, v27 offset:2672
    ds_read_u16 v223, v27 offset:2800
    v_mov_b32 v128, 0
    v_mov_b32 v129, 0
    v_mov_b32 v130, 0
    v_mov_b32 v131, 0
    v_mov_b32 v132, 0
    v_mov_b32 v133, 0
    v_mov_b32 v134, 0
    v_mov_b32 v135, 0
    v_mov_b32 v136, 0
    v_mov_b32 v137, 0
    v_mov_b32 v138, 0
    v_mov_b32 v139, 0
    v_mov_b32 v140, 0
    v_mov_b32 v141, 0
    v_mov_b32 v142, 0
    v_mov_b32 v143, 0
    v_mov_b32 v144, 0
    v_mov_b32 v145, 0
    v_mov_b32 v146, 0
    v_mov_b32 v147, 0
    v_mov_b32 v148, 0
    v_mov_b32 v149, 0
    v_mov_b32 v150, 0
    v_mov_b32 v151, 0
    v_mov_b32 v152, 0
    v_mov_b32 v153, 0
    v_mov_b32 v154, 0
    v_mov_b32 v155, 0
    v_mov_b32 v156, 0
    v_mov_b32 v157, 0
    v_mov_b32 v158, 0
    v_mov_b32 v159, 0
    v_mov_b32 v160, 0
    v_mov_b32 v161, 0
    v_mov_b32 v162, 0
    v_mov_b32 v163, 0
    v_mov_b32 v164, 0
    v_mov_b32 v165, 0
    v_mov_b32 v166, 0
    v_mov_b32 v167, 0
    v_mov_b32 v168, 0
    v_mov_b32 v169, 0
    v_mov_b32 v170, 0
    v_mov_b32 v171, 0
    v_mov_b32 v172, 0
    v_mov_b32 v173, 0
    v_mov_b32 v174, 0
    v_mov_b32 v175, 0
    v_mov_b32 v176, 0
    v_mov_b32 v177, 0
    v_mov_b32 v178, 0
    v_mov_b32 v179, 0
    v_mov_b32 v180, 0
    v_mov_b32 v181, 0
    v_mov_b32 v182, 0
    v_mov_b32 v183, 0
    v_mov_b32 v184, 0
    v_mov_b32 v185, 0
    v_mov_b32 v186, 0
    v_mov_b32 v187, 0
    v_mov_b32 v188, 0
    v_mov_b32 v189, 0
    v_mov_b32 v190, 0
    v_mov_b32 v191, 0
    s_waitcnt lgkmcnt(0)
    s_waitcnt vmcnt(16)
    v_lshlrev_b32 v60, 16, v192
    v_lshlrev_b32 v61, 16, v193
    v_lshlrev_b32 v62, 16, v194
    v_lshlrev_b32 v63, 16, v195
    v_dot2c_f32_bf16 v128, v192, v64
    v_dot2c_f32_bf16 v129, v60, v64
    v_dot2c_f32_bf16 v130, v192, v65
    v_dot2c_f32_bf16 v131, v60, v65
    v_dot2c_f32_bf16 v132, v192, v66
    v_dot2c_f32_bf16 v133, v60, v66
    v_dot2c_f32_bf16 v134, v192, v67
    v_dot2c_f32_bf16 v135, v60, v67
    v_dot2c_f32_bf16 v136, v192, v68
    v_dot2c_f32_bf16 v137, v60, v68
    v_dot2c_f32_bf16 v138, v192, v69
    v_dot2c_f32_bf16 v139, v60, v69
    v_dot2c_f32_bf16 v140, v192, v70
    v_dot2c_f32_bf16 v141, v60, v70
    v_dot2c_f32_bf16 v142, v192, v71
    v_dot2c_f32_bf16 v143, v60, v71
    v_dot2c_f32_bf16 v144, v193, v64
    v_dot2c_f32_bf16 v145, v61, v64
    v_dot2c_f32_bf16 v146, v193, v65
    v_dot2c_f32_bf16 v147, v61, v65
    v_dot2c_f32_bf16 v148, v193, v66
    v_dot2c_f32_bf16 v149, v61, v66
    v_dot2c_f32_bf16 v150, v193, v67
    v_dot2c_f32_bf16 v151, v61, v67
    v_dot2c_f32_bf16 v152, v193, v68
    v_dot2c_f32_bf16 v153, v61, v68
    v_dot2c_f32_bf16 v154, v193, v69
    v_dot2c_f32_bf16 v155, v61, v69
    v_dot2c_f32_bf16 v156, v193, v70
    v_dot2c_f32_bf16 v157, v61, v70
    v_dot2c_f32_bf16 v158, v193, v71
    v_dot2c_f32_bf16 v159, v61, v71
    v_dot2c_f32_bf16 v160, v194, v64
    v_dot2c_f32_bf16 v161, v62, v64
    v_dot2c_f32_bf16 v162, v194, v65
    v_dot2c_f32_bf16 v163, v62, v65
    v_dot2c_f32_bf16 v164, v194, v66
    v_dot2c_f32_bf16 v165, v62, v66
    v_dot2c_f32_bf16 v166, v194, v67
    v_dot2c_f32_bf16 v167, v62, v67
    v_dot2c_f32_bf16 v168, v194, v68
    v_dot2c_f32_bf16 v169, v62, v68
    v_dot2c_f32_bf16 v170, v194, v69
    v_dot2c_f32_bf16 v171, v62, v69
    v_dot2c_f32_bf16 v172, v194, v70
    v_dot2c_f32_bf16 v173, v62, v70
    v_dot2c_f32_bf16 v174, v194, v71
    v_dot2c_f32_bf16 v175, v62, v71
    v_dot2c_f32_bf16 v176, v195, v64
    v_dot2c_f32_bf16 v177, v63, v64
    v_dot2c_f32_bf16 v178, v195, v65
    v_dot2c_f32_bf16 v179, v63, v65
    v_dot2c_f32_bf16 v180, v195, v66
    v_dot2c_f32_bf16 v181, v63, v66
    v_dot2c_f32_bf16 v182, v195, v67
    v_dot2c_f32_bf16 v183, v63, v67
    v_dot2c_f32_bf16 v184, v195, v68
    v_dot2c_f32_bf16 v185, v63, v68
    v_dot2c_f32_bf16 v186, v195, v69
    v_dot2c_f32_bf16 v187, v63, v69
    v_dot2c_f32_bf16 v188, v195, v70
    v_dot2c_f32_bf16 v189, v63, v70
    v_dot2c_f32_bf16 v190, v195, v71
    v_dot2c_f32_bf16 v191, v63, v71
    s_waitcnt vmcnt(14)
    v_lshlrev_b32 v60, 16, v196
    v_lshlrev_b32 v61, 16, v197
    v_lshlrev_b32 v62, 16, v198
    v_lshlrev_b32 v63, 16, v199
    v_dot2c_f32_bf16 v128, v196, v72
    v_dot2c_f32_bf16 v129, v60, v72
    v_dot2c_f32_bf16 v130, v196, v73
    v_dot2c_f32_bf16 v131, v60, v73
    v_dot2c_f32_bf16 v132, v196, v74
    v_dot2c_f32_bf16 v133, v60, v74
    v_dot2c_f32_bf16 v134, v196, v75
    v_dot2c_f32_bf16 v135, v60, v75
    v_dot2c_f32_bf16 v136, v196, v76
    v_dot2c_f32_bf16 v137, v60, v76
    v_dot2c_f32_bf16 v138, v196, v77
    v_dot2c_f32_bf16 v139, v60, v77
    v_dot2c_f32_bf16 v140, v196, v78
    v_dot2c_f32_bf16 v141, v60, v78
    v_dot2c_f32_bf16 v142, v196, v79
    v_dot2c_f32_bf16 v143, v60, v79
    v_dot2c_f32_bf16 v144, v197, v72
    v_dot2c_f32_bf16 v145, v61, v72
    v_dot2c_f32_bf16 v146, v197, v73
    v_dot2c_f32_bf16 v147, v61, v73
    v_dot2c_f32_bf16 v148, v197, v74
    v_dot2c_f32_bf16 v149, v61, v74
    v_dot2c_f32_bf16 v150, v197, v75
    v_dot2c_f32_bf16 v151, v61, v75
    v_dot2c_f32_bf16 v152, v197, v76
    v_dot2c_f32_bf16 v153, v61, v76
    v_dot2c_f32_bf16 v154, v197, v77
    v_dot2c_f32_bf16 v155, v61, v77
    v_dot2c_f32_bf16 v156, v197, v78
    v_dot2c_f32_bf16 v157, v61, v78
    v_dot2c_f32_bf16 v158, v197, v79
    v_dot2c_f32_bf16 v159, v61, v79
    v_dot2c_f32_bf16 v160, v198, v72
    v_dot2c_f32_bf16 v161, v62, v72
    v_dot2c_f32_bf16 v162, v198, v73
    v_dot2c_f32_bf16 v163, v62, v73
    v_dot2c_f32_bf16 v164, v198, v74
    v_dot2c_f32_bf16 v165, v62, v74
    v_dot2c_f32_bf16 v166, v198, v75
    v_dot2c_f32_bf16 v167, v62, v75
    v_dot2c_f32_bf16 v168, v198, v76
    v_dot2c_f32_bf16 v169, v62, v76
    v_dot2c_f32_bf16 v170, v198, v77
    v_dot2c_f32_bf16 v171, v62, v77
    v_dot2c_f32_bf16 v172, v198, v78
    v_dot2c_f32_bf16 v173, v62, v78
    v_dot2c_f32_bf16 v174, v198, v79
    v_dot2c_f32_bf16 v175, v62, v79
    v_dot2c_f32_bf16 v176, v199, v72
    v_dot2c_f32_bf16 v177, v63, v72
    v_dot2c_f32_bf16 v178, v199, v73
    v_dot2c_f32_bf16 v179, v63, v73
    v_dot2c_f32_bf16 v180, v199, v74
    v_dot2c_f32_bf16 v181, v63, v74
    v_dot2c_f32_bf16 v182, v199, v75
    v_dot2c_f32_bf16 v183, v63, v75
    v_dot2c_f32_bf16 v184, v199, v76
    v_dot2c_f32_bf16 v185, v63, v76
    v_dot2c_f32_bf16 v186, v199, v77
    v_dot2c_f32_bf16 v187, v63, v77
    v_dot2c_f32_bf16 v188, v199, v78
    v_dot2c_f32_bf16 v189, v63, v78
    v_dot2c_f32_bf16 v190, v199, v79
    v_dot2c_f32_bf16 v191, v63, v79
    s_waitcnt vmcnt(12)
    v_lshlrev_b32 v60, 16, v200
    v_lshlrev_b32 v61, 16, v201
    v_lshlrev_b32 v62, 16, v202
    v_lshlrev_b32 v63, 16, v203
    v_dot2c_f32_bf16 v128, v200, v80
    v_dot2c_f32_bf16 v129, v60, v80
    v_dot2c_f32_bf16 v130, v200, v81
    v_dot2c_f32_bf16 v131, v60, v81
    v_dot2c_f32_bf16 v132, v200, v82
    v_dot2c_f32_bf16 v133, v60, v82
    v_dot2c_f32_bf16 v134, v200, v83
    v_dot2c_f32_bf16 v135, v60, v83
    v_dot2c_f32_bf16 v136, v200, v84
    v_dot2c_f32_bf16 v137, v60, v84
    v_dot2c_f32_bf16 v138, v200, v85
    v_dot2c_f32_bf16 v139, v60, v85
    v_dot2c_f32_bf16 v140, v200, v86
    v_dot2c_f32_bf16 v141, v60, v86
    v_dot2c_f32_bf16 v142, v200, v87
    v_dot2c_f32_bf16 v143, v60, v87
    v_dot2c_f32_bf16 v144, v201, v80
    v_dot2c_f32_bf16 v145, v61, v80
    v_dot2c_f32_bf16 v146, v201, v81
    v_dot2c_f32_bf16 v147, v61, v81
    v_dot2c_f32_bf16 v148, v201, v82
    v_dot2c_f32_bf16 v149, v61, v82
    v_dot2c_f32_bf16 v150, v201, v83
    v_dot2c_f32_bf16 v151, v61, v83
    v_dot2c_f32_bf16 v152, v201, v84
    v_dot2c_f32_bf16 v153, v61, v84
    v_dot2c_f32_bf16 v154, v201, v85
    v_dot2c_f32_bf16 v155, v61, v85
    v_dot2c_f32_bf16 v156, v201, v86
    v_dot2c_f32_bf16 v157, v61, v86
    v_dot2c_f32_bf16 v158, v201, v87
    v_dot2c_f32_bf16 v159, v61, v87
    v_dot2c_f32_bf16 v160, v202, v80
    v_dot2c_f32_bf16 v161, v62, v80
    v_dot2c_f32_bf16 v162, v202, v81
    v_dot2c_f32_bf16 v163, v62, v81
    v_dot2c_f32_bf16 v164, v202, v82
    v_dot2c_f32_bf16 v165, v62, v82
    v_dot2c_f32_bf16 v166, v202, v83
    v_dot2c_f32_bf16 v167, v62, v83
    v_dot2c_f32_bf16 v168, v202, v84
    v_dot2c_f32_bf16 v169, v62, v84
    v_dot2c_f32_bf16 v170, v202, v85
    v_dot2c_f32_bf16 v171, v62, v85
    v_dot2c_f32_bf16 v172, v202, v86
    v_dot2c_f32_bf16 v173, v62, v86
    v_dot2c_f32_bf16 v174, v202, v87
    v_dot2c_f32_bf16 v175, v62, v87
    v_dot2c_f32_bf16 v176, v203, v80
    v_dot2c_f32_bf16 v177, v63, v80
    v_dot2c_f32_bf16 v178, v203, v81
    v_dot2c_f32_bf16 v179, v63, v81
    v_dot2c_f32_bf16 v180, v203, v82
    v_dot2c_f32_bf16 v181, v63, v82
    v_dot2c_f32_bf16 v182, v203, v83
    v_dot2c_f32_bf16 v183, v63, v83
    v_dot2c_f32_bf16 v184, v203, v84
    v_dot2c_f32_bf16 v185, v63, v84
    v_dot2c_f32_bf16 v186, v203, v85
    v_dot2c_f32_bf16 v187, v63, v85
    v_dot2c_f32_bf16 v188, v203, v86
    v_dot2c_f32_bf16 v189, v63, v86
    v_dot2c_f32_bf16 v190, v203, v87
    v_dot2c_f32_bf16 v191, v63, v87
    s_waitcnt vmcnt(10)
    v_lshlrev_b32 v60, 16, v204
    v_lshlrev_b32 v61, 16, v205
    v_lshlrev_b32 v62, 16, v206
    v_lshlrev_b32 v63, 16, v207
    v_dot2c_f32_bf16 v128, v204, v88
    v_dot2c_f32_bf16 v129, v60, v88
    v_dot2c_f32_bf16 v130, v204, v89
    v_dot2c_f32_bf16 v131, v60, v89
    v_dot2c_f32_bf16 v132, v204, v90
    v_dot2c_f32_bf16 v133, v60, v90
    v_dot2c_f32_bf16 v134, v204, v91
    v_dot2c_f32_bf16 v135, v60, v91
    v_dot2c_f32_bf16 v136, v204, v92
    v_dot2c_f32_bf16 v137, v60, v92
    v_dot2c_f32_bf16 v138, v204, v93
    v_dot2c_f32_bf16 v139, v60, v93
    v_dot2c_f32_bf16 v140, v204, v94
    v_dot2c_f32_bf16 v141, v60, v94
    v_dot2c_f32_bf16 v142, v204, v95
    v_dot2c_f32_bf16 v143, v60, v95
    v_dot2c_f32_bf16 v144, v205, v88
    v_dot2c_f32_bf16 v145, v61, v88
    v_dot2c_f32_bf16 v146, v205, v89
    v_dot2c_f32_bf16 v147, v61, v89
    v_dot2c_f32_bf16 v148, v205, v90
    v_dot2c_f32_bf16 v149, v61, v90
    v_dot2c_f32_bf16 v150, v205, v91
    v_dot2c_f32_bf16 v151, v61, v91
    v_dot2c_f32_bf16 v152, v205, v92
    v_dot2c_f32_bf16 v153, v61, v92
    v_dot2c_f32_bf16 v154, v205, v93
    v_dot2c_f32_bf16 v155, v61, v93
    v_dot2c_f32_bf16 v156, v205, v94
    v_dot2c_f32_bf16 v157, v61, v94
    v_dot2c_f32_bf16 v158, v205, v95
    v_dot2c_f32_bf16 v159, v61, v95
    v_dot2c_f32_bf16 v160, v206, v88
    v_dot2c_f32_bf16 v161, v62, v88
    v_dot2c_f32_bf16 v162, v206, v89
    v_dot2c_f32_bf16 v163, v62, v89
    v_dot2c_f32_bf16 v164, v206, v90
    v_dot2c_f32_bf16 v165, v62, v90
    v_dot2c_f32_bf16 v166, v206, v91
    v_dot2c_f32_bf16 v167, v62, v91
    v_dot2c_f32_bf16 v168, v206, v92
    v_dot2c_f32_bf16 v169, v62, v92
    v_dot2c_f32_bf16 v170, v206, v93
    v_dot2c_f32_bf16 v171, v62, v93
    v_dot2c_f32_bf16 v172, v206, v94
    v_dot2c_f32_bf16 v173, v62, v94
    v_dot2c_f32_bf16 v174, v206, v95
    v_dot2c_f32_bf16 v175, v62, v95
    v_dot2c_f32_bf16 v176, v207, v88
    v_dot2c_f32_bf16 v177, v63, v88
    v_dot2c_f32_bf16 v178, v207, v89
    v_dot2c_f32_bf16 v179, v63, v89
    v_dot2c_f32_bf16 v180, v207, v90
    v_dot2c_f32_bf16 v181, v63, v90
    v_dot2c_f32_bf16 v182, v207, v91
    v_dot2c_f32_bf16 v183, v63, v91
    v_dot2c_f32_bf16 v184, v207, v92
    v_dot2c_f32_bf16 v185, v63, v92
    v_dot2c_f32_bf16 v186, v207, v93
    v_dot2c_f32_bf16 v187, v63, v93
    v_dot2c_f32_bf16 v188, v207, v94
    v_dot2c_f32_bf16 v189, v63, v94
    v_dot2c_f32_bf16 v190, v207, v95
    v_dot2c_f32_bf16 v191, v63, v95
    s_waitcnt vmcnt(8)
    v_lshlrev_b32 v60, 16, v208
    v_lshlrev_b32 v61, 16, v209
    v_lshlrev_b32 v62, 16, v210
    v_lshlrev_b32 v63, 16, v211
    v_dot2c_f32_bf16 v128, v208, v96
    v_dot2c_f32_bf16 v129, v60, v96
    v_dot2c_f32_bf16 v130, v208, v97
    v_dot2c_f32_bf16 v131, v60, v97
    v_dot2c_f32_bf16 v132, v208, v98
    v_dot2c_f32_bf16 v133, v60, v98
    v_dot2c_f32_bf16 v134, v208, v99
    v_dot2c_f32_bf16 v135, v60, v99
    v_dot2c_f32_bf16 v136, v208, v100
    v_dot2c_f32_bf16 v137, v60, v100
    v_dot2c_f32_bf16 v138, v208, v101
    v_dot2c_f32_bf16 v139, v60, v101
    v_dot2c_f32_bf16 v140, v208, v102
    v_dot2c_f32_bf16 v141, v60, v102
    v_dot2c_f32_bf16 v142, v208, v103
    v_dot2c_f32_bf16 v143, v60, v103
    v_dot2c_f32_bf16 v144, v209, v96
    v_dot2c_f32_bf16 v145, v61, v96
    v_dot2c_f32_bf16 v146, v209, v97
    v_dot2c_f32_bf16 v147, v61, v97
    v_dot2c_f32_bf16 v148, v209, v98
    v_dot2c_f32_bf16 v149, v61, v98
    v_dot2c_f32_bf16 v150, v209, v99
    v_dot2c_f32_bf16 v151, v61, v99
    v_dot2c_f32_bf16 v152, v209, v100
    v_dot2c_f32_bf16 v153, v61, v100
    v_dot2c_f32_bf16 v154, v209, v101
    v_dot2c_f32_bf16 v155, v61, v101
    v_dot2c_f32_bf16 v156, v209, v102
    v_dot2c_f32_bf16 v157, v61, v102
    v_dot2c_f32_bf16 v158, v209, v103
    v_dot2c_f32_bf16 v159, v61, v103
    v_dot2c_f32_bf16 v160, v210, v96
    v_dot2c_f32_bf16 v161, v62, v96
    v_dot2c_f32_bf16 v162, v210, v97
    v_dot2c_f32_bf16 v163, v62, v97
    v_dot2c_f32_bf16 v164, v210, v98
    v_dot2c_f32_bf16 v165, v62, v98
    v_dot2c_f32_bf16 v166, v210, v99
    v_dot2c_f32_bf16 v167, v62, v99
    v_dot2c_f32_bf16 v168, v210, v100
    v_dot2c_f32_bf16 v169, v62, v100
    v_dot2c_f32_bf16 v170, v210, v101
    v_dot2c_f32_bf16 v171, v62, v101
    v_dot2c_f32_bf16 v172, v210, v102
    v_dot2c_f32_bf16 v173, v62, v102
    v_dot2c_f32_bf16 v174, v210, v103
    v_dot2c_f32_bf16 v175, v62, v103
    v_dot2c_f32_bf16 v176, v211, v96
    v_dot2c_f32_bf16 v177, v63, v96
    v_dot2c_f32_bf16 v178, v211, v97
    v_dot2c_f32_bf16 v179, v63, v97
    v_dot2c_f32_bf16 v180, v211, v98
    v_dot2c_f32_bf16 v181, v63, v98
    v_dot2c_f32_bf16 v182, v211, v99
    v_dot2c_f32_bf16 v183, v63, v99
    v_dot2c_f32_bf16 v184, v211, v100
    v_dot2c_f32_bf16 v185, v63, v100
    v_dot2c_f32_bf16 v186, v211, v101
    v_dot2c_f32_bf16 v187, v63, v101
    v_dot2c_f32_bf16 v188, v211, v102
    v_dot2c_f32_bf16 v189, v63, v102
    v_dot2c_f32_bf16 v190, v211, v103
    v_dot2c_f32_bf16 v191, v63, v103
    s_waitcnt vmcnt(6)
    v_lshlrev_b32 v60, 16, v212
    v_lshlrev_b32 v61, 16, v213
    v_lshlrev_b32 v62, 16, v214
    v_lshlrev_b32 v63, 16, v215
    v_dot2c_f32_bf16 v128, v212, v104
    v_dot2c_f32_bf16 v129, v60, v104
    v_dot2c_f32_bf16 v130, v212, v105
    v_dot2c_f32_bf16 v131, v60, v105
    v_dot2c_f32_bf16 v132, v212, v106
    v_dot2c_f32_bf16 v133, v60, v106
    v_dot2c_f32_bf16 v134, v212, v107
    v_dot2c_f32_bf16 v135, v60, v107
    v_dot2c_f32_bf16 v136, v212, v108
    v_dot2c_f32_bf16 v137, v60, v108
    v_dot2c_f32_bf16 v138, v212, v109
    v_dot2c_f32_bf16 v139, v60, v109
    v_dot2c_f32_bf16 v140, v212, v110
    v_dot2c_f32_bf16 v141, v60, v110
    v_dot2c_f32_bf16 v142, v212, v111
    v_dot2c_f32_bf16 v143, v60, v111
    v_dot2c_f32_bf16 v144, v213, v104
    v_dot2c_f32_bf16 v145, v61, v104
    v_dot2c_f32_bf16 v146, v213, v105
    v_dot2c_f32_bf16 v147, v61, v105
    v_dot2c_f32_bf16 v148, v213, v106
    v_dot2c_f32_bf16 v149, v61, v106
    v_dot2c_f32_bf16 v150, v213, v107
    v_dot2c_f32_bf16 v151, v61, v107
    v_dot2c_f32_bf16 v152, v213, v108
    v_dot2c_f32_bf16 v153, v61, v108
    v_dot2c_f32_bf16 v154, v213, v109
    v_dot2c_f32_bf16 v155, v61, v109
    v_dot2c_f32_bf16 v156, v213, v110
    v_dot2c_f32_bf16 v157, v61, v110
    v_dot2c_f32_bf16 v158, v213, v111
    v_dot2c_f32_bf16 v159, v61, v111
    v_dot2c_f32_bf16 v160, v214, v104
    v_dot2c_f32_bf16 v161, v62, v104
    v_dot2c_f32_bf16 v162, v214, v105
    v_dot2c_f32_bf16 v163, v62, v105
    v_dot2c_f32_bf16 v164, v214, v106
    v_dot2c_f32_bf16 v165, v62, v106
    v_dot2c_f32_bf16 v166, v214, v107
    v_dot2c_f32_bf16 v167, v62, v107
    v_dot2c_f32_bf16 v168, v214, v108
    v_dot2c_f32_bf16 v169, v62, v108
    v_dot2c_f32_bf16 v170, v214, v109
    v_dot2c_f32_bf16 v171, v62, v109
    v_dot2c_f32_bf16 v172, v214, v110
    v_dot2c_f32_bf16 v173, v62, v110
    v_dot2c_f32_bf16 v174, v214, v111
    v_dot2c_f32_bf16 v175, v62, v111
    v_dot2c_f32_bf16 v176, v215, v104
    v_dot2c_f32_bf16 v177, v63, v104
    v_dot2c_f32_bf16 v178, v215, v105
    v_dot2c_f32_bf16 v179, v63, v105
    v_dot2c_f32_bf16 v180, v215, v106
    v_dot2c_f32_bf16 v181, v63, v106
    v_dot2c_f32_bf16 v182, v215, v107
    v_dot2c_f32_bf16 v183, v63, v107
    v_dot2c_f32_bf16 v184, v215, v108
    v_dot2c_f32_bf16 v185, v63, v108
    v_dot2c_f32_bf16 v186, v215, v109
    v_dot2c_f32_bf16 v187, v63, v109
    v_dot2c_f32_bf16 v188, v215, v110
    v_dot2c_f32_bf16 v189, v63, v110
    v_dot2c_f32_bf16 v190, v215, v111
    v_dot2c_f32_bf16 v191, v63, v111
    s_waitcnt vmcnt(4)
    v_lshlrev_b32 v60, 16, v216
    v_lshlrev_b32 v61, 16, v217
    v_lshlrev_b32 v62, 16, v218
    v_lshlrev_b32 v63, 16, v219
    v_dot2c_f32_bf16 v128, v216, v112
    v_dot2c_f32_bf16 v129, v60, v112
    v_dot2c_f32_bf16 v130, v216, v113
    v_dot2c_f32_bf16 v131, v60, v113
    v_dot2c_f32_bf16 v132, v216, v114
    v_dot2c_f32_bf16 v133, v60, v114
    v_dot2c_f32_bf16 v134, v216, v115
    v_dot2c_f32_bf16 v135, v60, v115
    v_dot2c_f32_bf16 v136, v216, v116
    v_dot2c_f32_bf16 v137, v60, v116
    v_dot2c_f32_bf16 v138, v216, v117
    v_dot2c_f32_bf16 v139, v60, v117
    v_dot2c_f32_bf16 v140, v216, v118
    v_dot2c_f32_bf16 v141, v60, v118
    v_dot2c_f32_bf16 v142, v216, v119
    v_dot2c_f32_bf16 v143, v60, v119
    v_dot2c_f32_bf16 v144, v217, v112
    v_dot2c_f32_bf16 v145, v61, v112
    v_dot2c_f32_bf16 v146, v217, v113
    v_dot2c_f32_bf16 v147, v61, v113
    v_dot2c_f32_bf16 v148, v217, v114
    v_dot2c_f32_bf16 v149, v61, v114
    v_dot2c_f32_bf16 v150, v217, v115
    v_dot2c_f32_bf16 v151, v61, v115
    v_dot2c_f32_bf16 v152, v217, v116
    v_dot2c_f32_bf16 v153, v61, v116
    v_dot2c_f32_bf16 v154, v217, v117
    v_dot2c_f32_bf16 v155, v61, v117
    v_dot2c_f32_bf16 v156, v217, v118
    v_dot2c_f32_bf16 v157, v61, v118
    v_dot2c_f32_bf16 v158, v217, v119
    v_dot2c_f32_bf16 v159, v61, v119
    v_dot2c_f32_bf16 v160, v218, v112
    v_dot2c_f32_bf16 v161, v62, v112
    v_dot2c_f32_bf16 v162, v218, v113
    v_dot2c_f32_bf16 v163, v62, v113
    v_dot2c_f32_bf16 v164, v218, v114
    v_dot2c_f32_bf16 v165, v62, v114
    v_dot2c_f32_bf16 v166, v218, v115
    v_dot2c_f32_bf16 v167, v62, v115
    v_dot2c_f32_bf16 v168, v218, v116
    v_dot2c_f32_bf16 v169, v62, v116
    v_dot2c_f32_bf16 v170, v218, v117
    v_dot2c_f32_bf16 v171, v62, v117
    v_dot2c_f32_bf16 v172, v218, v118
    v_dot2c_f32_bf16 v173, v62, v118
    v_dot2c_f32_bf16 v174, v218, v119
    v_dot2c_f32_bf16 v175, v62, v119
    v_dot2c_f32_bf16 v176, v219, v112
    v_dot2c_f32_bf16 v177, v63, v112
    v_dot2c_f32_bf16 v178, v219, v113
    v_dot2c_f32_bf16 v179, v63, v113
    v_dot2c_f32_bf16 v180, v219, v114
    v_dot2c_f32_bf16 v181, v63, v114
    v_dot2c_f32_bf16 v182, v219, v115
    v_dot2c_f32_bf16 v183, v63, v115
    v_dot2c_f32_bf16 v184, v219, v116
    v_dot2c_f32_bf16 v185, v63, v116
    v_dot2c_f32_bf16 v186, v219, v117
    v_dot2c_f32_bf16 v187, v63, v117
    v_dot2c_f32_bf16 v188, v219, v118
    v_dot2c_f32_bf16 v189, v63, v118
    v_dot2c_f32_bf16 v190, v219, v119
    v_dot2c_f32_bf16 v191, v63, v119
    s_waitcnt vmcnt(2)
    v_lshlrev_b32 v60, 16, v220
    v_lshlrev_b32 v61, 16, v221
    v_lshlrev_b32 v62, 16, v222
    v_lshlrev_b32 v63, 16, v223
    v_dot2c_f32_bf16 v128, v220, v120
    v_dot2c_f32_bf16 v129, v60, v120
    v_dot2c_f32_bf16 v130, v220, v121
    v_dot2c_f32_bf16 v131, v60, v121
    v_dot2c_f32_bf16 v132, v220, v122
    v_dot2c_f32_bf16 v133, v60, v122
    v_dot2c_f32_bf16 v134, v220, v123
    v_dot2c_f32_bf16 v135, v60, v123
    v_dot2c_f32_bf16 v136, v220, v124
    v_dot2c_f32_bf16 v137, v60, v124
    v_dot2c_f32_bf16 v138, v220, v125
    v_dot2c_f32_bf16 v139, v60, v125
    v_dot2c_f32_bf16 v140, v220, v126
    v_dot2c_f32_bf16 v141, v60, v126
    v_dot2c_f32_bf16 v142, v220, v127
    v_dot2c_f32_bf16 v143, v60, v127
    v_dot2c_f32_bf16 v144, v221, v120
    v_dot2c_f32_bf16 v145, v61, v120
    v_dot2c_f32_bf16 v146, v221, v121
    v_dot2c_f32_bf16 v147, v61, v121
    v_dot2c_f32_bf16 v148, v221, v122
    v_dot2c_f32_bf16 v149, v61, v122
    v_dot2c_f32_bf16 v150, v221, v123
    v_dot2c_f32_bf16 v151, v61, v123
    v_dot2c_f32_bf16 v152, v221, v124
    v_dot2c_f32_bf16 v153, v61, v124
    v_dot2c_f32_bf16 v154, v221, v125
    v_dot2c_f32_bf16 v155, v61, v125
    v_dot2c_f32_bf16 v156, v221, v126
    v_dot2c_f32_bf16 v157, v61, v126
    v_dot2c_f32_bf16 v158, v221, v127
    v_dot2c_f32_bf16 v159, v61, v127
    v_dot2c_f32_bf16 v160, v222, v120
    v_dot2c_f32_bf16 v161, v62, v120
    v_dot2c_f32_bf16 v162, v222, v121
    v_dot2c_f32_bf16 v163, v62, v121
    v_dot2c_f32_bf16 v164, v222, v122
    v_dot2c_f32_bf16 v165, v62, v122
    v_dot2c_f32_bf16 v166, v222, v123
    v_dot2c_f32_bf16 v167, v62, v123
    v_dot2c_f32_bf16 v168, v222, v124
    v_dot2c_f32_bf16 v169, v62, v124
    v_dot2c_f32_bf16 v170, v222, v125
    v_dot2c_f32_bf16 v171, v62, v125
    v_dot2c_f32_bf16 v172, v222, v126
    v_dot2c_f32_bf16 v173, v62, v126
    v_dot2c_f32_bf16 v174, v222, v127
    v_dot2c_f32_bf16 v175, v62, v127
    v_dot2c_f32_bf16 v176, v223, v120
    v_dot2c_f32_bf16 v177, v63, v120
    v_dot2c_f32_bf16 v178, v223, v121
    v_dot2c_f32_bf16 v179, v63, v121
    v_dot2c_f32_bf16 v180, v223, v122
    v_dot2c_f32_bf16 v181, v63, v122
    v_dot2c_f32_bf16 v182, v223, v123
    v_dot2c_f32_bf16 v183, v63, v123
    v_dot2c_f32_bf16 v184, v223, v124
    v_dot2c_f32_bf16 v185, v63, v124
    v_dot2c_f32_bf16 v186, v223, v125
    v_dot2c_f32_bf16 v187, v63, v125
    v_dot2c_f32_bf16 v188, v223, v126
    v_dot2c_f32_bf16 v189, v63, v126
    v_dot2c_f32_bf16 v190, v223, v127
    v_dot2c_f32_bf16 v191, v63, v127
    v_permlane32_swap_b32 v128, v136
    v_permlane32_swap_b32 v129, v137
    v_permlane32_swap_b32 v130, v138
    v_permlane32_swap_b32 v131, v139
    v_permlane32_swap_b32 v132, v140
    v_permlane32_swap_b32 v133, v141
    v_permlane32_swap_b32 v134, v142
    v_permlane32_swap_b32 v135, v143
    v_add_f32 v128, v128, v136
    v_add_f32 v129, v129, v137
    v_add_f32 v130, v130, v138
    v_add_f32 v131, v131, v139
    v_add_f32 v132, v132, v140
    v_add_f32 v133, v133, v141
    v_add_f32 v134, v134, v142
    v_add_f32 v135, v135, v143
    v_permlane32_swap_b32 v144, v152
    v_permlane32_swap_b32 v145, v153
    v_permlane32_swap_b32 v146, v154
    v_permlane32_swap_b32 v147, v155
    v_permlane32_swap_b32 v148, v156
    v_permlane32_swap_b32 v149, v157
    v_permlane32_swap_b32 v150, v158
    v_permlane32_swap_b32 v151, v159
    v_add_f32 v144, v144, v152
    v_add_f32 v145, v145, v153
    v_add_f32 v146, v146, v154
    v_add_f32 v147, v147, v155
    v_add_f32 v148, v148, v156
    v_add_f32 v149, v149, v157
    v_add_f32 v150, v150, v158
    v_add_f32 v151, v151, v159
    v_permlane32_swap_b32 v160, v168
    v_permlane32_swap_b32 v161, v169
    v_permlane32_swap_b32 v162, v170
    v_permlane32_swap_b32 v163, v171
    v_permlane32_swap_b32 v164, v172
    v_permlane32_swap_b32 v165, v173
    v_permlane32_swap_b32 v166, v174
    v_permlane32_swap_b32 v167, v175
    v_add_f32 v160, v160, v168
    v_add_f32 v161, v161, v169
    v_add_f32 v162, v162, v170
    v_add_f32 v163, v163, v171
    v_add_f32 v164, v164, v172
    v_add_f32 v165, v165, v173
    v_add_f32 v166, v166, v174
    v_add_f32 v167, v167, v175
    v_permlane32_swap_b32 v176, v184
    v_permlane32_swap_b32 v177, v185
    v_permlane32_swap_b32 v178, v186
    v_permlane32_swap_b32 v179, v187
    v_permlane32_swap_b32 v180, v188
    v_permlane32_swap_b32 v181, v189
    v_permlane32_swap_b32 v182, v190
    v_permlane32_swap_b32 v183, v191
    v_add_f32 v176, v176, v184
    v_add_f32 v177, v177, v185
    v_add_f32 v178, v178, v186
    v_add_f32 v179, v179, v187
    v_add_f32 v180, v180, v188
    v_add_f32 v181, v181, v189
    v_add_f32 v182, v182, v190
    v_add_f32 v183, v183, v191
    v_permlane16_swap_b32 v128, v160
    v_permlane16_swap_b32 v129, v161
    v_permlane16_swap_b32 v130, v162
    v_permlane16_swap_b32 v131, v163
    v_permlane16_swap_b32 v132, v164
    v_permlane16_swap_b32 v133, v165
    v_permlane16_swap_b32 v134, v166
    v_permlane16_swap_b32 v135, v167
    v_add_f32 v128, v128, v160
    v_add_f32 v129, v129, v161
    v_add_f32 v130, v130, v162
    v_add_f32 v131, v131, v163
    v_add_f32 v132, v132, v164
    v_add_f32 v133, v133, v165
    v_add_f32 v134, v134, v166
    v_add_f32 v135, v135, v167
    v_permlane16_swap_b32 v144, v176
    v_permlane16_swap_b32 v145, v177
    v_permlane16_swap_b32 v146, v178
    v_permlane16_swap_b32 v147, v179
    v_permlane16_swap_b32 v148, v180
    v_permlane16_swap_b32 v149, v181
    v_permlane16_swap_b32 v150, v182
    v_permlane16_swap_b32 v151, v183
    v_add_f32 v144, v144, v176
    v_add_f32 v145, v145, v177
    v_add_f32 v146, v146, v178
    v_add_f32 v147, v147, v179
    v_add_f32 v148, v148, v180
    v_add_f32 v149, v149, v181
    v_add_f32 v150, v150, v182
    v_add_f32 v151, v151, v183
    v_add_f32_dpp v128, v128, v128 row_ror:8 row_mask:0xf bank_mask:0x3
    s_nop 1
    v_add_f32_dpp v128, v144, v144 row_ror:8 row_mask:0xf bank_mask:0xc
    v_add_f32_dpp v129, v129, v129 row_ror:8 row_mask:0xf bank_mask:0x3
    s_nop 1
    v_add_f32_dpp v129, v145, v145 row_ror:8 row_mask:0xf bank_mask:0xc
    v_add_f32_dpp v130, v130, v130 row_ror:8 row_mask:0xf bank_mask:0x3
    s_nop 1
    v_add_f32_dpp v130, v146, v146 row_ror:8 row_mask:0xf bank_mask:0xc
    v_add_f32_dpp v131, v131, v131 row_ror:8 row_mask:0xf bank_mask:0x3
    s_nop 1
    v_add_f32_dpp v131, v147, v147 row_ror:8 row_mask:0xf bank_mask:0xc
    v_add_f32_dpp v132, v132, v132 row_ror:8 row_mask:0xf bank_mask:0x3
    s_nop 1
    v_add_f32_dpp v132, v148, v148 row_ror:8 row_mask:0xf bank_mask:0xc
    v_add_f32_dpp v133, v133, v133 row_ror:8 row_mask:0xf bank_mask:0x3
    s_nop 1
    v_add_f32_dpp v133, v149, v149 row_ror:8 row_mask:0xf bank_mask:0xc
    v_add_f32_dpp v134, v134, v134 row_ror:8 row_mask:0xf bank_mask:0x3
    s_nop 1
    v_add_f32_dpp v134, v150, v150 row_ror:8 row_mask:0xf bank_mask:0xc
    v_add_f32_dpp v135, v135, v135 row_ror:8 row_mask:0xf bank_mask:0x3
    s_nop 1
    v_add_f32_dpp v135, v151, v151 row_ror:8 row_mask:0xf bank_mask:0xc
    s_waitcnt vmcnt(0)
    v_mov_b32 v26, 0
    v_mov_b32 v31, 0x3f803f80
    v_and_b32 v27, 0xffff, v40
    v_and_b32 v28, 0xffff0000, v40
    v_dot2_f32_bf16 v29, v27, v44, 0
    v_dot2_f32_bf16 v30, v28, v44, 0
    s_nop 2
    v_cvt_pk_bf16_f32 v29, v29, v30
    v_dot2_f32_bf16 v26, v29, v31, v26
    v_and_b32 v27, 0xffff, v41
    v_and_b32 v28, 0xffff0000, v41
    v_dot2_f32_bf16 v29, v27, v45, 0
    v_dot2_f32_bf16 v30, v28, v45, 0
    s_nop 2
    v_cvt_pk_bf16_f32 v29, v29, v30
    v_dot2_f32_bf16 v26, v29, v31, v26
    v_and_b32 v27, 0xffff, v42
    v_and_b32 v28, 0xffff0000, v42
    v_dot2_f32_bf16 v29, v27, v46, 0
    v_dot2_f32_bf16 v30, v28, v46, 0
    s_nop 2
    v_cvt_pk_bf16_f32 v29, v29, v30
    v_dot2_f32_bf16 v26, v29, v31, v26
    v_and_b32 v27, 0xffff, v43
    v_and_b32 v28, 0xffff0000, v43
    v_dot2_f32_bf16 v29, v27, v47, 0
    v_dot2_f32_bf16 v30, v28, v47, 0
    s_nop 2
    v_cvt_pk_bf16_f32 v29, v29, v30
    v_dot2_f32_bf16 v26, v29, v31, v26
    s_nop 2
    v_add_f32_dpp v26, v26, v26 quad_perm:[1,0,3,2] row_mask:0xf bank_mask:0xf
    s_nop 1
    v_add_f32_dpp v26, v26, v26 quad_perm:[2,3,0,1] row_mask:0xf bank_mask:0xf
    s_nop 1
    v_add_f32_dpp v26, v26, v26 row_half_mirror row_mask:0xf bank_mask:0xf
    s_nop 1
    v_add_f32_dpp v26, v26, v26 row_mirror row_mask:0xf bank_mask:0xf
    v_mov_b32 v27, v26
    s_nop 1
    v_permlane16_swap_b32 v26, v27
    v_add_f32 v26, v26, v27
    v_mov_b32 v27, v26
    s_nop 1
    v_permlane32_swap_b32 v26, v27
    v_add_f32 v26, v26, v27
    v_cvt_pk_bf16_f32 v26, 0, v26
    v_mul_f32 v26, 0xbfb8aa3b, v26
    v_exp_f32 v26, v26
    s_nop 0
    v_add_f32 v26, 1.0, v26
    v_rcp_f32 v26, v26
    s_nop 0
    v_cvt_pk_bf16_f32 v56, 0, v26
    v_sub_f32 v26, 1.0, v56
    v_cvt_pk_bf16_f32 v57, 0, v26
    v_mov_b32 v23, 0
    s_mov_b32 s88, 0x40000
    s_mov_b64 exec, 1
L_cnt:
    global_load_dword v22, v23, s[26:27] sc1
    s_waitcnt vmcnt(0)
    v_readfirstlane_b32 s80, v22
    s_nop 1
    s_cmp_eq_u32 s80, 32
    s_cbranch_scc1 L_cntok
    s_sub_u32 s88, s88, 1
    s_cbranch_scc1 L_cntok
    s_sleep 16
    s_branch L_cnt
L_cntok:
    s_mov_b64 exec, -1
    s_cmp_lt_u32 s2, 32
    s_cbranch_scc1 L_nofp
    v_bfe_u32 v26, v0, 3, 2
    v_bfe_u32 v27, v0, 4, 1
    v_bfe_u32 v28, v0, 3, 1
    v_lshl_add_u32 v27, v27, 1, v28
    v_lshlrev_b32 v26, 9, v27
    v_lshrrev_b32 v27, 5, v0
    v_lshl_add_u32 v26, v27, 8, v26
    v_and_b32 v27, 7, v0
    v_lshl_add_u32 v26, v27, 5, v26
    s_lshl_b32 s80, s69, 11
    s_add_u32 s80, s80, 0x90000
    v_add_u32 v26, s80, v26
    global_store_dwordx4 v26, v[128:131], s[28:29] sc1
    global_store_dwordx4 v26, v[132:135], s[28:29] offset:16 sc1
L_nofp:
    s_nop 1
    s_mov_b32 s74, 0
    buffer_load_dwordx4 v[64:67], v59, s[56:59], s74 offen
    s_add_u32 s74, s74, 0x400
    buffer_load_dwordx4 v[68:71], v59, s[56:59], s74 offen
    s_add_u32 s74, s74, 0x400
    buffer_load_dwordx4 v[72:75], v59, s[56:59], s74 offen
    s_add_u32 s74, s74, 0x400
    buffer_load_dwordx4 v[76:79], v59, s[56:59], s74 offen
    s_add_u32 s74, s74, 0x400
    s_add_u32 s40, s28, 0x90000
    s_addc_u32 s41, s29, 0
    s_and_b32 s41, s41, 0xffff
    s_mov_b32 s42, 458752
    s_mov_b32 s43, 0x20000
    v_and_b32 v26, 31, v0
    v_min_u32 v26, 27, v26
    s_mul_i32 s80, s67, 28
    v_add_u32 v26, s80, v26
    v_lshrrev_b32 v27, 6, v26
    v_and_b32 v26, 63, v26
    v_lshlrev_b32 v26, 2, v26
    v_lshl_add_u32 v26, v27, 11, v26
    v_lshrrev_b32 v27, 5, v0
    v_lshl_add_u32 v26, v27, 8, v26
    s_lshl_b32 s80, s64, 9
    v_add_u32 v26, s80, v26
    s_mov_b32 s88, 0x40000
L_gp:
    s_mov_b32 s80, 0
    buffer_load_dword v2, v26, s[40:43], s80 offen sc1
    s_mov_b32 s80, 57344
    buffer_load_dword v3, v26, s[40:43], s80 offen sc1
    s_mov_b32 s80, 114688
    buffer_load_dword v4, v26, s[40:43], s80 offen sc1
    s_mov_b32 s80, 172032
    buffer_load_dword v5, v26, s[40:43], s80 offen sc1
    s_mov_b32 s80, 229376
    buffer_load_dword v6, v26, s[40:43], s80 offen sc1
    s_mov_b32 s80, 286720
    buffer_load_dword v7, v26, s[40:43], s80 offen sc1
    s_mov_b32 s80, 344064
    buffer_load_dword v8, v26, s[40:43], s80 offen sc1
    s_mov_b32 s80, 401408
    buffer_load_dword v9, v26, s[40:43], s80 offen sc1
    s_waitcnt vmcnt(0)
    v_max3_u32 v28, v2, v3, v4
    v_max3_u32 v29, v5, v6, v7
    v_max3_u32 v28, v28, v8, v9
    v_max_u32 v28, v28, v29
    v_cmp_eq_u32 vcc, -1, v28
    s_nop 1
    s_cbranch_vccz L_gpok
    s_sub_u32 s88, s88, 1
    s_cbranch_scc1 L_gpok
    s_sleep 16
    s_branch L_gp
L_gpok:
    s_nop 1
    v_add_f32 v2, v2, v3
    v_add_f32 v4, v4, v5
    v_add_f32 v6, v6, v7
    v_add_f32 v8, v8, v9
    v_add_f32 v2, v2, v4
    v_add_f32 v6, v6, v8
    v_add_f32 v2, v2, v6
    v_mov_b32 v3, v2
    s_nop 1
    v_permlane32_swap_b32 v2, v3
    v_cvt_pk_bf16_f32 v2, 0, v2
    v_cvt_pk_bf16_f32 v3, 0, v3
    v_mul_f32 v4, v2, v2
    v_mul_f32 v4, 0xbdd2d3e8, v4
    v_add_f32 v4, 0xc0135761, v4
    v_mul_f32 v4, v4, v2
    v_exp_f32 v4, v4
    s_nop 0
    v_add_f32 v4, 1.0, v4
    v_rcp_f32 v4, v4
    s_nop 0
    v_mul_f32 v4, v4, v2
    v_cvt_pk_bf16_f32 v4, 0, v4
    v_mul_f32 v4, v4, v3
    v_cvt_pk_bf16_f32 v5, v4, 0
    v_mov_b32 v48, 0
    v_mov_b32 v49, 0
    v_mov_b32 v50, 0
    v_mov_b32 v51, 0
    v_mov_b32 v52, 0
    v_mov_b32 v53, 0
    v_mov_b32 v54, 0
    v_mov_b32 v55, 0
    v_readlane_b32 s80, v5, 0
    s_nop 0
    s_lshl_b32 s81, s80, 16
    v_dot2c_f32_bf16 v48, s80, v64
    v_dot2c_f32_bf16 v49, s81, v64
    v_dot2c_f32_bf16 v50, s80, v65
    v_dot2c_f32_bf16 v51, s81, v65
    v_dot2c_f32_bf16 v52, s80, v66
    v_dot2c_f32_bf16 v53, s81, v66
    v_dot2c_f32_bf16 v54, s80, v67
    v_dot2c_f32_bf16 v55, s81, v67
    buffer_load_dwordx4 v[80:83], v59, s[56:59], s74 offen
    s_add_u32 s74, s74, 0x400
    v_readlane_b32 s82, v5, 1
    s_nop 0
    s_lshl_b32 s83, s82, 16
    v_dot2c_f32_bf16 v48, s82, v68
    v_dot2c_f32_bf16 v49, s83, v68
    v_dot2c_f32_bf16 v50, s82, v69
    v_dot2c_f32_bf16 v51, s83, v69
    v_dot2c_f32_bf16 v52, s82, v70
    v_dot2c_f32_bf16 v53, s83, v70
    v_dot2c_f32_bf16 v54, s82, v71
    v_dot2c_f32_bf16 v55, s83, v71
    buffer_load_dwordx4 v[84:87], v59, s[56:59], s74 offen
    s_add_u32 s74, s74, 0x400
    v_readlane_b32 s80, v5, 2
    s_nop 0
    s_lshl_b32 s81, s80, 16
    v_dot2c_f32_bf16 v48, s80, v72
    v_dot2c_f32_bf16 v49, s81, v72
    v_dot2c_f32_bf16 v50, s80, v73
    v_dot2c_f32_bf16 v51, s81, v73
    v_dot2c_f32_bf16 v52, s80, v74
    v_dot2c_f32_bf16 v53, s81, v74
    v_dot2c_f32_bf16 v54, s80, v75
    v_dot2c_f32_bf16 v55, s81, v75
    buffer_load_dwordx4 v[88:91], v59, s[56:59], s74 offen
    s_add_u32 s74, s74, 0x400
    v_readlane_b32 s82, v5, 3
    s_nop 0
    s_lshl_b32 s83, s82, 16
    v_dot2c_f32_bf16 v48, s82, v76
    v_dot2c_f32_bf16 v49, s83, v76
    v_dot2c_f32_bf16 v50, s82, v77
    v_dot2c_f32_bf16 v51, s83, v77
    v_dot2c_f32_bf16 v52, s82, v78
    v_dot2c_f32_bf16 v53, s83, v78
    v_dot2c_f32_bf16 v54, s82, v79
    v_dot2c_f32_bf16 v55, s83, v79
    buffer_load_dwordx4 v[92:95], v59, s[56:59], s74 offen
    s_add_u32 s74, s74, 0x400
    v_readlane_b32 s80, v5, 4
    s_waitcnt vmcnt(3)
    s_lshl_b32 s81, s80, 16
    v_dot2c_f32_bf16 v48, s80, v80
    v_dot2c_f32_bf16 v49, s81, v80
    v_dot2c_f32_bf16 v50, s80, v81
    v_dot2c_f32_bf16 v51, s81, v81
    v_dot2c_f32_bf16 v52, s80, v82
    v_dot2c_f32_bf16 v53, s81, v82
    v_dot2c_f32_bf16 v54, s80, v83
    v_dot2c_f32_bf16 v55, s81, v83
    buffer_load_dwordx4 v[96:99], v59, s[56:59], s74 offen
    s_add_u32 s74, s74, 0x400
    v_readlane_b32 s82, v5, 5
    s_waitcnt vmcnt(3)
    s_lshl_b32 s83, s82, 16
    v_dot2c_f32_bf16 v48, s82, v84
    v_dot2c_f32_bf16 v49, s83, v84
    v_dot2c_f32_bf16 v50, s82, v85
    v_dot2c_f32_bf16 v51, s83, v85
    v_dot2c_f32_bf16 v52, s82, v86
    v_dot2c_f32_bf16 v53, s83, v86
    v_dot2c_f32_bf16 v54, s82, v87
    v_dot2c_f32_bf16 v55, s83, v87
    buffer_load_dwordx4 v[100:103], v59, s[56:59], s74 offen
    s_add_u32 s74, s74, 0x400
    v_readlane_b32 s80, v5, 6
    s_waitcnt vmcnt(3)
    s_lshl_b32 s81, s80, 16
    v_dot2c_f32_bf16 v48, s80, v88
    v_dot2c_f32_bf16 v49, s81, v88
    v_dot2c_f32_bf16 v50, s80, v89
    v_dot2c_f32_bf16 v51, s81, v89
    v_dot2c_f32_bf16 v52, s80, v90
    v_dot2c_f32_bf16 v53, s81, v90
    v_dot2c_f32_bf16 v54, s80, v91
    v_dot2c_f32_bf16 v55, s81, v91
    buffer_load_dwordx4 v[104:107], v59, s[56:59], s74 offen
    s_add_u32 s74, s74, 0x400
    v_readlane_b32 s82, v5, 7
    s_waitcnt vmcnt(3)
    s_lshl_b32 s83, s82, 16
    v_dot2c_f32_bf16 v48, s82, v92
    v_dot2c_f32_bf16 v49, s83, v92
    v_dot2c_f32_bf16 v50, s82, v93
    v_dot2c_f32_bf16 v51, s83, v93
    v_dot2c_f32_bf16 v52, s82, v94
    v_dot2c_f32_bf16 v53, s83, v94
    v_dot2c_f32_bf16 v54, s82, v95
    v_dot2c_f32_bf16 v55, s83, v95
    buffer_load_dwordx4 v[108:111], v59, s[56:59], s74 offen
    s_add_u32 s74, s74, 0x400
    v_readlane_b32 s80, v5, 8
    s_waitcnt vmcnt(3)
    s_lshl_b32 s81, s80, 16
    v_dot2c_f32_bf16 v48, s80, v96
    v_dot2c_f32_bf16 v49, s81, v96
    v_dot2c_f32_bf16 v50, s80, v97
    v_dot2c_f32_bf16 v51, s81, v97
    v_dot2c_f32_bf16 v52, s80, v98
    v_dot2c_f32_bf16 v53, s81, v98
    v_dot2c_f32_bf16 v54, s80, v99
    v_dot2c_f32_bf16 v55, s81, v99
    buffer_load_dwordx4 v[112:115], v59, s[56:59], s74 offen
    s_add_u32 s74, s74, 0x400
    v_readlane_b32 s82, v5, 9
    s_waitcnt vmcnt(3)
    s_lshl_b32 s83, s82, 16
    v_dot2c_f32_bf16 v48, s82, v100
    v_dot2c_f32_bf16 v49, s83, v100
    v_dot2c_f32_bf16 v50, s82, v101
    v_dot2c_f32_bf16 v51, s83, v101
    v_dot2c_f32_bf16 v52, s82, v102
    v_dot2c_f32_bf16 v53, s83, v102
    v_dot2c_f32_bf16 v54, s82, v103
    v_dot2c_f32_bf16 v55, s83, v103
    buffer_load_dwordx4 v[116:119], v59, s[56:59], s74 offen
    s_add_u32 s74, s74, 0x400
    v_readlane_b32 s80, v5, 10
    s_waitcnt vmcnt(3)
    s_lshl_b32 s81, s80, 16
    v_dot2c_f32_bf16 v48, s80, v104
    v_dot2c_f32_bf16 v49, s81, v104
    v_dot2c_f32_bf16 v50, s80, v105
    v_dot2c_f32_bf16 v51, s81, v105
    v_dot2c_f32_bf16 v52, s80, v106
    v_dot2c_f32_bf16 v53, s81, v106
    v_dot2c_f32_bf16 v54, s80, v107
    v_dot2c_f32_bf16 v55, s81, v107
    buffer_load_dwordx4 v[120:123], v59, s[56:59], s74 offen
    s_add_u32 s74, s74, 0x400
    v_readlane_b32 s82, v5, 11
    s_waitcnt vmcnt(3)
    s_lshl_b32 s83, s82, 16
    v_dot2c_f32_bf16 v48, s82, v108
    v_dot2c_f32_bf16 v49, s83, v108
    v_dot2c_f32_bf16 v50, s82, v109
    v_dot2c_f32_bf16 v51, s83, v109
    v_dot2c_f32_bf16 v52, s82, v110
    v_dot2c_f32_bf16 v53, s83, v110
    v_dot2c_f32_bf16 v54, s82, v111
    v_dot2c_f32_bf16 v55, s83, v111
    buffer_load_dwordx4 v[124:127], v59, s[56:59], s74 offen
    s_add_u32 s74, s74, 0x400
    v_readlane_b32 s80, v5, 12
    s_waitcnt vmcnt(3)
    s_lshl_b32 s81, s80, 16
    v_dot2c_f32_bf16 v48, s80, v112
    v_dot2c_f32_bf16 v49, s81, v112
    v_dot2c_f32_bf16 v50, s80, v113
    v_dot2c_f32_bf16 v51, s81, v113
    v_dot2c_f32_bf16 v52, s80, v114
    v_dot2c_f32_bf16 v53, s81, v114
    v_dot2c_f32_bf16 v54, s80, v115
    v_dot2c_f32_bf16 v55, s81, v115
    buffer_load_dwordx4 v[128:131], v59, s[56:59], s74 offen
    s_add_u32 s74, s74, 0x400
    v_readlane_b32 s82, v5, 13
    s_waitcnt vmcnt(3)
    s_lshl_b32 s83, s82, 16
    v_dot2c_f32_bf16 v48, s82, v116
    v_dot2c_f32_bf16 v49, s83, v116
    v_dot2c_f32_bf16 v50, s82, v117
    v_dot2c_f32_bf16 v51, s83, v117
    v_dot2c_f32_bf16 v52, s82, v118
    v_dot2c_f32_bf16 v53, s83, v118
    v_dot2c_f32_bf16 v54, s82, v119
    v_dot2c_f32_bf16 v55, s83, v119
    buffer_load_dwordx4 v[132:135], v59, s[56:59], s74 offen
    s_add_u32 s74, s74, 0x400
    v_readlane_b32 s80, v5, 14
    s_waitcnt vmcnt(3)
    s_lshl_b32 s81, s80, 16
    v_dot2c_f32_bf16 v48, s80, v120
    v_dot2c_f32_bf16 v49, s81, v120
    v_dot2c_f32_bf16 v50, s80, v121
    v_dot2c_f32_bf16 v51, s81, v121
    v_dot2c_f32_bf16 v52, s80, v122
    v_dot2c_f32_bf16 v53, s81, v122
    v_dot2c_f32_bf16 v54, s80, v123
    v_dot2c_f32_bf16 v55, s81, v123
    buffer_load_dwordx4 v[136:139], v59, s[56:59], s74 offen
    s_add_u32 s74, s74, 0x400
    v_readlane_b32 s82, v5, 15
    s_waitcnt vmcnt(3)
    s_lshl_b32 s83, s82, 16
    v_dot2c_f32_bf16 v48, s82, v124
    v_dot2c_f32_bf16 v49, s83, v124
    v_dot2c_f32_bf16 v50, s82, v125
    v_dot2c_f32_bf16 v51, s83, v125
    v_dot2c_f32_bf16 v52, s82, v126
    v_dot2c_f32_bf16 v53, s83, v126
    v_dot2c_f32_bf16 v54, s82, v127
    v_dot2c_f32_bf16 v55, s83, v127
    buffer_load_dwordx4 v[140:143], v59, s[56:59], s74 offen
    s_add_u32 s74, s74, 0x400
    v_readlane_b32 s80, v5, 16
    s_waitcnt vmcnt(3)
    s_lshl_b32 s81, s80, 16
    v_dot2c_f32_bf16 v48, s80, v128
    v_dot2c_f32_bf16 v49, s81, v128
    v_dot2c_f32_bf16 v50, s80, v129
    v_dot2c_f32_bf16 v51, s81, v129
    v_dot2c_f32_bf16 v52, s80, v130
    v_dot2c_f32_bf16 v53, s81, v130
    v_dot2c_f32_bf16 v54, s80, v131
    v_dot2c_f32_bf16 v55, s81, v131
    buffer_load_dwordx4 v[144:147], v59, s[56:59], s74 offen
    s_add_u32 s74, s74, 0x400
    v_readlane_b32 s82, v5, 17
    s_waitcnt vmcnt(3)
    s_lshl_b32 s83, s82, 16
    v_dot2c_f32_bf16 v48, s82, v132
    v_dot2c_f32_bf16 v49, s83, v132
    v_dot2c_f32_bf16 v50, s82, v133
    v_dot2c_f32_bf16 v51, s83, v133
    v_dot2c_f32_bf16 v52, s82, v134
    v_dot2c_f32_bf16 v53, s83, v134
    v_dot2c_f32_bf16 v54, s82, v135
    v_dot2c_f32_bf16 v55, s83, v135
    buffer_load_dwordx4 v[148:151], v59, s[56:59], s74 offen
    s_add_u32 s74, s74, 0x400
    v_readlane_b32 s80, v5, 18
    s_waitcnt vmcnt(3)
    s_lshl_b32 s81, s80, 16
    v_dot2c_f32_bf16 v48, s80, v136
    v_dot2c_f32_bf16 v49, s81, v136
    v_dot2c_f32_bf16 v50, s80, v137
    v_dot2c_f32_bf16 v51, s81, v137
    v_dot2c_f32_bf16 v52, s80, v138
    v_dot2c_f32_bf16 v53, s81, v138
    v_dot2c_f32_bf16 v54, s80, v139
    v_dot2c_f32_bf16 v55, s81, v139
    buffer_load_dwordx4 v[152:155], v59, s[56:59], s74 offen
    s_add_u32 s74, s74, 0x400
    v_readlane_b32 s82, v5, 19
    s_waitcnt vmcnt(3)
    s_lshl_b32 s83, s82, 16
    v_dot2c_f32_bf16 v48, s82, v140
    v_dot2c_f32_bf16 v49, s83, v140
    v_dot2c_f32_bf16 v50, s82, v141
    v_dot2c_f32_bf16 v51, s83, v141
    v_dot2c_f32_bf16 v52, s82, v142
    v_dot2c_f32_bf16 v53, s83, v142
    v_dot2c_f32_bf16 v54, s82, v143
    v_dot2c_f32_bf16 v55, s83, v143
    buffer_load_dwordx4 v[156:159], v59, s[56:59], s74 offen
    s_add_u32 s74, s74, 0x400
    v_readlane_b32 s80, v5, 20
    s_waitcnt vmcnt(3)
    s_lshl_b32 s81, s80, 16
    v_dot2c_f32_bf16 v48, s80, v144
    v_dot2c_f32_bf16 v49, s81, v144
    v_dot2c_f32_bf16 v50, s80, v145
    v_dot2c_f32_bf16 v51, s81, v145
    v_dot2c_f32_bf16 v52, s80, v146
    v_dot2c_f32_bf16 v53, s81, v146
    v_dot2c_f32_bf16 v54, s80, v147
    v_dot2c_f32_bf16 v55, s81, v147
    buffer_load_dwordx4 v[160:163], v59, s[56:59], s74 offen
    s_add_u32 s74, s74, 0x400
    v_readlane_b32 s82, v5, 21
    s_waitcnt vmcnt(3)
    s_lshl_b32 s83, s82, 16
    v_dot2c_f32_bf16 v48, s82, v148
    v_dot2c_f32_bf16 v49, s83, v148
    v_dot2c_f32_bf16 v50, s82, v149
    v_dot2c_f32_bf16 v51, s83, v149
    v_dot2c_f32_bf16 v52, s82, v150
    v_dot2c_f32_bf16 v53, s83, v150
    v_dot2c_f32_bf16 v54, s82, v151
    v_dot2c_f32_bf16 v55, s83, v151
    buffer_load_dwordx4 v[164:167], v59, s[56:59], s74 offen
    s_add_u32 s74, s74, 0x400
    v_readlane_b32 s80, v5, 22
    s_waitcnt vmcnt(3)
    s_lshl_b32 s81, s80, 16
    v_dot2c_f32_bf16 v48, s80, v152
    v_dot2c_f32_bf16 v49, s81, v152
    v_dot2c_f32_bf16 v50, s80, v153
    v_dot2c_f32_bf16 v51, s81, v153
    v_dot2c_f32_bf16 v52, s80, v154
    v_dot2c_f32_bf16 v53, s81, v154
    v_dot2c_f32_bf16 v54, s80, v155
    v_dot2c_f32_bf16 v55, s81, v155
    buffer_load_dwordx4 v[168:171], v59, s[56:59], s74 offen
    s_add_u32 s74, s74, 0x400
    v_readlane_b32 s82, v5, 23
    s_waitcnt vmcnt(3)
    s_lshl_b32 s83, s82, 16
    v_dot2c_f32_bf16 v48, s82, v156
    v_dot2c_f32_bf16 v49, s83, v156
    v_dot2c_f32_bf16 v50, s82, v157
    v_dot2c_f32_bf16 v51, s83, v157
    v_dot2c_f32_bf16 v52, s82, v158
    v_dot2c_f32_bf16 v53, s83, v158
    v_dot2c_f32_bf16 v54, s82, v159
    v_dot2c_f32_bf16 v55, s83, v159
    buffer_load_dwordx4 v[172:175], v59, s[56:59], s74 offen
    s_add_u32 s74, s74, 0x400
    v_readlane_b32 s80, v5, 24
    s_waitcnt vmcnt(3)
    s_lshl_b32 s81, s80, 16
    v_dot2c_f32_bf16 v48, s80, v160
    v_dot2c_f32_bf16 v49, s81, v160
    v_dot2c_f32_bf16 v50, s80, v161
    v_dot2c_f32_bf16 v51, s81, v161
    v_dot2c_f32_bf16 v52, s80, v162
    v_dot2c_f32_bf16 v53, s81, v162
    v_dot2c_f32_bf16 v54, s80, v163
    v_dot2c_f32_bf16 v55, s81, v163
    v_readlane_b32 s82, v5, 25
    s_waitcnt vmcnt(2)
    s_lshl_b32 s83, s82, 16
    v_dot2c_f32_bf16 v48, s82, v164
    v_dot2c_f32_bf16 v49, s83, v164
    v_dot2c_f32_bf16 v50, s82, v165
    v_dot2c_f32_bf16 v51, s83, v165
    v_dot2c_f32_bf16 v52, s82, v166
    v_dot2c_f32_bf16 v53, s83, v166
    v_dot2c_f32_bf16 v54, s82, v167
    v_dot2c_f32_bf16 v55, s83, v167
    v_readlane_b32 s80, v5, 26
    s_waitcnt vmcnt(1)
    s_lshl_b32 s81, s80, 16
    v_dot2c_f32_bf16 v48, s80, v168
    v_dot2c_f32_bf16 v49, s81, v168
    v_dot2c_f32_bf16 v50, s80, v169
    v_dot2c_f32_bf16 v51, s81, v169
    v_dot2c_f32_bf16 v52, s80, v170
    v_dot2c_f32_bf16 v53, s81, v170
    v_dot2c_f32_bf16 v54, s80, v171
    v_dot2c_f32_bf16 v55, s81, v171
    v_readlane_b32 s82, v5, 27
    s_waitcnt vmcnt(0)
    s_lshl_b32 s83, s82, 16
    v_dot2c_f32_bf16 v48, s82, v172
    v_dot2c_f32_bf16 v49, s83, v172
    v_dot2c_f32_bf16 v50, s82, v173
    v_dot2c_f32_bf16 v51, s83, v173
    v_dot2c_f32_bf16 v52, s82, v174
    v_dot2c_f32_bf16 v53, s83, v174
    v_dot2c_f32_bf16 v54, s82, v175
    v_dot2c_f32_bf16 v55, s83, v175
    v_mul_f32 v48, v57, v48
    v_mul_f32 v49, v57, v49
    v_mul_f32 v50, v57, v50
    v_mul_f32 v51, v57, v51
    v_mul_f32 v52, v57, v52
    v_mul_f32 v53, v57, v53
    v_mul_f32 v54, v57, v54
    v_mul_f32 v55, v57, v55
    v_lshlrev_b32 v18, 5, v0
    ds_write_b128 v18, v[48:51] offset:4096
    ds_write_b128 v18, v[52:55] offset:4112
    v_lshlrev_b32 v18, 3, v0
    s_lshl_b32 s80, s65, 5
    v_add_u32 v19, s80, v18
    s_mov_b64 exec, 0xf
    s_mov_b32 s88, 0x400000
L_lst:
    ds_read_b64 v[20:21], v18 offset:2048
    s_waitcnt lgkmcnt(0)
    v_cmp_eq_u32 vcc, -1, v21
    s_nop 1
    s_cbranch_vccz L_lstok
    s_sub_u32 s88, s88, 1
    s_cbranch_scc1 L_lstok
    s_sleep 4
    s_branch L_lst
L_lstok:
    s_nop 1
    global_store_dwordx2 v19, v[20:21], s[84:85] sc1
    s_mov_b64 exec, -1
    v_and_b32 v23, 7, v0
    v_lshlrev_b32 v23, 3, v23
    s_mov_b32 s88, 0x40000
L_st:
    global_load_dwordx2 v[24:25], v23, s[84:85] sc1
    s_waitcnt vmcnt(0)
    v_cmp_eq_u32 vcc, -1, v25
    s_nop 1
    s_cbranch_vccz L_stok
    s_sub_u32 s88, s88, 1
    s_cbranch_scc1 L_stok
    s_sleep 8
    s_branch L_st
L_stok:
    s_nop 1
    v_mov_b32 v26, v24
    s_nop 1
    v_max_f32_dpp v26, v26, v26 quad_perm:[1,0,3,2] row_mask:0xf bank_mask:0xf
    s_nop 1
    v_max_f32_dpp v26, v26, v26 quad_perm:[2,3,0,1] row_mask:0xf bank_mask:0xf
    s_nop 1
    v_max_f32_dpp v26, v26, v26 row_half_mirror row_mask:0xf bank_mask:0xf
    v_sub_f32 v26, v24, v26
    v_mul_f32 v26, 0x3fb8aa3b, v26
    v_exp_f32 v26, v26
    s_nop 0
    v_mul_f32 v27, v26, v25
    s_nop 1
    v_add_f32_dpp v27, v27, v27 quad_perm:[1,0,3,2] row_mask:0xf bank_mask:0xf
    s_nop 1
    v_add_f32_dpp v27, v27, v27 quad_perm:[2,3,0,1] row_mask:0xf bank_mask:0xf
    s_nop 1
    v_add_f32_dpp v27, v27, v27 row_half_mirror row_mask:0xf bank_mask:0xf
    v_rcp_f32 v27, v27
    v_mul_f32 v26, v26, v56
    v_mul_f32 v26, v26, v27
    v_and_b32 v28, 3, v0
    v_lshlrev_b32 v28, 2, v28
    s_lshl_b32 s80, s65, 2
    s_lshl_b32 s80, 0xf, s80
    s_mov_b32 exec_lo, s80
    s_mov_b32 exec_hi, 0
    ds_write_b32 v28, v26 offset:2112
    s_mov_b64 exec, -1
    s_lshl_b32 s80, s64, 17
    s_lshl_b32 s81, s67, 5
    s_add_u32 s80, s80, s81
    v_lshlrev_b32 v32, 11, v0
    v_add_u32 v32, s80, v32
    s_lshl_b32 s80, s64, 10
    s_lshl_b32 s81, s67, 4
    s_add_u32 s80, s80, s81
    v_lshrrev_b32 v33, 3, v0
    v_lshlrev_b32 v33, 1, v33
    v_add_u32 v33, s80, v33
    s_mov_b32 s88, 0x40000
    s_waitcnt lgkmcnt(0)
    s_barrier
L_poll:
    global_load_dwordx4 v[64:67], v32, s[28:29] sc1
    global_load_dwordx4 v[68:71], v32, s[28:29] offset:16 sc1
    s_waitcnt vmcnt(0)
    v_max3_u32 v30, v64, v65, v66
    v_max3_u32 v31, v67, v68, v69
    v_max3_u32 v30, v30, v70, v71
    v_max_u32 v30, v30, v31
    v_cmp_eq_u32 vcc, -1, v30
    s_nop 1
    s_cbranch_vccz L_pollok
    s_sub_u32 s88, s88, 1
    s_cbranch_scc1 L_pollok
    s_mov_b64 exec, vcc
    s_sleep 1
    s_branch L_poll
L_pollok:
    s_mov_b64 exec, -1
    s_nop 1
    v_permlane32_swap_b32 v64, v68
    v_permlane32_swap_b32 v65, v69
    v_permlane32_swap_b32 v66, v70
    v_permlane32_swap_b32 v67, v71
    v_add_f32 v64, v64, v68
    v_add_f32 v65, v65, v69
    v_add_f32 v66, v66, v70
    v_add_f32 v67, v67, v71
    s_nop 0
    v_permlane16_swap_b32 v64, v66
    v_permlane16_swap_b32 v65, v67
    v_add_f32 v64, v64, v66
    v_add_f32 v65, v65, v67
    s_nop 0
    v_add_f32_dpp v64, v64, v64 row_ror:8 row_mask:0xf bank_mask:0x3
    s_nop 1
    v_add_f32_dpp v64, v65, v65 row_ror:8 row_mask:0xf bank_mask:0xc
    s_nop 1
    v_add_f32_dpp v64, v64, v64 row_half_mirror row_mask:0xf bank_mask:0xf
    s_nop 1
    v_add_f32_dpp v64, v64, v64 quad_perm:[1,0,3,2] row_mask:0xf bank_mask:0xf
    s_nop 1
    v_add_f32_dpp v64, v64, v64 quad_perm:[2,3,0,1] row_mask:0xf bank_mask:0xf
    v_cvt_pk_bf16_f32 v64, v64, v64
    s_mov_b32 exec_lo, 0x01010101
    s_mov_b32 exec_hi, 0x01010101
    global_store_short v33, v64, s[24:25]
    s_mov_b64 exec, -1
L_fin:
L_end:
    s_endpgm
.section .rodata,"a"
.p2align 6
.amdhsa_kernel gated_mix__mha_block_cached__geglu_ffn__decode_kernel
  .amdhsa_next_free_vgpr 256
  .amdhsa_next_free_sgpr 102
  .amdhsa_accum_offset 256
  .amdhsa_group_segment_fixed_size 0
  .amdhsa_kernarg_size 104
  .amdhsa_user_sgpr_count 2
  .amdhsa_user_sgpr_kernarg_segment_ptr 1
  .amdhsa_system_sgpr_workgroup_id_x 1
  .amdhsa_float_denorm_mode_32 3
.end_amdhsa_kernel
```
